```python
import torch

def _softmax(x, axis=-1):
    return torch.softmax(x, dim=axis)

def _gelu(x):
    return torch.nn.functional.gelu(x, approximate='tanh')

def _silu(x):
    return torch.nn.functional.silu(x)

def _sigmoid(x):
    return torch.sigmoid(x)

def _layernorm(x, axis=-1, eps=1e-05):
    m = x.mean(dim=axis, keepdim=True)
    v = x.var(dim=axis, keepdim=True, unbiased=False)
    return (x - m) / torch.sqrt(v + eps)

def _scatter_add(tgt, idx, src, axis=0):
    return tgt.clone().index_add_(axis, idx, src)

def _segment_sum(src, seg, n):
    out = torch.zeros((n,) + src.shape[1:], dtype=src.dtype)
    return out.index_add_(0, seg, src)

def _pad(x, pw):
    flat = tuple((v for pair in reversed(pw) for v in pair))
    return torch.nn.functional.pad(x, flat)
kernel_name = 'recurrent_scan__memory_aug_recurrent_mem_tr__glu_gated_reglu__prompt'

def setup_inputs():

    _w = lambda a: (lambda t: t.to(torch.bfloat16) if t.is_floating_point() else t)(torch.as_tensor(a))

    def _A_setup():
        B, S, Dm = (1, 2048, 1024)
        H, Dh = (32, 128)
        M, seg = (8, 32)
        seg = min(seg, S)
        S = S // seg * seg
        return {'x': _w((lambda *s: torch.randn(*s, dtype=torch.bfloat16) * 0.1)(B, S, Dm)), 'mem0': _w((lambda *s: torch.randn(*s, dtype=torch.bfloat16) * 1.6)(B, M, Dm)), 'Wq': _w((lambda *s: torch.randn(*s, dtype=torch.bfloat16) * 0.8)(Dm, H, Dh) * Dm ** (-0.5)), 'Wk': _w((lambda *s: torch.randn(*s, dtype=torch.bfloat16) * 0.8)(Dm, H, Dh) * Dm ** (-0.5)), 'Wv': _w((lambda *s: torch.randn(*s, dtype=torch.bfloat16) * 1.6)(Dm, H, Dh) * Dm ** (-0.5)), 'Wo': _w((lambda *s: torch.randn(*s, dtype=torch.bfloat16) * 1.6)(H, Dh, Dm) * (H * Dh) ** (-0.5)), 'seg_len': seg}
    _A_in = _A_setup()

    def _B_setup():
        B, S, D, F = (1, 2048, 1024, 3584)
        return {'x': _w((lambda *s: torch.randn(*s, dtype=torch.bfloat16) * 0.1)(B, S, D)), 'W_gate': _w((lambda *s: torch.randn(*s, dtype=torch.bfloat16) * 0.4)(D, F) * (2.0 / D) ** 0.5), 'W_up': _w((lambda *s: torch.randn(*s, dtype=torch.bfloat16) * 0.4)(D, F) * (2.0 / D) ** 0.5), 'W_down': _w((lambda *s: torch.randn(*s, dtype=torch.bfloat16) * 0.4)(F, D) * (1.0 / F) ** 0.5)}
    _B_in = _B_setup()
    return {'A_x': _A_in['x'], 'A_mem0': _A_in['mem0'], 'A_Wq': _A_in['Wq'], 'A_Wk': _A_in['Wk'], 'A_Wv': _A_in['Wv'], 'A_Wo': _A_in['Wo'], 'A_seg_len': _A_in['seg_len'], 'B_x': _B_in['x'], 'B_W_gate': _B_in['W_gate'], 'B_W_up': _B_in['W_up'], 'B_W_down': _B_in['W_down']}

def reference(A_x, A_mem0, A_Wq, A_Wk, A_Wv, A_Wo, A_seg_len, B_x, B_W_gate, B_W_up, B_W_down):

    def _A_ref(x, mem0, Wq, Wk, Wv, Wo, seg_len):
        B, S, Dm = x.shape
        H, Dh = (Wq.shape[1], Wq.shape[2])
        M = mem0.shape[1]
        scale = Dh ** (-0.5)
        n_seg = S // seg_len
        L = M + seg_len
        idx = torch.arange(L)
        mask = (idx[:, None] < M) | (idx[:, None] >= idx[None, :])
        mem = mem0
        outs = []
        for s in range(n_seg):
            xs = x[:, s * seg_len:(s + 1) * seg_len, :].clone()
            h = torch.concatenate([mem, xs], axis=1)
            q = torch.einsum('btd,dhe->bhte', h, Wq)
            k = torch.einsum('btd,dhe->bhte', h, Wk)
            v = torch.einsum('btd,dhe->bhte', h, Wv)
            scores = torch.einsum('bhqe,bhke->bhqk', q, k) * scale
            scores = torch.where(mask[None, None], scores, -1000000000.0)
            p = _softmax(scores, axis=-1)
            o = torch.einsum('bhqk,bhke->bhqe', p, v)
            o = torch.einsum('bhte,hed->btd', o, Wo)
            mem = o[:, :M, :].clone()
            outs.append(o[:, M:, :])
        return torch.concatenate(outs, axis=1)

    def _B_ref(x, W_gate, W_up, W_down):
        gate = torch.einsum('bsd,df->bsf', x, W_gate)
        up = torch.einsum('bsd,df->bsf', x, W_up)
        gate = gate * (lambda x, dt: x.to(dt))(gate > 0, gate.dtype)
        h = gate * up
        return torch.einsum('bsf,fd->bsd', h, W_down)
    x = A_x
    xn = _layernorm(x, axis=-1)
    s = _A_ref(xn, A_mem0, A_Wq, A_Wk, A_Wv, A_Wo, A_seg_len)
    g = _silu(_B_ref(xn, B_W_gate, B_W_up, B_W_down))
    return x + s * g
```

```asm
; @launch grid=(256,1,1) block=(256,1,1) lds=131328
.amdgcn_target "amdgcn-amd-amdhsa--gfx950"
.text
.globl recurrent_scan__memory_aug_recurrent_mem_tr__glu_gated_reglu__prompt_kernel
.p2align 8
.type recurrent_scan__memory_aug_recurrent_mem_tr__glu_gated_reglu__prompt_kernel,@function
recurrent_scan__memory_aug_recurrent_mem_tr__glu_gated_reglu__prompt_kernel:

  s_cmp_ge_u32 s2, 256
  s_cbranch_scc1 L_end
  s_load_dwordx2 s[90:91], s[0:1], 96
  v_lshrrev_b32 v1, 6, v0
  v_and_b32 v0, 63, v0
  s_getreg_b32 s92, hwreg(HW_REG_XCC_ID)
  v_readfirstlane_b32 s27, v1
  s_and_b32 s92, s92, 7
  s_mov_b32 s28, s27
  s_mov_b32 s77, s27
  s_add_u32 s94, s92, 0
  s_and_b32 s94, s94, 7
  s_lshr_b32 s93, s2, 3
  s_mov_b32 s95, 0
  s_load_dwordx2 s[50:51], s[0:1], 104
  s_waitcnt lgkmcnt(0)
  s_mov_b32 s4, s50
  s_mov_b32 s5, s51
  s_mov_b32 s6, 0x10000000
  s_mov_b32 s7, 0x20000
  s_mov_b32 s97, 0
L_role:
  s_cmp_lt_u32 s94, 4
  s_cbranch_scc1 L_cstart
  s_and_b32 s44, s94, 3
  s_lshl_b32 s45, s93, 2
  s_add_u32 s45, s45, s44
  s_load_dwordx2 s[52:53], s[0:1], 0
  s_lshl_b32 s40, s45, 4
  s_lshl_b32 s41, s27, 2
  s_add_u32 s40, s40, s41
  s_lshl_b32 s42, s40, 6
  s_add_u32 s42, s42, 0
  s_lshl_b32 s40, s40, 11
  s_add_u32 s41, s40, 4096
  v_and_b32 v2, 31, v0
  v_lshrrev_b32 v3, 5, v0
  v_lshlrev_b32 v1, 4, v2
  v_lshl_add_u32 v1, v3, 11, v1
  s_waitcnt lgkmcnt(0)
  s_mov_b32 s8, s52
  s_mov_b32 s9, s53
  s_mov_b32 s10, 0x400000
  s_mov_b32 s11, 0x20000
  buffer_load_dwordx4 v[4:7], v1, s[8:11], s40 offen offset:0
  buffer_load_dwordx4 v[8:11], v1, s[8:11], s40 offen offset:512
  buffer_load_dwordx4 v[12:15], v1, s[8:11], s40 offen offset:1024
  buffer_load_dwordx4 v[16:19], v1, s[8:11], s40 offen offset:1536
  buffer_load_dwordx4 v[20:23], v1, s[8:11], s41 offen offset:0
  buffer_load_dwordx4 v[24:27], v1, s[8:11], s41 offen offset:512
  buffer_load_dwordx4 v[28:31], v1, s[8:11], s41 offen offset:1024
  buffer_load_dwordx4 v[32:35], v1, s[8:11], s41 offen offset:1536
  v_lshrrev_b32 v36, 2, v2
  v_lshlrev_b32 v36, 17, v36
  v_lshl_add_u32 v36, v3, 6, v36
  v_and_b32 v37, 3, v2
  v_lshl_add_u32 v36, v37, 4, v36
  s_mov_b32 s46, 0
  s_cmp_lg_u32 s77, 0
  s_cbranch_scc1 L_pl_1
  s_cmp_lg_u32 s97, 0
  s_cbranch_scc1 L_pl_1
  s_mov_b32 s46, 1
  s_lshl_b32 s47, s92, 3
  s_lshl_b64 s[48:49], 1, s47
  s_and_b32 s47, s2, 7
  s_lshl_b32 s47, s47, 3
  v_mov_b32 v84, s47
  v_mov_b32 v82, s48
  v_mov_b32 v83, s49
  s_mov_b64 exec, 1
  global_atomic_add_x2 v84, v[82:83], s[90:91] offset:0 sc1
  s_mov_b64 exec, -1
L_pl_1:
  s_cmp_lg_u32 s46, 0
  s_cbranch_scc1 L_lnw_2_1
  s_waitcnt vmcnt(4)
L_lnw_2_1:
  s_waitcnt vmcnt(5)
  v_lshlrev_b32 v40, 16, v4
  v_and_b32 v41, 0xffff0000, v4
  v_lshlrev_b32 v42, 16, v5
  v_and_b32 v43, 0xffff0000, v5
  v_lshlrev_b32 v44, 16, v6
  v_and_b32 v45, 0xffff0000, v6
  v_lshlrev_b32 v46, 16, v7
  v_and_b32 v47, 0xffff0000, v7
  v_lshlrev_b32 v48, 16, v8
  v_and_b32 v49, 0xffff0000, v8
  v_lshlrev_b32 v50, 16, v9
  v_and_b32 v51, 0xffff0000, v9
  v_lshlrev_b32 v52, 16, v10
  v_and_b32 v53, 0xffff0000, v10
  v_lshlrev_b32 v54, 16, v11
  v_and_b32 v55, 0xffff0000, v11
  v_lshlrev_b32 v56, 16, v12
  v_and_b32 v57, 0xffff0000, v12
  v_lshlrev_b32 v58, 16, v13
  v_and_b32 v59, 0xffff0000, v13
  v_lshlrev_b32 v60, 16, v14
  v_and_b32 v61, 0xffff0000, v14
  v_lshlrev_b32 v62, 16, v15
  v_and_b32 v63, 0xffff0000, v15
  v_lshlrev_b32 v64, 16, v16
  v_and_b32 v65, 0xffff0000, v16
  v_lshlrev_b32 v66, 16, v17
  v_and_b32 v67, 0xffff0000, v17
  v_lshlrev_b32 v68, 16, v18
  v_and_b32 v69, 0xffff0000, v18
  v_lshlrev_b32 v70, 16, v19
  v_and_b32 v71, 0xffff0000, v19
  v_pk_add_f32 v[72:73], v[40:41], v[42:43]
  v_pk_add_f32 v[74:75], v[44:45], v[46:47]
  v_pk_add_f32 v[72:73], v[72:73], v[48:49]
  v_pk_add_f32 v[74:75], v[74:75], v[50:51]
  v_pk_add_f32 v[72:73], v[72:73], v[52:53]
  v_pk_add_f32 v[74:75], v[74:75], v[54:55]
  v_pk_add_f32 v[72:73], v[72:73], v[56:57]
  v_pk_add_f32 v[74:75], v[74:75], v[58:59]
  v_pk_add_f32 v[72:73], v[72:73], v[60:61]
  v_pk_add_f32 v[74:75], v[74:75], v[62:63]
  v_pk_add_f32 v[72:73], v[72:73], v[64:65]
  v_pk_add_f32 v[74:75], v[74:75], v[66:67]
  v_pk_add_f32 v[72:73], v[72:73], v[68:69]
  v_pk_add_f32 v[74:75], v[74:75], v[70:71]
  v_pk_add_f32 v[72:73], v[72:73], v[74:75]
  s_nop 0
  v_add_f32 v72, v72, v73
  s_nop 1
  v_add_f32_dpp v72, v72, v72 quad_perm:[1,0,3,2] row_mask:0xf bank_mask:0xf
  s_nop 1
  v_add_f32_dpp v72, v72, v72 quad_perm:[2,3,0,1] row_mask:0xf bank_mask:0xf
  s_nop 1
  v_add_f32_dpp v72, v72, v72 row_half_mirror row_mask:0xf bank_mask:0xf
  s_nop 1
  v_add_f32_dpp v72, v72, v72 row_mirror row_mask:0xf bank_mask:0xf
  v_mov_b32 v74, v72
  s_nop 1
  v_permlane16_swap_b32 v72, v74
  v_add_f32 v72, v72, v74
  v_mul_f32 v72, 0x3a800000, v72
  v_sub_f32 v40, v40, v72
  v_sub_f32 v41, v41, v72
  v_sub_f32 v42, v42, v72
  v_sub_f32 v43, v43, v72
  v_sub_f32 v44, v44, v72
  v_sub_f32 v45, v45, v72
  v_sub_f32 v46, v46, v72
  v_sub_f32 v47, v47, v72
  v_sub_f32 v48, v48, v72
  v_sub_f32 v49, v49, v72
  v_sub_f32 v50, v50, v72
  v_sub_f32 v51, v51, v72
  v_sub_f32 v52, v52, v72
  v_sub_f32 v53, v53, v72
  v_sub_f32 v54, v54, v72
  v_sub_f32 v55, v55, v72
  v_sub_f32 v56, v56, v72
  v_sub_f32 v57, v57, v72
  v_sub_f32 v58, v58, v72
  v_sub_f32 v59, v59, v72
  v_sub_f32 v60, v60, v72
  v_sub_f32 v61, v61, v72
  v_sub_f32 v62, v62, v72
  v_sub_f32 v63, v63, v72
  v_sub_f32 v64, v64, v72
  v_sub_f32 v65, v65, v72
  v_sub_f32 v66, v66, v72
  v_sub_f32 v67, v67, v72
  v_sub_f32 v68, v68, v72
  v_sub_f32 v69, v69, v72
  v_sub_f32 v70, v70, v72
  v_sub_f32 v71, v71, v72
  v_mul_f32 v72, v40, v40
  v_mul_f32 v73, v41, v41
  v_fmac_f32 v72, v42, v42
  v_fmac_f32 v73, v43, v43
  v_fmac_f32 v72, v44, v44
  v_fmac_f32 v73, v45, v45
  v_fmac_f32 v72, v46, v46
  v_fmac_f32 v73, v47, v47
  v_fmac_f32 v72, v48, v48
  v_fmac_f32 v73, v49, v49
  v_fmac_f32 v72, v50, v50
  v_fmac_f32 v73, v51, v51
  v_fmac_f32 v72, v52, v52
  v_fmac_f32 v73, v53, v53
  v_fmac_f32 v72, v54, v54
  v_fmac_f32 v73, v55, v55
  v_fmac_f32 v72, v56, v56
  v_fmac_f32 v73, v57, v57
  v_fmac_f32 v72, v58, v58
  v_fmac_f32 v73, v59, v59
  v_fmac_f32 v72, v60, v60
  v_fmac_f32 v73, v61, v61
  v_fmac_f32 v72, v62, v62
  v_fmac_f32 v73, v63, v63
  v_fmac_f32 v72, v64, v64
  v_fmac_f32 v73, v65, v65
  v_fmac_f32 v72, v66, v66
  v_fmac_f32 v73, v67, v67
  v_fmac_f32 v72, v68, v68
  v_fmac_f32 v73, v69, v69
  v_fmac_f32 v72, v70, v70
  v_fmac_f32 v73, v71, v71
  v_add_f32 v72, v72, v73
  s_nop 1
  v_add_f32_dpp v72, v72, v72 quad_perm:[1,0,3,2] row_mask:0xf bank_mask:0xf
  s_nop 1
  v_add_f32_dpp v72, v72, v72 quad_perm:[2,3,0,1] row_mask:0xf bank_mask:0xf
  s_nop 1
  v_add_f32_dpp v72, v72, v72 row_half_mirror row_mask:0xf bank_mask:0xf
  s_nop 1
  v_add_f32_dpp v72, v72, v72 row_mirror row_mask:0xf bank_mask:0xf
  v_mov_b32 v74, v72
  s_nop 1
  v_permlane16_swap_b32 v72, v74
  v_add_f32 v72, v72, v74
  v_mov_b32 v75, 0x3727c5ac
  v_fmac_f32 v75, 0x3a800000, v72
  v_rsq_f32 v75, v75
  s_nop 0
  v_mul_f32 v40, v40, v75
  v_mul_f32 v41, v41, v75
  v_mul_f32 v42, v42, v75
  v_mul_f32 v43, v43, v75
  v_mul_f32 v44, v44, v75
  v_mul_f32 v45, v45, v75
  v_mul_f32 v46, v46, v75
  v_mul_f32 v47, v47, v75
  v_mul_f32 v48, v48, v75
  v_mul_f32 v49, v49, v75
  v_mul_f32 v50, v50, v75
  v_mul_f32 v51, v51, v75
  v_mul_f32 v52, v52, v75
  v_mul_f32 v53, v53, v75
  v_mul_f32 v54, v54, v75
  v_mul_f32 v55, v55, v75
  v_mul_f32 v56, v56, v75
  v_mul_f32 v57, v57, v75
  v_mul_f32 v58, v58, v75
  v_mul_f32 v59, v59, v75
  v_mul_f32 v60, v60, v75
  v_mul_f32 v61, v61, v75
  v_mul_f32 v62, v62, v75
  v_mul_f32 v63, v63, v75
  v_mul_f32 v64, v64, v75
  v_mul_f32 v65, v65, v75
  v_mul_f32 v66, v66, v75
  v_mul_f32 v67, v67, v75
  v_mul_f32 v68, v68, v75
  v_mul_f32 v69, v69, v75
  v_mul_f32 v70, v70, v75
  v_mul_f32 v71, v71, v75
  v_cvt_pk_bf16_f32 v4, v40, v41
  v_cvt_pk_bf16_f32 v5, v42, v43
  v_cvt_pk_bf16_f32 v6, v44, v45
  v_cvt_pk_bf16_f32 v7, v46, v47
  v_cvt_pk_bf16_f32 v8, v48, v49
  v_cvt_pk_bf16_f32 v9, v50, v51
  v_cvt_pk_bf16_f32 v10, v52, v53
  v_cvt_pk_bf16_f32 v11, v54, v55
  v_cvt_pk_bf16_f32 v12, v56, v57
  v_cvt_pk_bf16_f32 v13, v58, v59
  v_cvt_pk_bf16_f32 v14, v60, v61
  v_cvt_pk_bf16_f32 v15, v62, v63
  v_cvt_pk_bf16_f32 v16, v64, v65
  v_cvt_pk_bf16_f32 v17, v66, v67
  v_cvt_pk_bf16_f32 v18, v68, v69
  v_cvt_pk_bf16_f32 v19, v70, v71
  s_add_u32 s43, s42, 0
  buffer_store_dwordx4 v[4:7], v36, s[4:7], s43 offen sc1
  s_add_u32 s43, s42, 1048576
  buffer_store_dwordx4 v[8:11], v36, s[4:7], s43 offen sc1
  s_add_u32 s43, s42, 2097152
  buffer_store_dwordx4 v[12:15], v36, s[4:7], s43 offen sc1
  s_add_u32 s43, s42, 3145728
  buffer_store_dwordx4 v[16:19], v36, s[4:7], s43 offen sc1
  s_cmp_lg_u32 s46, 0
  s_cbranch_scc1 L_lnw_3_1
  s_waitcnt vmcnt(4)
L_lnw_3_1:
  s_waitcnt vmcnt(5)
  v_lshlrev_b32 v40, 16, v20
  v_and_b32 v41, 0xffff0000, v20
  v_lshlrev_b32 v42, 16, v21
  v_and_b32 v43, 0xffff0000, v21
  v_lshlrev_b32 v44, 16, v22
  v_and_b32 v45, 0xffff0000, v22
  v_lshlrev_b32 v46, 16, v23
  v_and_b32 v47, 0xffff0000, v23
  v_lshlrev_b32 v48, 16, v24
  v_and_b32 v49, 0xffff0000, v24
  v_lshlrev_b32 v50, 16, v25
  v_and_b32 v51, 0xffff0000, v25
  v_lshlrev_b32 v52, 16, v26
  v_and_b32 v53, 0xffff0000, v26
  v_lshlrev_b32 v54, 16, v27
  v_and_b32 v55, 0xffff0000, v27
  v_lshlrev_b32 v56, 16, v28
  v_and_b32 v57, 0xffff0000, v28
  v_lshlrev_b32 v58, 16, v29
  v_and_b32 v59, 0xffff0000, v29
  v_lshlrev_b32 v60, 16, v30
  v_and_b32 v61, 0xffff0000, v30
  v_lshlrev_b32 v62, 16, v31
  v_and_b32 v63, 0xffff0000, v31
  v_lshlrev_b32 v64, 16, v32
  v_and_b32 v65, 0xffff0000, v32
  v_lshlrev_b32 v66, 16, v33
  v_and_b32 v67, 0xffff0000, v33
  v_lshlrev_b32 v68, 16, v34
  v_and_b32 v69, 0xffff0000, v34
  v_lshlrev_b32 v70, 16, v35
  v_and_b32 v71, 0xffff0000, v35
  v_pk_add_f32 v[72:73], v[40:41], v[42:43]
  v_pk_add_f32 v[74:75], v[44:45], v[46:47]
  v_pk_add_f32 v[72:73], v[72:73], v[48:49]
  v_pk_add_f32 v[74:75], v[74:75], v[50:51]
  v_pk_add_f32 v[72:73], v[72:73], v[52:53]
  v_pk_add_f32 v[74:75], v[74:75], v[54:55]
  v_pk_add_f32 v[72:73], v[72:73], v[56:57]
  v_pk_add_f32 v[74:75], v[74:75], v[58:59]
  v_pk_add_f32 v[72:73], v[72:73], v[60:61]
  v_pk_add_f32 v[74:75], v[74:75], v[62:63]
  v_pk_add_f32 v[72:73], v[72:73], v[64:65]
  v_pk_add_f32 v[74:75], v[74:75], v[66:67]
  v_pk_add_f32 v[72:73], v[72:73], v[68:69]
  v_pk_add_f32 v[74:75], v[74:75], v[70:71]
  v_pk_add_f32 v[72:73], v[72:73], v[74:75]
  s_nop 0
  v_add_f32 v72, v72, v73
  s_nop 1
  v_add_f32_dpp v72, v72, v72 quad_perm:[1,0,3,2] row_mask:0xf bank_mask:0xf
  s_nop 1
  v_add_f32_dpp v72, v72, v72 quad_perm:[2,3,0,1] row_mask:0xf bank_mask:0xf
  s_nop 1
  v_add_f32_dpp v72, v72, v72 row_half_mirror row_mask:0xf bank_mask:0xf
  s_nop 1
  v_add_f32_dpp v72, v72, v72 row_mirror row_mask:0xf bank_mask:0xf
  v_mov_b32 v74, v72
  s_nop 1
  v_permlane16_swap_b32 v72, v74
  v_add_f32 v72, v72, v74
  v_mul_f32 v72, 0x3a800000, v72
  v_sub_f32 v40, v40, v72
  v_sub_f32 v41, v41, v72
  v_sub_f32 v42, v42, v72
  v_sub_f32 v43, v43, v72
  v_sub_f32 v44, v44, v72
  v_sub_f32 v45, v45, v72
  v_sub_f32 v46, v46, v72
  v_sub_f32 v47, v47, v72
  v_sub_f32 v48, v48, v72
  v_sub_f32 v49, v49, v72
  v_sub_f32 v50, v50, v72
  v_sub_f32 v51, v51, v72
  v_sub_f32 v52, v52, v72
  v_sub_f32 v53, v53, v72
  v_sub_f32 v54, v54, v72
  v_sub_f32 v55, v55, v72
  v_sub_f32 v56, v56, v72
  v_sub_f32 v57, v57, v72
  v_sub_f32 v58, v58, v72
  v_sub_f32 v59, v59, v72
  v_sub_f32 v60, v60, v72
  v_sub_f32 v61, v61, v72
  v_sub_f32 v62, v62, v72
  v_sub_f32 v63, v63, v72
  v_sub_f32 v64, v64, v72
  v_sub_f32 v65, v65, v72
  v_sub_f32 v66, v66, v72
  v_sub_f32 v67, v67, v72
  v_sub_f32 v68, v68, v72
  v_sub_f32 v69, v69, v72
  v_sub_f32 v70, v70, v72
  v_sub_f32 v71, v71, v72
  v_mul_f32 v72, v40, v40
  v_mul_f32 v73, v41, v41
  v_fmac_f32 v72, v42, v42
  v_fmac_f32 v73, v43, v43
  v_fmac_f32 v72, v44, v44
  v_fmac_f32 v73, v45, v45
  v_fmac_f32 v72, v46, v46
  v_fmac_f32 v73, v47, v47
  v_fmac_f32 v72, v48, v48
  v_fmac_f32 v73, v49, v49
  v_fmac_f32 v72, v50, v50
  v_fmac_f32 v73, v51, v51
  v_fmac_f32 v72, v52, v52
  v_fmac_f32 v73, v53, v53
  v_fmac_f32 v72, v54, v54
  v_fmac_f32 v73, v55, v55
  v_fmac_f32 v72, v56, v56
  v_fmac_f32 v73, v57, v57
  v_fmac_f32 v72, v58, v58
  v_fmac_f32 v73, v59, v59
  v_fmac_f32 v72, v60, v60
  v_fmac_f32 v73, v61, v61
  v_fmac_f32 v72, v62, v62
  v_fmac_f32 v73, v63, v63
  v_fmac_f32 v72, v64, v64
  v_fmac_f32 v73, v65, v65
  v_fmac_f32 v72, v66, v66
  v_fmac_f32 v73, v67, v67
  v_fmac_f32 v72, v68, v68
  v_fmac_f32 v73, v69, v69
  v_fmac_f32 v72, v70, v70
  v_fmac_f32 v73, v71, v71
  v_add_f32 v72, v72, v73
  s_nop 1
  v_add_f32_dpp v72, v72, v72 quad_perm:[1,0,3,2] row_mask:0xf bank_mask:0xf
  s_nop 1
  v_add_f32_dpp v72, v72, v72 quad_perm:[2,3,0,1] row_mask:0xf bank_mask:0xf
  s_nop 1
  v_add_f32_dpp v72, v72, v72 row_half_mirror row_mask:0xf bank_mask:0xf
  s_nop 1
  v_add_f32_dpp v72, v72, v72 row_mirror row_mask:0xf bank_mask:0xf
  v_mov_b32 v74, v72
  s_nop 1
  v_permlane16_swap_b32 v72, v74
  v_add_f32 v72, v72, v74
  v_mov_b32 v75, 0x3727c5ac
  v_fmac_f32 v75, 0x3a800000, v72
  v_rsq_f32 v75, v75
  s_nop 0
  v_mul_f32 v40, v40, v75
  v_mul_f32 v41, v41, v75
  v_mul_f32 v42, v42, v75
  v_mul_f32 v43, v43, v75
  v_mul_f32 v44, v44, v75
  v_mul_f32 v45, v45, v75
  v_mul_f32 v46, v46, v75
  v_mul_f32 v47, v47, v75
  v_mul_f32 v48, v48, v75
  v_mul_f32 v49, v49, v75
  v_mul_f32 v50, v50, v75
  v_mul_f32 v51, v51, v75
  v_mul_f32 v52, v52, v75
  v_mul_f32 v53, v53, v75
  v_mul_f32 v54, v54, v75
  v_mul_f32 v55, v55, v75
  v_mul_f32 v56, v56, v75
  v_mul_f32 v57, v57, v75
  v_mul_f32 v58, v58, v75
  v_mul_f32 v59, v59, v75
  v_mul_f32 v60, v60, v75
  v_mul_f32 v61, v61, v75
  v_mul_f32 v62, v62, v75
  v_mul_f32 v63, v63, v75
  v_mul_f32 v64, v64, v75
  v_mul_f32 v65, v65, v75
  v_mul_f32 v66, v66, v75
  v_mul_f32 v67, v67, v75
  v_mul_f32 v68, v68, v75
  v_mul_f32 v69, v69, v75
  v_mul_f32 v70, v70, v75
  v_mul_f32 v71, v71, v75
  v_cvt_pk_bf16_f32 v20, v40, v41
  v_cvt_pk_bf16_f32 v21, v42, v43
  v_cvt_pk_bf16_f32 v22, v44, v45
  v_cvt_pk_bf16_f32 v23, v46, v47
  v_cvt_pk_bf16_f32 v24, v48, v49
  v_cvt_pk_bf16_f32 v25, v50, v51
  v_cvt_pk_bf16_f32 v26, v52, v53
  v_cvt_pk_bf16_f32 v27, v54, v55
  v_cvt_pk_bf16_f32 v28, v56, v57
  v_cvt_pk_bf16_f32 v29, v58, v59
  v_cvt_pk_bf16_f32 v30, v60, v61
  v_cvt_pk_bf16_f32 v31, v62, v63
  v_cvt_pk_bf16_f32 v32, v64, v65
  v_cvt_pk_bf16_f32 v33, v66, v67
  v_cvt_pk_bf16_f32 v34, v68, v69
  v_cvt_pk_bf16_f32 v35, v70, v71
  s_add_u32 s43, s42, 128
  buffer_store_dwordx4 v[20:23], v36, s[4:7], s43 offen sc1
  s_add_u32 s43, s42, 1048704
  buffer_store_dwordx4 v[24:27], v36, s[4:7], s43 offen sc1
  s_add_u32 s43, s42, 2097280
  buffer_store_dwordx4 v[28:31], v36, s[4:7], s43 offen sc1
  s_add_u32 s43, s42, 3145856
  buffer_store_dwordx4 v[32:35], v36, s[4:7], s43 offen sc1
  s_and_b32 s40, s45, 63
  s_mul_i32 s40, s40, 8192
  s_cmp_lt_u32 s45, 64
  s_cselect_b32 s41, 0, 4194304
  s_add_u32 s40, s40, s41
  s_add_u32 s40, s40, 95944704
  s_lshl_b32 s41, s27, 10
  s_add_u32 s40, s40, s41
  v_lshlrev_b32 v1, 4, v0
  v_mov_b32 v4, -1
  v_mov_b32 v5, -1
  v_mov_b32 v6, -1
  v_mov_b32 v7, -1
  buffer_store_dwordx4 v[4:7], v1, s[4:7], s40 offen sc1
  s_add_u32 s40, s40, 4096
  buffer_store_dwordx4 v[4:7], v1, s[4:7], s40 offen sc1
  s_cmp_lg_u32 s27, 0
  s_cbranch_scc1 L_fl_w
  s_mov_b32 s43, s45
  s_lshl_b32 s40, s43, 7
  s_add_u32 s40, s40, 117440512
  s_sub_u32 s41, s43, 72
  s_cmp_lt_u32 s41, 4
  s_cselect_b32 s41, 32, 0
  v_lshlrev_b32 v1, 2, v0
  v_mov_b32 v2, s41
  s_mov_b32 exec_lo, -1
  s_mov_b32 exec_hi, 0
  buffer_store_dword v2, v1, s[4:7], s40 offen sc1
  s_mov_b64 exec, -1
L_fl_w:
  s_waitcnt vmcnt(0)
  s_barrier
  s_cmp_lg_u32 s27, 0
  s_cbranch_scc1 L_ar_w
  s_add_u32 s40, s97, 128
  v_mov_b32 v4, s40
  v_mov_b32 v2, 1
  s_mov_b64 exec, 1
  global_atomic_add v3, v4, v2, s[90:91] sc0 sc1
  s_mov_b64 exec, -1
  v_and_b32 v19, 7, v0
  v_lshlrev_b32 v19, 3, v19
  s_add_u32 s40, s97, 64
  v_mov_b32 v23, s40
  global_load_dwordx2 v[20:21], v19, s[90:91] offset:0 sc1
  global_load_dword v22, v23, s[90:91] sc1
  s_waitcnt vmcnt(0)
  v_readfirstlane_b32 s40, v3
  s_lshl_b32 s41, s97, 5
  s_add_u32 s41, s41, 127
  s_cmp_eq_u32 s40, s41
  s_cbranch_scc0 L_ar_nl
  s_add_u32 s40, s97, 64
  v_mov_b32 v4, s40
  v_mov_b32 v2, 1
  s_mov_b64 exec, 1
  global_store_dword v4, v2, s[90:91] sc1
  s_mov_b64 exec, -1
L_ar_nl:
  s_mov_b32 s99, 400000
  s_cmp_lg_u32 s97, 0
  s_cbranch_scc1 L_wt_go
L_wt_v:
  v_sad_u8 v18, v20, 0, 0
  v_sad_u8 v18, v21, 0, v18
  s_mov_b64 exec, 0xff
  v_cmp_ne_u32 vcc, 32, v18
  s_mov_b64 exec, -1
  s_cbranch_vccz L_wt_vd
  s_sub_u32 s99, s99, 1
  s_cbranch_scc1 L_wt_to
  global_load_dwordx2 v[20:21], v19, s[90:91] offset:0 sc1
  s_waitcnt vmcnt(0)
  s_branch L_wt_v
L_wt_vd:
  v_readlane_b32 s40, v20, 0
  v_readlane_b32 s41, v21, 0
  s_mov_b32 s42, s40
  s_mov_b32 s43, s41
  v_readlane_b32 s40, v20, 1
  v_readlane_b32 s41, v21, 1
  s_or_b32 s42, s42, s40
  s_or_b32 s43, s43, s41
  v_readlane_b32 s40, v20, 2
  v_readlane_b32 s41, v21, 2
  s_or_b32 s42, s42, s40
  s_or_b32 s43, s43, s41
  v_readlane_b32 s40, v20, 3
  v_readlane_b32 s41, v21, 3
  s_or_b32 s42, s42, s40
  s_or_b32 s43, s43, s41
  v_readlane_b32 s40, v20, 4
  v_readlane_b32 s41, v21, 4
  s_or_b32 s42, s42, s40
  s_or_b32 s43, s43, s41
  v_readlane_b32 s40, v20, 5
  v_readlane_b32 s41, v21, 5
  s_or_b32 s42, s42, s40
  s_or_b32 s43, s43, s41
  v_readlane_b32 s40, v20, 6
  v_readlane_b32 s41, v21, 6
  s_or_b32 s42, s42, s40
  s_or_b32 s43, s43, s41
  v_readlane_b32 s40, v20, 7
  v_readlane_b32 s41, v21, 7
  s_or_b32 s42, s42, s40
  s_or_b32 s43, s43, s41
  s_cmp_eq_u32 s42, 538976288
  s_cselect_b32 s40, 1, 0
  s_cmp_eq_u32 s43, 0x20202020
  s_cselect_b32 s40, s40, 0
  s_cmp_eq_u32 s40, 0
  s_cbranch_scc0 L_wt_go
  v_mov_b32 v18, -2
  s_branch L_wt_f
L_wt_go:
  v_readfirstlane_b32 s40, v22
  s_nop 0

  s_cmp_lg_u32 s40, 0
  s_cbranch_scc1 L_wt_ok
  s_sub_u32 s99, s99, 1
  s_cbranch_scc1 L_wt_to

  global_load_dword v22, v23, s[90:91] sc1
  s_waitcnt vmcnt(0)
  s_branch L_wt_go
L_wt_to:
  v_mov_b32 v18, -1
  s_branch L_wt_f
L_wt_ok:
  v_mov_b32 v18, 0
L_wt_f:
  v_mov_b32 v16, 131072
  ds_write_b32 v16, v18 offset:8
  s_waitcnt lgkmcnt(0)
L_ar_w:
  s_barrier
  v_mov_b32 v16, 131072
  ds_read_b32 v17, v16 offset:8
  s_waitcnt lgkmcnt(0)
  v_readfirstlane_b32 s40, v17
  s_nop 0
  s_cmp_eq_u32 s40, -1
  s_cbranch_scc1 L_fail
  s_cmp_eq_u32 s40, -2
  s_cbranch_scc1 L_round2
  s_and_b32 s96, s94, 3
  s_branch L_tasks
L_round2:
  s_waitcnt vmcnt(0) lgkmcnt(0)
  s_barrier
  s_mov_b32 s97, 4
  s_mov_b32 s95, 2
  s_and_b32 s94, s2, 7
  s_mov_b32 s27, s77
  s_mov_b32 s28, s77
  s_branch L_role
L_cstart:
  s_mov_b32 s46, 0
  s_cmp_lg_u32 s77, 0
  s_cbranch_scc1 L_pl_4
  s_cmp_lg_u32 s97, 0
  s_cbranch_scc1 L_pl_4
  s_mov_b32 s46, 1
  s_lshl_b32 s47, s92, 3
  s_lshl_b64 s[48:49], 1, s47
  s_and_b32 s47, s2, 7
  s_lshl_b32 s47, s47, 3
  v_mov_b32 v84, s47
  v_mov_b32 v82, s48
  v_mov_b32 v83, s49
  s_mov_b64 exec, 1
  global_atomic_add_x2 v84, v[82:83], s[90:91] offset:0 sc1
  s_mov_b64 exec, -1
L_pl_4:
  s_cmp_eq_u32 s97, 0
  s_cbranch_scc1 L_car_w
  s_cmp_lg_u32 s77, 0
  s_cbranch_scc1 L_car_w
  s_add_u32 s40, s97, 128
  v_mov_b32 v4, s40
  v_mov_b32 v2, 1
  s_mov_b64 exec, 1
  global_atomic_add v3, v4, v2, s[90:91] sc0 sc1
  s_waitcnt vmcnt(0)
  v_readfirstlane_b32 s40, v3
  s_nop 0
  s_cmp_eq_u32 s40, 255
  s_cbranch_scc0 L_car_nl
  s_add_u32 s40, s97, 64
  v_mov_b32 v4, s40
  global_store_dword v4, v2, s[90:91] sc1
L_car_nl:
  s_mov_b64 exec, -1
L_car_w:
  s_mov_b32 s28, s77
  s_mov_b32 s29, s94
  s_mov_b32 s30, s93
  s_load_dwordx2 s[66:67], s[0:1], 16
  s_load_dwordx4 s[68:71], s[0:1], 24
  s_load_dwordx2 s[72:73], s[0:1], 40
  s_add_u32 s52, s4, 100663296
  s_addc_u32 s53, s5, 0
  s_sub_u32 s40, 0, s52
  s_and_b32 s40, s40, 0x3fffff
  s_add_u32 s52, s52, s40
  s_addc_u32 s53, s53, 0
  s_mov_b32 s8, s52
  s_mov_b32 s9, s53
  s_mov_b32 s10, 0x400000
  s_mov_b32 s11, 0x20000
  s_lshl_b32 s40, s29, 5
  s_add_u32 s40, s40, s30
  s_lshl_b32 s40, s40, 15
  s_lshl_b32 s41, s28, 13
  s_add_u32 s40, s40, s41
  s_add_u32 s41, s40, 4096
  v_lshlrev_b32 v1, 4, v0
  v_mov_b32 v4, -1
  v_mov_b32 v5, -1
  v_mov_b32 v6, -1
  v_mov_b32 v7, -1
  buffer_store_dwordx4 v[4:7], v1, s[8:11], s40 offen offset:0 sc1
  buffer_store_dwordx4 v[4:7], v1, s[8:11], s40 offen offset:1024 sc1
  buffer_store_dwordx4 v[4:7], v1, s[8:11], s40 offen offset:2048 sc1
  buffer_store_dwordx4 v[4:7], v1, s[8:11], s40 offen offset:3072 sc1
  buffer_store_dwordx4 v[4:7], v1, s[8:11], s41 offen offset:0 sc1
  buffer_store_dwordx4 v[4:7], v1, s[8:11], s41 offen offset:1024 sc1
  buffer_store_dwordx4 v[4:7], v1, s[8:11], s41 offen offset:2048 sc1
  buffer_store_dwordx4 v[4:7], v1, s[8:11], s41 offen offset:3072 sc1
  s_waitcnt lgkmcnt(0)
  s_mov_b32 s12, s66
  s_mov_b32 s13, s67
  s_mov_b32 s14, 0x800000
  s_mov_b32 s15, 0x20000
  s_mov_b32 s16, s68
  s_mov_b32 s17, s69
  s_mov_b32 s18, 0x800000
  s_mov_b32 s19, 0x20000
  s_mov_b32 s20, s70
  s_mov_b32 s21, s71
  s_mov_b32 s22, 0x800000
  s_mov_b32 s23, 0x20000
  s_mov_b32 s24, s72
  s_mov_b32 s25, s73
  s_mov_b32 s26, 0x800000
  s_mov_b32 s27, 0x20000
  s_lshl_b32 s50, s30, 2
  s_add_u32 s50, s50, s28
  s_lshl_b32 s50, s50, 16
  s_lshl_b32 s51, s29, 11
  s_add_u32 s50, s50, s51
  v_lshrrev_b32 v161, 3, v0
  v_lshlrev_b32 v161, 3, v161
  v_add_u32 v161, 3, v161
  v_min_u32 v161, 15, v161
  v_and_b32 v162, 7, v0
  v_lshlrev_b32 v162, 13, v162
  v_lshl_add_u32 v161, v161, 7, v162
  v_add_u32 v161, s50, v161
  s_mov_b64 exec, 0xffffff
  buffer_load_dword v160, v161, s[16:19], 0 offen
  buffer_load_dword v160, v161, s[20:23], 0 offen
  s_mov_b64 exec, -1
  s_xor_b32 s50, s30, 0
  s_lshr_b32 s50, s50, 2
  s_lshl_b32 s51, s29, 3
  s_add_u32 s50, s50, s51
  s_lshl_b32 s50, s50, 8
  s_and_b32 s51, s30, 3
  s_lshl_b32 s51, s51, 6
  s_add_u32 s50, s50, s51
  s_lshl_b32 s51, s28, 21
  s_add_u32 s50, s50, s51
  v_mov_b32 v16, 0
  v_bfe_u32 v255, v0, 2, 4
  v_lshl_add_u32 v16, v255, 13, v16
  v_bfe_u32 v255, v0, 0, 2
  v_lshl_add_u32 v16, v255, 4, v16
  v_add_u32 v16, s50, v16
  s_lshr_b32 s50, s30, 4
  s_lshl_b32 s50, s50, 2
  s_add_u32 s50, s50, s28
  s_lshl_b32 s51, s29, 3
  s_add_u32 s50, s50, s51
  s_lshl_b32 s50, s50, 18
  s_xor_b32 s51, s30, 0
  s_and_b32 s51, s51, 15
  s_lshl_b32 s51, s51, 7
  s_add_u32 s50, s50, s51
  v_mov_b32 v17, 0
  v_bfe_u32 v255, v0, 3, 3
  v_lshl_add_u32 v17, v255, 11, v17
  v_bfe_u32 v255, v0, 0, 3
  v_lshl_add_u32 v17, v255, 4, v17
  v_add_u32 v17, s50, v17
  s_lshl_b32 s52, s28, 15
  v_mov_b32 v18, 0
  v_bfe_u32 v255, v0, 5, 1
  v_lshl_add_u32 v18, v255, 10, v18
  v_bfe_u32 v255, v0, 4, 1
  v_lshl_add_u32 v18, v255, 8, v18
  v_bfe_u32 v255, v0, 2, 1
  v_lshl_add_u32 v18, v255, 6, v18
  v_bfe_u32 v255, v0, 3, 1
  v_lshl_add_u32 v18, v255, 9, v18
  v_bfe_u32 v255, v0, 0, 2
  v_lshl_add_u32 v18, v255, 3, v18
  v_add_u32 v18, s52, v18
  v_mov_b32 v19, 0x4000
  v_bfe_u32 v255, v0, 4, 1
  v_lshl_add_u32 v19, v255, 11, v19
  v_bfe_u32 v255, v0, 5, 1
  v_lshl_add_u32 v19, v255, 9, v19
  v_bfe_u32 v255, v0, 2, 1
  v_lshl_add_u32 v19, v255, 7, v19
  v_bfe_u32 v255, v0, 3, 1
  v_lshl_add_u32 v19, v255, 12, v19
  v_bfe_u32 v255, v0, 0, 2
  v_lshl_add_u32 v19, v255, 3, v19
  v_add_u32 v19, s52, v19
  s_add_u32 s53, s52, 0
  s_mov_b32 s54, 0
  s_mov_b32 m0, s53
  s_add_u32 s53, s53, 1024
  buffer_load_dwordx4 v16, s[16:19], s54 offen lds
  s_add_u32 s54, s54, 131072
  s_mov_b32 m0, s53
  s_add_u32 s53, s53, 1024
  buffer_load_dwordx4 v16, s[16:19], s54 offen lds
  s_add_u32 s54, s54, 131072
  s_mov_b32 m0, s53
  s_add_u32 s53, s53, 1024
  buffer_load_dwordx4 v16, s[16:19], s54 offen lds
  s_add_u32 s54, s54, 131072
  s_mov_b32 m0, s53
  s_add_u32 s53, s53, 1024
  buffer_load_dwordx4 v16, s[16:19], s54 offen lds
  s_add_u32 s54, s54, 131072
  s_mov_b32 m0, s53
  s_add_u32 s53, s53, 1024
  buffer_load_dwordx4 v16, s[16:19], s54 offen lds
  s_add_u32 s54, s54, 131072
  s_mov_b32 m0, s53
  s_add_u32 s53, s53, 1024
  buffer_load_dwordx4 v16, s[16:19], s54 offen lds
  s_add_u32 s54, s54, 131072
  s_mov_b32 m0, s53
  s_add_u32 s53, s53, 1024
  buffer_load_dwordx4 v16, s[16:19], s54 offen lds
  s_add_u32 s54, s54, 131072
  s_mov_b32 m0, s53
  s_add_u32 s53, s53, 1024
  buffer_load_dwordx4 v16, s[16:19], s54 offen lds
  s_add_u32 s54, s54, 131072
  s_mov_b32 m0, s53
  s_add_u32 s53, s53, 1024
  buffer_load_dwordx4 v16, s[16:19], s54 offen lds
  s_add_u32 s54, s54, 131072
  s_mov_b32 m0, s53
  s_add_u32 s53, s53, 1024
  buffer_load_dwordx4 v16, s[16:19], s54 offen lds
  s_add_u32 s54, s54, 131072
  s_mov_b32 m0, s53
  s_add_u32 s53, s53, 1024
  buffer_load_dwordx4 v16, s[16:19], s54 offen lds
  s_add_u32 s54, s54, 131072
  s_mov_b32 m0, s53
  s_add_u32 s53, s53, 1024
  buffer_load_dwordx4 v16, s[16:19], s54 offen lds
  s_add_u32 s54, s54, 131072
  s_mov_b32 m0, s53
  s_add_u32 s53, s53, 1024
  buffer_load_dwordx4 v16, s[16:19], s54 offen lds
  s_add_u32 s54, s54, 131072
  s_mov_b32 m0, s53
  s_add_u32 s53, s53, 1024
  buffer_load_dwordx4 v16, s[16:19], s54 offen lds
  s_add_u32 s54, s54, 131072
  s_mov_b32 m0, s53
  s_add_u32 s53, s53, 1024
  buffer_load_dwordx4 v16, s[16:19], s54 offen lds
  s_add_u32 s54, s54, 131072
  s_mov_b32 m0, s53
  s_add_u32 s53, s53, 1024
  buffer_load_dwordx4 v16, s[16:19], s54 offen lds
  s_add_u32 s54, s54, 131072
  s_add_u32 s53, s52, 16384
  s_mov_b32 s54, 0
  s_mov_b32 m0, s53
  s_add_u32 s53, s53, 1024
  buffer_load_dwordx4 v16, s[20:23], s54 offen lds
  s_add_u32 s54, s54, 131072
  s_mov_b32 m0, s53
  s_add_u32 s53, s53, 1024
  buffer_load_dwordx4 v16, s[20:23], s54 offen lds
  s_add_u32 s54, s54, 131072
  s_mov_b32 m0, s53
  s_add_u32 s53, s53, 1024
  buffer_load_dwordx4 v16, s[20:23], s54 offen lds
  s_add_u32 s54, s54, 131072
  s_mov_b32 m0, s53
  s_add_u32 s53, s53, 1024
  buffer_load_dwordx4 v16, s[20:23], s54 offen lds
  s_add_u32 s54, s54, 131072
  s_mov_b32 m0, s53
  s_add_u32 s53, s53, 1024
  buffer_load_dwordx4 v16, s[20:23], s54 offen lds
  s_add_u32 s54, s54, 131072
  s_mov_b32 m0, s53
  s_add_u32 s53, s53, 1024
  buffer_load_dwordx4 v16, s[20:23], s54 offen lds
  s_add_u32 s54, s54, 131072
  s_mov_b32 m0, s53
  s_add_u32 s53, s53, 1024
  buffer_load_dwordx4 v16, s[20:23], s54 offen lds
  s_add_u32 s54, s54, 131072
  s_mov_b32 m0, s53
  s_add_u32 s53, s53, 1024
  buffer_load_dwordx4 v16, s[20:23], s54 offen lds
  s_add_u32 s54, s54, 131072
  s_mov_b32 m0, s53
  s_add_u32 s53, s53, 1024
  buffer_load_dwordx4 v16, s[20:23], s54 offen lds
  s_add_u32 s54, s54, 131072
  s_mov_b32 m0, s53
  s_add_u32 s53, s53, 1024
  buffer_load_dwordx4 v16, s[20:23], s54 offen lds
  s_add_u32 s54, s54, 131072
  s_mov_b32 m0, s53
  s_add_u32 s53, s53, 1024
  buffer_load_dwordx4 v16, s[20:23], s54 offen lds
  s_add_u32 s54, s54, 131072
  s_mov_b32 m0, s53
  s_add_u32 s53, s53, 1024
  buffer_load_dwordx4 v16, s[20:23], s54 offen lds
  s_add_u32 s54, s54, 131072
  s_mov_b32 m0, s53
  s_add_u32 s53, s53, 1024
  buffer_load_dwordx4 v16, s[20:23], s54 offen lds
  s_add_u32 s54, s54, 131072
  s_mov_b32 m0, s53
  s_add_u32 s53, s53, 1024
  buffer_load_dwordx4 v16, s[20:23], s54 offen lds
  s_add_u32 s54, s54, 131072
  s_mov_b32 m0, s53
  s_add_u32 s53, s53, 1024
  buffer_load_dwordx4 v16, s[20:23], s54 offen lds
  s_add_u32 s54, s54, 131072
  s_mov_b32 m0, s53
  s_add_u32 s53, s53, 1024
  buffer_load_dwordx4 v16, s[20:23], s54 offen lds
  s_add_u32 s54, s54, 131072
  s_waitcnt vmcnt(16)
  ds_read_b64_tr_b16 a[64:65], v18 offset:0
  ds_read_b64_tr_b16 a[66:67], v18 offset:128
  ds_read_b64_tr_b16 a[68:69], v18 offset:2048
  ds_read_b64_tr_b16 a[70:71], v18 offset:2176
  ds_read_b64_tr_b16 a[72:73], v18 offset:4096
  ds_read_b64_tr_b16 a[74:75], v18 offset:4224
  ds_read_b64_tr_b16 a[76:77], v18 offset:6144
  ds_read_b64_tr_b16 a[78:79], v18 offset:6272
  ds_read_b64_tr_b16 a[80:81], v18 offset:8192
  ds_read_b64_tr_b16 a[82:83], v18 offset:8320
  ds_read_b64_tr_b16 a[84:85], v18 offset:10240
  ds_read_b64_tr_b16 a[86:87], v18 offset:10368
  ds_read_b64_tr_b16 a[88:89], v18 offset:12288
  ds_read_b64_tr_b16 a[90:91], v18 offset:12416
  ds_read_b64_tr_b16 a[92:93], v18 offset:14336
  ds_read_b64_tr_b16 a[94:95], v18 offset:14464
  ds_read_b64_tr_b16 a[96:97], v18 offset:32
  ds_read_b64_tr_b16 a[98:99], v18 offset:160
  ds_read_b64_tr_b16 a[100:101], v18 offset:2080
  ds_read_b64_tr_b16 a[102:103], v18 offset:2208
  ds_read_b64_tr_b16 a[104:105], v18 offset:4128
  ds_read_b64_tr_b16 a[106:107], v18 offset:4256
  ds_read_b64_tr_b16 a[108:109], v18 offset:6176
  ds_read_b64_tr_b16 a[110:111], v18 offset:6304
  ds_read_b64_tr_b16 a[112:113], v18 offset:8224
  ds_read_b64_tr_b16 a[114:115], v18 offset:8352
  ds_read_b64_tr_b16 a[116:117], v18 offset:10272
  ds_read_b64_tr_b16 a[118:119], v18 offset:10400
  ds_read_b64_tr_b16 a[120:121], v18 offset:12320
  ds_read_b64_tr_b16 a[122:123], v18 offset:12448
  ds_read_b64_tr_b16 a[124:125], v18 offset:14368
  ds_read_b64_tr_b16 a[126:127], v18 offset:14496
  s_waitcnt lgkmcnt(0)
  s_add_u32 s53, s52, 0
  s_mov_b32 s54, 0
  s_mov_b32 m0, s53
  s_add_u32 s53, s53, 1024
  buffer_load_dwordx4 v16, s[12:15], s54 offen lds
  s_add_u32 s54, s54, 131072
  s_mov_b32 m0, s53
  s_add_u32 s53, s53, 1024
  buffer_load_dwordx4 v16, s[12:15], s54 offen lds
  s_add_u32 s54, s54, 131072
  s_mov_b32 m0, s53
  s_add_u32 s53, s53, 1024
  buffer_load_dwordx4 v16, s[12:15], s54 offen lds
  s_add_u32 s54, s54, 131072
  s_mov_b32 m0, s53
  s_add_u32 s53, s53, 1024
  buffer_load_dwordx4 v16, s[12:15], s54 offen lds
  s_add_u32 s54, s54, 131072
  s_mov_b32 m0, s53
  s_add_u32 s53, s53, 1024
  buffer_load_dwordx4 v16, s[12:15], s54 offen lds
  s_add_u32 s54, s54, 131072
  s_mov_b32 m0, s53
  s_add_u32 s53, s53, 1024
  buffer_load_dwordx4 v16, s[12:15], s54 offen lds
  s_add_u32 s54, s54, 131072
  s_mov_b32 m0, s53
  s_add_u32 s53, s53, 1024
  buffer_load_dwordx4 v16, s[12:15], s54 offen lds
  s_add_u32 s54, s54, 131072
  s_mov_b32 m0, s53
  s_add_u32 s53, s53, 1024
  buffer_load_dwordx4 v16, s[12:15], s54 offen lds
  s_add_u32 s54, s54, 131072
  s_mov_b32 m0, s53
  s_add_u32 s53, s53, 1024
  buffer_load_dwordx4 v16, s[12:15], s54 offen lds
  s_add_u32 s54, s54, 131072
  s_mov_b32 m0, s53
  s_add_u32 s53, s53, 1024
  buffer_load_dwordx4 v16, s[12:15], s54 offen lds
  s_add_u32 s54, s54, 131072
  s_mov_b32 m0, s53
  s_add_u32 s53, s53, 1024
  buffer_load_dwordx4 v16, s[12:15], s54 offen lds
  s_add_u32 s54, s54, 131072
  s_mov_b32 m0, s53
  s_add_u32 s53, s53, 1024
  buffer_load_dwordx4 v16, s[12:15], s54 offen lds
  s_add_u32 s54, s54, 131072
  s_mov_b32 m0, s53
  s_add_u32 s53, s53, 1024
  buffer_load_dwordx4 v16, s[12:15], s54 offen lds
  s_add_u32 s54, s54, 131072
  s_mov_b32 m0, s53
  s_add_u32 s53, s53, 1024
  buffer_load_dwordx4 v16, s[12:15], s54 offen lds
  s_add_u32 s54, s54, 131072
  s_mov_b32 m0, s53
  s_add_u32 s53, s53, 1024
  buffer_load_dwordx4 v16, s[12:15], s54 offen lds
  s_add_u32 s54, s54, 131072
  s_mov_b32 m0, s53
  s_add_u32 s53, s53, 1024
  buffer_load_dwordx4 v16, s[12:15], s54 offen lds
  s_add_u32 s54, s54, 131072
  s_waitcnt vmcnt(16)
  ds_read_b64_tr_b16 a[128:129], v18 offset:16384
  ds_read_b64_tr_b16 a[130:131], v18 offset:16512
  ds_read_b64_tr_b16 a[132:133], v18 offset:18432
  ds_read_b64_tr_b16 a[134:135], v18 offset:18560
  ds_read_b64_tr_b16 a[136:137], v18 offset:20480
  ds_read_b64_tr_b16 a[138:139], v18 offset:20608
  ds_read_b64_tr_b16 a[140:141], v18 offset:22528
  ds_read_b64_tr_b16 a[142:143], v18 offset:22656
  ds_read_b64_tr_b16 a[144:145], v18 offset:24576
  ds_read_b64_tr_b16 a[146:147], v18 offset:24704
  ds_read_b64_tr_b16 a[148:149], v18 offset:26624
  ds_read_b64_tr_b16 a[150:151], v18 offset:26752
  ds_read_b64_tr_b16 a[152:153], v18 offset:28672
  ds_read_b64_tr_b16 a[154:155], v18 offset:28800
  ds_read_b64_tr_b16 a[156:157], v18 offset:30720
  ds_read_b64_tr_b16 a[158:159], v18 offset:30848
  ds_read_b64_tr_b16 a[160:161], v18 offset:16416
  ds_read_b64_tr_b16 a[162:163], v18 offset:16544
  ds_read_b64_tr_b16 a[164:165], v18 offset:18464
  ds_read_b64_tr_b16 a[166:167], v18 offset:18592
  ds_read_b64_tr_b16 a[168:169], v18 offset:20512
  ds_read_b64_tr_b16 a[170:171], v18 offset:20640
  ds_read_b64_tr_b16 a[172:173], v18 offset:22560
  ds_read_b64_tr_b16 a[174:175], v18 offset:22688
  ds_read_b64_tr_b16 a[176:177], v18 offset:24608
  ds_read_b64_tr_b16 a[178:179], v18 offset:24736
  ds_read_b64_tr_b16 a[180:181], v18 offset:26656
  ds_read_b64_tr_b16 a[182:183], v18 offset:26784
  ds_read_b64_tr_b16 a[184:185], v18 offset:28704
  ds_read_b64_tr_b16 a[186:187], v18 offset:28832
  ds_read_b64_tr_b16 a[188:189], v18 offset:30752
  ds_read_b64_tr_b16 a[190:191], v18 offset:30880
  s_waitcnt lgkmcnt(0)
  s_add_u32 s53, s52, 16384
  s_mov_b32 s54, 0
  s_mov_b32 m0, s53
  s_add_u32 s53, s53, 1024
  buffer_load_dwordx4 v17, s[24:27], s54 offen lds
  s_add_u32 s54, s54, 16384
  s_mov_b32 m0, s53
  s_add_u32 s53, s53, 1024
  buffer_load_dwordx4 v17, s[24:27], s54 offen lds
  s_add_u32 s54, s54, 16384
  s_mov_b32 m0, s53
  s_add_u32 s53, s53, 1024
  buffer_load_dwordx4 v17, s[24:27], s54 offen lds
  s_add_u32 s54, s54, 16384
  s_mov_b32 m0, s53
  s_add_u32 s53, s53, 1024
  buffer_load_dwordx4 v17, s[24:27], s54 offen lds
  s_add_u32 s54, s54, 16384
  s_mov_b32 m0, s53
  s_add_u32 s53, s53, 1024
  buffer_load_dwordx4 v17, s[24:27], s54 offen lds
  s_add_u32 s54, s54, 16384
  s_mov_b32 m0, s53
  s_add_u32 s53, s53, 1024
  buffer_load_dwordx4 v17, s[24:27], s54 offen lds
  s_add_u32 s54, s54, 16384
  s_mov_b32 m0, s53
  s_add_u32 s53, s53, 1024
  buffer_load_dwordx4 v17, s[24:27], s54 offen lds
  s_add_u32 s54, s54, 16384
  s_mov_b32 m0, s53
  s_add_u32 s53, s53, 1024
  buffer_load_dwordx4 v17, s[24:27], s54 offen lds
  s_add_u32 s54, s54, 16384
  s_mov_b32 m0, s53
  s_add_u32 s53, s53, 1024
  buffer_load_dwordx4 v17, s[24:27], s54 offen lds
  s_add_u32 s54, s54, 16384
  s_mov_b32 m0, s53
  s_add_u32 s53, s53, 1024
  buffer_load_dwordx4 v17, s[24:27], s54 offen lds
  s_add_u32 s54, s54, 16384
  s_mov_b32 m0, s53
  s_add_u32 s53, s53, 1024
  buffer_load_dwordx4 v17, s[24:27], s54 offen lds
  s_add_u32 s54, s54, 16384
  s_mov_b32 m0, s53
  s_add_u32 s53, s53, 1024
  buffer_load_dwordx4 v17, s[24:27], s54 offen lds
  s_add_u32 s54, s54, 16384
  s_mov_b32 m0, s53
  s_add_u32 s53, s53, 1024
  buffer_load_dwordx4 v17, s[24:27], s54 offen lds
  s_add_u32 s54, s54, 16384
  s_mov_b32 m0, s53
  s_add_u32 s53, s53, 1024
  buffer_load_dwordx4 v17, s[24:27], s54 offen lds
  s_add_u32 s54, s54, 16384
  s_mov_b32 m0, s53
  s_add_u32 s53, s53, 1024
  buffer_load_dwordx4 v17, s[24:27], s54 offen lds
  s_add_u32 s54, s54, 16384
  s_mov_b32 m0, s53
  s_add_u32 s53, s53, 1024
  buffer_load_dwordx4 v17, s[24:27], s54 offen lds
  s_add_u32 s54, s54, 16384
  s_waitcnt vmcnt(16)
  ds_read_b64_tr_b16 a[0:1], v18 offset:0
  ds_read_b64_tr_b16 a[2:3], v18 offset:128
  ds_read_b64_tr_b16 a[4:5], v18 offset:2048
  ds_read_b64_tr_b16 a[6:7], v18 offset:2176
  ds_read_b64_tr_b16 a[8:9], v18 offset:4096
  ds_read_b64_tr_b16 a[10:11], v18 offset:4224
  ds_read_b64_tr_b16 a[12:13], v18 offset:6144
  ds_read_b64_tr_b16 a[14:15], v18 offset:6272
  ds_read_b64_tr_b16 a[16:17], v18 offset:8192
  ds_read_b64_tr_b16 a[18:19], v18 offset:8320
  ds_read_b64_tr_b16 a[20:21], v18 offset:10240
  ds_read_b64_tr_b16 a[22:23], v18 offset:10368
  ds_read_b64_tr_b16 a[24:25], v18 offset:12288
  ds_read_b64_tr_b16 a[26:27], v18 offset:12416
  ds_read_b64_tr_b16 a[28:29], v18 offset:14336
  ds_read_b64_tr_b16 a[30:31], v18 offset:14464
  ds_read_b64_tr_b16 a[32:33], v18 offset:32
  ds_read_b64_tr_b16 a[34:35], v18 offset:160
  ds_read_b64_tr_b16 a[36:37], v18 offset:2080
  ds_read_b64_tr_b16 a[38:39], v18 offset:2208
  ds_read_b64_tr_b16 a[40:41], v18 offset:4128
  ds_read_b64_tr_b16 a[42:43], v18 offset:4256
  ds_read_b64_tr_b16 a[44:45], v18 offset:6176
  ds_read_b64_tr_b16 a[46:47], v18 offset:6304
  ds_read_b64_tr_b16 a[48:49], v18 offset:8224
  ds_read_b64_tr_b16 a[50:51], v18 offset:8352
  ds_read_b64_tr_b16 a[52:53], v18 offset:10272
  ds_read_b64_tr_b16 a[54:55], v18 offset:10400
  ds_read_b64_tr_b16 a[56:57], v18 offset:12320
  ds_read_b64_tr_b16 a[58:59], v18 offset:12448
  ds_read_b64_tr_b16 a[60:61], v18 offset:14368
  ds_read_b64_tr_b16 a[62:63], v18 offset:14496
  s_waitcnt vmcnt(0)
  ds_read_b64_tr_b16 a[192:193], v19 offset:0
  ds_read_b64_tr_b16 a[194:195], v19 offset:256
  ds_read_b64_tr_b16 a[196:197], v19 offset:1024
  ds_read_b64_tr_b16 a[198:199], v19 offset:1280
  ds_read_b64_tr_b16 a[200:201], v19 offset:8192
  ds_read_b64_tr_b16 a[202:203], v19 offset:8448
  ds_read_b64_tr_b16 a[204:205], v19 offset:9216
  ds_read_b64_tr_b16 a[206:207], v19 offset:9472
  ds_read_b64_tr_b16 a[208:209], v19 offset:32
  ds_read_b64_tr_b16 a[210:211], v19 offset:288
  ds_read_b64_tr_b16 a[212:213], v19 offset:1056
  ds_read_b64_tr_b16 a[214:215], v19 offset:1312
  ds_read_b64_tr_b16 a[216:217], v19 offset:8224
  ds_read_b64_tr_b16 a[218:219], v19 offset:8480
  ds_read_b64_tr_b16 a[220:221], v19 offset:9248
  ds_read_b64_tr_b16 a[222:223], v19 offset:9504
  ds_read_b64_tr_b16 a[224:225], v19 offset:64
  ds_read_b64_tr_b16 a[226:227], v19 offset:320
  ds_read_b64_tr_b16 a[228:229], v19 offset:1088
  ds_read_b64_tr_b16 a[230:231], v19 offset:1344
  ds_read_b64_tr_b16 a[232:233], v19 offset:8256
  ds_read_b64_tr_b16 a[234:235], v19 offset:8512
  ds_read_b64_tr_b16 a[236:237], v19 offset:9280
  ds_read_b64_tr_b16 a[238:239], v19 offset:9536
  ds_read_b64_tr_b16 a[240:241], v19 offset:96
  ds_read_b64_tr_b16 a[242:243], v19 offset:352
  ds_read_b64_tr_b16 a[244:245], v19 offset:1120
  ds_read_b64_tr_b16 a[246:247], v19 offset:1376
  ds_read_b64_tr_b16 a[248:249], v19 offset:8288
  ds_read_b64_tr_b16 a[250:251], v19 offset:8544
  ds_read_b64_tr_b16 a[252:253], v19 offset:9312
  ds_read_b64_tr_b16 a[254:255], v19 offset:9568
  s_waitcnt lgkmcnt(0)
  s_barrier
  s_cmp_lg_u32 s77, 0
  s_cbranch_scc1 L_cw_w
  v_mov_b32 v24, 0x1000
  s_add_u32 s40, s29, s30
  s_add_u32 s40, s40, s97
  s_cmp_lg_u32 s40, 0
  s_cselect_b32 s41, 1, 0
  s_cmp_lg_u32 s97, 0
  s_cbranch_scc1 L_cw_nt
  v_mov_b32 v4, 192
  v_mov_b32 v2, s41
  s_mov_b64 exec, 1
  global_atomic_add v24, v4, v2, s[90:91] sc0 sc1
  s_mov_b64 exec, -1
  s_cmp_lg_u32 s41, 0
  s_cbranch_scc1 L_cw_nt
  s_waitcnt vmcnt(0)
  v_mov_b32 v24, 0x1000
L_cw_nt:
  v_and_b32 v19, 7, v0
  v_lshlrev_b32 v19, 3, v19
  s_add_u32 s40, s97, 64
  v_mov_b32 v23, s40
  global_load_dwordx2 v[20:21], v19, s[90:91] offset:0 sc1
  global_load_dword v22, v23, s[90:91] sc1
  s_waitcnt vmcnt(0)
  s_mov_b32 s99, 400000
  s_cmp_lg_u32 s97, 0
  s_cbranch_scc1 L_cw_go
L_cw_v:
  v_sad_u8 v18, v20, 0, 0
  v_sad_u8 v18, v21, 0, v18
  s_mov_b64 exec, 0xff
  v_cmp_ne_u32 vcc, 32, v18
  s_mov_b64 exec, -1
  s_cbranch_vccz L_cw_vd
  s_sub_u32 s99, s99, 1
  s_cbranch_scc1 L_cw_to
  global_load_dwordx2 v[20:21], v19, s[90:91] offset:0 sc1
  s_waitcnt vmcnt(0)
  s_branch L_cw_v
L_cw_vd:
  v_readlane_b32 s40, v20, 0
  v_readlane_b32 s41, v21, 0
  s_mov_b32 s42, s40
  s_mov_b32 s43, s41
  v_readlane_b32 s40, v20, 1
  v_readlane_b32 s41, v21, 1
  s_or_b32 s42, s42, s40
  s_or_b32 s43, s43, s41
  v_readlane_b32 s40, v20, 2
  v_readlane_b32 s41, v21, 2
  s_or_b32 s42, s42, s40
  s_or_b32 s43, s43, s41
  v_readlane_b32 s40, v20, 3
  v_readlane_b32 s41, v21, 3
  s_or_b32 s42, s42, s40
  s_or_b32 s43, s43, s41
  v_readlane_b32 s40, v20, 4
  v_readlane_b32 s41, v21, 4
  s_or_b32 s42, s42, s40
  s_or_b32 s43, s43, s41
  v_readlane_b32 s40, v20, 5
  v_readlane_b32 s41, v21, 5
  s_or_b32 s42, s42, s40
  s_or_b32 s43, s43, s41
  v_readlane_b32 s40, v20, 6
  v_readlane_b32 s41, v21, 6
  s_or_b32 s42, s42, s40
  s_or_b32 s43, s43, s41
  v_readlane_b32 s40, v20, 7
  v_readlane_b32 s41, v21, 7
  s_or_b32 s42, s42, s40
  s_or_b32 s43, s43, s41
  s_cmp_eq_u32 s42, 538976288
  s_cselect_b32 s40, 1, 0
  s_cmp_eq_u32 s43, 0x20202020
  s_cselect_b32 s40, s40, 0
  s_cmp_eq_u32 s40, 0
  s_cbranch_scc0 L_cw_go
  v_mov_b32 v18, -2
  s_branch L_cw_f
L_cw_go:
  v_readfirstlane_b32 s40, v22
  s_nop 0

  s_cmp_lg_u32 s40, 0
  s_cbranch_scc1 L_cw_ok
  s_sub_u32 s99, s99, 1
  s_cbranch_scc1 L_cw_to

  global_load_dword v22, v23, s[90:91] sc1
  s_waitcnt vmcnt(0)
  s_branch L_cw_go
L_cw_to:
  v_mov_b32 v18, -1
  s_branch L_cw_f
L_cw_ok:
  v_mov_b32 v18, 0
  s_lshl_b32 s40, s29, 7
  s_add_u32 s40, s40, 117450880
  v_mov_b32 v1, s40
  v_mov_b32 v2, 1
  s_mov_b64 exec, 1
  buffer_atomic_add v2, v1, s[4:7], 0 offen sc1
  s_mov_b64 exec, -1

L_cw_f:
  v_readfirstlane_b32 s40, v24
  v_mov_b32 v16, 131072
  s_nop 0
  v_mov_b32 v19, s40
  ds_write_b32 v16, v18 offset:8
  ds_write_b32 v16, v19 offset:12
  s_waitcnt lgkmcnt(0)
L_cw_w:
  s_barrier
  v_mov_b32 v16, 131072
  ds_read_b32 v17, v16 offset:8
  ds_read_b32 v19, v16 offset:12
  s_waitcnt lgkmcnt(0)
  v_readfirstlane_b32 s40, v17
  s_nop 0
  s_cmp_eq_u32 s40, -1
  s_cbranch_scc1 L_fail
  s_cmp_eq_u32 s40, -2
  s_cbranch_scc1 L_round2
L_centry:
  s_mov_b32 s28, s77
  s_mov_b32 s29, s94
  s_mov_b32 s30, s93
  s_load_dwordx2 s[64:65], s[0:1], 8
  s_mov_b32 s42, 0
  s_waitcnt lgkmcnt(0)
  s_add_u32 s50, s4, 100663296
  s_addc_u32 s51, s5, 0
  s_sub_u32 s52, 0, s50
  s_and_b32 s52, s52, 0x3fffff
  s_add_u32 s50, s50, s52
  s_addc_u32 s51, s51, 0
  s_mov_b32 s8, s50
  s_mov_b32 s9, s51
  s_mov_b32 s10, 0x400000
  s_mov_b32 s11, 0x20000
  s_mov_b32 s12, s64
  s_mov_b32 s13, s65
  s_mov_b32 s14, 0x4000
  s_mov_b32 s15, 0x20000
  s_lshr_b32 s50, s30, 2
  s_and_b32 s51, s30, 3
  s_lshr_b32 s52, s30, 4
  s_and_b32 s43, s30, 15
  s_lshl_b32 s53, s52, 2
  s_add_u32 s53, s53, s28
  s_lshl_b32 s54, s29, 3
  s_add_u32 s55, s54, s53
  s_add_u32 s54, s54, s50
  s_lshl_b32 s56, s29, 1
  s_add_u32 s56, s56, s52
  s_lshl_b32 s58, s28, 12
  v_mov_b32 v1, 0
  v_bfe_u32 v255, v0, 5, 1
  v_lshl_add_u32 v1, v255, 9, v1
  v_bfe_u32 v255, v0, 2, 2
  v_lshl_add_u32 v1, v255, 7, v1
  v_bfe_u32 v255, v0, 0, 1
  v_lshl_add_u32 v1, v255, 6, v1
  v_bfe_u32 v255, v0, 4, 1
  v_lshl_add_u32 v1, v255, 5, v1
  v_bfe_u32 v255, v0, 1, 1
  v_lshl_add_u32 v1, v255, 4, v1
  v_add_u32 v1, s58, v1
  s_lshl_b32 s58, s29, 14
  s_lshl_b32 s59, s30, 9
  s_add_u32 s58, s58, s59
  s_lshl_b32 s59, s28, 7
  s_add_u32 s58, s58, s59
  v_mov_b32 v2, 0x300000
  v_bfe_u32 v255, v0, 4, 1
  v_lshl_add_u32 v2, v255, 6, v2
  v_bfe_u32 v255, v0, 0, 4
  v_lshl_add_u32 v2, v255, 2, v2
  v_bfe_u32 v255, v0, 5, 1
  v_lshl_add_u32 v2, v255, 17, v2
  v_add_u32 v2, s58, v2
  s_lshl_b32 s58, s29, 16
  s_mul_i32 s59, s53, 6144
  s_add_u32 s58, s58, s59
  v_mov_b32 v3, 0
  v_bfe_u32 v255, v0, 1, 1
  v_lshl_add_u32 v3, v255, 11, v3
  v_bfe_u32 v255, v0, 2, 2
  v_lshl_add_u32 v3, v255, 7, v3
  v_bfe_u32 v255, v0, 0, 1
  v_lshl_add_u32 v3, v255, 6, v3
  v_bfe_u32 v255, v0, 4, 2
  v_lshl_add_u32 v3, v255, 4, v3
  v_add_u32 v3, s58, v3
  v_mov_b32 v4, 0x1000
  v_bfe_u32 v255, v0, 0, 6
  v_lshl_add_u32 v4, v255, 3, v4
  v_add_u32 v4, s58, v4
  s_lshl_b32 s58, s29, 16
  s_mul_i32 s59, s50, 6144
  s_add_u32 s58, s58, s59
  s_cmp_eq_u32 s28, 3
  s_cselect_b32 s59, 0, s28
  s_lshl_b32 s59, s59, 11
  s_add_u32 s58, s58, s59
  s_lshl_b32 s59, s51, 9
  s_add_u32 s58, s58, s59
  v_mov_b32 v5, 0
  v_bfe_u32 v255, v0, 0, 6
  v_lshl_add_u32 v5, v255, 3, v5
  v_add_u32 v5, s58, v5
  s_lshl_b32 s58, s43, 14
  s_lshl_b32 s59, s42, 13
  s_add_u32 s58, s58, s59
  s_lshl_b32 s59, s56, 9
  s_add_u32 s58, s58, s59
  s_lshl_b32 s59, s28, 7
  s_add_u32 s58, s58, s59
  v_mov_b32 v6, 0
  v_bfe_u32 v255, v0, 4, 1
  v_lshl_add_u32 v6, v255, 12, v6
  v_bfe_u32 v255, v0, 5, 1
  v_lshl_add_u32 v6, v255, 6, v6
  v_bfe_u32 v255, v0, 0, 4
  v_lshl_add_u32 v6, v255, 2, v6
  v_add_u32 v6, s58, v6
  s_lshr_b32 s58, s30, 1
  s_lshl_b32 s58, s58, 14
  s_lshl_b32 s59, s42, 13
  s_add_u32 s58, s58, s59
  s_and_b32 s59, s30, 1
  s_lshl_b32 s59, s59, 12
  s_add_u32 s58, s58, s59
  s_lshl_b32 s59, s28, 7
  s_add_u32 s58, s58, s59
  v_mov_b32 v7, 0
  v_bfe_u32 v255, v0, 5, 1
  v_lshl_add_u32 v7, v255, 11, v7
  v_bfe_u32 v255, v0, 4, 1
  v_lshl_add_u32 v7, v255, 6, v7
  v_bfe_u32 v255, v0, 0, 4
  v_lshl_add_u32 v7, v255, 2, v7
  v_add_u32 v7, s58, v7
  s_lshl_b32 s58, s55, 13
  v_mov_b32 v8, 0x1800000
  v_bfe_u32 v255, v0, 0, 6
  v_lshl_add_u32 v8, v255, 4, v8
  v_add_u32 v8, s58, v8
  v_add_u32 v9, 4096, v8
  v_mov_b32 v10, 0x2800000
  v_bfe_u32 v255, v0, 0, 6
  v_lshl_add_u32 v10, v255, 4, v10
  v_add_u32 v10, s58, v10
  v_add_u32 v11, 4096, v10
  s_lshl_b32 s58, s55, 13
  s_lshl_b32 s59, s43, 9
  s_add_u32 s58, s58, s59
  v_mov_b32 v159, 0x1880000
  v_bfe_u32 v255, v0, 0, 3
  v_lshl_add_u32 v159, v255, 6, v159
  v_add_u32 v159, s58, v159
  v_bfe_u32 v255, v0, 3, 1
  v_mul_u32_u24 v255, 64512, v255
  v_lshl_add_u32 v159, v255, 8, v159
  s_lshl_b32 s58, s55, 11
  v_mov_b32 v246, 0x5800000
  v_bfe_u32 v255, v0, 2, 2
  v_lshl_add_u32 v246, v255, 7, v246
  v_bfe_u32 v255, v0, 0, 1
  v_lshl_add_u32 v246, v255, 6, v246
  v_bfe_u32 v255, v0, 4, 2
  v_lshl_add_u32 v246, v255, 4, v246
  v_add_u32 v246, s58, v246
  v_mov_b32 v247, 0x5c00000
  v_bfe_u32 v255, v0, 0, 6
  v_lshl_add_u32 v247, v255, 3, v247
  v_add_u32 v247, s58, v247
  s_mul_i32 s58, s28, 3584
  v_mov_b32 v13, 0
  v_bfe_u32 v255, v0, 4, 2
  v_lshl_add_u32 v13, v255, 8, v13
  v_bfe_u32 v255, v0, 4, 2
  v_lshl_add_u32 v13, v255, 6, v13
  v_bfe_u32 v255, v0, 0, 4
  v_lshl_add_u32 v13, v255, 2, v13
  v_add_u32 v13, s58, v13
  v_add_u32 v158, 1280, v13
  v_mov_b32 v14, 0xa00
  v_bfe_u32 v255, v0, 0, 6
  v_lshl_add_u32 v14, v255, 4, v14
  v_add_u32 v14, s58, v14
  s_mul_i32 s58, s28, 1280
  v_mov_b32 v15, 0
  v_bfe_u32 v255, v0, 3, 3
  v_lshl_add_u32 v15, v255, 7, v15
  v_bfe_u32 v255, v0, 3, 3
  v_lshl_add_u32 v15, v255, 5, v15
  v_bfe_u32 v255, v0, 0, 3
  v_lshl_add_u32 v15, v255, 4, v15
  v_add_u32 v15, s58, v15
  v_mov_b32 v250, 0xa00
  v_bfe_u32 v255, v0, 0, 6
  v_lshl_add_u32 v250, v255, 4, v250
  s_cmp_eq_u32 s28, 2
  s_cselect_b64 vcc, -1, 0
  v_cndmask_b32 v15, v15, v250, vcc
  s_mul_i32 s58, s28, 2304
  v_mov_b32 v244, 0x4000
  v_bfe_u32 v255, v0, 4, 2
  v_lshl_add_u32 v244, v255, 9, v244
  v_bfe_u32 v255, v0, 4, 2
  v_lshl_add_u32 v244, v255, 6, v244
  v_bfe_u32 v255, v0, 0, 4
  v_lshl_add_u32 v244, v255, 2, v244
  v_add_u32 v244, s58, v244
  s_mul_i32 s58, s28, 576
  v_mov_b32 v245, 0x4000
  v_bfe_u32 v255, v0, 5, 1
  v_lshl_add_u32 v245, v255, 8, v245
  v_bfe_u32 v255, v0, 5, 1
  v_lshl_add_u32 v245, v255, 5, v245
  v_bfe_u32 v255, v0, 0, 5
  v_lshl_add_u32 v245, v255, 3, v245
  v_add_u32 v245, s58, v245
  v_bfe_u32 v250, v0, 1, 1
  v_cmp_eq_u32 vcc, 1, v250
  v_mov_b32 v12, 0x44444444
  v_mov_b32 v250, 0xeeeeeeee
  s_nop 1
  v_cndmask_b32 v12, v12, v250, vcc
  v_cmp_le_u32 vcc, 32, v0
  v_mov_b32 v251, -1
  v_mov_b32 v250, 0
  v_mov_b32 v149, 0
  v_mov_b32 v150, 0
  s_nop 1
  v_mov_b32 v240, -1
  v_mov_b32 v144, 0x3f803f80
  v_mov_b32 v241, -1
  v_mov_b32 v145, 0x3f803f80
  v_mov_b32 v242, -1
  v_mov_b32 v146, 0x3f803f80
  v_mov_b32 v243, -1
  v_mov_b32 v147, 0x3f803f80
  v_cndmask_b32 v248, v250, v251, vcc
  v_mov_b32 v249, 0xfffffffe
  v_cndmask_b32 v249, v249, v251, vcc
  s_mov_b32 s41, 0x3e0293ee
  s_mov_b32 s46, 0xcccccccc
  s_mov_b32 s47, 0xcccccccc
  s_mov_b32 s44, 0x33333333
  s_mov_b32 s45, 0x33333333
  s_cmp_eq_u32 s95, 2
  s_cbranch_scc1 L_chain_g
  s_branch L_chain_l
L_chain_l:
  s_mov_b32 s48, 0
  s_add_u32 s50, s29, s30
  s_cmp_lg_u32 s50, 0
  s_cbranch_scc1 LL_np
  s_cmp_eq_u32 s28, 2
  s_cselect_b32 s48, 1, 0
LL_np:
  s_add_u32 s50, s29, s30
  s_add_u32 s50, s50, s28
  s_cmp_lg_u32 s50, 0
  s_cbranch_scc1 LL_npr
  s_mov_b64 exec, 1
  s_mov_b32 s56, -1
  s_mov_b32 s57, -1
  s_waitcnt vmcnt(0)
  s_mov_b32 s51, 835584
  s_memtime s[52:53]
  s_waitcnt lgkmcnt(0)
  buffer_store_dword v240, off, s[8:11], s51 sc1
  s_waitcnt vmcnt(0)
  s_memtime s[54:55]
  s_waitcnt lgkmcnt(0)
  s_sub_u32 s54, s54, s52
  s_min_u32 s56, s56, s54
  s_mov_b32 s51, 843776
  s_memtime s[52:53]
  s_waitcnt lgkmcnt(0)
  buffer_store_dword v240, off, s[8:11], s51 sc1
  s_waitcnt vmcnt(0)
  s_memtime s[54:55]
  s_waitcnt lgkmcnt(0)
  s_sub_u32 s54, s54, s52
  s_min_u32 s57, s57, s54
  s_mov_b32 s51, 901120
  s_memtime s[52:53]
  s_waitcnt lgkmcnt(0)
  buffer_store_dword v240, off, s[8:11], s51 sc1
  s_waitcnt vmcnt(0)
  s_memtime s[54:55]
  s_waitcnt lgkmcnt(0)
  s_sub_u32 s54, s54, s52
  s_min_u32 s56, s56, s54
  s_mov_b32 s51, 909312
  s_memtime s[52:53]
  s_waitcnt lgkmcnt(0)
  buffer_store_dword v240, off, s[8:11], s51 sc1
  s_waitcnt vmcnt(0)
  s_memtime s[54:55]
  s_waitcnt lgkmcnt(0)
  s_sub_u32 s54, s54, s52
  s_min_u32 s57, s57, s54
  s_mov_b32 s51, 966656
  s_memtime s[52:53]
  s_waitcnt lgkmcnt(0)
  buffer_store_dword v240, off, s[8:11], s51 sc1
  s_waitcnt vmcnt(0)
  s_memtime s[54:55]
  s_waitcnt lgkmcnt(0)
  s_sub_u32 s54, s54, s52
  s_min_u32 s56, s56, s54
  s_mov_b32 s51, 974848
  s_memtime s[52:53]
  s_waitcnt lgkmcnt(0)
  buffer_store_dword v240, off, s[8:11], s51 sc1
  s_waitcnt vmcnt(0)
  s_memtime s[54:55]
  s_waitcnt lgkmcnt(0)
  s_sub_u32 s54, s54, s52
  s_min_u32 s57, s57, s54
  s_mov_b32 s51, 1032192
  s_memtime s[52:53]
  s_waitcnt lgkmcnt(0)
  buffer_store_dword v240, off, s[8:11], s51 sc1
  s_waitcnt vmcnt(0)
  s_memtime s[54:55]
  s_waitcnt lgkmcnt(0)
  s_sub_u32 s54, s54, s52
  s_min_u32 s56, s56, s54
  s_mov_b32 s51, 1040384
  s_memtime s[52:53]
  s_waitcnt lgkmcnt(0)
  buffer_store_dword v240, off, s[8:11], s51 sc1
  s_waitcnt vmcnt(0)
  s_memtime s[54:55]
  s_waitcnt lgkmcnt(0)
  s_sub_u32 s54, s54, s52
  s_min_u32 s57, s57, s54
  s_cmp_lt_u32 s57, s56
  s_cselect_b32 s56, 2, 1
  s_mov_b32 s51, 117450752
  v_mov_b32 v17, s56
  buffer_store_dword v17, off, s[4:7], s51 sc1
  s_mov_b64 exec, -1
LL_npr:
  s_cmp_lg_u32 s28, 0
  s_cbranch_scc1 LL_kvw
  v_lshlrev_b32 v252, 7, v0
  v_mov_b32 v16, 32
  v_cmp_eq_u32 vcc, 4, v0
  s_mov_b32 s49, 117450240
  s_mov_b32 s40, 100000
  v_cndmask_b32 v16, v16, 1, vcc

  s_mov_b64 exec, 0x1ff
LL_kv0:

  buffer_load_dword v253, v252, s[4:7], s49 offen sc1
  s_waitcnt vmcnt(0)
  v_cmp_gt_u32 vcc, v16, v253
  s_cbranch_vccz LL_kv0ok
  s_sub_u32 s40, s40, 1
  s_cbranch_scc0 LL_kv0
  v_mov_b32 v253, 0
LL_kv0ok:
  s_mov_b64 exec, -1
  v_readlane_b32 s50, v253, 4
  v_mov_b32 v16, 131072
  s_nop 0
  v_mov_b32 v17, s50
  ds_write_b32 v16, v17 offset:24
  s_waitcnt lgkmcnt(0)
LL_kvw:
  s_barrier
  v_mov_b32 v16, 131072
  ds_read_b32 v17, v16 offset:24
  s_waitcnt lgkmcnt(0)
  v_readfirstlane_b32 s50, v17
  s_nop 0
  s_cmp_eq_u32 s50, 0
  s_cbranch_scc1 L_fail
  s_sub_u32 s50, s50, 1
  s_and_b32 s50, s50, 1
  s_lshl_b32 s50, s50, 13
  v_add_u32 v6, s50, v6
  v_add_u32 v7, s50, v7
  s_lshl_b32 s50, s30, 6
  s_lshl_b32 s51, s28, 12
  s_add_u32 s50, s50, s51
  v_mov_b32 v251, 0
  v_bfe_u32 v255, v0, 4, 1
  v_lshl_add_u32 v251, v255, 11, v251
  v_bfe_u32 v255, v0, 0, 4
  v_lshl_add_u32 v251, v255, 2, v251
  v_add_u32 v251, s50, v251
  buffer_load_dword v16, v251, s[12:15], 0 offen
  s_mov_b32 s31, 0
  s_mov_b32 s50, 0
  s_waitcnt vmcnt(0)
  v_med3_u32 v16, v16, v248, v249
  buffer_store_dword v16, v2, s[8:11], 0 offen
  buffer_load_dwordx4 v[56:59], v8, s[4:7], s50 offen offset:0
  buffer_load_dwordx4 v[60:63], v8, s[4:7], s50 offen offset:1024
  buffer_load_dwordx4 v[64:67], v8, s[4:7], s50 offen offset:2048
  buffer_load_dwordx4 v[68:71], v8, s[4:7], s50 offen offset:3072
  buffer_load_dwordx4 v[72:75], v9, s[4:7], s50 offen offset:0
  buffer_load_dwordx4 v[76:79], v9, s[4:7], s50 offen offset:1024
  buffer_load_dwordx4 v[80:83], v9, s[4:7], s50 offen offset:2048
  buffer_load_dwordx4 v[84:87], v9, s[4:7], s50 offen offset:3072
LL_step:
  s_and_b32 s50, s31, 3
  s_lshl_b32 s32, s50, 16
  s_lshl_b32 s51, s29, 14
  s_add_u32 s32, s32, s51
  s_add_u32 s32, s32, 3145728
  s_lshl_b32 s33, s50, 18
  s_xor_b32 s34, s33, 524288
  s_add_u32 s33, s33, 2097152
  s_add_u32 s34, s34, 2097152
  s_lshl_b32 s35, s50, 18
  s_xor_b32 s36, s35, 524288
  s_add_u32 s50, s31, 1
  s_and_b32 s50, s50, 3
  s_lshl_b32 s37, s50, 16
  s_lshl_b32 s38, s31, 18

  s_lshl_b32 s39, s31, 16
  v_xor_b32 v252, s37, v2
  v_mov_b32 v32, 0
  v_mov_b32 v33, 0
  v_mov_b32 v34, 0
  v_mov_b32 v35, 0
  v_mov_b32 v36, 0
  v_mov_b32 v37, 0
  v_mov_b32 v38, 0
  v_mov_b32 v39, 0
  v_mov_b32 v40, 0
  v_mov_b32 v41, 0
  v_mov_b32 v42, 0
  v_mov_b32 v43, 0
  v_mov_b32 v44, 0
  v_mov_b32 v45, 0
  v_mov_b32 v46, 0
  v_mov_b32 v47, 0
  v_mov_b32 v48, 0
  v_mov_b32 v49, 0
  v_mov_b32 v50, 0
  v_mov_b32 v51, 0
  v_mov_b32 v52, 0
  v_mov_b32 v53, 0
  v_mov_b32 v54, 0
  v_mov_b32 v55, 0
  s_mov_b32 s40, 200000
  buffer_load_dwordx4 v[16:19], v1, s[8:11], s32 offen offset:0 sc1
  buffer_load_dwordx4 v[20:23], v1, s[8:11], s32 offen offset:1024 sc1
  buffer_load_dwordx4 v[24:27], v1, s[8:11], s32 offen offset:2048 sc1
  buffer_load_dwordx4 v[28:31], v1, s[8:11], s32 offen offset:3072 sc1
  s_waitcnt vmcnt(0)
LL_pa_chk:
  v_max3_u32 v250, v16, v20, v24
  v_max_u32 v250, v250, v28
  v_cmp_eq_u32 vcc, -1, v250
  s_cbranch_vccz LL_pa_ok
  s_waitcnt vmcnt(0)
  v_cmp_eq_u32 s[52:53], -1, v16
  v_cmp_eq_u32 s[54:55], -1, v20
  v_cmp_eq_u32 s[56:57], -1, v24
  v_cmp_eq_u32 s[58:59], -1, v28
  s_mov_b64 exec, s[52:53]
  buffer_load_dwordx4 v[16:19], v1, s[8:11], s32 offen offset:0 sc1
  s_mov_b64 exec, s[54:55]
  buffer_load_dwordx4 v[20:23], v1, s[8:11], s32 offen offset:1024 sc1
  s_mov_b64 exec, s[56:57]
  buffer_load_dwordx4 v[24:27], v1, s[8:11], s32 offen offset:2048 sc1
  s_mov_b64 exec, s[58:59]
  buffer_load_dwordx4 v[28:31], v1, s[8:11], s32 offen offset:3072 sc1
  s_mov_b64 exec, -1
  s_waitcnt vmcnt(0)
  s_sub_u32 s40, s40, 1
  s_cbranch_scc0 LL_pa_chk
  s_branch L_fail
LL_pa_ok:
  s_cmp_eq_u32 s48, 0
  s_cbranch_scc1 LL_npub
  s_sub_u32 s50, s31, 1
  s_max_i32 s50, s50, 0
  v_mov_b32 v254, s50
  s_mov_b32 s49, 117444736
  buffer_store_dword v254, off, s[4:7], s49 sc1
LL_npub:
  s_cmp_lg_u32 s28, 3
  s_cbranch_scc1 LL_nkv
  s_and_b32 s50, s31, 7
  s_cmp_lg_u32 s50, 5
  s_cbranch_scc1 LL_nkv
  s_add_u32 s50, s31, 3
  s_lshr_b32 s50, s50, 3
  s_min_u32 s50, s50, 7
  s_max_u32 s50, s50, 1
  s_lshl_b32 s50, s50, 7
  s_add_u32 s49, s50, 117440512
  buffer_load_dword v253, off, s[4:7], s49 sc1
LL_nkv:
  v_smfmac_f32_16x16x64_bf16 v[32:35], v[16:19], a[0:7], v12
  buffer_load_dwordx4 v[88:91], v10, s[4:7], s38 offen offset:0
  v_smfmac_f32_16x16x64_bf16 v[36:39], v[16:19], a[32:39], v12
  v_smfmac_f32_16x16x64_bf16 v[32:35], v[20:23], a[8:15], v12
  v_smfmac_f32_16x16x64_bf16 v[36:39], v[20:23], a[40:47], v12
  buffer_load_dwordx4 v[92:95], v10, s[4:7], s38 offen offset:1024
  v_smfmac_f32_16x16x64_bf16 v[32:35], v[24:27], a[16:23], v12
  v_smfmac_f32_16x16x64_bf16 v[36:39], v[24:27], a[48:55], v12
  v_smfmac_f32_16x16x64_bf16 v[32:35], v[28:31], a[24:31], v12
  buffer_load_dwordx4 v[96:99], v10, s[4:7], s38 offen offset:2048
  v_smfmac_f32_16x16x64_bf16 v[36:39], v[28:31], a[56:63], v12
  v_smfmac_f32_16x16x64_bf16 v[40:43], v[16:19], a[64:71], v12
  v_smfmac_f32_16x16x64_bf16 v[44:47], v[16:19], a[96:103], v12
  buffer_load_dwordx4 v[100:103], v10, s[4:7], s38 offen offset:3072
  v_smfmac_f32_16x16x64_bf16 v[40:43], v[20:23], a[72:79], v12
  v_smfmac_f32_16x16x64_bf16 v[44:47], v[20:23], a[104:111], v12
  s_nop 3
  v_smfmac_f32_16x16x64_bf16 v[40:43], v[24:27], a[80:87], v12
  v_pk_add_f32 v[32:33], v[32:33], v[34:35]
  v_smfmac_f32_16x16x64_bf16 v[44:47], v[24:27], a[112:119], v12
  buffer_load_dwordx4 v[104:107], v11, s[4:7], s38 offen offset:0
  v_pk_add_f32 v[36:37], v[36:37], v[38:39]
  v_smfmac_f32_16x16x64_bf16 v[40:43], v[28:31], a[88:95], v12
  ds_write2_b32 v13, v32, v36 offset0:0 offset1:16
  v_smfmac_f32_16x16x64_bf16 v[44:47], v[28:31], a[120:127], v12
  ds_write2_b32 v13, v33, v37 offset0:40 offset1:56
  v_smfmac_f32_16x16x64_bf16 v[48:51], v[16:19], a[128:135], v12
  buffer_load_dwordx4 v[108:111], v11, s[4:7], s38 offen offset:1024
  v_smfmac_f32_16x16x64_bf16 v[52:55], v[16:19], a[160:167], v12
  v_smfmac_f32_16x16x64_bf16 v[48:51], v[20:23], a[136:143], v12
  buffer_load_dwordx4 v[112:115], v11, s[4:7], s38 offen offset:2048
  v_smfmac_f32_16x16x64_bf16 v[52:55], v[20:23], a[168:175], v12
  s_nop 3
  v_smfmac_f32_16x16x64_bf16 v[48:51], v[24:27], a[144:151], v12
  v_pk_add_f32 v[40:41], v[40:41], v[42:43]
  v_smfmac_f32_16x16x64_bf16 v[52:55], v[24:27], a[176:183], v12
  buffer_load_dwordx4 v[116:119], v11, s[4:7], s38 offen offset:3072
  v_pk_add_f32 v[44:45], v[44:45], v[46:47]
  v_smfmac_f32_16x16x64_bf16 v[48:51], v[28:31], a[152:159], v12
  ds_write2_b32 v158, v40, v44 offset0:0 offset1:16
  v_smfmac_f32_16x16x64_bf16 v[52:55], v[28:31], a[184:191], v12
  ds_write2_b32 v158, v41, v45 offset0:40 offset1:56
  s_nop 7
  v_pk_add_f32 v[48:49], v[48:49], v[50:51]
  v_pk_add_f32 v[50:51], v[52:53], v[54:55]
  ds_write_b128 v14, v[48:51]
  s_cmp_lg_u32 s28, 3
  s_cbranch_scc1 LL_kvok
  s_and_b32 s50, s31, 7
  s_cmp_lg_u32 s50, 5
  s_cbranch_scc1 LL_kvok
  s_waitcnt vmcnt(8)
  s_mov_b32 s40, 100000
LL_kvp:
  v_readfirstlane_b32 s50, v253
  s_nop 0
  s_cmp_ge_u32 s50, 64
  s_cbranch_scc1 LL_kvok
  buffer_load_dword v253, off, s[4:7], s49 sc1
  s_waitcnt vmcnt(0)
  s_sub_u32 s40, s40, 1
  s_cbranch_scc0 LL_kvp
  s_branch L_fail
LL_kvok:
  s_waitcnt lgkmcnt(0)
  s_barrier
  s_cmp_eq_u32 s31, 63
  s_cbranch_scc1 LL_last
  s_cmp_eq_u32 s28, 3
  s_cbranch_scc1 LL_nob
  ds_read_b128 v[16:19], v15 offset:0
  ds_read_b128 v[20:23], v15 offset:3584
  ds_read_b128 v[24:27], v15 offset:7168
  ds_read_b128 v[28:31], v15 offset:10752
  s_waitcnt lgkmcnt(2)
  v_pk_add_f32 v[16:17], v[16:17], v[20:21]
  v_pk_add_f32 v[18:19], v[18:19], v[22:23]
  s_waitcnt lgkmcnt(0)
  v_pk_add_f32 v[24:25], v[24:25], v[28:29]
  v_pk_add_f32 v[26:27], v[26:27], v[30:31]
  v_pk_add_f32 v[16:17], v[16:17], v[24:25]
  v_pk_add_f32 v[18:19], v[18:19], v[26:27]
  v_cvt_pk_bf16_f32 v20, v16, v17
  v_cvt_pk_bf16_f32 v21, v18, v19
  buffer_store_dwordx2 v[20:21], v5, s[8:11], s33 offen
  s_branch LL_nob2
LL_nob:
  s_add_u32 s50, s34, 4096
  buffer_store_dwordx2 v[240:241], v5, s[8:11], s34 offen
  buffer_store_dwordx2 v[240:241], v5, s[8:11], s34 offen offset:2048
  buffer_store_dwordx2 v[240:241], v5, s[8:11], s50 offen
LL_nob2:
  v_mov_b32 v220, 0
  v_mov_b32 v221, 0
  v_mov_b32 v222, 0
  v_mov_b32 v223, 0
  v_mov_b32 v224, 0
  v_mov_b32 v225, 0
  v_mov_b32 v226, 0
  v_mov_b32 v227, 0
  v_mov_b32 v228, 0
  v_mov_b32 v229, 0
  v_mov_b32 v230, 0
  v_mov_b32 v231, 0
  v_mov_b32 v232, 0
  v_mov_b32 v233, 0
  v_mov_b32 v234, 0
  v_mov_b32 v235, 0
  s_waitcnt vmcnt(0)
  s_mov_b32 s40, 200000
  buffer_load_dwordx4 v[120:123], v3, s[8:11], s33 offen offset:0 sc1
  buffer_load_dwordx4 v[124:127], v3, s[8:11], s33 offen offset:512 sc1
  buffer_load_dwordx4 v[128:131], v3, s[8:11], s33 offen offset:1024 sc1
  buffer_load_dwordx4 v[132:135], v3, s[8:11], s33 offen offset:1536 sc1
  buffer_load_dwordx2 v[136:137], v4, s[8:11], s33 offen offset:0 sc1
  buffer_load_dwordx2 v[138:139], v4, s[8:11], s33 offen offset:512 sc1
  buffer_load_dwordx2 v[140:141], v4, s[8:11], s33 offen offset:1024 sc1
  buffer_load_dwordx2 v[142:143], v4, s[8:11], s33 offen offset:1536 sc1
  s_waitcnt vmcnt(0)
LL_pb_chk:
  v_max3_u32 v250, v120, v124, v128
  v_max3_u32 v250, v250, v132, v136
  v_max3_u32 v250, v250, v138, v140
  v_max_u32 v250, v250, v142
  v_cmp_eq_u32 vcc, -1, v250
  s_cbranch_vccz LL_pb_ok
  s_waitcnt vmcnt(0)
  v_cmp_eq_u32 s[52:53], -1, v120
  v_cmp_eq_u32 s[54:55], -1, v124
  v_cmp_eq_u32 s[56:57], -1, v128
  v_cmp_eq_u32 s[58:59], -1, v132
  s_mov_b64 exec, s[52:53]
  buffer_load_dwordx4 v[120:123], v3, s[8:11], s33 offen offset:0 sc1
  s_mov_b64 exec, s[54:55]
  buffer_load_dwordx4 v[124:127], v3, s[8:11], s33 offen offset:512 sc1
  s_mov_b64 exec, s[56:57]
  buffer_load_dwordx4 v[128:131], v3, s[8:11], s33 offen offset:1024 sc1
  s_mov_b64 exec, s[58:59]
  buffer_load_dwordx4 v[132:135], v3, s[8:11], s33 offen offset:1536 sc1
  s_mov_b64 exec, -1
  v_cmp_eq_u32 s[52:53], -1, v136
  v_cmp_eq_u32 s[54:55], -1, v138
  v_cmp_eq_u32 s[56:57], -1, v140
  v_cmp_eq_u32 s[58:59], -1, v142
  s_mov_b64 exec, s[52:53]
  buffer_load_dwordx2 v[136:137], v4, s[8:11], s33 offen offset:0 sc1
  s_mov_b64 exec, s[54:55]
  buffer_load_dwordx2 v[138:139], v4, s[8:11], s33 offen offset:512 sc1
  s_mov_b64 exec, s[56:57]
  buffer_load_dwordx2 v[140:141], v4, s[8:11], s33 offen offset:1024 sc1
  s_mov_b64 exec, s[58:59]
  buffer_load_dwordx2 v[142:143], v4, s[8:11], s33 offen offset:1536 sc1
  s_mov_b64 exec, -1
  s_waitcnt vmcnt(0)
  s_sub_u32 s40, s40, 1
  s_cbranch_scc0 LL_pb_chk
  s_branch L_fail
LL_pb_ok:
  s_add_u32 s50, s38, 262144
  v_mfma_f32_16x16x32_bf16 v[176:179], v[120:123], v[120:123], 0
  s_mov_b64 exec, 0xffff
  buffer_load_dword v160, v159, s[4:7], s38 offen
  s_mov_b64 exec, -1
  v_mfma_f32_16x16x32_bf16 v[168:171], v[56:59], v[120:123], 0
  buffer_load_dwordx4 v[56:59], v8, s[4:7], s50 offen offset:0
  v_mfma_f32_16x16x32_bf16 v[172:175], v[72:75], v[120:123], 0
  buffer_load_dwordx4 v[72:75], v9, s[4:7], s50 offen offset:0
  v_mfma_f32_16x16x32_bf16 v[176:179], v[124:127], v[124:127], v[176:179]
  v_mfma_f32_16x16x32_bf16 v[168:171], v[60:63], v[124:127], v[168:171]
  buffer_load_dwordx4 v[60:63], v8, s[4:7], s50 offen offset:1024
  v_mfma_f32_16x16x32_bf16 v[172:175], v[76:79], v[124:127], v[172:175]
  buffer_load_dwordx4 v[76:79], v9, s[4:7], s50 offen offset:1024
  v_mfma_f32_16x16x32_bf16 v[176:179], v[128:131], v[128:131], v[176:179]
  v_mfma_f32_16x16x32_bf16 v[168:171], v[64:67], v[128:131], v[168:171]
  buffer_load_dwordx4 v[64:67], v8, s[4:7], s50 offen offset:2048
  v_mfma_f32_16x16x32_bf16 v[172:175], v[80:83], v[128:131], v[172:175]
  buffer_load_dwordx4 v[80:83], v9, s[4:7], s50 offen offset:2048
  v_mfma_f32_16x16x32_bf16 v[176:179], v[132:135], v[132:135], v[176:179]
  v_mfma_f32_16x16x32_bf16 v[168:171], v[68:71], v[132:135], v[168:171]
  buffer_load_dwordx4 v[68:71], v8, s[4:7], s50 offen offset:3072
  v_mfma_f32_16x16x32_bf16 v[172:175], v[84:87], v[132:135], v[172:175]
  buffer_load_dwordx4 v[84:87], v9, s[4:7], s50 offen offset:3072
  buffer_store_dword v240, v6, s[8:11], s36 offen sc1
  s_mov_b64 vcc, s[44:45]
  s_nop 5
  v_max3_f32 v250, v178, v179, v168
  v_max3_f32 v250, v250, v169, v170
  v_max3_f32 v250, v250, v171, v172
  v_max3_f32 v250, v250, v173, v174
  v_max_f32 v250, v250, v175
  v_mov_b32 v251, v250
  s_nop 1
  v_permlane32_swap_b32 v250, v251
  v_max_f32 v250, v250, v251
  v_mov_b32 v251, v250
  s_nop 1
  v_permlane16_swap_b32 v250, v251
  v_max_f32 v250, v250, v251
  v_mul_f32 v250, s41, v250
  v_fma_f32 v178, v178, s41, -v250
  v_fma_f32 v179, v179, s41, -v250
  v_exp_f32 v178, v178
  v_exp_f32 v179, v179
  v_fma_f32 v168, v168, s41, -v250
  v_cvt_pk_bf16_f32 v148, v178, v179
  v_cvt_pk_bf16_f32 v151, v178, v179
  v_fma_f32 v169, v169, s41, -v250
  v_fma_f32 v170, v170, s41, -v250
  v_mfma_f32_16x16x16_bf16 v[152:155], v[144:145], v[148:149], 0
  v_mfma_f32_16x16x16_bf16 v[180:183], v[136:137], v[148:149], 0
  v_fma_f32 v171, v171, s41, -v250
  v_fma_f32 v172, v172, s41, -v250
  v_mfma_f32_16x16x16_bf16 v[184:187], v[136:137], v[150:151], 0
  v_fma_f32 v173, v173, s41, -v250
  v_fma_f32 v174, v174, s41, -v250
  v_mfma_f32_16x16x16_bf16 v[188:191], v[138:139], v[148:149], 0
  v_fma_f32 v175, v175, s41, -v250
  v_mfma_f32_16x16x16_bf16 v[192:195], v[138:139], v[150:151], 0
  v_exp_f32 v168, v168
  v_mfma_f32_16x16x16_bf16 v[196:199], v[140:141], v[148:149], 0
  v_exp_f32 v169, v169
  v_mfma_f32_16x16x16_bf16 v[200:203], v[140:141], v[150:151], 0
  v_exp_f32 v170, v170
  v_mfma_f32_16x16x16_bf16 v[204:207], v[142:143], v[148:149], 0
  v_exp_f32 v171, v171
  v_mfma_f32_16x16x16_bf16 v[208:211], v[142:143], v[150:151], 0
  v_exp_f32 v172, v172
  v_exp_f32 v173, v173
  v_exp_f32 v174, v174
  v_exp_f32 v175, v175
  s_nop 0
  v_cvt_pk_bf16_f32 v32, v168, v169
  v_cvt_pk_bf16_f32 v33, v170, v171
  v_cvt_pk_bf16_f32 v34, v172, v173
  v_cvt_pk_bf16_f32 v35, v174, v175
  s_nop 1
  v_mfma_f32_16x16x32_bf16 v[152:155], v[144:147], v[32:35], v[152:155]
  v_mfma_f32_16x16x32_bf16 v[180:183], v[88:91], v[32:35], v[180:183]
  v_mfma_f32_16x16x32_bf16 v[184:187], v[92:95], v[32:35], v[184:187]
  v_mfma_f32_16x16x32_bf16 v[188:191], v[96:99], v[32:35], v[188:191]
  v_mfma_f32_16x16x32_bf16 v[192:195], v[100:103], v[32:35], v[192:195]
  s_nop 3
  v_rcp_f32 v156, v152
  v_mfma_f32_16x16x32_bf16 v[196:199], v[104:107], v[32:35], v[196:199]
  s_nop 0
  v_mfma_f32_16x16x32_bf16 v[200:203], v[108:111], v[32:35], v[200:203]
  v_mov_b32_dpp v156, v156 quad_perm:[0,1,0,1] row_mask:0xf bank_mask:0xf
  v_mfma_f32_16x16x32_bf16 v[204:207], v[112:115], v[32:35], v[204:207]
  v_mov_b32 v157, v156
  v_cndmask_b32_dpp v180, v188, v180, vcc quad_perm:[0,1,0,1] row_mask:0xf bank_mask:0xf
  v_mfma_f32_16x16x32_bf16 v[208:211], v[116:119], v[32:35], v[208:211]
  v_cndmask_b32_dpp v181, v189, v181, vcc quad_perm:[0,1,0,1] row_mask:0xf bank_mask:0xf
  v_cndmask_b32_dpp v182, v190, v182, vcc quad_perm:[0,1,0,1] row_mask:0xf bank_mask:0xf
  v_cndmask_b32_dpp v183, v191, v183, vcc quad_perm:[0,1,0,1] row_mask:0xf bank_mask:0xf
  v_cndmask_b32_dpp v184, v192, v184, vcc quad_perm:[0,1,0,1] row_mask:0xf bank_mask:0xf
  v_cndmask_b32_dpp v185, v193, v185, vcc quad_perm:[0,1,0,1] row_mask:0xf bank_mask:0xf
  v_cndmask_b32_dpp v186, v194, v186, vcc quad_perm:[0,1,0,1] row_mask:0xf bank_mask:0xf
  v_cndmask_b32_dpp v187, v195, v187, vcc quad_perm:[0,1,0,1] row_mask:0xf bank_mask:0xf
  v_pk_mul_f32 v[180:181], v[180:181], v[156:157]
  v_pk_mul_f32 v[182:183], v[182:183], v[156:157]
  v_pk_mul_f32 v[184:185], v[184:185], v[156:157]
  v_pk_mul_f32 v[186:187], v[186:187], v[156:157]
  v_cvt_pk_bf16_f32 v212, v180, v181
  v_cvt_pk_bf16_f32 v213, v182, v183
  v_cvt_pk_bf16_f32 v214, v184, v185
  v_cvt_pk_bf16_f32 v215, v186, v187
  s_add_u32 s50, s38, 262144
  s_nop 0
  v_smfmac_f32_16x16x64_bf16 v[220:223], v[212:215], a[192:199], v12
  v_cndmask_b32_dpp v196, v204, v196, vcc quad_perm:[0,1,0,1] row_mask:0xf bank_mask:0xf
  v_cndmask_b32_dpp v197, v205, v197, vcc quad_perm:[0,1,0,1] row_mask:0xf bank_mask:0xf
  v_cndmask_b32_dpp v198, v206, v198, vcc quad_perm:[0,1,0,1] row_mask:0xf bank_mask:0xf
  v_cndmask_b32_dpp v199, v207, v199, vcc quad_perm:[0,1,0,1] row_mask:0xf bank_mask:0xf
  v_smfmac_f32_16x16x64_bf16 v[224:227], v[212:215], a[208:215], v12
  v_cndmask_b32_dpp v200, v208, v200, vcc quad_perm:[0,1,0,1] row_mask:0xf bank_mask:0xf
  v_cndmask_b32_dpp v201, v209, v201, vcc quad_perm:[0,1,0,1] row_mask:0xf bank_mask:0xf
  v_cndmask_b32_dpp v202, v210, v202, vcc quad_perm:[0,1,0,1] row_mask:0xf bank_mask:0xf
  v_cndmask_b32_dpp v203, v211, v203, vcc quad_perm:[0,1,0,1] row_mask:0xf bank_mask:0xf
  v_smfmac_f32_16x16x64_bf16 v[228:231], v[212:215], a[224:231], v12
  v_pk_mul_f32 v[196:197], v[196:197], v[156:157]
  v_pk_mul_f32 v[198:199], v[198:199], v[156:157]
  v_pk_mul_f32 v[200:201], v[200:201], v[156:157]
  v_pk_mul_f32 v[202:203], v[202:203], v[156:157]
  v_smfmac_f32_16x16x64_bf16 v[232:235], v[212:215], a[240:247], v12
  v_cvt_pk_bf16_f32 v216, v196, v197
  v_cvt_pk_bf16_f32 v217, v198, v199
  v_cvt_pk_bf16_f32 v218, v200, v201
  v_cvt_pk_bf16_f32 v219, v202, v203
  s_nop 1
  v_smfmac_f32_16x16x64_bf16 v[220:223], v[216:219], a[200:207], v12
  v_smfmac_f32_16x16x64_bf16 v[224:227], v[216:219], a[216:223], v12
  v_smfmac_f32_16x16x64_bf16 v[228:231], v[216:219], a[232:239], v12
  v_smfmac_f32_16x16x64_bf16 v[232:235], v[216:219], a[248:255], v12
  s_nop 4
  v_pk_add_f32 v[220:221], v[220:221], v[222:223]
  ds_write2_b32 v244, v220, v221 offset0:0 offset1:72
  v_pk_add_f32 v[224:225], v[224:225], v[226:227]
  ds_write2_b32 v244, v224, v225 offset0:16 offset1:88
  v_pk_add_f32 v[228:229], v[228:229], v[230:231]
  ds_write2_b32 v244, v228, v229 offset0:32 offset1:104
  v_pk_add_f32 v[232:233], v[232:233], v[234:235]
  ds_write2_b32 v244, v232, v233 offset0:48 offset1:120
  s_waitcnt lgkmcnt(0)
  s_barrier
  ds_read_b64 v[16:17], v245 offset:0
  ds_read_b64 v[18:19], v245 offset:2304
  ds_read_b64 v[20:21], v245 offset:4608
  ds_read_b64 v[22:23], v245 offset:6912
  s_waitcnt lgkmcnt(2)
  v_pk_add_f32 v[16:17], v[16:17], v[18:19]
  s_waitcnt lgkmcnt(0)
  v_pk_add_f32 v[20:21], v[20:21], v[22:23]
  v_pk_add_f32 v[16:17], v[16:17], v[20:21]
  v_cvt_pk_f16_f32 v18, v16, v17
  v_min_u32 v18, 0xfffffffe, v18
  buffer_store_dword v18, v6, s[8:11], s35 offen sc1
  s_cmp_ge_u32 s43, 8
  s_cbranch_scc1 LL_km_none
  s_cmp_eq_u32 s43, 0
  s_cbranch_scc0 LL_km_n0
  s_mov_b64 exec, s[46:47]
  buffer_store_dwordx4 v[120:123], v246, s[4:7], s39 offen offset:0 sc1
  s_mov_b64 exec, -1
  s_waitcnt vmcnt(1)
  s_branch LL_km_done
LL_km_n0:
  s_cmp_eq_u32 s43, 1
  s_cbranch_scc0 LL_km_n1
  s_mov_b64 exec, s[46:47]
  buffer_store_dwordx4 v[124:127], v246, s[4:7], s39 offen offset:512 sc1
  s_mov_b64 exec, -1
  s_waitcnt vmcnt(1)
  s_branch LL_km_done
LL_km_n1:
  s_cmp_eq_u32 s43, 2
  s_cbranch_scc0 LL_km_n2
  s_mov_b64 exec, s[46:47]
  buffer_store_dwordx4 v[128:131], v246, s[4:7], s39 offen offset:1024 sc1
  s_mov_b64 exec, -1
  s_waitcnt vmcnt(1)
  s_branch LL_km_done
LL_km_n2:
  s_cmp_eq_u32 s43, 3
  s_cbranch_scc0 LL_km_n3
  s_mov_b64 exec, s[46:47]
  buffer_store_dwordx4 v[132:135], v246, s[4:7], s39 offen offset:1536 sc1
  s_mov_b64 exec, -1
  s_waitcnt vmcnt(1)
  s_branch LL_km_done
LL_km_n3:
  s_cmp_eq_u32 s43, 4
  s_cbranch_scc0 LL_km_n4
  buffer_store_dwordx2 v[136:137], v247, s[4:7], s39 offen offset:0 sc1
  s_mov_b64 exec, -1
  s_waitcnt vmcnt(1)
  s_branch LL_km_done
LL_km_n4:
  s_cmp_eq_u32 s43, 5
  s_cbranch_scc0 LL_km_n5
  buffer_store_dwordx2 v[138:139], v247, s[4:7], s39 offen offset:512 sc1
  s_mov_b64 exec, -1
  s_waitcnt vmcnt(1)
  s_branch LL_km_done
LL_km_n5:
  s_cmp_eq_u32 s43, 6
  s_cbranch_scc0 LL_km_n6
  buffer_store_dwordx2 v[140:141], v247, s[4:7], s39 offen offset:1024 sc1
  s_mov_b64 exec, -1
  s_waitcnt vmcnt(1)
  s_branch LL_km_done
LL_km_n6:
  s_cmp_eq_u32 s43, 7
  s_cbranch_scc0 LL_km_n7
  buffer_store_dwordx2 v[142:143], v247, s[4:7], s39 offen offset:1536 sc1
  s_mov_b64 exec, -1
  s_waitcnt vmcnt(1)
  s_branch LL_km_done
LL_km_n7:
LL_km_none:
  s_waitcnt vmcnt(0)
LL_km_done:
  s_mov_b32 s40, 200000
  buffer_load_dword v20, v7, s[8:11], s35 offen offset:0 sc1
  buffer_load_dword v21, v7, s[8:11], s35 offen offset:512 sc1
  buffer_load_dword v22, v7, s[8:11], s35 offen offset:1024 sc1
  buffer_load_dword v23, v7, s[8:11], s35 offen offset:1536 sc1
  s_waitcnt vmcnt(0)
LL_pc_chk:
  v_max3_u32 v250, v20, v21, v22
  v_max_u32 v250, v250, v23
  v_cmp_eq_u32 vcc, -1, v250
  s_cbranch_vccz LL_pc_ok
  s_waitcnt vmcnt(0)
  v_cmp_eq_u32 s[52:53], -1, v20
  v_cmp_eq_u32 s[54:55], -1, v21
  v_cmp_eq_u32 s[56:57], -1, v22
  v_cmp_eq_u32 s[58:59], -1, v23
  s_mov_b64 exec, s[52:53]
  buffer_load_dword v20, v7, s[8:11], s35 offen offset:0 sc1
  s_mov_b64 exec, s[54:55]
  buffer_load_dword v21, v7, s[8:11], s35 offen offset:512 sc1
  s_mov_b64 exec, s[56:57]
  buffer_load_dword v22, v7, s[8:11], s35 offen offset:1024 sc1
  s_mov_b64 exec, s[58:59]
  buffer_load_dword v23, v7, s[8:11], s35 offen offset:1536 sc1
  s_mov_b64 exec, -1
  s_waitcnt vmcnt(0)
  s_sub_u32 s40, s40, 1
  s_cbranch_scc0 LL_pc_chk
  s_branch L_fail
LL_pc_ok:
  v_fma_mix_f32 v16, v20, 1.0, v21 op_sel_hi:[1,0,1]
  v_fma_mix_f32 v17, v20, 1.0, v21 op_sel:[1,0,1] op_sel_hi:[1,0,1]
  v_fma_mix_f32 v18, v22, 1.0, v23 op_sel_hi:[1,0,1]
  v_fma_mix_f32 v19, v22, 1.0, v23 op_sel:[1,0,1] op_sel_hi:[1,0,1]
  v_pk_add_f32 v[16:17], v[16:17], v[18:19]
  s_nop 1
  v_permlane32_swap_b32 v16, v17
  v_add_f32 v16, v16, v17
  v_mov_b32 v17, v16
  s_nop 1
  v_permlane32_swap_b32 v16, v17
  v_cvt_pk_bf16_f32 v16, v16, v17
  v_med3_u32 v16, v16, v248, v249
  buffer_store_dword v16, v252, s[8:11], 0 offen
  s_add_u32 s31, s31, 1
  s_branch LL_step
LL_last:
  s_cmp_eq_u32 s28, 0
  s_cbranch_scc1 L_chain_done
  s_cmp_eq_u32 s28, 3
  s_cbranch_scc1 L_chain_done
  ds_read_b128 v[16:19], v15 offset:0
  ds_read_b128 v[20:23], v15 offset:3584
  ds_read_b128 v[24:27], v15 offset:7168
  ds_read_b128 v[28:31], v15 offset:10752
  s_cmp_eq_u32 s28, 1
  s_cselect_b32 s50, 0, 4194304
  s_add_u32 s50, s50, 96403456
  s_lshl_b32 s51, s29, 14
  s_add_u32 s50, s50, s51
  s_lshl_b32 s51, s30, 9
  s_add_u32 s50, s50, s51
  v_lshlrev_b32 v250, 3, v0
  s_waitcnt lgkmcnt(0)
  v_pk_add_f32 v[16:17], v[16:17], v[20:21]
  v_pk_add_f32 v[18:19], v[18:19], v[22:23]
  v_pk_add_f32 v[24:25], v[24:25], v[28:29]
  v_pk_add_f32 v[26:27], v[26:27], v[30:31]
  v_pk_add_f32 v[16:17], v[16:17], v[24:25]
  v_pk_add_f32 v[18:19], v[18:19], v[26:27]
  v_cvt_pk_bf16_f32 v20, v16, v17
  v_cvt_pk_bf16_f32 v21, v18, v19
  buffer_store_dwordx2 v[20:21], v250, s[4:7], s50 offen sc1
  s_branch L_chain_done
L_chain_g:
  s_mov_b32 s48, 0
  s_add_u32 s50, s29, s30
  s_cmp_lg_u32 s50, 0
  s_cbranch_scc1 LG_np
  s_cmp_eq_u32 s28, 2
  s_cselect_b32 s48, 1, 0
LG_np:
  s_add_u32 s50, s29, s30
  s_add_u32 s50, s50, s28
  s_cmp_lg_u32 s50, 0
  s_cbranch_scc1 LG_npr
  s_mov_b64 exec, 1
  s_mov_b32 s56, -1
  s_mov_b32 s57, -1
  s_waitcnt vmcnt(0)
  s_mov_b32 s51, 835584
  s_memtime s[52:53]
  s_waitcnt lgkmcnt(0)
  buffer_store_dword v240, off, s[8:11], s51 sc1
  s_waitcnt vmcnt(0)
  s_memtime s[54:55]
  s_waitcnt lgkmcnt(0)
  s_sub_u32 s54, s54, s52
  s_min_u32 s56, s56, s54
  s_mov_b32 s51, 843776
  s_memtime s[52:53]
  s_waitcnt lgkmcnt(0)
  buffer_store_dword v240, off, s[8:11], s51 sc1
  s_waitcnt vmcnt(0)
  s_memtime s[54:55]
  s_waitcnt lgkmcnt(0)
  s_sub_u32 s54, s54, s52
  s_min_u32 s57, s57, s54
  s_mov_b32 s51, 901120
  s_memtime s[52:53]
  s_waitcnt lgkmcnt(0)
  buffer_store_dword v240, off, s[8:11], s51 sc1
  s_waitcnt vmcnt(0)
  s_memtime s[54:55]
  s_waitcnt lgkmcnt(0)
  s_sub_u32 s54, s54, s52
  s_min_u32 s56, s56, s54
  s_mov_b32 s51, 909312
  s_memtime s[52:53]
  s_waitcnt lgkmcnt(0)
  buffer_store_dword v240, off, s[8:11], s51 sc1
  s_waitcnt vmcnt(0)
  s_memtime s[54:55]
  s_waitcnt lgkmcnt(0)
  s_sub_u32 s54, s54, s52
  s_min_u32 s57, s57, s54
  s_mov_b32 s51, 966656
  s_memtime s[52:53]
  s_waitcnt lgkmcnt(0)
  buffer_store_dword v240, off, s[8:11], s51 sc1
  s_waitcnt vmcnt(0)
  s_memtime s[54:55]
  s_waitcnt lgkmcnt(0)
  s_sub_u32 s54, s54, s52
  s_min_u32 s56, s56, s54
  s_mov_b32 s51, 974848
  s_memtime s[52:53]
  s_waitcnt lgkmcnt(0)
  buffer_store_dword v240, off, s[8:11], s51 sc1
  s_waitcnt vmcnt(0)
  s_memtime s[54:55]
  s_waitcnt lgkmcnt(0)
  s_sub_u32 s54, s54, s52
  s_min_u32 s57, s57, s54
  s_mov_b32 s51, 1032192
  s_memtime s[52:53]
  s_waitcnt lgkmcnt(0)
  buffer_store_dword v240, off, s[8:11], s51 sc1
  s_waitcnt vmcnt(0)
  s_memtime s[54:55]
  s_waitcnt lgkmcnt(0)
  s_sub_u32 s54, s54, s52
  s_min_u32 s56, s56, s54
  s_mov_b32 s51, 1040384
  s_memtime s[52:53]
  s_waitcnt lgkmcnt(0)
  buffer_store_dword v240, off, s[8:11], s51 sc1
  s_waitcnt vmcnt(0)
  s_memtime s[54:55]
  s_waitcnt lgkmcnt(0)
  s_sub_u32 s54, s54, s52
  s_min_u32 s57, s57, s54
  s_cmp_lt_u32 s57, s56
  s_cselect_b32 s56, 2, 1
  s_mov_b32 s51, 117450752
  v_mov_b32 v17, s56
  buffer_store_dword v17, off, s[4:7], s51 sc1
  s_mov_b64 exec, -1
LG_npr:
  s_cmp_lg_u32 s28, 0
  s_cbranch_scc1 LG_kvw
  v_lshlrev_b32 v252, 7, v0
  v_mov_b32 v16, 32
  v_cmp_eq_u32 vcc, 4, v0
  s_mov_b32 s49, 117450240
  s_mov_b32 s40, 100000
  v_cndmask_b32 v16, v16, 1, vcc

  s_mov_b64 exec, 0x1ff
LG_kv0:

  buffer_load_dword v253, v252, s[4:7], s49 offen sc1
  s_waitcnt vmcnt(0)
  v_cmp_gt_u32 vcc, v16, v253
  s_cbranch_vccz LG_kv0ok
  s_sub_u32 s40, s40, 1
  s_cbranch_scc0 LG_kv0
  v_mov_b32 v253, 0
LG_kv0ok:
  s_mov_b64 exec, -1
  v_readlane_b32 s50, v253, 4
  v_mov_b32 v16, 131072
  s_nop 0
  v_mov_b32 v17, s50
  ds_write_b32 v16, v17 offset:24
  s_waitcnt lgkmcnt(0)
LG_kvw:
  s_barrier
  v_mov_b32 v16, 131072
  ds_read_b32 v17, v16 offset:24
  s_waitcnt lgkmcnt(0)
  v_readfirstlane_b32 s50, v17
  s_nop 0
  s_cmp_eq_u32 s50, 0
  s_cbranch_scc1 L_fail
  s_sub_u32 s50, s50, 1
  s_and_b32 s50, s50, 1
  s_lshl_b32 s50, s50, 13
  v_add_u32 v6, s50, v6
  v_add_u32 v7, s50, v7
  s_lshl_b32 s50, s30, 6
  s_lshl_b32 s51, s28, 12
  s_add_u32 s50, s50, s51
  v_mov_b32 v251, 0
  v_bfe_u32 v255, v0, 4, 1
  v_lshl_add_u32 v251, v255, 11, v251
  v_bfe_u32 v255, v0, 0, 4
  v_lshl_add_u32 v251, v255, 2, v251
  v_add_u32 v251, s50, v251
  buffer_load_dword v16, v251, s[12:15], 0 offen
  s_mov_b32 s31, 0
  s_mov_b32 s50, 0
  s_waitcnt vmcnt(0)
  v_med3_u32 v16, v16, v248, v249
  buffer_store_dword v16, v2, s[8:11], 0 offen sc1
  buffer_load_dwordx4 v[56:59], v8, s[4:7], s50 offen offset:0
  buffer_load_dwordx4 v[60:63], v8, s[4:7], s50 offen offset:1024
  buffer_load_dwordx4 v[64:67], v8, s[4:7], s50 offen offset:2048
  buffer_load_dwordx4 v[68:71], v8, s[4:7], s50 offen offset:3072
  buffer_load_dwordx4 v[72:75], v9, s[4:7], s50 offen offset:0
  buffer_load_dwordx4 v[76:79], v9, s[4:7], s50 offen offset:1024
  buffer_load_dwordx4 v[80:83], v9, s[4:7], s50 offen offset:2048
  buffer_load_dwordx4 v[84:87], v9, s[4:7], s50 offen offset:3072
LG_step:
  s_and_b32 s50, s31, 3
  s_lshl_b32 s32, s50, 16
  s_lshl_b32 s51, s29, 14
  s_add_u32 s32, s32, s51
  s_add_u32 s32, s32, 3145728
  s_lshl_b32 s33, s50, 18
  s_xor_b32 s34, s33, 524288
  s_add_u32 s33, s33, 2097152
  s_add_u32 s34, s34, 2097152
  s_lshl_b32 s35, s50, 18
  s_xor_b32 s36, s35, 524288
  s_add_u32 s50, s31, 1
  s_and_b32 s50, s50, 3
  s_lshl_b32 s37, s50, 16
  s_lshl_b32 s38, s31, 18

  s_lshl_b32 s39, s31, 16
  v_xor_b32 v252, s37, v2
  v_mov_b32 v32, 0
  v_mov_b32 v33, 0
  v_mov_b32 v34, 0
  v_mov_b32 v35, 0
  v_mov_b32 v36, 0
  v_mov_b32 v37, 0
  v_mov_b32 v38, 0
  v_mov_b32 v39, 0
  v_mov_b32 v40, 0
  v_mov_b32 v41, 0
  v_mov_b32 v42, 0
  v_mov_b32 v43, 0
  v_mov_b32 v44, 0
  v_mov_b32 v45, 0
  v_mov_b32 v46, 0
  v_mov_b32 v47, 0
  v_mov_b32 v48, 0
  v_mov_b32 v49, 0
  v_mov_b32 v50, 0
  v_mov_b32 v51, 0
  v_mov_b32 v52, 0
  v_mov_b32 v53, 0
  v_mov_b32 v54, 0
  v_mov_b32 v55, 0
  s_mov_b32 s40, 200000
  buffer_load_dwordx4 v[16:19], v1, s[8:11], s32 offen offset:0 sc1
  buffer_load_dwordx4 v[20:23], v1, s[8:11], s32 offen offset:1024 sc1
  buffer_load_dwordx4 v[24:27], v1, s[8:11], s32 offen offset:2048 sc1
  buffer_load_dwordx4 v[28:31], v1, s[8:11], s32 offen offset:3072 sc1
  s_waitcnt vmcnt(0)
LG_pa_chk:
  v_max3_u32 v250, v16, v20, v24
  v_max_u32 v250, v250, v28
  v_cmp_eq_u32 vcc, -1, v250
  s_cbranch_vccz LG_pa_ok
  s_waitcnt vmcnt(0)
  v_cmp_eq_u32 s[52:53], -1, v16
  v_cmp_eq_u32 s[54:55], -1, v20
  v_cmp_eq_u32 s[56:57], -1, v24
  v_cmp_eq_u32 s[58:59], -1, v28
  s_mov_b64 exec, s[52:53]
  buffer_load_dwordx4 v[16:19], v1, s[8:11], s32 offen offset:0 sc1
  s_mov_b64 exec, s[54:55]
  buffer_load_dwordx4 v[20:23], v1, s[8:11], s32 offen offset:1024 sc1
  s_mov_b64 exec, s[56:57]
  buffer_load_dwordx4 v[24:27], v1, s[8:11], s32 offen offset:2048 sc1
  s_mov_b64 exec, s[58:59]
  buffer_load_dwordx4 v[28:31], v1, s[8:11], s32 offen offset:3072 sc1
  s_mov_b64 exec, -1
  s_waitcnt vmcnt(0)
  s_sub_u32 s40, s40, 1
  s_cbranch_scc0 LG_pa_chk
  s_branch L_fail
LG_pa_ok:
  s_cmp_eq_u32 s48, 0
  s_cbranch_scc1 LG_npub
  s_sub_u32 s50, s31, 1
  s_max_i32 s50, s50, 0
  v_mov_b32 v254, s50
  s_mov_b32 s49, 117444736
  buffer_store_dword v254, off, s[4:7], s49 sc1
LG_npub:
  s_cmp_lg_u32 s28, 3
  s_cbranch_scc1 LG_nkv
  s_and_b32 s50, s31, 7
  s_cmp_lg_u32 s50, 5
  s_cbranch_scc1 LG_nkv
  s_add_u32 s50, s31, 3
  s_lshr_b32 s50, s50, 3
  s_min_u32 s50, s50, 7
  s_max_u32 s50, s50, 1
  s_lshl_b32 s50, s50, 7
  s_add_u32 s49, s50, 117440512
  buffer_load_dword v253, off, s[4:7], s49 sc1
LG_nkv:
  v_smfmac_f32_16x16x64_bf16 v[32:35], v[16:19], a[0:7], v12
  buffer_load_dwordx4 v[88:91], v10, s[4:7], s38 offen offset:0
  v_smfmac_f32_16x16x64_bf16 v[36:39], v[16:19], a[32:39], v12
  v_smfmac_f32_16x16x64_bf16 v[32:35], v[20:23], a[8:15], v12
  v_smfmac_f32_16x16x64_bf16 v[36:39], v[20:23], a[40:47], v12
  buffer_load_dwordx4 v[92:95], v10, s[4:7], s38 offen offset:1024
  v_smfmac_f32_16x16x64_bf16 v[32:35], v[24:27], a[16:23], v12
  v_smfmac_f32_16x16x64_bf16 v[36:39], v[24:27], a[48:55], v12
  v_smfmac_f32_16x16x64_bf16 v[32:35], v[28:31], a[24:31], v12
  buffer_load_dwordx4 v[96:99], v10, s[4:7], s38 offen offset:2048
  v_smfmac_f32_16x16x64_bf16 v[36:39], v[28:31], a[56:63], v12
  v_smfmac_f32_16x16x64_bf16 v[40:43], v[16:19], a[64:71], v12
  v_smfmac_f32_16x16x64_bf16 v[44:47], v[16:19], a[96:103], v12
  buffer_load_dwordx4 v[100:103], v10, s[4:7], s38 offen offset:3072
  v_smfmac_f32_16x16x64_bf16 v[40:43], v[20:23], a[72:79], v12
  v_smfmac_f32_16x16x64_bf16 v[44:47], v[20:23], a[104:111], v12
  s_nop 3
  v_smfmac_f32_16x16x64_bf16 v[40:43], v[24:27], a[80:87], v12
  v_pk_add_f32 v[32:33], v[32:33], v[34:35]
  v_smfmac_f32_16x16x64_bf16 v[44:47], v[24:27], a[112:119], v12
  buffer_load_dwordx4 v[104:107], v11, s[4:7], s38 offen offset:0
  v_pk_add_f32 v[36:37], v[36:37], v[38:39]
  v_smfmac_f32_16x16x64_bf16 v[40:43], v[28:31], a[88:95], v12
  ds_write2_b32 v13, v32, v36 offset0:0 offset1:16
  v_smfmac_f32_16x16x64_bf16 v[44:47], v[28:31], a[120:127], v12
  ds_write2_b32 v13, v33, v37 offset0:40 offset1:56
  v_smfmac_f32_16x16x64_bf16 v[48:51], v[16:19], a[128:135], v12
  buffer_load_dwordx4 v[108:111], v11, s[4:7], s38 offen offset:1024
  v_smfmac_f32_16x16x64_bf16 v[52:55], v[16:19], a[160:167], v12
  v_smfmac_f32_16x16x64_bf16 v[48:51], v[20:23], a[136:143], v12
  buffer_load_dwordx4 v[112:115], v11, s[4:7], s38 offen offset:2048
  v_smfmac_f32_16x16x64_bf16 v[52:55], v[20:23], a[168:175], v12
  s_nop 3
  v_smfmac_f32_16x16x64_bf16 v[48:51], v[24:27], a[144:151], v12
  v_pk_add_f32 v[40:41], v[40:41], v[42:43]
  v_smfmac_f32_16x16x64_bf16 v[52:55], v[24:27], a[176:183], v12
  buffer_load_dwordx4 v[116:119], v11, s[4:7], s38 offen offset:3072
  v_pk_add_f32 v[44:45], v[44:45], v[46:47]
  v_smfmac_f32_16x16x64_bf16 v[48:51], v[28:31], a[152:159], v12
  ds_write2_b32 v158, v40, v44 offset0:0 offset1:16
  v_smfmac_f32_16x16x64_bf16 v[52:55], v[28:31], a[184:191], v12
  ds_write2_b32 v158, v41, v45 offset0:40 offset1:56
  s_nop 7
  v_pk_add_f32 v[48:49], v[48:49], v[50:51]
  v_pk_add_f32 v[50:51], v[52:53], v[54:55]
  ds_write_b128 v14, v[48:51]
  s_cmp_lg_u32 s28, 3
  s_cbranch_scc1 LG_kvok
  s_and_b32 s50, s31, 7
  s_cmp_lg_u32 s50, 5
  s_cbranch_scc1 LG_kvok
  s_waitcnt vmcnt(8)
  s_mov_b32 s40, 100000
LG_kvp:
  v_readfirstlane_b32 s50, v253
  s_nop 0
  s_cmp_ge_u32 s50, 64
  s_cbranch_scc1 LG_kvok
  buffer_load_dword v253, off, s[4:7], s49 sc1
  s_waitcnt vmcnt(0)
  s_sub_u32 s40, s40, 1
  s_cbranch_scc0 LG_kvp
  s_branch L_fail
LG_kvok:
  s_waitcnt lgkmcnt(0)
  s_barrier
  s_cmp_eq_u32 s31, 63
  s_cbranch_scc1 LG_last
  s_cmp_eq_u32 s28, 3
  s_cbranch_scc1 LG_nob
  ds_read_b128 v[16:19], v15 offset:0
  ds_read_b128 v[20:23], v15 offset:3584
  ds_read_b128 v[24:27], v15 offset:7168
  ds_read_b128 v[28:31], v15 offset:10752
  s_waitcnt lgkmcnt(2)
  v_pk_add_f32 v[16:17], v[16:17], v[20:21]
  v_pk_add_f32 v[18:19], v[18:19], v[22:23]
  s_waitcnt lgkmcnt(0)
  v_pk_add_f32 v[24:25], v[24:25], v[28:29]
  v_pk_add_f32 v[26:27], v[26:27], v[30:31]
  v_pk_add_f32 v[16:17], v[16:17], v[24:25]
  v_pk_add_f32 v[18:19], v[18:19], v[26:27]
  v_cvt_pk_bf16_f32 v20, v16, v17
  v_cvt_pk_bf16_f32 v21, v18, v19
  buffer_store_dwordx2 v[20:21], v5, s[8:11], s33 offen sc1
  s_branch LG_nob2
LG_nob:
  s_add_u32 s50, s34, 4096
  buffer_store_dwordx2 v[240:241], v5, s[8:11], s34 offen sc1
  buffer_store_dwordx2 v[240:241], v5, s[8:11], s34 offen offset:2048 sc1
  buffer_store_dwordx2 v[240:241], v5, s[8:11], s50 offen sc1
LG_nob2:
  v_mov_b32 v220, 0
  v_mov_b32 v221, 0
  v_mov_b32 v222, 0
  v_mov_b32 v223, 0
  v_mov_b32 v224, 0
  v_mov_b32 v225, 0
  v_mov_b32 v226, 0
  v_mov_b32 v227, 0
  v_mov_b32 v228, 0
  v_mov_b32 v229, 0
  v_mov_b32 v230, 0
  v_mov_b32 v231, 0
  v_mov_b32 v232, 0
  v_mov_b32 v233, 0
  v_mov_b32 v234, 0
  v_mov_b32 v235, 0
  s_waitcnt vmcnt(0)
  s_mov_b32 s40, 200000
  buffer_load_dwordx4 v[120:123], v3, s[8:11], s33 offen offset:0 sc1
  buffer_load_dwordx4 v[124:127], v3, s[8:11], s33 offen offset:512 sc1
  buffer_load_dwordx4 v[128:131], v3, s[8:11], s33 offen offset:1024 sc1
  buffer_load_dwordx4 v[132:135], v3, s[8:11], s33 offen offset:1536 sc1
  buffer_load_dwordx2 v[136:137], v4, s[8:11], s33 offen offset:0 sc1
  buffer_load_dwordx2 v[138:139], v4, s[8:11], s33 offen offset:512 sc1
  buffer_load_dwordx2 v[140:141], v4, s[8:11], s33 offen offset:1024 sc1
  buffer_load_dwordx2 v[142:143], v4, s[8:11], s33 offen offset:1536 sc1
  s_waitcnt vmcnt(0)
LG_pb_chk:
  v_max3_u32 v250, v120, v124, v128
  v_max3_u32 v250, v250, v132, v136
  v_max3_u32 v250, v250, v138, v140
  v_max_u32 v250, v250, v142
  v_cmp_eq_u32 vcc, -1, v250
  s_cbranch_vccz LG_pb_ok
  s_waitcnt vmcnt(0)
  v_cmp_eq_u32 s[52:53], -1, v120
  v_cmp_eq_u32 s[54:55], -1, v124
  v_cmp_eq_u32 s[56:57], -1, v128
  v_cmp_eq_u32 s[58:59], -1, v132
  s_mov_b64 exec, s[52:53]
  buffer_load_dwordx4 v[120:123], v3, s[8:11], s33 offen offset:0 sc1
  s_mov_b64 exec, s[54:55]
  buffer_load_dwordx4 v[124:127], v3, s[8:11], s33 offen offset:512 sc1
  s_mov_b64 exec, s[56:57]
  buffer_load_dwordx4 v[128:131], v3, s[8:11], s33 offen offset:1024 sc1
  s_mov_b64 exec, s[58:59]
  buffer_load_dwordx4 v[132:135], v3, s[8:11], s33 offen offset:1536 sc1
  s_mov_b64 exec, -1
  v_cmp_eq_u32 s[52:53], -1, v136
  v_cmp_eq_u32 s[54:55], -1, v138
  v_cmp_eq_u32 s[56:57], -1, v140
  v_cmp_eq_u32 s[58:59], -1, v142
  s_mov_b64 exec, s[52:53]
  buffer_load_dwordx2 v[136:137], v4, s[8:11], s33 offen offset:0 sc1
  s_mov_b64 exec, s[54:55]
  buffer_load_dwordx2 v[138:139], v4, s[8:11], s33 offen offset:512 sc1
  s_mov_b64 exec, s[56:57]
  buffer_load_dwordx2 v[140:141], v4, s[8:11], s33 offen offset:1024 sc1
  s_mov_b64 exec, s[58:59]
  buffer_load_dwordx2 v[142:143], v4, s[8:11], s33 offen offset:1536 sc1
  s_mov_b64 exec, -1
  s_waitcnt vmcnt(0)
  s_sub_u32 s40, s40, 1
  s_cbranch_scc0 LG_pb_chk
  s_branch L_fail
LG_pb_ok:
  s_add_u32 s50, s38, 262144
  v_mfma_f32_16x16x32_bf16 v[176:179], v[120:123], v[120:123], 0
  s_mov_b64 exec, 0xffff
  buffer_load_dword v160, v159, s[4:7], s38 offen
  s_mov_b64 exec, -1
  v_mfma_f32_16x16x32_bf16 v[168:171], v[56:59], v[120:123], 0
  buffer_load_dwordx4 v[56:59], v8, s[4:7], s50 offen offset:0
  v_mfma_f32_16x16x32_bf16 v[172:175], v[72:75], v[120:123], 0
  buffer_load_dwordx4 v[72:75], v9, s[4:7], s50 offen offset:0
  v_mfma_f32_16x16x32_bf16 v[176:179], v[124:127], v[124:127], v[176:179]
  v_mfma_f32_16x16x32_bf16 v[168:171], v[60:63], v[124:127], v[168:171]
  buffer_load_dwordx4 v[60:63], v8, s[4:7], s50 offen offset:1024
  v_mfma_f32_16x16x32_bf16 v[172:175], v[76:79], v[124:127], v[172:175]
  buffer_load_dwordx4 v[76:79], v9, s[4:7], s50 offen offset:1024
  v_mfma_f32_16x16x32_bf16 v[176:179], v[128:131], v[128:131], v[176:179]
  v_mfma_f32_16x16x32_bf16 v[168:171], v[64:67], v[128:131], v[168:171]
  buffer_load_dwordx4 v[64:67], v8, s[4:7], s50 offen offset:2048
  v_mfma_f32_16x16x32_bf16 v[172:175], v[80:83], v[128:131], v[172:175]
  buffer_load_dwordx4 v[80:83], v9, s[4:7], s50 offen offset:2048
  v_mfma_f32_16x16x32_bf16 v[176:179], v[132:135], v[132:135], v[176:179]
  v_mfma_f32_16x16x32_bf16 v[168:171], v[68:71], v[132:135], v[168:171]
  buffer_load_dwordx4 v[68:71], v8, s[4:7], s50 offen offset:3072
  v_mfma_f32_16x16x32_bf16 v[172:175], v[84:87], v[132:135], v[172:175]
  buffer_load_dwordx4 v[84:87], v9, s[4:7], s50 offen offset:3072
  buffer_store_dword v240, v6, s[8:11], s36 offen sc1
  s_mov_b64 vcc, s[44:45]
  s_nop 5
  v_max3_f32 v250, v178, v179, v168
  v_max3_f32 v250, v250, v169, v170
  v_max3_f32 v250, v250, v171, v172
  v_max3_f32 v250, v250, v173, v174
  v_max_f32 v250, v250, v175
  v_mov_b32 v251, v250
  s_nop 1
  v_permlane32_swap_b32 v250, v251
  v_max_f32 v250, v250, v251
  v_mov_b32 v251, v250
  s_nop 1
  v_permlane16_swap_b32 v250, v251
  v_max_f32 v250, v250, v251
  v_mul_f32 v250, s41, v250
  v_fma_f32 v178, v178, s41, -v250
  v_fma_f32 v179, v179, s41, -v250
  v_exp_f32 v178, v178
  v_exp_f32 v179, v179
  v_fma_f32 v168, v168, s41, -v250
  v_cvt_pk_bf16_f32 v148, v178, v179
  v_cvt_pk_bf16_f32 v151, v178, v179
  v_fma_f32 v169, v169, s41, -v250
  v_fma_f32 v170, v170, s41, -v250
  v_mfma_f32_16x16x16_bf16 v[152:155], v[144:145], v[148:149], 0
  v_mfma_f32_16x16x16_bf16 v[180:183], v[136:137], v[148:149], 0
  v_fma_f32 v171, v171, s41, -v250
  v_fma_f32 v172, v172, s41, -v250
  v_mfma_f32_16x16x16_bf16 v[184:187], v[136:137], v[150:151], 0
  v_fma_f32 v173, v173, s41, -v250
  v_fma_f32 v174, v174, s41, -v250
  v_mfma_f32_16x16x16_bf16 v[188:191], v[138:139], v[148:149], 0
  v_fma_f32 v175, v175, s41, -v250
  v_mfma_f32_16x16x16_bf16 v[192:195], v[138:139], v[150:151], 0
  v_exp_f32 v168, v168
  v_mfma_f32_16x16x16_bf16 v[196:199], v[140:141], v[148:149], 0
  v_exp_f32 v169, v169
  v_mfma_f32_16x16x16_bf16 v[200:203], v[140:141], v[150:151], 0
  v_exp_f32 v170, v170
  v_mfma_f32_16x16x16_bf16 v[204:207], v[142:143], v[148:149], 0
  v_exp_f32 v171, v171
  v_mfma_f32_16x16x16_bf16 v[208:211], v[142:143], v[150:151], 0
  v_exp_f32 v172, v172
  v_exp_f32 v173, v173
  v_exp_f32 v174, v174
  v_exp_f32 v175, v175
  s_nop 0
  v_cvt_pk_bf16_f32 v32, v168, v169
  v_cvt_pk_bf16_f32 v33, v170, v171
  v_cvt_pk_bf16_f32 v34, v172, v173
  v_cvt_pk_bf16_f32 v35, v174, v175
  s_nop 1
  v_mfma_f32_16x16x32_bf16 v[152:155], v[144:147], v[32:35], v[152:155]
  v_mfma_f32_16x16x32_bf16 v[180:183], v[88:91], v[32:35], v[180:183]
  v_mfma_f32_16x16x32_bf16 v[184:187], v[92:95], v[32:35], v[184:187]
  v_mfma_f32_16x16x32_bf16 v[188:191], v[96:99], v[32:35], v[188:191]
  v_mfma_f32_16x16x32_bf16 v[192:195], v[100:103], v[32:35], v[192:195]
  s_nop 3
  v_rcp_f32 v156, v152
  v_mfma_f32_16x16x32_bf16 v[196:199], v[104:107], v[32:35], v[196:199]
  s_nop 0
  v_mfma_f32_16x16x32_bf16 v[200:203], v[108:111], v[32:35], v[200:203]
  v_mov_b32_dpp v156, v156 quad_perm:[0,1,0,1] row_mask:0xf bank_mask:0xf
  v_mfma_f32_16x16x32_bf16 v[204:207], v[112:115], v[32:35], v[204:207]
  v_mov_b32 v157, v156
  v_cndmask_b32_dpp v180, v188, v180, vcc quad_perm:[0,1,0,1] row_mask:0xf bank_mask:0xf
  v_mfma_f32_16x16x32_bf16 v[208:211], v[116:119], v[32:35], v[208:211]
  v_cndmask_b32_dpp v181, v189, v181, vcc quad_perm:[0,1,0,1] row_mask:0xf bank_mask:0xf
  v_cndmask_b32_dpp v182, v190, v182, vcc quad_perm:[0,1,0,1] row_mask:0xf bank_mask:0xf
  v_cndmask_b32_dpp v183, v191, v183, vcc quad_perm:[0,1,0,1] row_mask:0xf bank_mask:0xf
  v_cndmask_b32_dpp v184, v192, v184, vcc quad_perm:[0,1,0,1] row_mask:0xf bank_mask:0xf
  v_cndmask_b32_dpp v185, v193, v185, vcc quad_perm:[0,1,0,1] row_mask:0xf bank_mask:0xf
  v_cndmask_b32_dpp v186, v194, v186, vcc quad_perm:[0,1,0,1] row_mask:0xf bank_mask:0xf
  v_cndmask_b32_dpp v187, v195, v187, vcc quad_perm:[0,1,0,1] row_mask:0xf bank_mask:0xf
  v_pk_mul_f32 v[180:181], v[180:181], v[156:157]
  v_pk_mul_f32 v[182:183], v[182:183], v[156:157]
  v_pk_mul_f32 v[184:185], v[184:185], v[156:157]
  v_pk_mul_f32 v[186:187], v[186:187], v[156:157]
  v_cvt_pk_bf16_f32 v212, v180, v181
  v_cvt_pk_bf16_f32 v213, v182, v183
  v_cvt_pk_bf16_f32 v214, v184, v185
  v_cvt_pk_bf16_f32 v215, v186, v187
  s_add_u32 s50, s38, 262144
  s_nop 0
  v_smfmac_f32_16x16x64_bf16 v[220:223], v[212:215], a[192:199], v12
  v_cndmask_b32_dpp v196, v204, v196, vcc quad_perm:[0,1,0,1] row_mask:0xf bank_mask:0xf
  v_cndmask_b32_dpp v197, v205, v197, vcc quad_perm:[0,1,0,1] row_mask:0xf bank_mask:0xf
  v_cndmask_b32_dpp v198, v206, v198, vcc quad_perm:[0,1,0,1] row_mask:0xf bank_mask:0xf
  v_cndmask_b32_dpp v199, v207, v199, vcc quad_perm:[0,1,0,1] row_mask:0xf bank_mask:0xf
  v_smfmac_f32_16x16x64_bf16 v[224:227], v[212:215], a[208:215], v12
  v_cndmask_b32_dpp v200, v208, v200, vcc quad_perm:[0,1,0,1] row_mask:0xf bank_mask:0xf
  v_cndmask_b32_dpp v201, v209, v201, vcc quad_perm:[0,1,0,1] row_mask:0xf bank_mask:0xf
  v_cndmask_b32_dpp v202, v210, v202, vcc quad_perm:[0,1,0,1] row_mask:0xf bank_mask:0xf
  v_cndmask_b32_dpp v203, v211, v203, vcc quad_perm:[0,1,0,1] row_mask:0xf bank_mask:0xf
  v_smfmac_f32_16x16x64_bf16 v[228:231], v[212:215], a[224:231], v12
  v_pk_mul_f32 v[196:197], v[196:197], v[156:157]
  v_pk_mul_f32 v[198:199], v[198:199], v[156:157]
  v_pk_mul_f32 v[200:201], v[200:201], v[156:157]
  v_pk_mul_f32 v[202:203], v[202:203], v[156:157]
  v_smfmac_f32_16x16x64_bf16 v[232:235], v[212:215], a[240:247], v12
  v_cvt_pk_bf16_f32 v216, v196, v197
  v_cvt_pk_bf16_f32 v217, v198, v199
  v_cvt_pk_bf16_f32 v218, v200, v201
  v_cvt_pk_bf16_f32 v219, v202, v203
  s_nop 1
  v_smfmac_f32_16x16x64_bf16 v[220:223], v[216:219], a[200:207], v12
  v_smfmac_f32_16x16x64_bf16 v[224:227], v[216:219], a[216:223], v12
  v_smfmac_f32_16x16x64_bf16 v[228:231], v[216:219], a[232:239], v12
  v_smfmac_f32_16x16x64_bf16 v[232:235], v[216:219], a[248:255], v12
  s_nop 4
  v_pk_add_f32 v[220:221], v[220:221], v[222:223]
  ds_write2_b32 v244, v220, v221 offset0:0 offset1:72
  v_pk_add_f32 v[224:225], v[224:225], v[226:227]
  ds_write2_b32 v244, v224, v225 offset0:16 offset1:88
  v_pk_add_f32 v[228:229], v[228:229], v[230:231]
  ds_write2_b32 v244, v228, v229 offset0:32 offset1:104
  v_pk_add_f32 v[232:233], v[232:233], v[234:235]
  ds_write2_b32 v244, v232, v233 offset0:48 offset1:120
  s_waitcnt lgkmcnt(0)
  s_barrier
  ds_read_b64 v[16:17], v245 offset:0
  ds_read_b64 v[18:19], v245 offset:2304
  ds_read_b64 v[20:21], v245 offset:4608
  ds_read_b64 v[22:23], v245 offset:6912
  s_waitcnt lgkmcnt(2)
  v_pk_add_f32 v[16:17], v[16:17], v[18:19]
  s_waitcnt lgkmcnt(0)
  v_pk_add_f32 v[20:21], v[20:21], v[22:23]
  v_pk_add_f32 v[16:17], v[16:17], v[20:21]
  v_cvt_pk_f16_f32 v18, v16, v17
  v_min_u32 v18, 0xfffffffe, v18
  buffer_store_dword v18, v6, s[8:11], s35 offen sc1
  s_cmp_ge_u32 s43, 8
  s_cbranch_scc1 LG_km_none
  s_cmp_eq_u32 s43, 0
  s_cbranch_scc0 LG_km_n0
  s_mov_b64 exec, s[46:47]
  buffer_store_dwordx4 v[120:123], v246, s[4:7], s39 offen offset:0 sc1
  s_mov_b64 exec, -1
  s_waitcnt vmcnt(1)
  s_branch LG_km_done
LG_km_n0:
  s_cmp_eq_u32 s43, 1
  s_cbranch_scc0 LG_km_n1
  s_mov_b64 exec, s[46:47]
  buffer_store_dwordx4 v[124:127], v246, s[4:7], s39 offen offset:512 sc1
  s_mov_b64 exec, -1
  s_waitcnt vmcnt(1)
  s_branch LG_km_done
LG_km_n1:
  s_cmp_eq_u32 s43, 2
  s_cbranch_scc0 LG_km_n2
  s_mov_b64 exec, s[46:47]
  buffer_store_dwordx4 v[128:131], v246, s[4:7], s39 offen offset:1024 sc1
  s_mov_b64 exec, -1
  s_waitcnt vmcnt(1)
  s_branch LG_km_done
LG_km_n2:
  s_cmp_eq_u32 s43, 3
  s_cbranch_scc0 LG_km_n3
  s_mov_b64 exec, s[46:47]
  buffer_store_dwordx4 v[132:135], v246, s[4:7], s39 offen offset:1536 sc1
  s_mov_b64 exec, -1
  s_waitcnt vmcnt(1)
  s_branch LG_km_done
LG_km_n3:
  s_cmp_eq_u32 s43, 4
  s_cbranch_scc0 LG_km_n4
  buffer_store_dwordx2 v[136:137], v247, s[4:7], s39 offen offset:0 sc1
  s_mov_b64 exec, -1
  s_waitcnt vmcnt(1)
  s_branch LG_km_done
LG_km_n4:
  s_cmp_eq_u32 s43, 5
  s_cbranch_scc0 LG_km_n5
  buffer_store_dwordx2 v[138:139], v247, s[4:7], s39 offen offset:512 sc1
  s_mov_b64 exec, -1
  s_waitcnt vmcnt(1)
  s_branch LG_km_done
LG_km_n5:
  s_cmp_eq_u32 s43, 6
  s_cbranch_scc0 LG_km_n6
  buffer_store_dwordx2 v[140:141], v247, s[4:7], s39 offen offset:1024 sc1
  s_mov_b64 exec, -1
  s_waitcnt vmcnt(1)
  s_branch LG_km_done
LG_km_n6:
  s_cmp_eq_u32 s43, 7
  s_cbranch_scc0 LG_km_n7
  buffer_store_dwordx2 v[142:143], v247, s[4:7], s39 offen offset:1536 sc1
  s_mov_b64 exec, -1
  s_waitcnt vmcnt(1)
  s_branch LG_km_done
LG_km_n7:
LG_km_none:
  s_waitcnt vmcnt(0)
LG_km_done:
  s_mov_b32 s40, 200000
  buffer_load_dword v20, v7, s[8:11], s35 offen offset:0 sc1
  buffer_load_dword v21, v7, s[8:11], s35 offen offset:512 sc1
  buffer_load_dword v22, v7, s[8:11], s35 offen offset:1024 sc1
  buffer_load_dword v23, v7, s[8:11], s35 offen offset:1536 sc1
  s_waitcnt vmcnt(0)
LG_pc_chk:
  v_max3_u32 v250, v20, v21, v22
  v_max_u32 v250, v250, v23
  v_cmp_eq_u32 vcc, -1, v250
  s_cbranch_vccz LG_pc_ok
  s_waitcnt vmcnt(0)
  v_cmp_eq_u32 s[52:53], -1, v20
  v_cmp_eq_u32 s[54:55], -1, v21
  v_cmp_eq_u32 s[56:57], -1, v22
  v_cmp_eq_u32 s[58:59], -1, v23
  s_mov_b64 exec, s[52:53]
  buffer_load_dword v20, v7, s[8:11], s35 offen offset:0 sc1
  s_mov_b64 exec, s[54:55]
  buffer_load_dword v21, v7, s[8:11], s35 offen offset:512 sc1
  s_mov_b64 exec, s[56:57]
  buffer_load_dword v22, v7, s[8:11], s35 offen offset:1024 sc1
  s_mov_b64 exec, s[58:59]
  buffer_load_dword v23, v7, s[8:11], s35 offen offset:1536 sc1
  s_mov_b64 exec, -1
  s_waitcnt vmcnt(0)
  s_sub_u32 s40, s40, 1
  s_cbranch_scc0 LG_pc_chk
  s_branch L_fail
LG_pc_ok:
  v_fma_mix_f32 v16, v20, 1.0, v21 op_sel_hi:[1,0,1]
  v_fma_mix_f32 v17, v20, 1.0, v21 op_sel:[1,0,1] op_sel_hi:[1,0,1]
  v_fma_mix_f32 v18, v22, 1.0, v23 op_sel_hi:[1,0,1]
  v_fma_mix_f32 v19, v22, 1.0, v23 op_sel:[1,0,1] op_sel_hi:[1,0,1]
  v_pk_add_f32 v[16:17], v[16:17], v[18:19]
  s_nop 1
  v_permlane32_swap_b32 v16, v17
  v_add_f32 v16, v16, v17
  v_mov_b32 v17, v16
  s_nop 1
  v_permlane32_swap_b32 v16, v17
  v_cvt_pk_bf16_f32 v16, v16, v17
  v_med3_u32 v16, v16, v248, v249
  buffer_store_dword v16, v252, s[8:11], 0 offen sc1
  s_add_u32 s31, s31, 1
  s_branch LG_step
LG_last:
  s_cmp_eq_u32 s28, 0
  s_cbranch_scc1 L_chain_done
  s_cmp_eq_u32 s28, 3
  s_cbranch_scc1 L_chain_done
  ds_read_b128 v[16:19], v15 offset:0
  ds_read_b128 v[20:23], v15 offset:3584
  ds_read_b128 v[24:27], v15 offset:7168
  ds_read_b128 v[28:31], v15 offset:10752
  s_cmp_eq_u32 s28, 1
  s_cselect_b32 s50, 0, 4194304
  s_add_u32 s50, s50, 96403456
  s_lshl_b32 s51, s29, 14
  s_add_u32 s50, s50, s51
  s_lshl_b32 s51, s30, 9
  s_add_u32 s50, s50, s51
  v_lshlrev_b32 v250, 3, v0
  s_waitcnt lgkmcnt(0)
  v_pk_add_f32 v[16:17], v[16:17], v[20:21]
  v_pk_add_f32 v[18:19], v[18:19], v[22:23]
  v_pk_add_f32 v[24:25], v[24:25], v[28:29]
  v_pk_add_f32 v[26:27], v[26:27], v[30:31]
  v_pk_add_f32 v[16:17], v[16:17], v[24:25]
  v_pk_add_f32 v[18:19], v[18:19], v[26:27]
  v_cvt_pk_bf16_f32 v20, v16, v17
  v_cvt_pk_bf16_f32 v21, v18, v19
  buffer_store_dwordx2 v[20:21], v250, s[4:7], s50 offen sc1
  s_branch L_chain_done
L_chain_done:
  s_waitcnt vmcnt(0)
  s_barrier
  s_branch L_join
  s_cmp_lg_u32 s28, 0
  s_cbranch_scc1 L_end
  s_mov_b32 s40, 117444864
  v_mov_b32 v1, s40
  v_mov_b32 v2, 1
  s_mov_b64 exec, 1
  buffer_atomic_add v2, v1, s[4:7], 0 offen sc0 sc1
  s_waitcnt vmcnt(0)
  v_readfirstlane_b32 s40, v2
  s_nop 0
  s_cmp_eq_u32 s40, 127
  s_cbranch_scc0 L_end
  s_mov_b32 s40, 117444736
  v_mov_b32 v2, 64
  buffer_store_dword v2, off, s[4:7], s40 sc1
  s_waitcnt vmcnt(0)
  s_branch L_end
L_fail:
  v_mov_b32 v1, 232
  v_mov_b32 v2, 1
  s_mov_b64 exec, 1
  global_atomic_add v1, v2, s[90:91] sc1
  s_waitcnt vmcnt(0)
L_end:
  s_endpgm
L_tasks:
  s_mov_b32 s76, -1
  s_mov_b32 s27, s28
  s_mov_b32 s35, -1
  s_mov_b32 s78, 1
  s_mov_b32 s79, 131088
  s_mov_b32 s97, s93
  s_branch L_dispatch
L_join:
  s_mov_b32 s27, s77
  s_and_b32 s96, s94, 3
  s_mov_b32 s35, -1
  s_mov_b32 s78, 0
  s_mov_b32 s79, 131088
  s_mov_b32 s76, -1
L_next:
  s_cmp_lg_u32 s27, 0
  s_cbranch_scc1 L_next_a
  s_lshl_b32 s40, s96, 7
  s_add_u32 s40, s40, 117449728
  v_mov_b32 v1, s40
  v_mov_b32 v2, 1
  s_mov_b64 exec, 1
  buffer_atomic_add v2, v1, s[4:7], 0 offen sc0 sc1
  s_xor_b32 s79, s79, 4
  v_mov_b32 v1, s79
  s_waitcnt vmcnt(0)
  ds_write_b32 v1, v2
  s_waitcnt lgkmcnt(0)
  s_mov_b64 exec, -1
  s_branch L_next_b
L_next_a:
  s_xor_b32 s79, s79, 4
  s_waitcnt vmcnt(0)
L_next_b:
  s_barrier
  s_cmp_lg_u32 s27, 0
  s_cbranch_scc1 L_next_w
  s_mov_b64 exec, 1
  s_cmp_lg_u32 s76, -1
  s_cbranch_scc1 L_nosig
  s_cmp_eq_u32 s35, -1
  s_cbranch_scc1 L_nosig
  s_and_b32 s40, s35, 0xffff
  s_add_u32 s40, s40, 117440512
  s_lshr_b32 s41, s35, 16
  s_add_u32 s41, s41, 1
  v_mov_b32 v1, s40
  v_mov_b32 v2, s41
  buffer_atomic_add v2, v1, s[4:7], 0 offen sc1
L_nosig:
  s_mov_b64 exec, -1
L_next_w:
  v_mov_b32 v1, s79
  ds_read_b32 v3, v1
  s_waitcnt lgkmcnt(0)
  v_readfirstlane_b32 s97, v3
L_dispatch:
  s_cmp_lt_u32 s97, 444
  s_cbranch_scc1 L_more
  s_cmp_eq_u32 s76, -1
  s_cbranch_scc1 L_fp_5
  s_waitcnt vmcnt(0)
  s_barrier
  s_cmp_eq_u32 s76, -1
  s_cbranch_scc1 L_pe_6
  s_cmp_lg_u32 s27, 0
  s_cbranch_scc1 L_pe_6_c
  s_and_b32 s47, s76, 0xffff
  s_add_u32 s47, s47, 117440512
  s_lshr_b32 s48, s76, 16
  s_add_u32 s48, s48, 1
  v_mov_b32 v18, s47
  v_mov_b32 v19, s48
  s_mov_b64 exec, 1
  buffer_atomic_add v19, v18, s[4:7], 0 offen sc1
  s_mov_b64 exec, -1
L_pe_6_c:
  s_mov_b32 s76, -1
L_pe_6:
L_fp_5:
  s_waitcnt vmcnt(0)
  s_branch L_end
L_more:
  s_cmp_lt_u32 s97, 236
  s_cbranch_scc0 L_tr_7
  s_cmp_lt_u32 s97, 150
  s_cbranch_scc0 L_tr_8
  s_cmp_lt_u32 s97, 107
  s_cbranch_scc0 L_tr_9
  s_cmp_lt_u32 s97, 63
  s_cbranch_scc0 L_tr_10
  s_cmp_lt_u32 s97, 48
  s_cbranch_scc0 L_tr_11
  s_cmp_lt_u32 s97, 32
  s_cbranch_scc0 L_tr_12
  s_sub_u32 s98, s97, 0
  s_branch T_KVQ
L_tr_12:
  s_sub_u32 s98, s97, 32
  s_and_b32 s40, s98, 0
  s_add_u32 s40, s40, 1
  s_lshl_b32 s40, s40, 4
  s_lshr_b32 s98, s98, 0
  s_add_u32 s98, s98, s40
  s_branch T_KVH
L_tr_11:
  s_cmp_lt_u32 s97, 55
  s_cbranch_scc0 L_tr_13
  s_sub_u32 s98, s97, 48
  s_and_b32 s28, s98, 0
  s_add_u32 s28, s28, 0
  s_lshr_b32 s98, s98, 0
  s_branch T_GU
L_tr_13:
  s_sub_u32 s98, s97, 55
  s_and_b32 s28, s98, 0
  s_add_u32 s28, s28, 2
  s_lshr_b32 s98, s98, 0
  s_branch T_KV
L_tr_10:
  s_cmp_lt_u32 s97, 85
  s_cbranch_scc0 L_tr_14
  s_cmp_lt_u32 s97, 77
  s_cbranch_scc0 L_tr_15
  s_sub_u32 s98, s97, 63
  s_and_b32 s28, s98, 1
  s_add_u32 s28, s28, 4
  s_lshr_b32 s98, s98, 1
  s_branch T_GU
L_tr_15:
  s_sub_u32 s98, s97, 77
  s_and_b32 s28, s98, 0
  s_add_u32 s28, s28, 3
  s_lshr_b32 s98, s98, 0
  s_branch T_KV
L_tr_14:
  s_cmp_lt_u32 s97, 99
  s_cbranch_scc0 L_tr_16
  s_sub_u32 s98, s97, 85
  s_and_b32 s28, s98, 1
  s_add_u32 s28, s28, 2
  s_lshr_b32 s98, s98, 1
  s_branch T_GU
L_tr_16:
  s_cmp_lt_u32 s97, 106
  s_cbranch_scc0 L_tr_17
  s_sub_u32 s98, s97, 99
  s_and_b32 s28, s98, 0
  s_add_u32 s28, s28, 1
  s_lshr_b32 s98, s98, 0
  s_branch T_GU
L_tr_17:
  s_sub_u32 s98, s97, 106
  s_branch T_D
L_tr_9:
  s_cmp_lt_u32 s97, 132
  s_cbranch_scc0 L_tr_18
  s_cmp_lt_u32 s97, 129
  s_cbranch_scc0 L_tr_19
  s_cmp_lt_u32 s97, 115
  s_cbranch_scc0 L_tr_20
  s_sub_u32 s98, s97, 107
  s_and_b32 s28, s98, 0
  s_add_u32 s28, s28, 4
  s_lshr_b32 s98, s98, 0
  s_branch T_KV
L_tr_20:
  s_sub_u32 s98, s97, 115
  s_and_b32 s28, s98, 1
  s_add_u32 s28, s28, 6
  s_lshr_b32 s98, s98, 1
  s_branch T_GU
L_tr_19:
  s_cmp_lt_u32 s97, 130
  s_cbranch_scc0 L_tr_21
  s_sub_u32 s98, s97, 127
  s_branch T_D
L_tr_21:
  s_cmp_lt_u32 s97, 131
  s_cbranch_scc0 L_tr_22
  s_sub_u32 s98, s97, 127
  s_branch T_D
L_tr_22:
  s_sub_u32 s98, s97, 130
  s_branch T_D
L_tr_18:
  s_cmp_lt_u32 s97, 137
  s_cbranch_scc0 L_tr_23
  s_cmp_lt_u32 s97, 136
  s_cbranch_scc0 L_tr_24
  s_sub_u32 s98, s97, 132
  s_and_b32 s28, s98, 0
  s_add_u32 s28, s28, 1
  s_lshr_b32 s98, s98, 0
  s_branch T_Q
L_tr_24:
  s_sub_u32 s98, s97, 132
  s_branch T_D
L_tr_23:
  s_cmp_lt_u32 s97, 138
  s_cbranch_scc0 L_tr_25
  s_sub_u32 s98, s97, 132
  s_branch T_D
L_tr_25:
  s_cmp_lt_u32 s97, 142
  s_cbranch_scc0 L_tr_26
  s_sub_u32 s98, s97, 138
  s_and_b32 s28, s98, 0
  s_add_u32 s28, s28, 0
  s_lshr_b32 s98, s98, 0
  s_branch T_Q
L_tr_26:
  s_sub_u32 s98, s97, 142
  s_and_b32 s28, s98, 0
  s_add_u32 s28, s28, 5
  s_lshr_b32 s98, s98, 0
  s_branch T_KV
L_tr_8:
  s_cmp_lt_u32 s97, 188
  s_cbranch_scc0 L_tr_27
  s_cmp_lt_u32 s97, 167
  s_cbranch_scc0 L_tr_28
  s_cmp_lt_u32 s97, 162
  s_cbranch_scc0 L_tr_29
  s_cmp_lt_u32 s97, 158
  s_cbranch_scc0 L_tr_30
  s_sub_u32 s98, s97, 150
  s_and_b32 s28, s98, 0
  s_add_u32 s28, s28, 7
  s_lshr_b32 s98, s98, 0
  s_branch T_KV
L_tr_30:
  s_sub_u32 s98, s97, 158
  s_branch T_WOF
L_tr_29:
  s_cmp_lt_u32 s97, 166
  s_cbranch_scc0 L_tr_31
  s_sub_u32 s98, s97, 162
  s_and_b32 s28, s98, 0
  s_add_u32 s28, s28, 3
  s_lshr_b32 s98, s98, 0
  s_branch T_Q
L_tr_31:
  s_sub_u32 s98, s97, 160
  s_branch T_D
L_tr_28:
  s_cmp_lt_u32 s97, 176
  s_cbranch_scc0 L_tr_32
  s_cmp_lt_u32 s97, 168
  s_cbranch_scc0 L_tr_33
  s_sub_u32 s98, s97, 160
  s_branch T_D
L_tr_33:
  s_sub_u32 s98, s97, 168
  s_and_b32 s28, s98, 0
  s_add_u32 s28, s28, 6
  s_lshr_b32 s98, s98, 0
  s_branch T_KV
L_tr_32:
  s_cmp_lt_u32 s97, 180
  s_cbranch_scc0 L_tr_34
  s_sub_u32 s98, s97, 176
  s_and_b32 s28, s98, 0
  s_add_u32 s28, s28, 2
  s_lshr_b32 s98, s98, 0
  s_branch T_Q
L_tr_34:
  s_cmp_lt_u32 s97, 184
  s_cbranch_scc0 L_tr_35
  s_sub_u32 s98, s97, 180
  s_and_b32 s28, s98, 0
  s_add_u32 s28, s28, 5
  s_lshr_b32 s98, s98, 0
  s_branch T_Q
L_tr_35:
  s_sub_u32 s98, s97, 184
  s_and_b32 s28, s98, 0
  s_add_u32 s28, s28, 7
  s_lshr_b32 s98, s98, 0
  s_branch T_Q
L_tr_27:
  s_cmp_lt_u32 s97, 214
  s_cbranch_scc0 L_tr_36
  s_cmp_lt_u32 s97, 204
  s_cbranch_scc0 L_tr_37
  s_cmp_lt_u32 s97, 192
  s_cbranch_scc0 L_tr_38
  s_sub_u32 s98, s97, 188
  s_and_b32 s28, s98, 0
  s_add_u32 s28, s28, 4
  s_lshr_b32 s98, s98, 0
  s_branch T_Q
L_tr_38:
  s_sub_u32 s98, s97, 192
  s_branch T_A
L_tr_37:
  s_cmp_lt_u32 s97, 205
  s_cbranch_scc0 L_tr_39
  s_sub_u32 s98, s97, 204
  s_branch T_W
L_tr_39:
  s_cmp_lt_u32 s97, 213
  s_cbranch_scc0 L_tr_40
  s_sub_u32 s98, s97, 193
  s_branch T_A
L_tr_40:
  s_sub_u32 s98, s97, 212
  s_branch T_W
L_tr_36:
  s_cmp_lt_u32 s97, 226
  s_cbranch_scc0 L_tr_41
  s_cmp_lt_u32 s97, 218
  s_cbranch_scc0 L_tr_42
  s_sub_u32 s98, s97, 214
  s_and_b32 s28, s98, 0
  s_add_u32 s28, s28, 6
  s_lshr_b32 s98, s98, 0
  s_branch T_Q
L_tr_42:
  s_sub_u32 s98, s97, 198
  s_branch T_A
L_tr_41:
  s_cmp_lt_u32 s97, 227
  s_cbranch_scc0 L_tr_43
  s_sub_u32 s98, s97, 224
  s_branch T_W
L_tr_43:
  s_cmp_lt_u32 s97, 235
  s_cbranch_scc0 L_tr_44
  s_sub_u32 s98, s97, 199
  s_branch T_A
L_tr_44:
  s_sub_u32 s98, s97, 232
  s_branch T_W
L_tr_7:
  s_cmp_lt_u32 s97, 316
  s_cbranch_scc0 L_tr_45
  s_cmp_lt_u32 s97, 276
  s_cbranch_scc0 L_tr_46
  s_cmp_lt_u32 s97, 254
  s_cbranch_scc0 L_tr_47
  s_cmp_lt_u32 s97, 245
  s_cbranch_scc0 L_tr_48
  s_cmp_lt_u32 s97, 244
  s_cbranch_scc0 L_tr_49
  s_sub_u32 s98, s97, 200
  s_branch T_A
L_tr_49:
  s_sub_u32 s98, s97, 240
  s_branch T_W
L_tr_48:
  s_cmp_lt_u32 s97, 253
  s_cbranch_scc0 L_tr_50
  s_sub_u32 s98, s97, 201
  s_branch T_A
L_tr_50:
  s_sub_u32 s98, s97, 248
  s_branch T_W
L_tr_47:
  s_cmp_lt_u32 s97, 263
  s_cbranch_scc0 L_tr_51
  s_cmp_lt_u32 s97, 262
  s_cbranch_scc0 L_tr_52
  s_sub_u32 s98, s97, 202
  s_branch T_A
L_tr_52:
  s_sub_u32 s98, s97, 256
  s_branch T_W
L_tr_51:
  s_cmp_lt_u32 s97, 271
  s_cbranch_scc0 L_tr_53
  s_sub_u32 s98, s97, 203
  s_branch T_A
L_tr_53:
  s_cmp_lt_u32 s97, 272
  s_cbranch_scc0 L_tr_54
  s_sub_u32 s98, s97, 264
  s_branch T_W
L_tr_54:
  s_sub_u32 s98, s97, 204
  s_branch T_A
L_tr_46:
  s_cmp_lt_u32 s97, 296
  s_cbranch_scc0 L_tr_55
  s_cmp_lt_u32 s97, 284
  s_cbranch_scc0 L_tr_56
  s_cmp_lt_u32 s97, 280
  s_cbranch_scc0 L_tr_57
  s_sub_u32 s98, s97, 268
  s_branch T_W
L_tr_57:
  s_sub_u32 s98, s97, 208
  s_branch T_A
L_tr_56:
  s_cmp_lt_u32 s97, 288
  s_cbranch_scc0 L_tr_58
  s_sub_u32 s98, s97, 272
  s_branch T_W
L_tr_58:
  s_cmp_lt_u32 s97, 292
  s_cbranch_scc0 L_tr_59
  s_sub_u32 s98, s97, 212
  s_branch T_A
L_tr_59:
  s_sub_u32 s98, s97, 276
  s_branch T_W
L_tr_55:
  s_cmp_lt_u32 s97, 304
  s_cbranch_scc0 L_tr_60
  s_cmp_lt_u32 s97, 300
  s_cbranch_scc0 L_tr_61
  s_sub_u32 s98, s97, 216
  s_branch T_A
L_tr_61:
  s_sub_u32 s98, s97, 280
  s_branch T_W
L_tr_60:
  s_cmp_lt_u32 s97, 308
  s_cbranch_scc0 L_tr_62
  s_sub_u32 s98, s97, 220
  s_branch T_A
L_tr_62:
  s_cmp_lt_u32 s97, 312
  s_cbranch_scc0 L_tr_63
  s_sub_u32 s98, s97, 284
  s_branch T_W
L_tr_63:
  s_sub_u32 s98, s97, 224
  s_branch T_A
L_tr_45:
  s_cmp_lt_u32 s97, 356
  s_cbranch_scc0 L_tr_64
  s_cmp_lt_u32 s97, 336
  s_cbranch_scc0 L_tr_65
  s_cmp_lt_u32 s97, 324
  s_cbranch_scc0 L_tr_66
  s_cmp_lt_u32 s97, 320
  s_cbranch_scc0 L_tr_67
  s_sub_u32 s98, s97, 288
  s_branch T_W
L_tr_67:
  s_sub_u32 s98, s97, 228
  s_branch T_A
L_tr_66:
  s_cmp_lt_u32 s97, 328
  s_cbranch_scc0 L_tr_68
  s_sub_u32 s98, s97, 292
  s_branch T_W
L_tr_68:
  s_cmp_lt_u32 s97, 332
  s_cbranch_scc0 L_tr_69
  s_sub_u32 s98, s97, 232
  s_branch T_A
L_tr_69:
  s_sub_u32 s98, s97, 296
  s_branch T_W
L_tr_65:
  s_cmp_lt_u32 s97, 344
  s_cbranch_scc0 L_tr_70
  s_cmp_lt_u32 s97, 340
  s_cbranch_scc0 L_tr_71
  s_sub_u32 s98, s97, 236
  s_branch T_A
L_tr_71:
  s_sub_u32 s98, s97, 300
  s_branch T_W
L_tr_70:
  s_cmp_lt_u32 s97, 348
  s_cbranch_scc0 L_tr_72
  s_sub_u32 s98, s97, 240
  s_branch T_A
L_tr_72:
  s_cmp_lt_u32 s97, 352
  s_cbranch_scc0 L_tr_73
  s_sub_u32 s98, s97, 304
  s_branch T_W
L_tr_73:
  s_sub_u32 s98, s97, 244
  s_branch T_A
L_tr_64:
  s_cmp_lt_u32 s97, 388
  s_cbranch_scc0 L_tr_74
  s_cmp_lt_u32 s97, 364
  s_cbranch_scc0 L_tr_75
  s_cmp_lt_u32 s97, 360
  s_cbranch_scc0 L_tr_76
  s_sub_u32 s98, s97, 308
  s_branch T_W
L_tr_76:
  s_sub_u32 s98, s97, 248
  s_branch T_AL
L_tr_75:
  s_cmp_lt_u32 s97, 368
  s_cbranch_scc0 L_tr_77
  s_sub_u32 s98, s97, 312
  s_branch T_W
L_tr_77:
  s_cmp_lt_u32 s97, 372
  s_cbranch_scc0 L_tr_78
  s_sub_u32 s98, s97, 252
  s_branch T_AL
L_tr_78:
  s_sub_u32 s98, s97, 316
  s_branch T_W
L_tr_74:
  s_cmp_lt_u32 s97, 408
  s_cbranch_scc0 L_tr_79
  s_cmp_lt_u32 s97, 392
  s_cbranch_scc0 L_tr_80
  s_sub_u32 s98, s97, 268
  s_branch T_AL
L_tr_80:
  s_sub_u32 s98, s97, 320
  s_branch T_W
L_tr_79:
  s_cmp_lt_u32 s97, 412
  s_cbranch_scc0 L_tr_81
  s_sub_u32 s98, s97, 284
  s_branch T_AL
L_tr_81:
  s_cmp_lt_u32 s97, 428
  s_cbranch_scc0 L_tr_82
  s_sub_u32 s98, s97, 324
  s_branch T_W
L_tr_82:
  s_sub_u32 s98, s97, 324
  s_branch T_W
T_KVQ:
  s_lshr_b32 s28, s98, 4
  s_and_b32 s40, s98, 7
  s_lshl_b32 s29, s96, 3
  s_add_u32 s29, s29, s40
  s_lshl_b32 s35, s96, 7
  s_add_u32 s35, s35, 9728
  s_bitcmp1_b32 s98, 3
  s_cbranch_scc1 T_KVQ_v
  s_load_dwordx2 s[52:53], s[0:1], 24
  s_mov_b32 s33, 64
  s_mov_b32 s34, 8192
  s_mul_i32 s20, s28, 8192
  s_add_u32 s20, s20, 0
  s_lshl_b32 s21, s29, 8
  s_add_u32 s22, s21, 256
  s_mov_b32 s31, 6
  s_waitcnt lgkmcnt(0)
  s_mov_b32 s12, s52
  s_mov_b32 s13, s53
  s_mov_b32 s14, 0x800000
  s_mov_b32 s15, 0x20000
  s_mov_b32 s16, s52
  s_mov_b32 s17, s53
  s_mov_b32 s18, 0x800000
  s_mov_b32 s19, 0x20000
  s_mov_b32 s8, s4
  s_mov_b32 s9, s5
  s_mov_b32 s10, s6
  s_mov_b32 s11, s7
  v_and_b32 v20, 63, v0
  v_and_b32 v21, 15, v20
  v_lshrrev_b32 v22, 4, v20
  v_lshrrev_b32 v23, 3, v20
  v_and_b32 v23, 1, v23
  v_lshlrev_b32 v23, 1, v23
  v_xor_b32 v23, v22, v23
  v_lshlrev_b32 v23, 4, v23
  v_lshlrev_b32 v24, 6, v21
  v_add_u32 v23, v23, v24
  s_lshr_b32 s40, s27, 1
  s_lshl_b32 s40, s40, 12
  v_add_u32 v1, s40, v23
  v_add_u32 v2, 0x10000, v1
  v_and_b32 v23, 3, v20
  v_lshrrev_b32 v24, 2, v20
  v_and_b32 v24, 3, v24
  v_and_b32 v25, 1, v22
  v_lshlrev_b32 v25, 2, v25
  v_or_b32 v25, v25, v24
  v_lshlrev_b32 v26, 3, v22
  v_add_u32 v26, v26, v24
  v_lshlrev_b32 v26, 8, v26
  v_lshlrev_b32 v23, 3, v23
  v_add_u32 v26, v26, v23
  v_add_u32 v26, 0x4000, v26
  s_and_b32 s40, s27, 1
  s_lshl_b32 s40, s40, 2
  s_add_u32 s41, s40, 0
  v_xor_b32 v27, s41, v25
  v_lshlrev_b32 v27, 5, v27
  v_add_u32 v4, v26, v27
  v_add_u32 v8, 0x10000, v4
  s_add_u32 s41, s40, 1
  v_xor_b32 v27, s41, v25
  v_lshlrev_b32 v27, 5, v27
  v_add_u32 v5, v26, v27
  v_add_u32 v9, 0x10000, v5
  s_add_u32 s41, s40, 2
  v_xor_b32 v27, s41, v25
  v_lshlrev_b32 v27, 5, v27
  v_add_u32 v6, v26, v27
  v_add_u32 v10, 0x10000, v6
  s_add_u32 s41, s40, 3
  v_xor_b32 v27, s41, v25
  v_lshlrev_b32 v27, 5, v27
  v_add_u32 v7, v26, v27
  v_add_u32 v11, 0x10000, v7
  v_lshrrev_b32 v23, 2, v20
  s_lshl_b32 s40, s27, 5
  v_add_u32 v23, s40, v23
  v_mul_lo_u32 v23, v23, s33
  v_lshrrev_b32 v24, 5, v20
  v_lshlrev_b32 v24, 1, v24
  v_and_b32 v25, 3, v20
  v_xor_b32 v24, v24, v25
  v_lshlrev_b32 v24, 4, v24
  v_add_u32 v12, v23, v24
  s_lshl_b32 s40, s33, 4
  v_add_u32 v13, s40, v12
  v_lshrrev_b32 v23, 4, v20
  s_and_b32 s40, s27, 1
  s_lshl_b32 s40, s40, 2
  v_or_b32 v24, s40, v23
  v_and_b32 v25, 15, v20
  v_lshrrev_b32 v26, 1, v25
  v_xor_b32 v26, v26, v24
  v_lshlrev_b32 v26, 5, v26
  v_and_b32 v25, 1, v25
  v_lshlrev_b32 v25, 4, v25
  v_add_u32 v26, v26, v25
  s_lshl_b32 s40, s27, 3
  v_add_u32 v23, s40, v23
  v_mul_lo_u32 v23, v23, s34
  v_add_u32 v16, v23, v26
  s_lshl_b32 s40, s34, 2
  v_add_u32 v17, s40, v16
  s_lshl_b32 s24, s27, 11
  s_lshl_b32 s25, s27, 11
  s_add_u32 s25, s25, 0x4000
  s_lshl_b32 s23, s34, 5
  s_add_u32 m0, s24, 0
  s_nop 0
  buffer_load_dwordx4 v12, s[8:11], s20 offen lds
  s_add_u32 m0, s24, 1024
  s_nop 0
  buffer_load_dwordx4 v13, s[8:11], s20 offen lds
  s_add_u32 m0, s25, 0
  s_nop 0
  buffer_load_dwordx4 v16, s[12:15], s21 offen lds
  s_add_u32 m0, s25, 1024
  s_nop 0
  buffer_load_dwordx4 v17, s[12:15], s21 offen lds
  s_add_u32 s20, s20, 131072
  s_add_u32 s21, s21, s23
  s_add_u32 m0, s24, 32768
  s_nop 0
  buffer_load_dwordx4 v12, s[8:11], s20 offen lds
  s_add_u32 m0, s24, 33792
  s_nop 0
  buffer_load_dwordx4 v13, s[8:11], s20 offen lds
  s_add_u32 m0, s25, 32768
  s_nop 0
  buffer_load_dwordx4 v16, s[12:15], s21 offen lds
  s_add_u32 m0, s25, 33792
  s_nop 0
  buffer_load_dwordx4 v17, s[12:15], s21 offen lds
  s_add_u32 s20, s20, 131072
  s_add_u32 s21, s21, s23
  s_add_u32 m0, s24, 65536
  s_nop 0
  buffer_load_dwordx4 v12, s[8:11], s20 offen lds
  s_add_u32 m0, s24, 66560
  s_nop 0
  buffer_load_dwordx4 v13, s[8:11], s20 offen lds
  s_add_u32 m0, s25, 65536
  s_nop 0
  buffer_load_dwordx4 v16, s[12:15], s21 offen lds
  s_add_u32 m0, s25, 66560
  s_nop 0
  buffer_load_dwordx4 v17, s[12:15], s21 offen lds
  s_add_u32 s20, s20, 131072
  s_add_u32 s21, s21, s23
  s_add_u32 m0, s24, 98304
  s_nop 0
  buffer_load_dwordx4 v12, s[8:11], s20 offen lds
  s_add_u32 m0, s24, 99328
  s_nop 0
  buffer_load_dwordx4 v13, s[8:11], s20 offen lds
  s_add_u32 m0, s25, 98304
  s_nop 0
  buffer_load_dwordx4 v16, s[12:15], s21 offen lds
  s_add_u32 m0, s25, 99328
  s_nop 0
  buffer_load_dwordx4 v17, s[12:15], s21 offen lds
  s_add_u32 s20, s20, 131072
  s_add_u32 s21, s21, s23
  s_waitcnt vmcnt(12)
  s_barrier
  s_cmp_eq_u32 s76, -1
  s_cbranch_scc1 L_pe_83
  s_cmp_lg_u32 s27, 0
  s_cbranch_scc1 L_pe_83_c
  s_and_b32 s47, s76, 0xffff
  s_add_u32 s47, s47, 117440512
  s_lshr_b32 s48, s76, 16
  s_add_u32 s48, s48, 1
  v_mov_b32 v18, s47
  v_mov_b32 v19, s48
  s_mov_b64 exec, 1
  buffer_atomic_add v19, v18, s[4:7], 0 offen sc1
  s_mov_b64 exec, -1
L_pe_83_c:
  s_mov_b32 s76, -1
L_pe_83:
  ds_read_b128 v[64:67], v1 offset:0
  ds_read_b64_tr_b16 v[32:33], v4 offset:0
  ds_read_b64_tr_b16 v[34:35], v4 offset:1024
  ds_read_b128 v[68:71], v1 offset:1024
  ds_read_b64_tr_b16 v[36:37], v5 offset:0
  ds_read_b64_tr_b16 v[38:39], v5 offset:1024
  ds_read_b128 v[72:75], v1 offset:2048
  ds_read_b64_tr_b16 v[40:41], v6 offset:0
  ds_read_b64_tr_b16 v[42:43], v6 offset:1024
  ds_read_b128 v[76:79], v1 offset:3072
  ds_read_b64_tr_b16 v[44:45], v7 offset:0
  ds_read_b64_tr_b16 v[46:47], v7 offset:1024
  s_waitcnt vmcnt(8) lgkmcnt(0)
  s_barrier
  v_mfma_f32_16x16x32_bf16 v[128:131], v[32:35], v[64:67], 0
  s_add_u32 m0, s24, 0
  ds_read_b128 v[96:99], v1 offset:32768
  v_mfma_f32_16x16x32_bf16 v[132:135], v[36:39], v[64:67], 0
  buffer_load_dwordx4 v12, s[8:11], s20 offen lds
  ds_read_b64_tr_b16 v[48:49], v4 offset:32768
  v_mfma_f32_16x16x32_bf16 v[136:139], v[40:43], v[64:67], 0
  ds_read_b64_tr_b16 v[50:51], v4 offset:33792
  v_mfma_f32_16x16x32_bf16 v[140:143], v[44:47], v[64:67], 0
  v_mfma_f32_16x16x32_bf16 v[144:147], v[32:35], v[68:71], 0
  s_add_u32 m0, s24, 1024
  ds_read_b128 v[100:103], v1 offset:33792
  v_mfma_f32_16x16x32_bf16 v[148:151], v[36:39], v[68:71], 0
  buffer_load_dwordx4 v13, s[8:11], s20 offen lds
  ds_read_b64_tr_b16 v[52:53], v5 offset:32768
  v_mfma_f32_16x16x32_bf16 v[152:155], v[40:43], v[68:71], 0
  ds_read_b64_tr_b16 v[54:55], v5 offset:33792
  v_mfma_f32_16x16x32_bf16 v[156:159], v[44:47], v[68:71], 0
  v_mfma_f32_16x16x32_bf16 v[160:163], v[32:35], v[72:75], 0
  s_add_u32 m0, s25, 0
  ds_read_b128 v[104:107], v1 offset:34816
  v_mfma_f32_16x16x32_bf16 v[164:167], v[36:39], v[72:75], 0
  buffer_load_dwordx4 v16, s[12:15], s21 offen lds
  ds_read_b64_tr_b16 v[56:57], v6 offset:32768
  v_mfma_f32_16x16x32_bf16 v[168:171], v[40:43], v[72:75], 0
  ds_read_b64_tr_b16 v[58:59], v6 offset:33792
  v_mfma_f32_16x16x32_bf16 v[172:175], v[44:47], v[72:75], 0
  v_mfma_f32_16x16x32_bf16 v[176:179], v[32:35], v[76:79], 0
  s_add_u32 m0, s25, 1024
  ds_read_b128 v[108:111], v1 offset:35840
  v_mfma_f32_16x16x32_bf16 v[180:183], v[36:39], v[76:79], 0
  buffer_load_dwordx4 v17, s[12:15], s21 offen lds
  s_add_u32 s20, s20, 131072
  ds_read_b64_tr_b16 v[60:61], v7 offset:32768
  v_mfma_f32_16x16x32_bf16 v[184:187], v[40:43], v[76:79], 0
  s_add_u32 s21, s21, s23
  ds_read_b64_tr_b16 v[62:63], v7 offset:33792
  v_mfma_f32_16x16x32_bf16 v[188:191], v[44:47], v[76:79], 0
  s_waitcnt vmcnt(8) lgkmcnt(0)
  s_barrier
  v_mfma_f32_16x16x32_bf16 v[128:131], v[48:51], v[96:99], v[128:131]
  s_add_u32 m0, s24, 32768
  ds_read_b128 v[64:67], v2 offset:0
  v_mfma_f32_16x16x32_bf16 v[132:135], v[52:55], v[96:99], v[132:135]
  buffer_load_dwordx4 v12, s[8:11], s20 offen lds
  ds_read_b64_tr_b16 v[32:33], v8 offset:0
  v_mfma_f32_16x16x32_bf16 v[136:139], v[56:59], v[96:99], v[136:139]
  ds_read_b64_tr_b16 v[34:35], v8 offset:1024
  v_mfma_f32_16x16x32_bf16 v[140:143], v[60:63], v[96:99], v[140:143]
  v_mfma_f32_16x16x32_bf16 v[144:147], v[48:51], v[100:103], v[144:147]
  s_add_u32 m0, s24, 33792
  ds_read_b128 v[68:71], v2 offset:1024
  v_mfma_f32_16x16x32_bf16 v[148:151], v[52:55], v[100:103], v[148:151]
  buffer_load_dwordx4 v13, s[8:11], s20 offen lds
  ds_read_b64_tr_b16 v[36:37], v9 offset:0
  v_mfma_f32_16x16x32_bf16 v[152:155], v[56:59], v[100:103], v[152:155]
  ds_read_b64_tr_b16 v[38:39], v9 offset:1024
  v_mfma_f32_16x16x32_bf16 v[156:159], v[60:63], v[100:103], v[156:159]
  v_mfma_f32_16x16x32_bf16 v[160:163], v[48:51], v[104:107], v[160:163]
  s_add_u32 m0, s25, 32768
  ds_read_b128 v[72:75], v2 offset:2048
  v_mfma_f32_16x16x32_bf16 v[164:167], v[52:55], v[104:107], v[164:167]
  buffer_load_dwordx4 v16, s[12:15], s21 offen lds
  ds_read_b64_tr_b16 v[40:41], v10 offset:0
  v_mfma_f32_16x16x32_bf16 v[168:171], v[56:59], v[104:107], v[168:171]
  ds_read_b64_tr_b16 v[42:43], v10 offset:1024
  v_mfma_f32_16x16x32_bf16 v[172:175], v[60:63], v[104:107], v[172:175]
  v_mfma_f32_16x16x32_bf16 v[176:179], v[48:51], v[108:111], v[176:179]
  s_add_u32 m0, s25, 33792
  ds_read_b128 v[76:79], v2 offset:3072
  v_mfma_f32_16x16x32_bf16 v[180:183], v[52:55], v[108:111], v[180:183]
  buffer_load_dwordx4 v17, s[12:15], s21 offen lds
  s_add_u32 s20, s20, 131072
  ds_read_b64_tr_b16 v[44:45], v11 offset:0
  v_mfma_f32_16x16x32_bf16 v[184:187], v[56:59], v[108:111], v[184:187]
  s_add_u32 s21, s21, s23
  ds_read_b64_tr_b16 v[46:47], v11 offset:1024
  v_mfma_f32_16x16x32_bf16 v[188:191], v[60:63], v[108:111], v[188:191]
  s_waitcnt vmcnt(8) lgkmcnt(0)
  s_barrier
  v_mfma_f32_16x16x32_bf16 v[128:131], v[32:35], v[64:67], v[128:131]
  s_add_u32 m0, s24, 65536
  ds_read_b128 v[96:99], v2 offset:32768
  v_mfma_f32_16x16x32_bf16 v[132:135], v[36:39], v[64:67], v[132:135]
  buffer_load_dwordx4 v12, s[8:11], s20 offen lds
  ds_read_b64_tr_b16 v[48:49], v8 offset:32768
  v_mfma_f32_16x16x32_bf16 v[136:139], v[40:43], v[64:67], v[136:139]
  ds_read_b64_tr_b16 v[50:51], v8 offset:33792
  v_mfma_f32_16x16x32_bf16 v[140:143], v[44:47], v[64:67], v[140:143]
  v_mfma_f32_16x16x32_bf16 v[144:147], v[32:35], v[68:71], v[144:147]
  s_add_u32 m0, s24, 66560
  ds_read_b128 v[100:103], v2 offset:33792
  v_mfma_f32_16x16x32_bf16 v[148:151], v[36:39], v[68:71], v[148:151]
  buffer_load_dwordx4 v13, s[8:11], s20 offen lds
  ds_read_b64_tr_b16 v[52:53], v9 offset:32768
  v_mfma_f32_16x16x32_bf16 v[152:155], v[40:43], v[68:71], v[152:155]
  ds_read_b64_tr_b16 v[54:55], v9 offset:33792
  v_mfma_f32_16x16x32_bf16 v[156:159], v[44:47], v[68:71], v[156:159]
  v_mfma_f32_16x16x32_bf16 v[160:163], v[32:35], v[72:75], v[160:163]
  s_add_u32 m0, s25, 65536
  ds_read_b128 v[104:107], v2 offset:34816
  v_mfma_f32_16x16x32_bf16 v[164:167], v[36:39], v[72:75], v[164:167]
  buffer_load_dwordx4 v16, s[12:15], s21 offen lds
  ds_read_b64_tr_b16 v[56:57], v10 offset:32768
  v_mfma_f32_16x16x32_bf16 v[168:171], v[40:43], v[72:75], v[168:171]
  ds_read_b64_tr_b16 v[58:59], v10 offset:33792
  v_mfma_f32_16x16x32_bf16 v[172:175], v[44:47], v[72:75], v[172:175]
  v_mfma_f32_16x16x32_bf16 v[176:179], v[32:35], v[76:79], v[176:179]
  s_add_u32 m0, s25, 66560
  ds_read_b128 v[108:111], v2 offset:35840
  v_mfma_f32_16x16x32_bf16 v[180:183], v[36:39], v[76:79], v[180:183]
  buffer_load_dwordx4 v17, s[12:15], s21 offen lds
  s_add_u32 s20, s20, 131072
  ds_read_b64_tr_b16 v[60:61], v11 offset:32768
  v_mfma_f32_16x16x32_bf16 v[184:187], v[40:43], v[76:79], v[184:187]
  s_add_u32 s21, s21, s23
  ds_read_b64_tr_b16 v[62:63], v11 offset:33792
  v_mfma_f32_16x16x32_bf16 v[188:191], v[44:47], v[76:79], v[188:191]
  s_waitcnt vmcnt(8) lgkmcnt(0)
  s_barrier
  v_mfma_f32_16x16x32_bf16 v[128:131], v[48:51], v[96:99], v[128:131]
  s_add_u32 m0, s24, 98304
  ds_read_b128 v[64:67], v1 offset:0
  v_mfma_f32_16x16x32_bf16 v[132:135], v[52:55], v[96:99], v[132:135]
  buffer_load_dwordx4 v12, s[8:11], s20 offen lds
  ds_read_b64_tr_b16 v[32:33], v4 offset:0
  v_mfma_f32_16x16x32_bf16 v[136:139], v[56:59], v[96:99], v[136:139]
  ds_read_b64_tr_b16 v[34:35], v4 offset:1024
  v_mfma_f32_16x16x32_bf16 v[140:143], v[60:63], v[96:99], v[140:143]
  v_mfma_f32_16x16x32_bf16 v[144:147], v[48:51], v[100:103], v[144:147]
  s_add_u32 m0, s24, 99328
  ds_read_b128 v[68:71], v1 offset:1024
  v_mfma_f32_16x16x32_bf16 v[148:151], v[52:55], v[100:103], v[148:151]
  buffer_load_dwordx4 v13, s[8:11], s20 offen lds
  ds_read_b64_tr_b16 v[36:37], v5 offset:0
  v_mfma_f32_16x16x32_bf16 v[152:155], v[56:59], v[100:103], v[152:155]
  ds_read_b64_tr_b16 v[38:39], v5 offset:1024
  v_mfma_f32_16x16x32_bf16 v[156:159], v[60:63], v[100:103], v[156:159]
  v_mfma_f32_16x16x32_bf16 v[160:163], v[48:51], v[104:107], v[160:163]
  s_add_u32 m0, s25, 98304
  ds_read_b128 v[72:75], v1 offset:2048
  v_mfma_f32_16x16x32_bf16 v[164:167], v[52:55], v[104:107], v[164:167]
  buffer_load_dwordx4 v16, s[12:15], s21 offen lds
  ds_read_b64_tr_b16 v[40:41], v6 offset:0
  v_mfma_f32_16x16x32_bf16 v[168:171], v[56:59], v[104:107], v[168:171]
  ds_read_b64_tr_b16 v[42:43], v6 offset:1024
  v_mfma_f32_16x16x32_bf16 v[172:175], v[60:63], v[104:107], v[172:175]
  v_mfma_f32_16x16x32_bf16 v[176:179], v[48:51], v[108:111], v[176:179]
  s_add_u32 m0, s25, 99328
  ds_read_b128 v[76:79], v1 offset:3072
  v_mfma_f32_16x16x32_bf16 v[180:183], v[52:55], v[108:111], v[180:183]
  buffer_load_dwordx4 v17, s[12:15], s21 offen lds
  s_add_u32 s20, s20, 131072
  ds_read_b64_tr_b16 v[44:45], v7 offset:0
  v_mfma_f32_16x16x32_bf16 v[184:187], v[56:59], v[108:111], v[184:187]
  s_add_u32 s21, s21, s23
  ds_read_b64_tr_b16 v[46:47], v7 offset:1024
  v_mfma_f32_16x16x32_bf16 v[188:191], v[60:63], v[108:111], v[188:191]
  s_mov_b32 s26, s31
T_KVQ_mk_loop:
  s_waitcnt vmcnt(8) lgkmcnt(0)
  s_barrier
  v_mfma_f32_16x16x32_bf16 v[128:131], v[32:35], v[64:67], v[128:131]
  s_add_u32 m0, s24, 0
  ds_read_b128 v[96:99], v1 offset:32768
  v_mfma_f32_16x16x32_bf16 v[132:135], v[36:39], v[64:67], v[132:135]
  buffer_load_dwordx4 v12, s[8:11], s20 offen lds
  ds_read_b64_tr_b16 v[48:49], v4 offset:32768
  v_mfma_f32_16x16x32_bf16 v[136:139], v[40:43], v[64:67], v[136:139]
  ds_read_b64_tr_b16 v[50:51], v4 offset:33792
  v_mfma_f32_16x16x32_bf16 v[140:143], v[44:47], v[64:67], v[140:143]
  v_mfma_f32_16x16x32_bf16 v[144:147], v[32:35], v[68:71], v[144:147]
  s_add_u32 m0, s24, 1024
  ds_read_b128 v[100:103], v1 offset:33792
  v_mfma_f32_16x16x32_bf16 v[148:151], v[36:39], v[68:71], v[148:151]
  buffer_load_dwordx4 v13, s[8:11], s20 offen lds
  ds_read_b64_tr_b16 v[52:53], v5 offset:32768
  v_mfma_f32_16x16x32_bf16 v[152:155], v[40:43], v[68:71], v[152:155]
  ds_read_b64_tr_b16 v[54:55], v5 offset:33792
  v_mfma_f32_16x16x32_bf16 v[156:159], v[44:47], v[68:71], v[156:159]
  v_mfma_f32_16x16x32_bf16 v[160:163], v[32:35], v[72:75], v[160:163]
  s_add_u32 m0, s25, 0
  ds_read_b128 v[104:107], v1 offset:34816
  v_mfma_f32_16x16x32_bf16 v[164:167], v[36:39], v[72:75], v[164:167]
  buffer_load_dwordx4 v16, s[12:15], s21 offen lds
  ds_read_b64_tr_b16 v[56:57], v6 offset:32768
  v_mfma_f32_16x16x32_bf16 v[168:171], v[40:43], v[72:75], v[168:171]
  ds_read_b64_tr_b16 v[58:59], v6 offset:33792
  v_mfma_f32_16x16x32_bf16 v[172:175], v[44:47], v[72:75], v[172:175]
  v_mfma_f32_16x16x32_bf16 v[176:179], v[32:35], v[76:79], v[176:179]
  s_add_u32 m0, s25, 1024
  ds_read_b128 v[108:111], v1 offset:35840
  v_mfma_f32_16x16x32_bf16 v[180:183], v[36:39], v[76:79], v[180:183]
  buffer_load_dwordx4 v17, s[12:15], s21 offen lds
  s_add_u32 s20, s20, 131072
  ds_read_b64_tr_b16 v[60:61], v7 offset:32768
  v_mfma_f32_16x16x32_bf16 v[184:187], v[40:43], v[76:79], v[184:187]
  s_add_u32 s21, s21, s23
  ds_read_b64_tr_b16 v[62:63], v7 offset:33792
  v_mfma_f32_16x16x32_bf16 v[188:191], v[44:47], v[76:79], v[188:191]
  s_waitcnt vmcnt(8) lgkmcnt(0)
  s_barrier
  v_mfma_f32_16x16x32_bf16 v[128:131], v[48:51], v[96:99], v[128:131]
  s_add_u32 m0, s24, 32768
  ds_read_b128 v[64:67], v2 offset:0
  v_mfma_f32_16x16x32_bf16 v[132:135], v[52:55], v[96:99], v[132:135]
  buffer_load_dwordx4 v12, s[8:11], s20 offen lds
  ds_read_b64_tr_b16 v[32:33], v8 offset:0
  v_mfma_f32_16x16x32_bf16 v[136:139], v[56:59], v[96:99], v[136:139]
  ds_read_b64_tr_b16 v[34:35], v8 offset:1024
  v_mfma_f32_16x16x32_bf16 v[140:143], v[60:63], v[96:99], v[140:143]
  v_mfma_f32_16x16x32_bf16 v[144:147], v[48:51], v[100:103], v[144:147]
  s_add_u32 m0, s24, 33792
  ds_read_b128 v[68:71], v2 offset:1024
  v_mfma_f32_16x16x32_bf16 v[148:151], v[52:55], v[100:103], v[148:151]
  buffer_load_dwordx4 v13, s[8:11], s20 offen lds
  ds_read_b64_tr_b16 v[36:37], v9 offset:0
  v_mfma_f32_16x16x32_bf16 v[152:155], v[56:59], v[100:103], v[152:155]
  ds_read_b64_tr_b16 v[38:39], v9 offset:1024
  v_mfma_f32_16x16x32_bf16 v[156:159], v[60:63], v[100:103], v[156:159]
  v_mfma_f32_16x16x32_bf16 v[160:163], v[48:51], v[104:107], v[160:163]
  s_add_u32 m0, s25, 32768
  ds_read_b128 v[72:75], v2 offset:2048
  v_mfma_f32_16x16x32_bf16 v[164:167], v[52:55], v[104:107], v[164:167]
  buffer_load_dwordx4 v16, s[12:15], s21 offen lds
  ds_read_b64_tr_b16 v[40:41], v10 offset:0
  v_mfma_f32_16x16x32_bf16 v[168:171], v[56:59], v[104:107], v[168:171]
  ds_read_b64_tr_b16 v[42:43], v10 offset:1024
  v_mfma_f32_16x16x32_bf16 v[172:175], v[60:63], v[104:107], v[172:175]
  v_mfma_f32_16x16x32_bf16 v[176:179], v[48:51], v[108:111], v[176:179]
  s_add_u32 m0, s25, 33792
  ds_read_b128 v[76:79], v2 offset:3072
  v_mfma_f32_16x16x32_bf16 v[180:183], v[52:55], v[108:111], v[180:183]
  buffer_load_dwordx4 v17, s[12:15], s21 offen lds
  s_add_u32 s20, s20, 131072
  ds_read_b64_tr_b16 v[44:45], v11 offset:0
  v_mfma_f32_16x16x32_bf16 v[184:187], v[56:59], v[108:111], v[184:187]
  s_add_u32 s21, s21, s23
  ds_read_b64_tr_b16 v[46:47], v11 offset:1024
  v_mfma_f32_16x16x32_bf16 v[188:191], v[60:63], v[108:111], v[188:191]
  s_waitcnt vmcnt(8) lgkmcnt(0)
  s_barrier
  v_mfma_f32_16x16x32_bf16 v[128:131], v[32:35], v[64:67], v[128:131]
  s_add_u32 m0, s24, 65536
  ds_read_b128 v[96:99], v2 offset:32768
  v_mfma_f32_16x16x32_bf16 v[132:135], v[36:39], v[64:67], v[132:135]
  buffer_load_dwordx4 v12, s[8:11], s20 offen lds
  ds_read_b64_tr_b16 v[48:49], v8 offset:32768
  v_mfma_f32_16x16x32_bf16 v[136:139], v[40:43], v[64:67], v[136:139]
  ds_read_b64_tr_b16 v[50:51], v8 offset:33792
  v_mfma_f32_16x16x32_bf16 v[140:143], v[44:47], v[64:67], v[140:143]
  v_mfma_f32_16x16x32_bf16 v[144:147], v[32:35], v[68:71], v[144:147]
  s_add_u32 m0, s24, 66560
  ds_read_b128 v[100:103], v2 offset:33792
  v_mfma_f32_16x16x32_bf16 v[148:151], v[36:39], v[68:71], v[148:151]
  buffer_load_dwordx4 v13, s[8:11], s20 offen lds
  ds_read_b64_tr_b16 v[52:53], v9 offset:32768
  v_mfma_f32_16x16x32_bf16 v[152:155], v[40:43], v[68:71], v[152:155]
  ds_read_b64_tr_b16 v[54:55], v9 offset:33792
  v_mfma_f32_16x16x32_bf16 v[156:159], v[44:47], v[68:71], v[156:159]
  v_mfma_f32_16x16x32_bf16 v[160:163], v[32:35], v[72:75], v[160:163]
  s_add_u32 m0, s25, 65536
  ds_read_b128 v[104:107], v2 offset:34816
  v_mfma_f32_16x16x32_bf16 v[164:167], v[36:39], v[72:75], v[164:167]
  buffer_load_dwordx4 v16, s[12:15], s21 offen lds
  ds_read_b64_tr_b16 v[56:57], v10 offset:32768
  v_mfma_f32_16x16x32_bf16 v[168:171], v[40:43], v[72:75], v[168:171]
  ds_read_b64_tr_b16 v[58:59], v10 offset:33792
  v_mfma_f32_16x16x32_bf16 v[172:175], v[44:47], v[72:75], v[172:175]
  v_mfma_f32_16x16x32_bf16 v[176:179], v[32:35], v[76:79], v[176:179]
  s_add_u32 m0, s25, 66560
  ds_read_b128 v[108:111], v2 offset:35840
  v_mfma_f32_16x16x32_bf16 v[180:183], v[36:39], v[76:79], v[180:183]
  buffer_load_dwordx4 v17, s[12:15], s21 offen lds
  s_add_u32 s20, s20, 131072
  ds_read_b64_tr_b16 v[60:61], v11 offset:32768
  v_mfma_f32_16x16x32_bf16 v[184:187], v[40:43], v[76:79], v[184:187]
  s_add_u32 s21, s21, s23
  ds_read_b64_tr_b16 v[62:63], v11 offset:33792
  v_mfma_f32_16x16x32_bf16 v[188:191], v[44:47], v[76:79], v[188:191]
  s_waitcnt vmcnt(8) lgkmcnt(0)
  s_barrier
  v_mfma_f32_16x16x32_bf16 v[128:131], v[48:51], v[96:99], v[128:131]
  s_add_u32 m0, s24, 98304
  ds_read_b128 v[64:67], v1 offset:0
  v_mfma_f32_16x16x32_bf16 v[132:135], v[52:55], v[96:99], v[132:135]
  buffer_load_dwordx4 v12, s[8:11], s20 offen lds
  ds_read_b64_tr_b16 v[32:33], v4 offset:0
  v_mfma_f32_16x16x32_bf16 v[136:139], v[56:59], v[96:99], v[136:139]
  ds_read_b64_tr_b16 v[34:35], v4 offset:1024
  v_mfma_f32_16x16x32_bf16 v[140:143], v[60:63], v[96:99], v[140:143]
  v_mfma_f32_16x16x32_bf16 v[144:147], v[48:51], v[100:103], v[144:147]
  s_add_u32 m0, s24, 99328
  ds_read_b128 v[68:71], v1 offset:1024
  v_mfma_f32_16x16x32_bf16 v[148:151], v[52:55], v[100:103], v[148:151]
  buffer_load_dwordx4 v13, s[8:11], s20 offen lds
  ds_read_b64_tr_b16 v[36:37], v5 offset:0
  v_mfma_f32_16x16x32_bf16 v[152:155], v[56:59], v[100:103], v[152:155]
  ds_read_b64_tr_b16 v[38:39], v5 offset:1024
  v_mfma_f32_16x16x32_bf16 v[156:159], v[60:63], v[100:103], v[156:159]
  v_mfma_f32_16x16x32_bf16 v[160:163], v[48:51], v[104:107], v[160:163]
  s_add_u32 m0, s25, 98304
  ds_read_b128 v[72:75], v1 offset:2048
  v_mfma_f32_16x16x32_bf16 v[164:167], v[52:55], v[104:107], v[164:167]
  buffer_load_dwordx4 v16, s[12:15], s21 offen lds
  ds_read_b64_tr_b16 v[40:41], v6 offset:0
  v_mfma_f32_16x16x32_bf16 v[168:171], v[56:59], v[104:107], v[168:171]
  ds_read_b64_tr_b16 v[42:43], v6 offset:1024
  v_mfma_f32_16x16x32_bf16 v[172:175], v[60:63], v[104:107], v[172:175]
  v_mfma_f32_16x16x32_bf16 v[176:179], v[48:51], v[108:111], v[176:179]
  s_add_u32 m0, s25, 99328
  ds_read_b128 v[76:79], v1 offset:3072
  v_mfma_f32_16x16x32_bf16 v[180:183], v[52:55], v[108:111], v[180:183]
  buffer_load_dwordx4 v17, s[12:15], s21 offen lds
  s_add_u32 s20, s20, 131072
  ds_read_b64_tr_b16 v[44:45], v7 offset:0
  v_mfma_f32_16x16x32_bf16 v[184:187], v[56:59], v[108:111], v[184:187]
  s_add_u32 s21, s21, s23
  ds_read_b64_tr_b16 v[46:47], v7 offset:1024
  v_mfma_f32_16x16x32_bf16 v[188:191], v[60:63], v[108:111], v[188:191]
  s_sub_u32 s26, s26, 1
  s_cmp_lg_u32 s26, 0
  s_cbranch_scc1 T_KVQ_mk_loop
  s_waitcnt vmcnt(8) lgkmcnt(0)
  s_barrier
  v_mfma_f32_16x16x32_bf16 v[128:131], v[32:35], v[64:67], v[128:131]
  ds_read_b128 v[96:99], v1 offset:32768
  v_mfma_f32_16x16x32_bf16 v[132:135], v[36:39], v[64:67], v[132:135]
  ds_read_b64_tr_b16 v[48:49], v4 offset:32768
  v_mfma_f32_16x16x32_bf16 v[136:139], v[40:43], v[64:67], v[136:139]
  ds_read_b64_tr_b16 v[50:51], v4 offset:33792
  v_mfma_f32_16x16x32_bf16 v[140:143], v[44:47], v[64:67], v[140:143]
  v_mfma_f32_16x16x32_bf16 v[144:147], v[32:35], v[68:71], v[144:147]
  ds_read_b128 v[100:103], v1 offset:33792
  v_mfma_f32_16x16x32_bf16 v[148:151], v[36:39], v[68:71], v[148:151]
  ds_read_b64_tr_b16 v[52:53], v5 offset:32768
  v_mfma_f32_16x16x32_bf16 v[152:155], v[40:43], v[68:71], v[152:155]
  ds_read_b64_tr_b16 v[54:55], v5 offset:33792
  v_mfma_f32_16x16x32_bf16 v[156:159], v[44:47], v[68:71], v[156:159]
  v_mfma_f32_16x16x32_bf16 v[160:163], v[32:35], v[72:75], v[160:163]
  ds_read_b128 v[104:107], v1 offset:34816
  v_mfma_f32_16x16x32_bf16 v[164:167], v[36:39], v[72:75], v[164:167]
  ds_read_b64_tr_b16 v[56:57], v6 offset:32768
  v_mfma_f32_16x16x32_bf16 v[168:171], v[40:43], v[72:75], v[168:171]
  ds_read_b64_tr_b16 v[58:59], v6 offset:33792
  v_mfma_f32_16x16x32_bf16 v[172:175], v[44:47], v[72:75], v[172:175]
  v_mfma_f32_16x16x32_bf16 v[176:179], v[32:35], v[76:79], v[176:179]
  ds_read_b128 v[108:111], v1 offset:35840
  v_mfma_f32_16x16x32_bf16 v[180:183], v[36:39], v[76:79], v[180:183]
  ds_read_b64_tr_b16 v[60:61], v7 offset:32768
  v_mfma_f32_16x16x32_bf16 v[184:187], v[40:43], v[76:79], v[184:187]
  ds_read_b64_tr_b16 v[62:63], v7 offset:33792
  v_mfma_f32_16x16x32_bf16 v[188:191], v[44:47], v[76:79], v[188:191]
  s_waitcnt vmcnt(4) lgkmcnt(0)
  s_barrier
  v_mfma_f32_16x16x32_bf16 v[128:131], v[48:51], v[96:99], v[128:131]
  ds_read_b128 v[64:67], v2 offset:0
  v_mfma_f32_16x16x32_bf16 v[132:135], v[52:55], v[96:99], v[132:135]
  ds_read_b64_tr_b16 v[32:33], v8 offset:0
  v_mfma_f32_16x16x32_bf16 v[136:139], v[56:59], v[96:99], v[136:139]
  ds_read_b64_tr_b16 v[34:35], v8 offset:1024
  v_mfma_f32_16x16x32_bf16 v[140:143], v[60:63], v[96:99], v[140:143]
  v_mfma_f32_16x16x32_bf16 v[144:147], v[48:51], v[100:103], v[144:147]
  ds_read_b128 v[68:71], v2 offset:1024
  v_mfma_f32_16x16x32_bf16 v[148:151], v[52:55], v[100:103], v[148:151]
  ds_read_b64_tr_b16 v[36:37], v9 offset:0
  v_mfma_f32_16x16x32_bf16 v[152:155], v[56:59], v[100:103], v[152:155]
  ds_read_b64_tr_b16 v[38:39], v9 offset:1024
  v_mfma_f32_16x16x32_bf16 v[156:159], v[60:63], v[100:103], v[156:159]
  v_mfma_f32_16x16x32_bf16 v[160:163], v[48:51], v[104:107], v[160:163]
  ds_read_b128 v[72:75], v2 offset:2048
  v_mfma_f32_16x16x32_bf16 v[164:167], v[52:55], v[104:107], v[164:167]
  ds_read_b64_tr_b16 v[40:41], v10 offset:0
  v_mfma_f32_16x16x32_bf16 v[168:171], v[56:59], v[104:107], v[168:171]
  ds_read_b64_tr_b16 v[42:43], v10 offset:1024
  v_mfma_f32_16x16x32_bf16 v[172:175], v[60:63], v[104:107], v[172:175]
  v_mfma_f32_16x16x32_bf16 v[176:179], v[48:51], v[108:111], v[176:179]
  ds_read_b128 v[76:79], v2 offset:3072
  v_mfma_f32_16x16x32_bf16 v[180:183], v[52:55], v[108:111], v[180:183]
  ds_read_b64_tr_b16 v[44:45], v11 offset:0
  v_mfma_f32_16x16x32_bf16 v[184:187], v[56:59], v[108:111], v[184:187]
  ds_read_b64_tr_b16 v[46:47], v11 offset:1024
  v_mfma_f32_16x16x32_bf16 v[188:191], v[60:63], v[108:111], v[188:191]
  s_waitcnt vmcnt(0) lgkmcnt(0)
  s_barrier
  v_mfma_f32_16x16x32_bf16 v[128:131], v[32:35], v[64:67], v[128:131]
  ds_read_b128 v[96:99], v2 offset:32768
  v_mfma_f32_16x16x32_bf16 v[132:135], v[36:39], v[64:67], v[132:135]
  ds_read_b64_tr_b16 v[48:49], v8 offset:32768
  v_mfma_f32_16x16x32_bf16 v[136:139], v[40:43], v[64:67], v[136:139]
  ds_read_b64_tr_b16 v[50:51], v8 offset:33792
  v_mfma_f32_16x16x32_bf16 v[140:143], v[44:47], v[64:67], v[140:143]
  v_mfma_f32_16x16x32_bf16 v[144:147], v[32:35], v[68:71], v[144:147]
  ds_read_b128 v[100:103], v2 offset:33792
  v_mfma_f32_16x16x32_bf16 v[148:151], v[36:39], v[68:71], v[148:151]
  ds_read_b64_tr_b16 v[52:53], v9 offset:32768
  v_mfma_f32_16x16x32_bf16 v[152:155], v[40:43], v[68:71], v[152:155]
  ds_read_b64_tr_b16 v[54:55], v9 offset:33792
  v_mfma_f32_16x16x32_bf16 v[156:159], v[44:47], v[68:71], v[156:159]
  v_mfma_f32_16x16x32_bf16 v[160:163], v[32:35], v[72:75], v[160:163]
  ds_read_b128 v[104:107], v2 offset:34816
  v_mfma_f32_16x16x32_bf16 v[164:167], v[36:39], v[72:75], v[164:167]
  ds_read_b64_tr_b16 v[56:57], v10 offset:32768
  v_mfma_f32_16x16x32_bf16 v[168:171], v[40:43], v[72:75], v[168:171]
  ds_read_b64_tr_b16 v[58:59], v10 offset:33792
  v_mfma_f32_16x16x32_bf16 v[172:175], v[44:47], v[72:75], v[172:175]
  v_mfma_f32_16x16x32_bf16 v[176:179], v[32:35], v[76:79], v[176:179]
  ds_read_b128 v[108:111], v2 offset:35840
  v_mfma_f32_16x16x32_bf16 v[180:183], v[36:39], v[76:79], v[180:183]
  ds_read_b64_tr_b16 v[60:61], v11 offset:32768
  v_mfma_f32_16x16x32_bf16 v[184:187], v[40:43], v[76:79], v[184:187]
  ds_read_b64_tr_b16 v[62:63], v11 offset:33792
  v_mfma_f32_16x16x32_bf16 v[188:191], v[44:47], v[76:79], v[188:191]
  s_waitcnt lgkmcnt(0)
  s_barrier
  v_mfma_f32_16x16x32_bf16 v[128:131], v[48:51], v[96:99], v[128:131]
  v_mfma_f32_16x16x32_bf16 v[132:135], v[52:55], v[96:99], v[132:135]
  v_mfma_f32_16x16x32_bf16 v[136:139], v[56:59], v[96:99], v[136:139]
  v_mfma_f32_16x16x32_bf16 v[140:143], v[60:63], v[96:99], v[140:143]
  v_mfma_f32_16x16x32_bf16 v[144:147], v[48:51], v[100:103], v[144:147]
  v_mfma_f32_16x16x32_bf16 v[148:151], v[52:55], v[100:103], v[148:151]
  v_mfma_f32_16x16x32_bf16 v[152:155], v[56:59], v[100:103], v[152:155]
  v_mfma_f32_16x16x32_bf16 v[156:159], v[60:63], v[100:103], v[156:159]
  v_mfma_f32_16x16x32_bf16 v[160:163], v[48:51], v[104:107], v[160:163]
  v_mfma_f32_16x16x32_bf16 v[164:167], v[52:55], v[104:107], v[164:167]
  v_mfma_f32_16x16x32_bf16 v[168:171], v[56:59], v[104:107], v[168:171]
  v_mfma_f32_16x16x32_bf16 v[172:175], v[60:63], v[104:107], v[172:175]
  v_mfma_f32_16x16x32_bf16 v[176:179], v[48:51], v[108:111], v[176:179]
  v_mfma_f32_16x16x32_bf16 v[180:183], v[52:55], v[108:111], v[180:183]
  v_mfma_f32_16x16x32_bf16 v[184:187], v[56:59], v[108:111], v[184:187]
  v_mfma_f32_16x16x32_bf16 v[188:191], v[60:63], v[108:111], v[188:191]
  s_nop 7
  v_and_b32 v20, 63, v0
  v_and_b32 v21, 15, v20
  v_bfe_u32 v22, v20, 4, 1
  v_bfe_u32 v24, v20, 5, 1
  v_lshlrev_b32 v23, 4, v21
  v_lshl_add_u32 v23, v22, 9, v23
  v_lshl_add_u32 v23, v24, 8, v23
  s_lshr_b32 s40, s27, 1
  s_and_b32 s41, s27, 1
  s_lshl_b32 s42, s28, 2
  s_lshl_b32 s43, s40, 1
  s_add_u32 s42, s42, s43
  s_lshl_b32 s42, s42, 18
  s_lshl_b32 s43, s29, 13
  s_add_u32 s42, s42, s43
  s_lshl_b32 s43, s41, 11
  s_add_u32 s42, s42, s43
  s_add_u32 s45, s42, 25165824
  s_add_u32 s46, s45, 0
  v_cvt_pk_bf16_f32 v32, v128, v129
  v_cvt_pk_bf16_f32 v33, v130, v131
  v_cvt_pk_bf16_f32 v34, v132, v133
  v_cvt_pk_bf16_f32 v35, v134, v135
  s_nop 1
  v_permlane16_swap_b32 v32, v34
  v_permlane16_swap_b32 v33, v35
  buffer_store_dwordx4 v[32:35], v23, s[4:7], s46 offen offset:0 sc1
  v_cvt_pk_bf16_f32 v36, v136, v137
  v_cvt_pk_bf16_f32 v37, v138, v139
  v_cvt_pk_bf16_f32 v38, v140, v141
  v_cvt_pk_bf16_f32 v39, v142, v143
  s_nop 1
  v_permlane16_swap_b32 v36, v38
  v_permlane16_swap_b32 v37, v39
  buffer_store_dwordx4 v[36:39], v23, s[4:7], s46 offen offset:1024 sc1
  s_add_u32 s46, s45, 4096
  v_cvt_pk_bf16_f32 v40, v144, v145
  v_cvt_pk_bf16_f32 v41, v146, v147
  v_cvt_pk_bf16_f32 v42, v148, v149
  v_cvt_pk_bf16_f32 v43, v150, v151
  s_nop 1
  v_permlane16_swap_b32 v40, v42
  v_permlane16_swap_b32 v41, v43
  buffer_store_dwordx4 v[40:43], v23, s[4:7], s46 offen offset:0 sc1
  v_cvt_pk_bf16_f32 v44, v152, v153
  v_cvt_pk_bf16_f32 v45, v154, v155
  v_cvt_pk_bf16_f32 v46, v156, v157
  v_cvt_pk_bf16_f32 v47, v158, v159
  s_nop 1
  v_permlane16_swap_b32 v44, v46
  v_permlane16_swap_b32 v45, v47
  buffer_store_dwordx4 v[44:47], v23, s[4:7], s46 offen offset:1024 sc1
  s_add_u32 s46, s45, 262144
  v_cvt_pk_bf16_f32 v32, v160, v161
  v_cvt_pk_bf16_f32 v33, v162, v163
  v_cvt_pk_bf16_f32 v34, v164, v165
  v_cvt_pk_bf16_f32 v35, v166, v167
  s_nop 1
  v_permlane16_swap_b32 v32, v34
  v_permlane16_swap_b32 v33, v35
  buffer_store_dwordx4 v[32:35], v23, s[4:7], s46 offen offset:0 sc1
  v_cvt_pk_bf16_f32 v36, v168, v169
  v_cvt_pk_bf16_f32 v37, v170, v171
  v_cvt_pk_bf16_f32 v38, v172, v173
  v_cvt_pk_bf16_f32 v39, v174, v175
  s_nop 1
  v_permlane16_swap_b32 v36, v38
  v_permlane16_swap_b32 v37, v39
  buffer_store_dwordx4 v[36:39], v23, s[4:7], s46 offen offset:1024 sc1
  s_add_u32 s46, s45, 266240
  v_cvt_pk_bf16_f32 v40, v176, v177
  v_cvt_pk_bf16_f32 v41, v178, v179
  v_cvt_pk_bf16_f32 v42, v180, v181
  v_cvt_pk_bf16_f32 v43, v182, v183
  s_nop 1
  v_permlane16_swap_b32 v40, v42
  v_permlane16_swap_b32 v41, v43
  buffer_store_dwordx4 v[40:43], v23, s[4:7], s46 offen offset:0 sc1
  v_cvt_pk_bf16_f32 v44, v184, v185
  v_cvt_pk_bf16_f32 v45, v186, v187
  v_cvt_pk_bf16_f32 v46, v188, v189
  v_cvt_pk_bf16_f32 v47, v190, v191
  s_nop 1
  v_permlane16_swap_b32 v44, v46
  v_permlane16_swap_b32 v45, v47
  buffer_store_dwordx4 v[44:47], v23, s[4:7], s46 offen offset:1024 sc1
  s_branch L_next
T_KVQ_v:
  s_load_dwordx2 s[52:53], s[0:1], 32
  s_mov_b32 s33, 64
  s_mov_b32 s34, 8192
  s_mul_i32 s20, s28, 8192
  s_add_u32 s20, s20, 0
  s_lshl_b32 s21, s29, 8
  s_add_u32 s22, s21, 256
  s_mov_b32 s31, 6
  s_waitcnt lgkmcnt(0)
  s_mov_b32 s12, s52
  s_mov_b32 s13, s53
  s_mov_b32 s14, 0x800000
  s_mov_b32 s15, 0x20000
  s_mov_b32 s16, s52
  s_mov_b32 s17, s53
  s_mov_b32 s18, 0x800000
  s_mov_b32 s19, 0x20000
  s_mov_b32 s8, s4
  s_mov_b32 s9, s5
  s_mov_b32 s10, s6
  s_mov_b32 s11, s7
  v_and_b32 v20, 63, v0
  v_and_b32 v21, 15, v20
  v_lshrrev_b32 v22, 4, v20
  v_lshrrev_b32 v23, 3, v20
  v_and_b32 v23, 1, v23
  v_lshlrev_b32 v23, 1, v23
  v_xor_b32 v23, v22, v23
  v_lshlrev_b32 v23, 4, v23
  v_lshlrev_b32 v24, 6, v21
  v_add_u32 v23, v23, v24
  s_lshr_b32 s40, s27, 1
  s_lshl_b32 s40, s40, 12
  v_add_u32 v1, s40, v23
  v_add_u32 v2, 0x10000, v1
  v_and_b32 v23, 3, v20
  v_lshrrev_b32 v24, 2, v20
  v_and_b32 v24, 3, v24
  v_and_b32 v25, 1, v22
  v_lshlrev_b32 v25, 2, v25
  v_or_b32 v25, v25, v24
  v_lshlrev_b32 v26, 3, v22
  v_add_u32 v26, v26, v24
  v_lshlrev_b32 v26, 8, v26
  v_lshlrev_b32 v23, 3, v23
  v_add_u32 v26, v26, v23
  v_add_u32 v26, 0x4000, v26
  s_and_b32 s40, s27, 1
  s_lshl_b32 s40, s40, 2
  s_add_u32 s41, s40, 0
  v_xor_b32 v27, s41, v25
  v_lshlrev_b32 v27, 5, v27
  v_add_u32 v4, v26, v27
  v_add_u32 v8, 0x10000, v4
  s_add_u32 s41, s40, 1
  v_xor_b32 v27, s41, v25
  v_lshlrev_b32 v27, 5, v27
  v_add_u32 v5, v26, v27
  v_add_u32 v9, 0x10000, v5
  s_add_u32 s41, s40, 2
  v_xor_b32 v27, s41, v25
  v_lshlrev_b32 v27, 5, v27
  v_add_u32 v6, v26, v27
  v_add_u32 v10, 0x10000, v6
  s_add_u32 s41, s40, 3
  v_xor_b32 v27, s41, v25
  v_lshlrev_b32 v27, 5, v27
  v_add_u32 v7, v26, v27
  v_add_u32 v11, 0x10000, v7
  v_lshrrev_b32 v23, 2, v20
  s_lshl_b32 s40, s27, 5
  v_add_u32 v23, s40, v23
  v_mul_lo_u32 v23, v23, s33
  v_lshrrev_b32 v24, 5, v20
  v_lshlrev_b32 v24, 1, v24
  v_and_b32 v25, 3, v20
  v_xor_b32 v24, v24, v25
  v_lshlrev_b32 v24, 4, v24
  v_add_u32 v12, v23, v24
  s_lshl_b32 s40, s33, 4
  v_add_u32 v13, s40, v12
  v_lshrrev_b32 v23, 4, v20
  s_and_b32 s40, s27, 1
  s_lshl_b32 s40, s40, 2
  v_or_b32 v24, s40, v23
  v_and_b32 v25, 15, v20
  v_lshrrev_b32 v26, 1, v25
  v_xor_b32 v26, v26, v24
  v_lshlrev_b32 v26, 5, v26
  v_and_b32 v25, 1, v25
  v_lshlrev_b32 v25, 4, v25
  v_add_u32 v26, v26, v25
  s_lshl_b32 s40, s27, 3
  v_add_u32 v23, s40, v23
  v_mul_lo_u32 v23, v23, s34
  v_add_u32 v16, v23, v26
  s_lshl_b32 s40, s34, 2
  v_add_u32 v17, s40, v16
  s_lshl_b32 s24, s27, 11
  s_lshl_b32 s25, s27, 11
  s_add_u32 s25, s25, 0x4000
  s_lshl_b32 s23, s34, 5
  s_add_u32 m0, s24, 0
  s_nop 0
  buffer_load_dwordx4 v12, s[8:11], s20 offen lds
  s_add_u32 m0, s24, 1024
  s_nop 0
  buffer_load_dwordx4 v13, s[8:11], s20 offen lds
  s_add_u32 m0, s25, 0
  s_nop 0
  buffer_load_dwordx4 v16, s[12:15], s21 offen lds
  s_add_u32 m0, s25, 1024
  s_nop 0
  buffer_load_dwordx4 v17, s[12:15], s21 offen lds
  s_add_u32 s20, s20, 131072
  s_add_u32 s21, s21, s23
  s_add_u32 m0, s24, 32768
  s_nop 0
  buffer_load_dwordx4 v12, s[8:11], s20 offen lds
  s_add_u32 m0, s24, 33792
  s_nop 0
  buffer_load_dwordx4 v13, s[8:11], s20 offen lds
  s_add_u32 m0, s25, 32768
  s_nop 0
  buffer_load_dwordx4 v16, s[12:15], s21 offen lds
  s_add_u32 m0, s25, 33792
  s_nop 0
  buffer_load_dwordx4 v17, s[12:15], s21 offen lds
  s_add_u32 s20, s20, 131072
  s_add_u32 s21, s21, s23
  s_add_u32 m0, s24, 65536
  s_nop 0
  buffer_load_dwordx4 v12, s[8:11], s20 offen lds
  s_add_u32 m0, s24, 66560
  s_nop 0
  buffer_load_dwordx4 v13, s[8:11], s20 offen lds
  s_add_u32 m0, s25, 65536
  s_nop 0
  buffer_load_dwordx4 v16, s[12:15], s21 offen lds
  s_add_u32 m0, s25, 66560
  s_nop 0
  buffer_load_dwordx4 v17, s[12:15], s21 offen lds
  s_add_u32 s20, s20, 131072
  s_add_u32 s21, s21, s23
  s_add_u32 m0, s24, 98304
  s_nop 0
  buffer_load_dwordx4 v12, s[8:11], s20 offen lds
  s_add_u32 m0, s24, 99328
  s_nop 0
  buffer_load_dwordx4 v13, s[8:11], s20 offen lds
  s_add_u32 m0, s25, 98304
  s_nop 0
  buffer_load_dwordx4 v16, s[12:15], s21 offen lds
  s_add_u32 m0, s25, 99328
  s_nop 0
  buffer_load_dwordx4 v17, s[12:15], s21 offen lds
  s_add_u32 s20, s20, 131072
  s_add_u32 s21, s21, s23
  s_waitcnt vmcnt(12)
  s_barrier
  s_cmp_eq_u32 s76, -1
  s_cbranch_scc1 L_pe_84
  s_cmp_lg_u32 s27, 0
  s_cbranch_scc1 L_pe_84_c
  s_and_b32 s47, s76, 0xffff
  s_add_u32 s47, s47, 117440512
  s_lshr_b32 s48, s76, 16
  s_add_u32 s48, s48, 1
  v_mov_b32 v18, s47
  v_mov_b32 v19, s48
  s_mov_b64 exec, 1
  buffer_atomic_add v19, v18, s[4:7], 0 offen sc1
  s_mov_b64 exec, -1
L_pe_84_c:
  s_mov_b32 s76, -1
L_pe_84:
  ds_read_b128 v[64:67], v1 offset:0
  ds_read_b64_tr_b16 v[32:33], v4 offset:0
  ds_read_b64_tr_b16 v[34:35], v4 offset:1024
  ds_read_b128 v[68:71], v1 offset:1024
  ds_read_b64_tr_b16 v[36:37], v5 offset:0
  ds_read_b64_tr_b16 v[38:39], v5 offset:1024
  ds_read_b128 v[72:75], v1 offset:2048
  ds_read_b64_tr_b16 v[40:41], v6 offset:0
  ds_read_b64_tr_b16 v[42:43], v6 offset:1024
  ds_read_b128 v[76:79], v1 offset:3072
  ds_read_b64_tr_b16 v[44:45], v7 offset:0
  ds_read_b64_tr_b16 v[46:47], v7 offset:1024
  s_waitcnt vmcnt(8) lgkmcnt(0)
  s_barrier
  v_mfma_f32_16x16x32_bf16 v[128:131], v[64:67], v[32:35], 0
  s_add_u32 m0, s24, 0
  ds_read_b128 v[96:99], v1 offset:32768
  v_mfma_f32_16x16x32_bf16 v[132:135], v[64:67], v[36:39], 0
  buffer_load_dwordx4 v12, s[8:11], s20 offen lds
  ds_read_b64_tr_b16 v[48:49], v4 offset:32768
  v_mfma_f32_16x16x32_bf16 v[136:139], v[64:67], v[40:43], 0
  ds_read_b64_tr_b16 v[50:51], v4 offset:33792
  v_mfma_f32_16x16x32_bf16 v[140:143], v[64:67], v[44:47], 0
  v_mfma_f32_16x16x32_bf16 v[144:147], v[68:71], v[32:35], 0
  s_add_u32 m0, s24, 1024
  ds_read_b128 v[100:103], v1 offset:33792
  v_mfma_f32_16x16x32_bf16 v[148:151], v[68:71], v[36:39], 0
  buffer_load_dwordx4 v13, s[8:11], s20 offen lds
  ds_read_b64_tr_b16 v[52:53], v5 offset:32768
  v_mfma_f32_16x16x32_bf16 v[152:155], v[68:71], v[40:43], 0
  ds_read_b64_tr_b16 v[54:55], v5 offset:33792
  v_mfma_f32_16x16x32_bf16 v[156:159], v[68:71], v[44:47], 0
  v_mfma_f32_16x16x32_bf16 v[160:163], v[72:75], v[32:35], 0
  s_add_u32 m0, s25, 0
  ds_read_b128 v[104:107], v1 offset:34816
  v_mfma_f32_16x16x32_bf16 v[164:167], v[72:75], v[36:39], 0
  buffer_load_dwordx4 v16, s[12:15], s21 offen lds
  ds_read_b64_tr_b16 v[56:57], v6 offset:32768
  v_mfma_f32_16x16x32_bf16 v[168:171], v[72:75], v[40:43], 0
  ds_read_b64_tr_b16 v[58:59], v6 offset:33792
  v_mfma_f32_16x16x32_bf16 v[172:175], v[72:75], v[44:47], 0
  v_mfma_f32_16x16x32_bf16 v[176:179], v[76:79], v[32:35], 0
  s_add_u32 m0, s25, 1024
  ds_read_b128 v[108:111], v1 offset:35840
  v_mfma_f32_16x16x32_bf16 v[180:183], v[76:79], v[36:39], 0
  buffer_load_dwordx4 v17, s[12:15], s21 offen lds
  s_add_u32 s20, s20, 131072
  ds_read_b64_tr_b16 v[60:61], v7 offset:32768
  v_mfma_f32_16x16x32_bf16 v[184:187], v[76:79], v[40:43], 0
  s_add_u32 s21, s21, s23
  ds_read_b64_tr_b16 v[62:63], v7 offset:33792
  v_mfma_f32_16x16x32_bf16 v[188:191], v[76:79], v[44:47], 0
  s_waitcnt vmcnt(8) lgkmcnt(0)
  s_barrier
  v_mfma_f32_16x16x32_bf16 v[128:131], v[96:99], v[48:51], v[128:131]
  s_add_u32 m0, s24, 32768
  ds_read_b128 v[64:67], v2 offset:0
  v_mfma_f32_16x16x32_bf16 v[132:135], v[96:99], v[52:55], v[132:135]
  buffer_load_dwordx4 v12, s[8:11], s20 offen lds
  ds_read_b64_tr_b16 v[32:33], v8 offset:0
  v_mfma_f32_16x16x32_bf16 v[136:139], v[96:99], v[56:59], v[136:139]
  ds_read_b64_tr_b16 v[34:35], v8 offset:1024
  v_mfma_f32_16x16x32_bf16 v[140:143], v[96:99], v[60:63], v[140:143]
  v_mfma_f32_16x16x32_bf16 v[144:147], v[100:103], v[48:51], v[144:147]
  s_add_u32 m0, s24, 33792
  ds_read_b128 v[68:71], v2 offset:1024
  v_mfma_f32_16x16x32_bf16 v[148:151], v[100:103], v[52:55], v[148:151]
  buffer_load_dwordx4 v13, s[8:11], s20 offen lds
  ds_read_b64_tr_b16 v[36:37], v9 offset:0
  v_mfma_f32_16x16x32_bf16 v[152:155], v[100:103], v[56:59], v[152:155]
  ds_read_b64_tr_b16 v[38:39], v9 offset:1024
  v_mfma_f32_16x16x32_bf16 v[156:159], v[100:103], v[60:63], v[156:159]
  v_mfma_f32_16x16x32_bf16 v[160:163], v[104:107], v[48:51], v[160:163]
  s_add_u32 m0, s25, 32768
  ds_read_b128 v[72:75], v2 offset:2048
  v_mfma_f32_16x16x32_bf16 v[164:167], v[104:107], v[52:55], v[164:167]
  buffer_load_dwordx4 v16, s[12:15], s21 offen lds
  ds_read_b64_tr_b16 v[40:41], v10 offset:0
  v_mfma_f32_16x16x32_bf16 v[168:171], v[104:107], v[56:59], v[168:171]
  ds_read_b64_tr_b16 v[42:43], v10 offset:1024
  v_mfma_f32_16x16x32_bf16 v[172:175], v[104:107], v[60:63], v[172:175]
  v_mfma_f32_16x16x32_bf16 v[176:179], v[108:111], v[48:51], v[176:179]
  s_add_u32 m0, s25, 33792
  ds_read_b128 v[76:79], v2 offset:3072
  v_mfma_f32_16x16x32_bf16 v[180:183], v[108:111], v[52:55], v[180:183]
  buffer_load_dwordx4 v17, s[12:15], s21 offen lds
  s_add_u32 s20, s20, 131072
  ds_read_b64_tr_b16 v[44:45], v11 offset:0
  v_mfma_f32_16x16x32_bf16 v[184:187], v[108:111], v[56:59], v[184:187]
  s_add_u32 s21, s21, s23
  ds_read_b64_tr_b16 v[46:47], v11 offset:1024
  v_mfma_f32_16x16x32_bf16 v[188:191], v[108:111], v[60:63], v[188:191]
  s_waitcnt vmcnt(8) lgkmcnt(0)
  s_barrier
  v_mfma_f32_16x16x32_bf16 v[128:131], v[64:67], v[32:35], v[128:131]
  s_add_u32 m0, s24, 65536
  ds_read_b128 v[96:99], v2 offset:32768
  v_mfma_f32_16x16x32_bf16 v[132:135], v[64:67], v[36:39], v[132:135]
  buffer_load_dwordx4 v12, s[8:11], s20 offen lds
  ds_read_b64_tr_b16 v[48:49], v8 offset:32768
  v_mfma_f32_16x16x32_bf16 v[136:139], v[64:67], v[40:43], v[136:139]
  ds_read_b64_tr_b16 v[50:51], v8 offset:33792
  v_mfma_f32_16x16x32_bf16 v[140:143], v[64:67], v[44:47], v[140:143]
  v_mfma_f32_16x16x32_bf16 v[144:147], v[68:71], v[32:35], v[144:147]
  s_add_u32 m0, s24, 66560
  ds_read_b128 v[100:103], v2 offset:33792
  v_mfma_f32_16x16x32_bf16 v[148:151], v[68:71], v[36:39], v[148:151]
  buffer_load_dwordx4 v13, s[8:11], s20 offen lds
  ds_read_b64_tr_b16 v[52:53], v9 offset:32768
  v_mfma_f32_16x16x32_bf16 v[152:155], v[68:71], v[40:43], v[152:155]
  ds_read_b64_tr_b16 v[54:55], v9 offset:33792
  v_mfma_f32_16x16x32_bf16 v[156:159], v[68:71], v[44:47], v[156:159]
  v_mfma_f32_16x16x32_bf16 v[160:163], v[72:75], v[32:35], v[160:163]
  s_add_u32 m0, s25, 65536
  ds_read_b128 v[104:107], v2 offset:34816
  v_mfma_f32_16x16x32_bf16 v[164:167], v[72:75], v[36:39], v[164:167]
  buffer_load_dwordx4 v16, s[12:15], s21 offen lds
  ds_read_b64_tr_b16 v[56:57], v10 offset:32768
  v_mfma_f32_16x16x32_bf16 v[168:171], v[72:75], v[40:43], v[168:171]
  ds_read_b64_tr_b16 v[58:59], v10 offset:33792
  v_mfma_f32_16x16x32_bf16 v[172:175], v[72:75], v[44:47], v[172:175]
  v_mfma_f32_16x16x32_bf16 v[176:179], v[76:79], v[32:35], v[176:179]
  s_add_u32 m0, s25, 66560
  ds_read_b128 v[108:111], v2 offset:35840
  v_mfma_f32_16x16x32_bf16 v[180:183], v[76:79], v[36:39], v[180:183]
  buffer_load_dwordx4 v17, s[12:15], s21 offen lds
  s_add_u32 s20, s20, 131072
  ds_read_b64_tr_b16 v[60:61], v11 offset:32768
  v_mfma_f32_16x16x32_bf16 v[184:187], v[76:79], v[40:43], v[184:187]
  s_add_u32 s21, s21, s23
  ds_read_b64_tr_b16 v[62:63], v11 offset:33792
  v_mfma_f32_16x16x32_bf16 v[188:191], v[76:79], v[44:47], v[188:191]
  s_waitcnt vmcnt(8) lgkmcnt(0)
  s_barrier
  v_mfma_f32_16x16x32_bf16 v[128:131], v[96:99], v[48:51], v[128:131]
  s_add_u32 m0, s24, 98304
  ds_read_b128 v[64:67], v1 offset:0
  v_mfma_f32_16x16x32_bf16 v[132:135], v[96:99], v[52:55], v[132:135]
  buffer_load_dwordx4 v12, s[8:11], s20 offen lds
  ds_read_b64_tr_b16 v[32:33], v4 offset:0
  v_mfma_f32_16x16x32_bf16 v[136:139], v[96:99], v[56:59], v[136:139]
  ds_read_b64_tr_b16 v[34:35], v4 offset:1024
  v_mfma_f32_16x16x32_bf16 v[140:143], v[96:99], v[60:63], v[140:143]
  v_mfma_f32_16x16x32_bf16 v[144:147], v[100:103], v[48:51], v[144:147]
  s_add_u32 m0, s24, 99328
  ds_read_b128 v[68:71], v1 offset:1024
  v_mfma_f32_16x16x32_bf16 v[148:151], v[100:103], v[52:55], v[148:151]
  buffer_load_dwordx4 v13, s[8:11], s20 offen lds
  ds_read_b64_tr_b16 v[36:37], v5 offset:0
  v_mfma_f32_16x16x32_bf16 v[152:155], v[100:103], v[56:59], v[152:155]
  ds_read_b64_tr_b16 v[38:39], v5 offset:1024
  v_mfma_f32_16x16x32_bf16 v[156:159], v[100:103], v[60:63], v[156:159]
  v_mfma_f32_16x16x32_bf16 v[160:163], v[104:107], v[48:51], v[160:163]
  s_add_u32 m0, s25, 98304
  ds_read_b128 v[72:75], v1 offset:2048
  v_mfma_f32_16x16x32_bf16 v[164:167], v[104:107], v[52:55], v[164:167]
  buffer_load_dwordx4 v16, s[12:15], s21 offen lds
  ds_read_b64_tr_b16 v[40:41], v6 offset:0
  v_mfma_f32_16x16x32_bf16 v[168:171], v[104:107], v[56:59], v[168:171]
  ds_read_b64_tr_b16 v[42:43], v6 offset:1024
  v_mfma_f32_16x16x32_bf16 v[172:175], v[104:107], v[60:63], v[172:175]
  v_mfma_f32_16x16x32_bf16 v[176:179], v[108:111], v[48:51], v[176:179]
  s_add_u32 m0, s25, 99328
  ds_read_b128 v[76:79], v1 offset:3072
  v_mfma_f32_16x16x32_bf16 v[180:183], v[108:111], v[52:55], v[180:183]
  buffer_load_dwordx4 v17, s[12:15], s21 offen lds
  s_add_u32 s20, s20, 131072
  ds_read_b64_tr_b16 v[44:45], v7 offset:0
  v_mfma_f32_16x16x32_bf16 v[184:187], v[108:111], v[56:59], v[184:187]
  s_add_u32 s21, s21, s23
  ds_read_b64_tr_b16 v[46:47], v7 offset:1024
  v_mfma_f32_16x16x32_bf16 v[188:191], v[108:111], v[60:63], v[188:191]
  s_mov_b32 s26, s31
T_KVQ_mv_loop:
  s_waitcnt vmcnt(8) lgkmcnt(0)
  s_barrier
  v_mfma_f32_16x16x32_bf16 v[128:131], v[64:67], v[32:35], v[128:131]
  s_add_u32 m0, s24, 0
  ds_read_b128 v[96:99], v1 offset:32768
  v_mfma_f32_16x16x32_bf16 v[132:135], v[64:67], v[36:39], v[132:135]
  buffer_load_dwordx4 v12, s[8:11], s20 offen lds
  ds_read_b64_tr_b16 v[48:49], v4 offset:32768
  v_mfma_f32_16x16x32_bf16 v[136:139], v[64:67], v[40:43], v[136:139]
  ds_read_b64_tr_b16 v[50:51], v4 offset:33792
  v_mfma_f32_16x16x32_bf16 v[140:143], v[64:67], v[44:47], v[140:143]
  v_mfma_f32_16x16x32_bf16 v[144:147], v[68:71], v[32:35], v[144:147]
  s_add_u32 m0, s24, 1024
  ds_read_b128 v[100:103], v1 offset:33792
  v_mfma_f32_16x16x32_bf16 v[148:151], v[68:71], v[36:39], v[148:151]
  buffer_load_dwordx4 v13, s[8:11], s20 offen lds
  ds_read_b64_tr_b16 v[52:53], v5 offset:32768
  v_mfma_f32_16x16x32_bf16 v[152:155], v[68:71], v[40:43], v[152:155]
  ds_read_b64_tr_b16 v[54:55], v5 offset:33792
  v_mfma_f32_16x16x32_bf16 v[156:159], v[68:71], v[44:47], v[156:159]
  v_mfma_f32_16x16x32_bf16 v[160:163], v[72:75], v[32:35], v[160:163]
  s_add_u32 m0, s25, 0
  ds_read_b128 v[104:107], v1 offset:34816
  v_mfma_f32_16x16x32_bf16 v[164:167], v[72:75], v[36:39], v[164:167]
  buffer_load_dwordx4 v16, s[12:15], s21 offen lds
  ds_read_b64_tr_b16 v[56:57], v6 offset:32768
  v_mfma_f32_16x16x32_bf16 v[168:171], v[72:75], v[40:43], v[168:171]
  ds_read_b64_tr_b16 v[58:59], v6 offset:33792
  v_mfma_f32_16x16x32_bf16 v[172:175], v[72:75], v[44:47], v[172:175]
  v_mfma_f32_16x16x32_bf16 v[176:179], v[76:79], v[32:35], v[176:179]
  s_add_u32 m0, s25, 1024
  ds_read_b128 v[108:111], v1 offset:35840
  v_mfma_f32_16x16x32_bf16 v[180:183], v[76:79], v[36:39], v[180:183]
  buffer_load_dwordx4 v17, s[12:15], s21 offen lds
  s_add_u32 s20, s20, 131072
  ds_read_b64_tr_b16 v[60:61], v7 offset:32768
  v_mfma_f32_16x16x32_bf16 v[184:187], v[76:79], v[40:43], v[184:187]
  s_add_u32 s21, s21, s23
  ds_read_b64_tr_b16 v[62:63], v7 offset:33792
  v_mfma_f32_16x16x32_bf16 v[188:191], v[76:79], v[44:47], v[188:191]
  s_waitcnt vmcnt(8) lgkmcnt(0)
  s_barrier
  v_mfma_f32_16x16x32_bf16 v[128:131], v[96:99], v[48:51], v[128:131]
  s_add_u32 m0, s24, 32768
  ds_read_b128 v[64:67], v2 offset:0
  v_mfma_f32_16x16x32_bf16 v[132:135], v[96:99], v[52:55], v[132:135]
  buffer_load_dwordx4 v12, s[8:11], s20 offen lds
  ds_read_b64_tr_b16 v[32:33], v8 offset:0
  v_mfma_f32_16x16x32_bf16 v[136:139], v[96:99], v[56:59], v[136:139]
  ds_read_b64_tr_b16 v[34:35], v8 offset:1024
  v_mfma_f32_16x16x32_bf16 v[140:143], v[96:99], v[60:63], v[140:143]
  v_mfma_f32_16x16x32_bf16 v[144:147], v[100:103], v[48:51], v[144:147]
  s_add_u32 m0, s24, 33792
  ds_read_b128 v[68:71], v2 offset:1024
  v_mfma_f32_16x16x32_bf16 v[148:151], v[100:103], v[52:55], v[148:151]
  buffer_load_dwordx4 v13, s[8:11], s20 offen lds
  ds_read_b64_tr_b16 v[36:37], v9 offset:0
  v_mfma_f32_16x16x32_bf16 v[152:155], v[100:103], v[56:59], v[152:155]
  ds_read_b64_tr_b16 v[38:39], v9 offset:1024
  v_mfma_f32_16x16x32_bf16 v[156:159], v[100:103], v[60:63], v[156:159]
  v_mfma_f32_16x16x32_bf16 v[160:163], v[104:107], v[48:51], v[160:163]
  s_add_u32 m0, s25, 32768
  ds_read_b128 v[72:75], v2 offset:2048
  v_mfma_f32_16x16x32_bf16 v[164:167], v[104:107], v[52:55], v[164:167]
  buffer_load_dwordx4 v16, s[12:15], s21 offen lds
  ds_read_b64_tr_b16 v[40:41], v10 offset:0
  v_mfma_f32_16x16x32_bf16 v[168:171], v[104:107], v[56:59], v[168:171]
  ds_read_b64_tr_b16 v[42:43], v10 offset:1024
  v_mfma_f32_16x16x32_bf16 v[172:175], v[104:107], v[60:63], v[172:175]
  v_mfma_f32_16x16x32_bf16 v[176:179], v[108:111], v[48:51], v[176:179]
  s_add_u32 m0, s25, 33792
  ds_read_b128 v[76:79], v2 offset:3072
  v_mfma_f32_16x16x32_bf16 v[180:183], v[108:111], v[52:55], v[180:183]
  buffer_load_dwordx4 v17, s[12:15], s21 offen lds
  s_add_u32 s20, s20, 131072
  ds_read_b64_tr_b16 v[44:45], v11 offset:0
  v_mfma_f32_16x16x32_bf16 v[184:187], v[108:111], v[56:59], v[184:187]
  s_add_u32 s21, s21, s23
  ds_read_b64_tr_b16 v[46:47], v11 offset:1024
  v_mfma_f32_16x16x32_bf16 v[188:191], v[108:111], v[60:63], v[188:191]
  s_waitcnt vmcnt(8) lgkmcnt(0)
  s_barrier
  v_mfma_f32_16x16x32_bf16 v[128:131], v[64:67], v[32:35], v[128:131]
  s_add_u32 m0, s24, 65536
  ds_read_b128 v[96:99], v2 offset:32768
  v_mfma_f32_16x16x32_bf16 v[132:135], v[64:67], v[36:39], v[132:135]
  buffer_load_dwordx4 v12, s[8:11], s20 offen lds
  ds_read_b64_tr_b16 v[48:49], v8 offset:32768
  v_mfma_f32_16x16x32_bf16 v[136:139], v[64:67], v[40:43], v[136:139]
  ds_read_b64_tr_b16 v[50:51], v8 offset:33792
  v_mfma_f32_16x16x32_bf16 v[140:143], v[64:67], v[44:47], v[140:143]
  v_mfma_f32_16x16x32_bf16 v[144:147], v[68:71], v[32:35], v[144:147]
  s_add_u32 m0, s24, 66560
  ds_read_b128 v[100:103], v2 offset:33792
  v_mfma_f32_16x16x32_bf16 v[148:151], v[68:71], v[36:39], v[148:151]
  buffer_load_dwordx4 v13, s[8:11], s20 offen lds
  ds_read_b64_tr_b16 v[52:53], v9 offset:32768
  v_mfma_f32_16x16x32_bf16 v[152:155], v[68:71], v[40:43], v[152:155]
  ds_read_b64_tr_b16 v[54:55], v9 offset:33792
  v_mfma_f32_16x16x32_bf16 v[156:159], v[68:71], v[44:47], v[156:159]
  v_mfma_f32_16x16x32_bf16 v[160:163], v[72:75], v[32:35], v[160:163]
  s_add_u32 m0, s25, 65536
  ds_read_b128 v[104:107], v2 offset:34816
  v_mfma_f32_16x16x32_bf16 v[164:167], v[72:75], v[36:39], v[164:167]
  buffer_load_dwordx4 v16, s[12:15], s21 offen lds
  ds_read_b64_tr_b16 v[56:57], v10 offset:32768
  v_mfma_f32_16x16x32_bf16 v[168:171], v[72:75], v[40:43], v[168:171]
  ds_read_b64_tr_b16 v[58:59], v10 offset:33792
  v_mfma_f32_16x16x32_bf16 v[172:175], v[72:75], v[44:47], v[172:175]
  v_mfma_f32_16x16x32_bf16 v[176:179], v[76:79], v[32:35], v[176:179]
  s_add_u32 m0, s25, 66560
  ds_read_b128 v[108:111], v2 offset:35840
  v_mfma_f32_16x16x32_bf16 v[180:183], v[76:79], v[36:39], v[180:183]
  buffer_load_dwordx4 v17, s[12:15], s21 offen lds
  s_add_u32 s20, s20, 131072
  ds_read_b64_tr_b16 v[60:61], v11 offset:32768
  v_mfma_f32_16x16x32_bf16 v[184:187], v[76:79], v[40:43], v[184:187]
  s_add_u32 s21, s21, s23
  ds_read_b64_tr_b16 v[62:63], v11 offset:33792
  v_mfma_f32_16x16x32_bf16 v[188:191], v[76:79], v[44:47], v[188:191]
  s_waitcnt vmcnt(8) lgkmcnt(0)
  s_barrier
  v_mfma_f32_16x16x32_bf16 v[128:131], v[96:99], v[48:51], v[128:131]
  s_add_u32 m0, s24, 98304
  ds_read_b128 v[64:67], v1 offset:0
  v_mfma_f32_16x16x32_bf16 v[132:135], v[96:99], v[52:55], v[132:135]
  buffer_load_dwordx4 v12, s[8:11], s20 offen lds
  ds_read_b64_tr_b16 v[32:33], v4 offset:0
  v_mfma_f32_16x16x32_bf16 v[136:139], v[96:99], v[56:59], v[136:139]
  ds_read_b64_tr_b16 v[34:35], v4 offset:1024
  v_mfma_f32_16x16x32_bf16 v[140:143], v[96:99], v[60:63], v[140:143]
  v_mfma_f32_16x16x32_bf16 v[144:147], v[100:103], v[48:51], v[144:147]
  s_add_u32 m0, s24, 99328
  ds_read_b128 v[68:71], v1 offset:1024
  v_mfma_f32_16x16x32_bf16 v[148:151], v[100:103], v[52:55], v[148:151]
  buffer_load_dwordx4 v13, s[8:11], s20 offen lds
  ds_read_b64_tr_b16 v[36:37], v5 offset:0
  v_mfma_f32_16x16x32_bf16 v[152:155], v[100:103], v[56:59], v[152:155]
  ds_read_b64_tr_b16 v[38:39], v5 offset:1024
  v_mfma_f32_16x16x32_bf16 v[156:159], v[100:103], v[60:63], v[156:159]
  v_mfma_f32_16x16x32_bf16 v[160:163], v[104:107], v[48:51], v[160:163]
  s_add_u32 m0, s25, 98304
  ds_read_b128 v[72:75], v1 offset:2048
  v_mfma_f32_16x16x32_bf16 v[164:167], v[104:107], v[52:55], v[164:167]
  buffer_load_dwordx4 v16, s[12:15], s21 offen lds
  ds_read_b64_tr_b16 v[40:41], v6 offset:0
  v_mfma_f32_16x16x32_bf16 v[168:171], v[104:107], v[56:59], v[168:171]
  ds_read_b64_tr_b16 v[42:43], v6 offset:1024
  v_mfma_f32_16x16x32_bf16 v[172:175], v[104:107], v[60:63], v[172:175]
  v_mfma_f32_16x16x32_bf16 v[176:179], v[108:111], v[48:51], v[176:179]
  s_add_u32 m0, s25, 99328
  ds_read_b128 v[76:79], v1 offset:3072
  v_mfma_f32_16x16x32_bf16 v[180:183], v[108:111], v[52:55], v[180:183]
  buffer_load_dwordx4 v17, s[12:15], s21 offen lds
  s_add_u32 s20, s20, 131072
  ds_read_b64_tr_b16 v[44:45], v7 offset:0
  v_mfma_f32_16x16x32_bf16 v[184:187], v[108:111], v[56:59], v[184:187]
  s_add_u32 s21, s21, s23
  ds_read_b64_tr_b16 v[46:47], v7 offset:1024
  v_mfma_f32_16x16x32_bf16 v[188:191], v[108:111], v[60:63], v[188:191]
  s_sub_u32 s26, s26, 1
  s_cmp_lg_u32 s26, 0
  s_cbranch_scc1 T_KVQ_mv_loop
  s_waitcnt vmcnt(8) lgkmcnt(0)
  s_barrier
  v_mfma_f32_16x16x32_bf16 v[128:131], v[64:67], v[32:35], v[128:131]
  ds_read_b128 v[96:99], v1 offset:32768
  v_mfma_f32_16x16x32_bf16 v[132:135], v[64:67], v[36:39], v[132:135]
  ds_read_b64_tr_b16 v[48:49], v4 offset:32768
  v_mfma_f32_16x16x32_bf16 v[136:139], v[64:67], v[40:43], v[136:139]
  ds_read_b64_tr_b16 v[50:51], v4 offset:33792
  v_mfma_f32_16x16x32_bf16 v[140:143], v[64:67], v[44:47], v[140:143]
  v_mfma_f32_16x16x32_bf16 v[144:147], v[68:71], v[32:35], v[144:147]
  ds_read_b128 v[100:103], v1 offset:33792
  v_mfma_f32_16x16x32_bf16 v[148:151], v[68:71], v[36:39], v[148:151]
  ds_read_b64_tr_b16 v[52:53], v5 offset:32768
  v_mfma_f32_16x16x32_bf16 v[152:155], v[68:71], v[40:43], v[152:155]
  ds_read_b64_tr_b16 v[54:55], v5 offset:33792
  v_mfma_f32_16x16x32_bf16 v[156:159], v[68:71], v[44:47], v[156:159]
  v_mfma_f32_16x16x32_bf16 v[160:163], v[72:75], v[32:35], v[160:163]
  ds_read_b128 v[104:107], v1 offset:34816
  v_mfma_f32_16x16x32_bf16 v[164:167], v[72:75], v[36:39], v[164:167]
  ds_read_b64_tr_b16 v[56:57], v6 offset:32768
  v_mfma_f32_16x16x32_bf16 v[168:171], v[72:75], v[40:43], v[168:171]
  ds_read_b64_tr_b16 v[58:59], v6 offset:33792
  v_mfma_f32_16x16x32_bf16 v[172:175], v[72:75], v[44:47], v[172:175]
  v_mfma_f32_16x16x32_bf16 v[176:179], v[76:79], v[32:35], v[176:179]
  ds_read_b128 v[108:111], v1 offset:35840
  v_mfma_f32_16x16x32_bf16 v[180:183], v[76:79], v[36:39], v[180:183]
  ds_read_b64_tr_b16 v[60:61], v7 offset:32768
  v_mfma_f32_16x16x32_bf16 v[184:187], v[76:79], v[40:43], v[184:187]
  ds_read_b64_tr_b16 v[62:63], v7 offset:33792
  v_mfma_f32_16x16x32_bf16 v[188:191], v[76:79], v[44:47], v[188:191]
  s_waitcnt vmcnt(4) lgkmcnt(0)
  s_barrier
  v_mfma_f32_16x16x32_bf16 v[128:131], v[96:99], v[48:51], v[128:131]
  ds_read_b128 v[64:67], v2 offset:0
  v_mfma_f32_16x16x32_bf16 v[132:135], v[96:99], v[52:55], v[132:135]
  ds_read_b64_tr_b16 v[32:33], v8 offset:0
  v_mfma_f32_16x16x32_bf16 v[136:139], v[96:99], v[56:59], v[136:139]
  ds_read_b64_tr_b16 v[34:35], v8 offset:1024
  v_mfma_f32_16x16x32_bf16 v[140:143], v[96:99], v[60:63], v[140:143]
  v_mfma_f32_16x16x32_bf16 v[144:147], v[100:103], v[48:51], v[144:147]
  ds_read_b128 v[68:71], v2 offset:1024
  v_mfma_f32_16x16x32_bf16 v[148:151], v[100:103], v[52:55], v[148:151]
  ds_read_b64_tr_b16 v[36:37], v9 offset:0
  v_mfma_f32_16x16x32_bf16 v[152:155], v[100:103], v[56:59], v[152:155]
  ds_read_b64_tr_b16 v[38:39], v9 offset:1024
  v_mfma_f32_16x16x32_bf16 v[156:159], v[100:103], v[60:63], v[156:159]
  v_mfma_f32_16x16x32_bf16 v[160:163], v[104:107], v[48:51], v[160:163]
  ds_read_b128 v[72:75], v2 offset:2048
  v_mfma_f32_16x16x32_bf16 v[164:167], v[104:107], v[52:55], v[164:167]
  ds_read_b64_tr_b16 v[40:41], v10 offset:0
  v_mfma_f32_16x16x32_bf16 v[168:171], v[104:107], v[56:59], v[168:171]
  ds_read_b64_tr_b16 v[42:43], v10 offset:1024
  v_mfma_f32_16x16x32_bf16 v[172:175], v[104:107], v[60:63], v[172:175]
  v_mfma_f32_16x16x32_bf16 v[176:179], v[108:111], v[48:51], v[176:179]
  ds_read_b128 v[76:79], v2 offset:3072
  v_mfma_f32_16x16x32_bf16 v[180:183], v[108:111], v[52:55], v[180:183]
  ds_read_b64_tr_b16 v[44:45], v11 offset:0
  v_mfma_f32_16x16x32_bf16 v[184:187], v[108:111], v[56:59], v[184:187]
  ds_read_b64_tr_b16 v[46:47], v11 offset:1024
  v_mfma_f32_16x16x32_bf16 v[188:191], v[108:111], v[60:63], v[188:191]
  s_waitcnt vmcnt(0) lgkmcnt(0)
  s_barrier
  v_mfma_f32_16x16x32_bf16 v[128:131], v[64:67], v[32:35], v[128:131]
  ds_read_b128 v[96:99], v2 offset:32768
  v_mfma_f32_16x16x32_bf16 v[132:135], v[64:67], v[36:39], v[132:135]
  ds_read_b64_tr_b16 v[48:49], v8 offset:32768
  v_mfma_f32_16x16x32_bf16 v[136:139], v[64:67], v[40:43], v[136:139]
  ds_read_b64_tr_b16 v[50:51], v8 offset:33792
  v_mfma_f32_16x16x32_bf16 v[140:143], v[64:67], v[44:47], v[140:143]
  v_mfma_f32_16x16x32_bf16 v[144:147], v[68:71], v[32:35], v[144:147]
  ds_read_b128 v[100:103], v2 offset:33792
  v_mfma_f32_16x16x32_bf16 v[148:151], v[68:71], v[36:39], v[148:151]
  ds_read_b64_tr_b16 v[52:53], v9 offset:32768
  v_mfma_f32_16x16x32_bf16 v[152:155], v[68:71], v[40:43], v[152:155]
  ds_read_b64_tr_b16 v[54:55], v9 offset:33792
  v_mfma_f32_16x16x32_bf16 v[156:159], v[68:71], v[44:47], v[156:159]
  v_mfma_f32_16x16x32_bf16 v[160:163], v[72:75], v[32:35], v[160:163]
  ds_read_b128 v[104:107], v2 offset:34816
  v_mfma_f32_16x16x32_bf16 v[164:167], v[72:75], v[36:39], v[164:167]
  ds_read_b64_tr_b16 v[56:57], v10 offset:32768
  v_mfma_f32_16x16x32_bf16 v[168:171], v[72:75], v[40:43], v[168:171]
  ds_read_b64_tr_b16 v[58:59], v10 offset:33792
  v_mfma_f32_16x16x32_bf16 v[172:175], v[72:75], v[44:47], v[172:175]
  v_mfma_f32_16x16x32_bf16 v[176:179], v[76:79], v[32:35], v[176:179]
  ds_read_b128 v[108:111], v2 offset:35840
  v_mfma_f32_16x16x32_bf16 v[180:183], v[76:79], v[36:39], v[180:183]
  ds_read_b64_tr_b16 v[60:61], v11 offset:32768
  v_mfma_f32_16x16x32_bf16 v[184:187], v[76:79], v[40:43], v[184:187]
  ds_read_b64_tr_b16 v[62:63], v11 offset:33792
  v_mfma_f32_16x16x32_bf16 v[188:191], v[76:79], v[44:47], v[188:191]
  s_waitcnt lgkmcnt(0)
  s_barrier
  v_mfma_f32_16x16x32_bf16 v[128:131], v[96:99], v[48:51], v[128:131]
  v_mfma_f32_16x16x32_bf16 v[132:135], v[96:99], v[52:55], v[132:135]
  v_mfma_f32_16x16x32_bf16 v[136:139], v[96:99], v[56:59], v[136:139]
  v_mfma_f32_16x16x32_bf16 v[140:143], v[96:99], v[60:63], v[140:143]
  v_mfma_f32_16x16x32_bf16 v[144:147], v[100:103], v[48:51], v[144:147]
  v_mfma_f32_16x16x32_bf16 v[148:151], v[100:103], v[52:55], v[148:151]
  v_mfma_f32_16x16x32_bf16 v[152:155], v[100:103], v[56:59], v[152:155]
  v_mfma_f32_16x16x32_bf16 v[156:159], v[100:103], v[60:63], v[156:159]
  v_mfma_f32_16x16x32_bf16 v[160:163], v[104:107], v[48:51], v[160:163]
  v_mfma_f32_16x16x32_bf16 v[164:167], v[104:107], v[52:55], v[164:167]
  v_mfma_f32_16x16x32_bf16 v[168:171], v[104:107], v[56:59], v[168:171]
  v_mfma_f32_16x16x32_bf16 v[172:175], v[104:107], v[60:63], v[172:175]
  v_mfma_f32_16x16x32_bf16 v[176:179], v[108:111], v[48:51], v[176:179]
  v_mfma_f32_16x16x32_bf16 v[180:183], v[108:111], v[52:55], v[180:183]
  v_mfma_f32_16x16x32_bf16 v[184:187], v[108:111], v[56:59], v[184:187]
  v_mfma_f32_16x16x32_bf16 v[188:191], v[108:111], v[60:63], v[188:191]
  s_nop 7
  v_and_b32 v20, 63, v0
  v_lshlrev_b32 v23, 4, v20
  s_lshr_b32 s40, s27, 1
  s_and_b32 s41, s27, 1
  s_lshl_b32 s42, s28, 2
  s_lshl_b32 s43, s40, 1
  s_add_u32 s42, s42, s43
  s_lshl_b32 s42, s42, 18
  s_lshl_b32 s43, s29, 13
  s_add_u32 s42, s42, s43
  s_lshl_b32 s43, s41, 12
  s_add_u32 s42, s42, s43
  s_add_u32 s45, s42, 41943040
  s_add_u32 s46, s45, 0
  v_cvt_pk_bf16_f32 v32, v128, v129
  v_cvt_pk_bf16_f32 v33, v130, v131
  v_cvt_pk_bf16_f32 v34, v144, v145
  v_cvt_pk_bf16_f32 v35, v146, v147
  buffer_store_dwordx4 v[32:35], v23, s[4:7], s46 offen offset:0 sc1
  v_cvt_pk_bf16_f32 v36, v132, v133
  v_cvt_pk_bf16_f32 v37, v134, v135
  v_cvt_pk_bf16_f32 v38, v148, v149
  v_cvt_pk_bf16_f32 v39, v150, v151
  buffer_store_dwordx4 v[36:39], v23, s[4:7], s46 offen offset:1024 sc1
  v_cvt_pk_bf16_f32 v40, v136, v137
  v_cvt_pk_bf16_f32 v41, v138, v139
  v_cvt_pk_bf16_f32 v42, v152, v153
  v_cvt_pk_bf16_f32 v43, v154, v155
  buffer_store_dwordx4 v[40:43], v23, s[4:7], s46 offen offset:2048 sc1
  v_cvt_pk_bf16_f32 v44, v140, v141
  v_cvt_pk_bf16_f32 v45, v142, v143
  v_cvt_pk_bf16_f32 v46, v156, v157
  v_cvt_pk_bf16_f32 v47, v158, v159
  buffer_store_dwordx4 v[44:47], v23, s[4:7], s46 offen offset:3072 sc1
  s_add_u32 s46, s45, 262144
  v_cvt_pk_bf16_f32 v32, v160, v161
  v_cvt_pk_bf16_f32 v33, v162, v163
  v_cvt_pk_bf16_f32 v34, v176, v177
  v_cvt_pk_bf16_f32 v35, v178, v179
  buffer_store_dwordx4 v[32:35], v23, s[4:7], s46 offen offset:0 sc1
  v_cvt_pk_bf16_f32 v36, v164, v165
  v_cvt_pk_bf16_f32 v37, v166, v167
  v_cvt_pk_bf16_f32 v38, v180, v181
  v_cvt_pk_bf16_f32 v39, v182, v183
  buffer_store_dwordx4 v[36:39], v23, s[4:7], s46 offen offset:1024 sc1
  v_cvt_pk_bf16_f32 v40, v168, v169
  v_cvt_pk_bf16_f32 v41, v170, v171
  v_cvt_pk_bf16_f32 v42, v184, v185
  v_cvt_pk_bf16_f32 v43, v186, v187
  buffer_store_dwordx4 v[40:43], v23, s[4:7], s46 offen offset:2048 sc1
  v_cvt_pk_bf16_f32 v44, v172, v173
  v_cvt_pk_bf16_f32 v45, v174, v175
  v_cvt_pk_bf16_f32 v46, v188, v189
  v_cvt_pk_bf16_f32 v47, v190, v191
  buffer_store_dwordx4 v[44:47], v23, s[4:7], s46 offen offset:3072 sc1
  s_branch L_next
T_KVH:
  s_lshr_b32 s28, s98, 4
  s_and_b32 s40, s98, 7
  s_lshl_b32 s29, s96, 3
  s_add_u32 s29, s29, s40
  s_lshl_b32 s35, s28, 7
  s_add_u32 s35, s35, 0
  s_bitcmp1_b32 s98, 3
  s_cbranch_scc1 T_KVH_v
  s_load_dwordx2 s[52:53], s[0:1], 24
  s_mov_b32 s33, 64
  s_mov_b32 s34, 8192
  s_mul_i32 s20, s28, 16384
  s_add_u32 s20, s20, 0
  s_lshl_b32 s21, s29, 8
  s_add_u32 s22, s21, 256
  s_mov_b32 s31, 6
  s_waitcnt lgkmcnt(0)
  s_mov_b32 s12, s52
  s_mov_b32 s13, s53
  s_mov_b32 s14, 0x800000
  s_mov_b32 s15, 0x20000
  s_mov_b32 s16, s52
  s_mov_b32 s17, s53
  s_mov_b32 s18, 0x800000
  s_mov_b32 s19, 0x20000
  s_mov_b32 s8, s4
  s_mov_b32 s9, s5
  s_mov_b32 s10, s6
  s_mov_b32 s11, s7
  v_and_b32 v20, 63, v0
  v_and_b32 v21, 15, v20
  v_lshrrev_b32 v22, 4, v20
  v_lshrrev_b32 v23, 3, v20
  v_and_b32 v23, 1, v23
  v_lshlrev_b32 v23, 1, v23
  v_xor_b32 v23, v22, v23
  v_lshlrev_b32 v23, 4, v23
  v_lshlrev_b32 v24, 6, v21
  v_add_u32 v23, v23, v24
  s_lshr_b32 s40, s27, 1
  s_lshl_b32 s40, s40, 13
  v_add_u32 v1, s40, v23
  v_add_u32 v2, 0x10000, v1
  v_and_b32 v23, 3, v20
  v_lshrrev_b32 v24, 2, v20
  v_and_b32 v24, 3, v24
  v_and_b32 v25, 1, v22
  v_lshlrev_b32 v25, 2, v25
  v_or_b32 v25, v25, v24
  v_lshlrev_b32 v26, 3, v22
  v_add_u32 v26, v26, v24
  v_lshlrev_b32 v26, 8, v26
  v_lshlrev_b32 v23, 3, v23
  v_add_u32 v26, v26, v23
  v_add_u32 v26, 0x4000, v26
  s_and_b32 s40, s27, 1
  s_lshl_b32 s40, s40, 2
  s_add_u32 s41, s40, 0
  v_xor_b32 v27, s41, v25
  v_lshlrev_b32 v27, 5, v27
  v_add_u32 v4, v26, v27
  v_add_u32 v8, 0x10000, v4
  s_add_u32 s41, s40, 1
  v_xor_b32 v27, s41, v25
  v_lshlrev_b32 v27, 5, v27
  v_add_u32 v5, v26, v27
  v_add_u32 v9, 0x10000, v5
  s_add_u32 s41, s40, 2
  v_xor_b32 v27, s41, v25
  v_lshlrev_b32 v27, 5, v27
  v_add_u32 v6, v26, v27
  v_add_u32 v10, 0x10000, v6
  s_add_u32 s41, s40, 3
  v_xor_b32 v27, s41, v25
  v_lshlrev_b32 v27, 5, v27
  v_add_u32 v7, v26, v27
  v_add_u32 v11, 0x10000, v7
  v_lshrrev_b32 v23, 2, v20
  s_lshl_b32 s40, s27, 6
  v_add_u32 v23, s40, v23
  v_mul_lo_u32 v23, v23, s33
  v_lshrrev_b32 v24, 5, v20
  v_lshlrev_b32 v24, 1, v24
  v_and_b32 v25, 3, v20
  v_xor_b32 v24, v24, v25
  v_lshlrev_b32 v24, 4, v24
  v_add_u32 v12, v23, v24
  s_lshl_b32 s40, s33, 4
  v_add_u32 v13, s40, v12
  v_add_u32 v14, s40, v13
  v_add_u32 v15, s40, v14
  v_lshrrev_b32 v23, 4, v20
  s_and_b32 s40, s27, 1
  s_lshl_b32 s40, s40, 2
  v_or_b32 v24, s40, v23
  v_and_b32 v25, 15, v20
  v_lshrrev_b32 v26, 1, v25
  v_xor_b32 v26, v26, v24
  v_lshlrev_b32 v26, 5, v26
  v_and_b32 v25, 1, v25
  v_lshlrev_b32 v25, 4, v25
  v_add_u32 v26, v26, v25
  s_lshl_b32 s40, s27, 3
  v_add_u32 v23, s40, v23
  v_mul_lo_u32 v23, v23, s34
  v_add_u32 v16, v23, v26
  s_lshl_b32 s40, s34, 2
  v_add_u32 v17, s40, v16
  s_lshl_b32 s24, s27, 12
  s_lshl_b32 s25, s27, 11
  s_add_u32 s25, s25, 0x4000
  s_lshl_b32 s23, s34, 5
  s_add_u32 m0, s24, 0
  s_nop 0
  buffer_load_dwordx4 v12, s[8:11], s20 offen lds
  s_add_u32 m0, s24, 1024
  s_nop 0
  buffer_load_dwordx4 v13, s[8:11], s20 offen lds
  s_add_u32 m0, s24, 2048
  s_nop 0
  buffer_load_dwordx4 v14, s[8:11], s20 offen lds
  s_add_u32 m0, s24, 3072
  s_nop 0
  buffer_load_dwordx4 v15, s[8:11], s20 offen lds
  s_add_u32 m0, s25, 0
  s_nop 0
  buffer_load_dwordx4 v16, s[12:15], s21 offen lds
  s_add_u32 m0, s25, 1024
  s_nop 0
  buffer_load_dwordx4 v17, s[12:15], s21 offen lds
  s_add_u32 s20, s20, 131072
  s_add_u32 s21, s21, s23
  s_add_u32 m0, s24, 32768
  s_nop 0
  buffer_load_dwordx4 v12, s[8:11], s20 offen lds
  s_add_u32 m0, s24, 33792
  s_nop 0
  buffer_load_dwordx4 v13, s[8:11], s20 offen lds
  s_add_u32 m0, s24, 34816
  s_nop 0
  buffer_load_dwordx4 v14, s[8:11], s20 offen lds
  s_add_u32 m0, s24, 35840
  s_nop 0
  buffer_load_dwordx4 v15, s[8:11], s20 offen lds
  s_add_u32 m0, s25, 32768
  s_nop 0
  buffer_load_dwordx4 v16, s[12:15], s21 offen lds
  s_add_u32 m0, s25, 33792
  s_nop 0
  buffer_load_dwordx4 v17, s[12:15], s21 offen lds
  s_add_u32 s20, s20, 131072
  s_add_u32 s21, s21, s23
  s_add_u32 m0, s24, 65536
  s_nop 0
  buffer_load_dwordx4 v12, s[8:11], s20 offen lds
  s_add_u32 m0, s24, 66560
  s_nop 0
  buffer_load_dwordx4 v13, s[8:11], s20 offen lds
  s_add_u32 m0, s24, 67584
  s_nop 0
  buffer_load_dwordx4 v14, s[8:11], s20 offen lds
  s_add_u32 m0, s24, 68608
  s_nop 0
  buffer_load_dwordx4 v15, s[8:11], s20 offen lds
  s_add_u32 m0, s25, 65536
  s_nop 0
  buffer_load_dwordx4 v16, s[12:15], s21 offen lds
  s_add_u32 m0, s25, 66560
  s_nop 0
  buffer_load_dwordx4 v17, s[12:15], s21 offen lds
  s_add_u32 s20, s20, 131072
  s_add_u32 s21, s21, s23
  s_add_u32 m0, s24, 98304
  s_nop 0
  buffer_load_dwordx4 v12, s[8:11], s20 offen lds
  s_add_u32 m0, s24, 99328
  s_nop 0
  buffer_load_dwordx4 v13, s[8:11], s20 offen lds
  s_add_u32 m0, s24, 100352
  s_nop 0
  buffer_load_dwordx4 v14, s[8:11], s20 offen lds
  s_add_u32 m0, s24, 101376
  s_nop 0
  buffer_load_dwordx4 v15, s[8:11], s20 offen lds
  s_add_u32 m0, s25, 98304
  s_nop 0
  buffer_load_dwordx4 v16, s[12:15], s21 offen lds
  s_add_u32 m0, s25, 99328
  s_nop 0
  buffer_load_dwordx4 v17, s[12:15], s21 offen lds
  s_add_u32 s20, s20, 131072
  s_add_u32 s21, s21, s23
  s_waitcnt vmcnt(18)
  s_barrier
  s_cmp_eq_u32 s76, -1
  s_cbranch_scc1 L_pe_85
  s_cmp_lg_u32 s27, 0
  s_cbranch_scc1 L_pe_85_c
  s_and_b32 s47, s76, 0xffff
  s_add_u32 s47, s47, 117440512
  s_lshr_b32 s48, s76, 16
  s_add_u32 s48, s48, 1
  v_mov_b32 v18, s47
  v_mov_b32 v19, s48
  s_mov_b64 exec, 1
  buffer_atomic_add v19, v18, s[4:7], 0 offen sc1
  s_mov_b64 exec, -1
L_pe_85_c:
  s_mov_b32 s76, -1
L_pe_85:
  ds_read_b128 v[64:67], v1 offset:0
  ds_read_b64_tr_b16 v[32:33], v4 offset:0
  ds_read_b128 v[68:71], v1 offset:1024
  ds_read_b64_tr_b16 v[34:35], v4 offset:1024
  ds_read_b128 v[72:75], v1 offset:2048
  ds_read_b64_tr_b16 v[36:37], v5 offset:0
  ds_read_b128 v[76:79], v1 offset:3072
  ds_read_b64_tr_b16 v[38:39], v5 offset:1024
  ds_read_b128 v[80:83], v1 offset:4096
  ds_read_b64_tr_b16 v[40:41], v6 offset:0
  ds_read_b128 v[84:87], v1 offset:5120
  ds_read_b64_tr_b16 v[42:43], v6 offset:1024
  ds_read_b128 v[88:91], v1 offset:6144
  ds_read_b64_tr_b16 v[44:45], v7 offset:0
  ds_read_b128 v[92:95], v1 offset:7168
  ds_read_b64_tr_b16 v[46:47], v7 offset:1024
  s_waitcnt vmcnt(12) lgkmcnt(0)
  s_barrier
  v_mfma_f32_16x16x32_bf16 v[128:131], v[32:35], v[64:67], 0
  ds_read_b128 v[96:99], v1 offset:32768
  v_mfma_f32_16x16x32_bf16 v[132:135], v[36:39], v[64:67], 0
  s_add_u32 m0, s24, 0
  ds_read_b64_tr_b16 v[48:49], v4 offset:32768
  v_mfma_f32_16x16x32_bf16 v[136:139], v[40:43], v[64:67], 0
  buffer_load_dwordx4 v12, s[8:11], s20 offen lds
  v_mfma_f32_16x16x32_bf16 v[140:143], v[44:47], v[64:67], 0
  ds_read_b128 v[100:103], v1 offset:33792
  v_mfma_f32_16x16x32_bf16 v[144:147], v[32:35], v[68:71], 0
  ds_read_b64_tr_b16 v[50:51], v4 offset:33792
  v_mfma_f32_16x16x32_bf16 v[148:151], v[36:39], v[68:71], 0
  s_add_u32 m0, s24, 1024
  v_mfma_f32_16x16x32_bf16 v[152:155], v[40:43], v[68:71], 0
  buffer_load_dwordx4 v13, s[8:11], s20 offen lds
  ds_read_b128 v[104:107], v1 offset:34816
  v_mfma_f32_16x16x32_bf16 v[156:159], v[44:47], v[68:71], 0
  ds_read_b64_tr_b16 v[52:53], v5 offset:32768
  v_mfma_f32_16x16x32_bf16 v[160:163], v[32:35], v[72:75], 0
  v_mfma_f32_16x16x32_bf16 v[164:167], v[36:39], v[72:75], 0
  s_add_u32 m0, s24, 2048
  ds_read_b128 v[108:111], v1 offset:35840
  v_mfma_f32_16x16x32_bf16 v[168:171], v[40:43], v[72:75], 0
  buffer_load_dwordx4 v14, s[8:11], s20 offen lds
  ds_read_b64_tr_b16 v[54:55], v5 offset:33792
  v_mfma_f32_16x16x32_bf16 v[172:175], v[44:47], v[72:75], 0
  v_mfma_f32_16x16x32_bf16 v[176:179], v[32:35], v[76:79], 0
  ds_read_b128 v[112:115], v1 offset:36864
  v_mfma_f32_16x16x32_bf16 v[180:183], v[36:39], v[76:79], 0
  s_add_u32 m0, s24, 3072
  ds_read_b64_tr_b16 v[56:57], v6 offset:32768
  v_mfma_f32_16x16x32_bf16 v[184:187], v[40:43], v[76:79], 0
  buffer_load_dwordx4 v15, s[8:11], s20 offen lds
  v_mfma_f32_16x16x32_bf16 v[188:191], v[44:47], v[76:79], 0
  ds_read_b128 v[116:119], v1 offset:37888
  v_mfma_f32_16x16x32_bf16 v[192:195], v[32:35], v[80:83], 0
  ds_read_b64_tr_b16 v[58:59], v6 offset:33792
  v_mfma_f32_16x16x32_bf16 v[196:199], v[36:39], v[80:83], 0
  s_add_u32 m0, s25, 0
  v_mfma_f32_16x16x32_bf16 v[200:203], v[40:43], v[80:83], 0
  buffer_load_dwordx4 v16, s[12:15], s21 offen lds
  ds_read_b128 v[120:123], v1 offset:38912
  v_mfma_f32_16x16x32_bf16 v[204:207], v[44:47], v[80:83], 0
  ds_read_b64_tr_b16 v[60:61], v7 offset:32768
  v_mfma_f32_16x16x32_bf16 v[208:211], v[32:35], v[84:87], 0
  v_mfma_f32_16x16x32_bf16 v[212:215], v[36:39], v[84:87], 0
  s_add_u32 m0, s25, 1024
  ds_read_b128 v[124:127], v1 offset:39936
  v_mfma_f32_16x16x32_bf16 v[216:219], v[40:43], v[84:87], 0
  buffer_load_dwordx4 v17, s[12:15], s21 offen lds
  ds_read_b64_tr_b16 v[62:63], v7 offset:33792
  v_mfma_f32_16x16x32_bf16 v[220:223], v[44:47], v[84:87], 0
  v_mfma_f32_16x16x32_bf16 v[224:227], v[32:35], v[88:91], 0
  v_mfma_f32_16x16x32_bf16 v[228:231], v[36:39], v[88:91], 0
  v_mfma_f32_16x16x32_bf16 v[232:235], v[40:43], v[88:91], 0
  s_add_u32 s20, s20, 131072
  v_mfma_f32_16x16x32_bf16 v[236:239], v[44:47], v[88:91], 0
  s_add_u32 s21, s21, s23
  v_mfma_f32_16x16x32_bf16 v[240:243], v[32:35], v[92:95], 0
  v_mfma_f32_16x16x32_bf16 v[244:247], v[36:39], v[92:95], 0
  v_mfma_f32_16x16x32_bf16 v[248:251], v[40:43], v[92:95], 0
  v_mfma_f32_16x16x32_bf16 v[252:255], v[44:47], v[92:95], 0
  s_waitcnt vmcnt(12) lgkmcnt(0)
  s_barrier
  v_mfma_f32_16x16x32_bf16 v[128:131], v[48:51], v[96:99], v[128:131]
  ds_read_b128 v[64:67], v2 offset:0
  v_mfma_f32_16x16x32_bf16 v[132:135], v[52:55], v[96:99], v[132:135]
  s_add_u32 m0, s24, 32768
  ds_read_b64_tr_b16 v[32:33], v8 offset:0
  v_mfma_f32_16x16x32_bf16 v[136:139], v[56:59], v[96:99], v[136:139]
  buffer_load_dwordx4 v12, s[8:11], s20 offen lds
  v_mfma_f32_16x16x32_bf16 v[140:143], v[60:63], v[96:99], v[140:143]
  ds_read_b128 v[68:71], v2 offset:1024
  v_mfma_f32_16x16x32_bf16 v[144:147], v[48:51], v[100:103], v[144:147]
  ds_read_b64_tr_b16 v[34:35], v8 offset:1024
  v_mfma_f32_16x16x32_bf16 v[148:151], v[52:55], v[100:103], v[148:151]
  s_add_u32 m0, s24, 33792
  v_mfma_f32_16x16x32_bf16 v[152:155], v[56:59], v[100:103], v[152:155]
  buffer_load_dwordx4 v13, s[8:11], s20 offen lds
  ds_read_b128 v[72:75], v2 offset:2048
  v_mfma_f32_16x16x32_bf16 v[156:159], v[60:63], v[100:103], v[156:159]
  ds_read_b64_tr_b16 v[36:37], v9 offset:0
  v_mfma_f32_16x16x32_bf16 v[160:163], v[48:51], v[104:107], v[160:163]
  v_mfma_f32_16x16x32_bf16 v[164:167], v[52:55], v[104:107], v[164:167]
  s_add_u32 m0, s24, 34816
  ds_read_b128 v[76:79], v2 offset:3072
  v_mfma_f32_16x16x32_bf16 v[168:171], v[56:59], v[104:107], v[168:171]
  buffer_load_dwordx4 v14, s[8:11], s20 offen lds
  ds_read_b64_tr_b16 v[38:39], v9 offset:1024
  v_mfma_f32_16x16x32_bf16 v[172:175], v[60:63], v[104:107], v[172:175]
  v_mfma_f32_16x16x32_bf16 v[176:179], v[48:51], v[108:111], v[176:179]
  ds_read_b128 v[80:83], v2 offset:4096
  v_mfma_f32_16x16x32_bf16 v[180:183], v[52:55], v[108:111], v[180:183]
  s_add_u32 m0, s24, 35840
  ds_read_b64_tr_b16 v[40:41], v10 offset:0
  v_mfma_f32_16x16x32_bf16 v[184:187], v[56:59], v[108:111], v[184:187]
  buffer_load_dwordx4 v15, s[8:11], s20 offen lds
  v_mfma_f32_16x16x32_bf16 v[188:191], v[60:63], v[108:111], v[188:191]
  ds_read_b128 v[84:87], v2 offset:5120
  v_mfma_f32_16x16x32_bf16 v[192:195], v[48:51], v[112:115], v[192:195]
  ds_read_b64_tr_b16 v[42:43], v10 offset:1024
  v_mfma_f32_16x16x32_bf16 v[196:199], v[52:55], v[112:115], v[196:199]
  s_add_u32 m0, s25, 32768
  v_mfma_f32_16x16x32_bf16 v[200:203], v[56:59], v[112:115], v[200:203]
  buffer_load_dwordx4 v16, s[12:15], s21 offen lds
  ds_read_b128 v[88:91], v2 offset:6144
  v_mfma_f32_16x16x32_bf16 v[204:207], v[60:63], v[112:115], v[204:207]
  ds_read_b64_tr_b16 v[44:45], v11 offset:0
  v_mfma_f32_16x16x32_bf16 v[208:211], v[48:51], v[116:119], v[208:211]
  v_mfma_f32_16x16x32_bf16 v[212:215], v[52:55], v[116:119], v[212:215]
  s_add_u32 m0, s25, 33792
  ds_read_b128 v[92:95], v2 offset:7168
  v_mfma_f32_16x16x32_bf16 v[216:219], v[56:59], v[116:119], v[216:219]
  buffer_load_dwordx4 v17, s[12:15], s21 offen lds
  ds_read_b64_tr_b16 v[46:47], v11 offset:1024
  v_mfma_f32_16x16x32_bf16 v[220:223], v[60:63], v[116:119], v[220:223]
  v_mfma_f32_16x16x32_bf16 v[224:227], v[48:51], v[120:123], v[224:227]
  v_mfma_f32_16x16x32_bf16 v[228:231], v[52:55], v[120:123], v[228:231]
  v_mfma_f32_16x16x32_bf16 v[232:235], v[56:59], v[120:123], v[232:235]
  s_add_u32 s20, s20, 131072
  v_mfma_f32_16x16x32_bf16 v[236:239], v[60:63], v[120:123], v[236:239]
  s_add_u32 s21, s21, s23
  v_mfma_f32_16x16x32_bf16 v[240:243], v[48:51], v[124:127], v[240:243]
  v_mfma_f32_16x16x32_bf16 v[244:247], v[52:55], v[124:127], v[244:247]
  v_mfma_f32_16x16x32_bf16 v[248:251], v[56:59], v[124:127], v[248:251]
  v_mfma_f32_16x16x32_bf16 v[252:255], v[60:63], v[124:127], v[252:255]
  s_waitcnt vmcnt(12) lgkmcnt(0)
  s_barrier
  v_mfma_f32_16x16x32_bf16 v[128:131], v[32:35], v[64:67], v[128:131]
  ds_read_b128 v[96:99], v2 offset:32768
  v_mfma_f32_16x16x32_bf16 v[132:135], v[36:39], v[64:67], v[132:135]
  s_add_u32 m0, s24, 65536
  ds_read_b64_tr_b16 v[48:49], v8 offset:32768
  v_mfma_f32_16x16x32_bf16 v[136:139], v[40:43], v[64:67], v[136:139]
  buffer_load_dwordx4 v12, s[8:11], s20 offen lds
  v_mfma_f32_16x16x32_bf16 v[140:143], v[44:47], v[64:67], v[140:143]
  ds_read_b128 v[100:103], v2 offset:33792
  v_mfma_f32_16x16x32_bf16 v[144:147], v[32:35], v[68:71], v[144:147]
  ds_read_b64_tr_b16 v[50:51], v8 offset:33792
  v_mfma_f32_16x16x32_bf16 v[148:151], v[36:39], v[68:71], v[148:151]
  s_add_u32 m0, s24, 66560
  v_mfma_f32_16x16x32_bf16 v[152:155], v[40:43], v[68:71], v[152:155]
  buffer_load_dwordx4 v13, s[8:11], s20 offen lds
  ds_read_b128 v[104:107], v2 offset:34816
  v_mfma_f32_16x16x32_bf16 v[156:159], v[44:47], v[68:71], v[156:159]
  ds_read_b64_tr_b16 v[52:53], v9 offset:32768
  v_mfma_f32_16x16x32_bf16 v[160:163], v[32:35], v[72:75], v[160:163]
  v_mfma_f32_16x16x32_bf16 v[164:167], v[36:39], v[72:75], v[164:167]
  s_add_u32 m0, s24, 67584
  ds_read_b128 v[108:111], v2 offset:35840
  v_mfma_f32_16x16x32_bf16 v[168:171], v[40:43], v[72:75], v[168:171]
  buffer_load_dwordx4 v14, s[8:11], s20 offen lds
  ds_read_b64_tr_b16 v[54:55], v9 offset:33792
  v_mfma_f32_16x16x32_bf16 v[172:175], v[44:47], v[72:75], v[172:175]
  v_mfma_f32_16x16x32_bf16 v[176:179], v[32:35], v[76:79], v[176:179]
  ds_read_b128 v[112:115], v2 offset:36864
  v_mfma_f32_16x16x32_bf16 v[180:183], v[36:39], v[76:79], v[180:183]
  s_add_u32 m0, s24, 68608
  ds_read_b64_tr_b16 v[56:57], v10 offset:32768
  v_mfma_f32_16x16x32_bf16 v[184:187], v[40:43], v[76:79], v[184:187]
  buffer_load_dwordx4 v15, s[8:11], s20 offen lds
  v_mfma_f32_16x16x32_bf16 v[188:191], v[44:47], v[76:79], v[188:191]
  ds_read_b128 v[116:119], v2 offset:37888
  v_mfma_f32_16x16x32_bf16 v[192:195], v[32:35], v[80:83], v[192:195]
  ds_read_b64_tr_b16 v[58:59], v10 offset:33792
  v_mfma_f32_16x16x32_bf16 v[196:199], v[36:39], v[80:83], v[196:199]
  s_add_u32 m0, s25, 65536
  v_mfma_f32_16x16x32_bf16 v[200:203], v[40:43], v[80:83], v[200:203]
  buffer_load_dwordx4 v16, s[12:15], s21 offen lds
  ds_read_b128 v[120:123], v2 offset:38912
  v_mfma_f32_16x16x32_bf16 v[204:207], v[44:47], v[80:83], v[204:207]
  ds_read_b64_tr_b16 v[60:61], v11 offset:32768
  v_mfma_f32_16x16x32_bf16 v[208:211], v[32:35], v[84:87], v[208:211]
  v_mfma_f32_16x16x32_bf16 v[212:215], v[36:39], v[84:87], v[212:215]
  s_add_u32 m0, s25, 66560
  ds_read_b128 v[124:127], v2 offset:39936
  v_mfma_f32_16x16x32_bf16 v[216:219], v[40:43], v[84:87], v[216:219]
  buffer_load_dwordx4 v17, s[12:15], s21 offen lds
  ds_read_b64_tr_b16 v[62:63], v11 offset:33792
  v_mfma_f32_16x16x32_bf16 v[220:223], v[44:47], v[84:87], v[220:223]
  v_mfma_f32_16x16x32_bf16 v[224:227], v[32:35], v[88:91], v[224:227]
  v_mfma_f32_16x16x32_bf16 v[228:231], v[36:39], v[88:91], v[228:231]
  v_mfma_f32_16x16x32_bf16 v[232:235], v[40:43], v[88:91], v[232:235]
  s_add_u32 s20, s20, 131072
  v_mfma_f32_16x16x32_bf16 v[236:239], v[44:47], v[88:91], v[236:239]
  s_add_u32 s21, s21, s23
  v_mfma_f32_16x16x32_bf16 v[240:243], v[32:35], v[92:95], v[240:243]
  v_mfma_f32_16x16x32_bf16 v[244:247], v[36:39], v[92:95], v[244:247]
  v_mfma_f32_16x16x32_bf16 v[248:251], v[40:43], v[92:95], v[248:251]
  v_mfma_f32_16x16x32_bf16 v[252:255], v[44:47], v[92:95], v[252:255]
  s_waitcnt vmcnt(12) lgkmcnt(0)
  s_barrier
  v_mfma_f32_16x16x32_bf16 v[128:131], v[48:51], v[96:99], v[128:131]
  ds_read_b128 v[64:67], v1 offset:0
  v_mfma_f32_16x16x32_bf16 v[132:135], v[52:55], v[96:99], v[132:135]
  s_add_u32 m0, s24, 98304
  ds_read_b64_tr_b16 v[32:33], v4 offset:0
  v_mfma_f32_16x16x32_bf16 v[136:139], v[56:59], v[96:99], v[136:139]
  buffer_load_dwordx4 v12, s[8:11], s20 offen lds
  v_mfma_f32_16x16x32_bf16 v[140:143], v[60:63], v[96:99], v[140:143]
  ds_read_b128 v[68:71], v1 offset:1024
  v_mfma_f32_16x16x32_bf16 v[144:147], v[48:51], v[100:103], v[144:147]
  ds_read_b64_tr_b16 v[34:35], v4 offset:1024
  v_mfma_f32_16x16x32_bf16 v[148:151], v[52:55], v[100:103], v[148:151]
  s_add_u32 m0, s24, 99328
  v_mfma_f32_16x16x32_bf16 v[152:155], v[56:59], v[100:103], v[152:155]
  buffer_load_dwordx4 v13, s[8:11], s20 offen lds
  ds_read_b128 v[72:75], v1 offset:2048
  v_mfma_f32_16x16x32_bf16 v[156:159], v[60:63], v[100:103], v[156:159]
  ds_read_b64_tr_b16 v[36:37], v5 offset:0
  v_mfma_f32_16x16x32_bf16 v[160:163], v[48:51], v[104:107], v[160:163]
  v_mfma_f32_16x16x32_bf16 v[164:167], v[52:55], v[104:107], v[164:167]
  s_add_u32 m0, s24, 100352
  ds_read_b128 v[76:79], v1 offset:3072
  v_mfma_f32_16x16x32_bf16 v[168:171], v[56:59], v[104:107], v[168:171]
  buffer_load_dwordx4 v14, s[8:11], s20 offen lds
  ds_read_b64_tr_b16 v[38:39], v5 offset:1024
  v_mfma_f32_16x16x32_bf16 v[172:175], v[60:63], v[104:107], v[172:175]
  v_mfma_f32_16x16x32_bf16 v[176:179], v[48:51], v[108:111], v[176:179]
  ds_read_b128 v[80:83], v1 offset:4096
  v_mfma_f32_16x16x32_bf16 v[180:183], v[52:55], v[108:111], v[180:183]
  s_add_u32 m0, s24, 101376
  ds_read_b64_tr_b16 v[40:41], v6 offset:0
  v_mfma_f32_16x16x32_bf16 v[184:187], v[56:59], v[108:111], v[184:187]
  buffer_load_dwordx4 v15, s[8:11], s20 offen lds
  v_mfma_f32_16x16x32_bf16 v[188:191], v[60:63], v[108:111], v[188:191]
  ds_read_b128 v[84:87], v1 offset:5120
  v_mfma_f32_16x16x32_bf16 v[192:195], v[48:51], v[112:115], v[192:195]
  ds_read_b64_tr_b16 v[42:43], v6 offset:1024
  v_mfma_f32_16x16x32_bf16 v[196:199], v[52:55], v[112:115], v[196:199]
  s_add_u32 m0, s25, 98304
  v_mfma_f32_16x16x32_bf16 v[200:203], v[56:59], v[112:115], v[200:203]
  buffer_load_dwordx4 v16, s[12:15], s21 offen lds
  ds_read_b128 v[88:91], v1 offset:6144
  v_mfma_f32_16x16x32_bf16 v[204:207], v[60:63], v[112:115], v[204:207]
  ds_read_b64_tr_b16 v[44:45], v7 offset:0
  v_mfma_f32_16x16x32_bf16 v[208:211], v[48:51], v[116:119], v[208:211]
  v_mfma_f32_16x16x32_bf16 v[212:215], v[52:55], v[116:119], v[212:215]
  s_add_u32 m0, s25, 99328
  ds_read_b128 v[92:95], v1 offset:7168
  v_mfma_f32_16x16x32_bf16 v[216:219], v[56:59], v[116:119], v[216:219]
  buffer_load_dwordx4 v17, s[12:15], s21 offen lds
  ds_read_b64_tr_b16 v[46:47], v7 offset:1024
  v_mfma_f32_16x16x32_bf16 v[220:223], v[60:63], v[116:119], v[220:223]
  v_mfma_f32_16x16x32_bf16 v[224:227], v[48:51], v[120:123], v[224:227]
  v_mfma_f32_16x16x32_bf16 v[228:231], v[52:55], v[120:123], v[228:231]
  v_mfma_f32_16x16x32_bf16 v[232:235], v[56:59], v[120:123], v[232:235]
  s_add_u32 s20, s20, 131072
  v_mfma_f32_16x16x32_bf16 v[236:239], v[60:63], v[120:123], v[236:239]
  s_add_u32 s21, s21, s23
  v_mfma_f32_16x16x32_bf16 v[240:243], v[48:51], v[124:127], v[240:243]
  v_mfma_f32_16x16x32_bf16 v[244:247], v[52:55], v[124:127], v[244:247]
  v_mfma_f32_16x16x32_bf16 v[248:251], v[56:59], v[124:127], v[248:251]
  v_mfma_f32_16x16x32_bf16 v[252:255], v[60:63], v[124:127], v[252:255]
  s_mov_b32 s26, s31
T_KVH_mk_loop:
  s_waitcnt vmcnt(12) lgkmcnt(0)
  s_barrier
  v_mfma_f32_16x16x32_bf16 v[128:131], v[32:35], v[64:67], v[128:131]
  ds_read_b128 v[96:99], v1 offset:32768
  v_mfma_f32_16x16x32_bf16 v[132:135], v[36:39], v[64:67], v[132:135]
  s_add_u32 m0, s24, 0
  ds_read_b64_tr_b16 v[48:49], v4 offset:32768
  v_mfma_f32_16x16x32_bf16 v[136:139], v[40:43], v[64:67], v[136:139]
  buffer_load_dwordx4 v12, s[8:11], s20 offen lds
  v_mfma_f32_16x16x32_bf16 v[140:143], v[44:47], v[64:67], v[140:143]
  ds_read_b128 v[100:103], v1 offset:33792
  v_mfma_f32_16x16x32_bf16 v[144:147], v[32:35], v[68:71], v[144:147]
  ds_read_b64_tr_b16 v[50:51], v4 offset:33792
  v_mfma_f32_16x16x32_bf16 v[148:151], v[36:39], v[68:71], v[148:151]
  s_add_u32 m0, s24, 1024
  v_mfma_f32_16x16x32_bf16 v[152:155], v[40:43], v[68:71], v[152:155]
  buffer_load_dwordx4 v13, s[8:11], s20 offen lds
  ds_read_b128 v[104:107], v1 offset:34816
  v_mfma_f32_16x16x32_bf16 v[156:159], v[44:47], v[68:71], v[156:159]
  ds_read_b64_tr_b16 v[52:53], v5 offset:32768
  v_mfma_f32_16x16x32_bf16 v[160:163], v[32:35], v[72:75], v[160:163]
  v_mfma_f32_16x16x32_bf16 v[164:167], v[36:39], v[72:75], v[164:167]
  s_add_u32 m0, s24, 2048
  ds_read_b128 v[108:111], v1 offset:35840
  v_mfma_f32_16x16x32_bf16 v[168:171], v[40:43], v[72:75], v[168:171]
  buffer_load_dwordx4 v14, s[8:11], s20 offen lds
  ds_read_b64_tr_b16 v[54:55], v5 offset:33792
  v_mfma_f32_16x16x32_bf16 v[172:175], v[44:47], v[72:75], v[172:175]
  v_mfma_f32_16x16x32_bf16 v[176:179], v[32:35], v[76:79], v[176:179]
  ds_read_b128 v[112:115], v1 offset:36864
  v_mfma_f32_16x16x32_bf16 v[180:183], v[36:39], v[76:79], v[180:183]
  s_add_u32 m0, s24, 3072
  ds_read_b64_tr_b16 v[56:57], v6 offset:32768
  v_mfma_f32_16x16x32_bf16 v[184:187], v[40:43], v[76:79], v[184:187]
  buffer_load_dwordx4 v15, s[8:11], s20 offen lds
  v_mfma_f32_16x16x32_bf16 v[188:191], v[44:47], v[76:79], v[188:191]
  ds_read_b128 v[116:119], v1 offset:37888
  v_mfma_f32_16x16x32_bf16 v[192:195], v[32:35], v[80:83], v[192:195]
  ds_read_b64_tr_b16 v[58:59], v6 offset:33792
  v_mfma_f32_16x16x32_bf16 v[196:199], v[36:39], v[80:83], v[196:199]
  s_add_u32 m0, s25, 0
  v_mfma_f32_16x16x32_bf16 v[200:203], v[40:43], v[80:83], v[200:203]
  buffer_load_dwordx4 v16, s[12:15], s21 offen lds
  ds_read_b128 v[120:123], v1 offset:38912
  v_mfma_f32_16x16x32_bf16 v[204:207], v[44:47], v[80:83], v[204:207]
  ds_read_b64_tr_b16 v[60:61], v7 offset:32768
  v_mfma_f32_16x16x32_bf16 v[208:211], v[32:35], v[84:87], v[208:211]
  v_mfma_f32_16x16x32_bf16 v[212:215], v[36:39], v[84:87], v[212:215]
  s_add_u32 m0, s25, 1024
  ds_read_b128 v[124:127], v1 offset:39936
  v_mfma_f32_16x16x32_bf16 v[216:219], v[40:43], v[84:87], v[216:219]
  buffer_load_dwordx4 v17, s[12:15], s21 offen lds
  ds_read_b64_tr_b16 v[62:63], v7 offset:33792
  v_mfma_f32_16x16x32_bf16 v[220:223], v[44:47], v[84:87], v[220:223]
  v_mfma_f32_16x16x32_bf16 v[224:227], v[32:35], v[88:91], v[224:227]
  v_mfma_f32_16x16x32_bf16 v[228:231], v[36:39], v[88:91], v[228:231]
  v_mfma_f32_16x16x32_bf16 v[232:235], v[40:43], v[88:91], v[232:235]
  s_add_u32 s20, s20, 131072
  v_mfma_f32_16x16x32_bf16 v[236:239], v[44:47], v[88:91], v[236:239]
  s_add_u32 s21, s21, s23
  v_mfma_f32_16x16x32_bf16 v[240:243], v[32:35], v[92:95], v[240:243]
  v_mfma_f32_16x16x32_bf16 v[244:247], v[36:39], v[92:95], v[244:247]
  v_mfma_f32_16x16x32_bf16 v[248:251], v[40:43], v[92:95], v[248:251]
  v_mfma_f32_16x16x32_bf16 v[252:255], v[44:47], v[92:95], v[252:255]
  s_waitcnt vmcnt(12) lgkmcnt(0)
  s_barrier
  v_mfma_f32_16x16x32_bf16 v[128:131], v[48:51], v[96:99], v[128:131]
  ds_read_b128 v[64:67], v2 offset:0
  v_mfma_f32_16x16x32_bf16 v[132:135], v[52:55], v[96:99], v[132:135]
  s_add_u32 m0, s24, 32768
  ds_read_b64_tr_b16 v[32:33], v8 offset:0
  v_mfma_f32_16x16x32_bf16 v[136:139], v[56:59], v[96:99], v[136:139]
  buffer_load_dwordx4 v12, s[8:11], s20 offen lds
  v_mfma_f32_16x16x32_bf16 v[140:143], v[60:63], v[96:99], v[140:143]
  ds_read_b128 v[68:71], v2 offset:1024
  v_mfma_f32_16x16x32_bf16 v[144:147], v[48:51], v[100:103], v[144:147]
  ds_read_b64_tr_b16 v[34:35], v8 offset:1024
  v_mfma_f32_16x16x32_bf16 v[148:151], v[52:55], v[100:103], v[148:151]
  s_add_u32 m0, s24, 33792
  v_mfma_f32_16x16x32_bf16 v[152:155], v[56:59], v[100:103], v[152:155]
  buffer_load_dwordx4 v13, s[8:11], s20 offen lds
  ds_read_b128 v[72:75], v2 offset:2048
  v_mfma_f32_16x16x32_bf16 v[156:159], v[60:63], v[100:103], v[156:159]
  ds_read_b64_tr_b16 v[36:37], v9 offset:0
  v_mfma_f32_16x16x32_bf16 v[160:163], v[48:51], v[104:107], v[160:163]
  v_mfma_f32_16x16x32_bf16 v[164:167], v[52:55], v[104:107], v[164:167]
  s_add_u32 m0, s24, 34816
  ds_read_b128 v[76:79], v2 offset:3072
  v_mfma_f32_16x16x32_bf16 v[168:171], v[56:59], v[104:107], v[168:171]
  buffer_load_dwordx4 v14, s[8:11], s20 offen lds
  ds_read_b64_tr_b16 v[38:39], v9 offset:1024
  v_mfma_f32_16x16x32_bf16 v[172:175], v[60:63], v[104:107], v[172:175]
  v_mfma_f32_16x16x32_bf16 v[176:179], v[48:51], v[108:111], v[176:179]
  ds_read_b128 v[80:83], v2 offset:4096
  v_mfma_f32_16x16x32_bf16 v[180:183], v[52:55], v[108:111], v[180:183]
  s_add_u32 m0, s24, 35840
  ds_read_b64_tr_b16 v[40:41], v10 offset:0
  v_mfma_f32_16x16x32_bf16 v[184:187], v[56:59], v[108:111], v[184:187]
  buffer_load_dwordx4 v15, s[8:11], s20 offen lds
  v_mfma_f32_16x16x32_bf16 v[188:191], v[60:63], v[108:111], v[188:191]
  ds_read_b128 v[84:87], v2 offset:5120
  v_mfma_f32_16x16x32_bf16 v[192:195], v[48:51], v[112:115], v[192:195]
  ds_read_b64_tr_b16 v[42:43], v10 offset:1024
  v_mfma_f32_16x16x32_bf16 v[196:199], v[52:55], v[112:115], v[196:199]
  s_add_u32 m0, s25, 32768
  v_mfma_f32_16x16x32_bf16 v[200:203], v[56:59], v[112:115], v[200:203]
  buffer_load_dwordx4 v16, s[12:15], s21 offen lds
  ds_read_b128 v[88:91], v2 offset:6144
  v_mfma_f32_16x16x32_bf16 v[204:207], v[60:63], v[112:115], v[204:207]
  ds_read_b64_tr_b16 v[44:45], v11 offset:0
  v_mfma_f32_16x16x32_bf16 v[208:211], v[48:51], v[116:119], v[208:211]
  v_mfma_f32_16x16x32_bf16 v[212:215], v[52:55], v[116:119], v[212:215]
  s_add_u32 m0, s25, 33792
  ds_read_b128 v[92:95], v2 offset:7168
  v_mfma_f32_16x16x32_bf16 v[216:219], v[56:59], v[116:119], v[216:219]
  buffer_load_dwordx4 v17, s[12:15], s21 offen lds
  ds_read_b64_tr_b16 v[46:47], v11 offset:1024
  v_mfma_f32_16x16x32_bf16 v[220:223], v[60:63], v[116:119], v[220:223]
  v_mfma_f32_16x16x32_bf16 v[224:227], v[48:51], v[120:123], v[224:227]
  v_mfma_f32_16x16x32_bf16 v[228:231], v[52:55], v[120:123], v[228:231]
  v_mfma_f32_16x16x32_bf16 v[232:235], v[56:59], v[120:123], v[232:235]
  s_add_u32 s20, s20, 131072
  v_mfma_f32_16x16x32_bf16 v[236:239], v[60:63], v[120:123], v[236:239]
  s_add_u32 s21, s21, s23
  v_mfma_f32_16x16x32_bf16 v[240:243], v[48:51], v[124:127], v[240:243]
  v_mfma_f32_16x16x32_bf16 v[244:247], v[52:55], v[124:127], v[244:247]
  v_mfma_f32_16x16x32_bf16 v[248:251], v[56:59], v[124:127], v[248:251]
  v_mfma_f32_16x16x32_bf16 v[252:255], v[60:63], v[124:127], v[252:255]
  s_waitcnt vmcnt(12) lgkmcnt(0)
  s_barrier
  v_mfma_f32_16x16x32_bf16 v[128:131], v[32:35], v[64:67], v[128:131]
  ds_read_b128 v[96:99], v2 offset:32768
  v_mfma_f32_16x16x32_bf16 v[132:135], v[36:39], v[64:67], v[132:135]
  s_add_u32 m0, s24, 65536
  ds_read_b64_tr_b16 v[48:49], v8 offset:32768
  v_mfma_f32_16x16x32_bf16 v[136:139], v[40:43], v[64:67], v[136:139]
  buffer_load_dwordx4 v12, s[8:11], s20 offen lds
  v_mfma_f32_16x16x32_bf16 v[140:143], v[44:47], v[64:67], v[140:143]
  ds_read_b128 v[100:103], v2 offset:33792
  v_mfma_f32_16x16x32_bf16 v[144:147], v[32:35], v[68:71], v[144:147]
  ds_read_b64_tr_b16 v[50:51], v8 offset:33792
  v_mfma_f32_16x16x32_bf16 v[148:151], v[36:39], v[68:71], v[148:151]
  s_add_u32 m0, s24, 66560
  v_mfma_f32_16x16x32_bf16 v[152:155], v[40:43], v[68:71], v[152:155]
  buffer_load_dwordx4 v13, s[8:11], s20 offen lds
  ds_read_b128 v[104:107], v2 offset:34816
  v_mfma_f32_16x16x32_bf16 v[156:159], v[44:47], v[68:71], v[156:159]
  ds_read_b64_tr_b16 v[52:53], v9 offset:32768
  v_mfma_f32_16x16x32_bf16 v[160:163], v[32:35], v[72:75], v[160:163]
  v_mfma_f32_16x16x32_bf16 v[164:167], v[36:39], v[72:75], v[164:167]
  s_add_u32 m0, s24, 67584
  ds_read_b128 v[108:111], v2 offset:35840
  v_mfma_f32_16x16x32_bf16 v[168:171], v[40:43], v[72:75], v[168:171]
  buffer_load_dwordx4 v14, s[8:11], s20 offen lds
  ds_read_b64_tr_b16 v[54:55], v9 offset:33792
  v_mfma_f32_16x16x32_bf16 v[172:175], v[44:47], v[72:75], v[172:175]
  v_mfma_f32_16x16x32_bf16 v[176:179], v[32:35], v[76:79], v[176:179]
  ds_read_b128 v[112:115], v2 offset:36864
  v_mfma_f32_16x16x32_bf16 v[180:183], v[36:39], v[76:79], v[180:183]
  s_add_u32 m0, s24, 68608
  ds_read_b64_tr_b16 v[56:57], v10 offset:32768
  v_mfma_f32_16x16x32_bf16 v[184:187], v[40:43], v[76:79], v[184:187]
  buffer_load_dwordx4 v15, s[8:11], s20 offen lds
  v_mfma_f32_16x16x32_bf16 v[188:191], v[44:47], v[76:79], v[188:191]
  ds_read_b128 v[116:119], v2 offset:37888
  v_mfma_f32_16x16x32_bf16 v[192:195], v[32:35], v[80:83], v[192:195]
  ds_read_b64_tr_b16 v[58:59], v10 offset:33792
  v_mfma_f32_16x16x32_bf16 v[196:199], v[36:39], v[80:83], v[196:199]
  s_add_u32 m0, s25, 65536
  v_mfma_f32_16x16x32_bf16 v[200:203], v[40:43], v[80:83], v[200:203]
  buffer_load_dwordx4 v16, s[12:15], s21 offen lds
  ds_read_b128 v[120:123], v2 offset:38912
  v_mfma_f32_16x16x32_bf16 v[204:207], v[44:47], v[80:83], v[204:207]
  ds_read_b64_tr_b16 v[60:61], v11 offset:32768
  v_mfma_f32_16x16x32_bf16 v[208:211], v[32:35], v[84:87], v[208:211]
  v_mfma_f32_16x16x32_bf16 v[212:215], v[36:39], v[84:87], v[212:215]
  s_add_u32 m0, s25, 66560
  ds_read_b128 v[124:127], v2 offset:39936
  v_mfma_f32_16x16x32_bf16 v[216:219], v[40:43], v[84:87], v[216:219]
  buffer_load_dwordx4 v17, s[12:15], s21 offen lds
  ds_read_b64_tr_b16 v[62:63], v11 offset:33792
  v_mfma_f32_16x16x32_bf16 v[220:223], v[44:47], v[84:87], v[220:223]
  v_mfma_f32_16x16x32_bf16 v[224:227], v[32:35], v[88:91], v[224:227]
  v_mfma_f32_16x16x32_bf16 v[228:231], v[36:39], v[88:91], v[228:231]
  v_mfma_f32_16x16x32_bf16 v[232:235], v[40:43], v[88:91], v[232:235]
  s_add_u32 s20, s20, 131072
  v_mfma_f32_16x16x32_bf16 v[236:239], v[44:47], v[88:91], v[236:239]
  s_add_u32 s21, s21, s23
  v_mfma_f32_16x16x32_bf16 v[240:243], v[32:35], v[92:95], v[240:243]
  v_mfma_f32_16x16x32_bf16 v[244:247], v[36:39], v[92:95], v[244:247]
  v_mfma_f32_16x16x32_bf16 v[248:251], v[40:43], v[92:95], v[248:251]
  v_mfma_f32_16x16x32_bf16 v[252:255], v[44:47], v[92:95], v[252:255]
  s_waitcnt vmcnt(12) lgkmcnt(0)
  s_barrier
  v_mfma_f32_16x16x32_bf16 v[128:131], v[48:51], v[96:99], v[128:131]
  ds_read_b128 v[64:67], v1 offset:0
  v_mfma_f32_16x16x32_bf16 v[132:135], v[52:55], v[96:99], v[132:135]
  s_add_u32 m0, s24, 98304
  ds_read_b64_tr_b16 v[32:33], v4 offset:0
  v_mfma_f32_16x16x32_bf16 v[136:139], v[56:59], v[96:99], v[136:139]
  buffer_load_dwordx4 v12, s[8:11], s20 offen lds
  v_mfma_f32_16x16x32_bf16 v[140:143], v[60:63], v[96:99], v[140:143]
  ds_read_b128 v[68:71], v1 offset:1024
  v_mfma_f32_16x16x32_bf16 v[144:147], v[48:51], v[100:103], v[144:147]
  ds_read_b64_tr_b16 v[34:35], v4 offset:1024
  v_mfma_f32_16x16x32_bf16 v[148:151], v[52:55], v[100:103], v[148:151]
  s_add_u32 m0, s24, 99328
  v_mfma_f32_16x16x32_bf16 v[152:155], v[56:59], v[100:103], v[152:155]
  buffer_load_dwordx4 v13, s[8:11], s20 offen lds
  ds_read_b128 v[72:75], v1 offset:2048
  v_mfma_f32_16x16x32_bf16 v[156:159], v[60:63], v[100:103], v[156:159]
  ds_read_b64_tr_b16 v[36:37], v5 offset:0
  v_mfma_f32_16x16x32_bf16 v[160:163], v[48:51], v[104:107], v[160:163]
  v_mfma_f32_16x16x32_bf16 v[164:167], v[52:55], v[104:107], v[164:167]
  s_add_u32 m0, s24, 100352
  ds_read_b128 v[76:79], v1 offset:3072
  v_mfma_f32_16x16x32_bf16 v[168:171], v[56:59], v[104:107], v[168:171]
  buffer_load_dwordx4 v14, s[8:11], s20 offen lds
  ds_read_b64_tr_b16 v[38:39], v5 offset:1024
  v_mfma_f32_16x16x32_bf16 v[172:175], v[60:63], v[104:107], v[172:175]
  v_mfma_f32_16x16x32_bf16 v[176:179], v[48:51], v[108:111], v[176:179]
  ds_read_b128 v[80:83], v1 offset:4096
  v_mfma_f32_16x16x32_bf16 v[180:183], v[52:55], v[108:111], v[180:183]
  s_add_u32 m0, s24, 101376
  ds_read_b64_tr_b16 v[40:41], v6 offset:0
  v_mfma_f32_16x16x32_bf16 v[184:187], v[56:59], v[108:111], v[184:187]
  buffer_load_dwordx4 v15, s[8:11], s20 offen lds
  v_mfma_f32_16x16x32_bf16 v[188:191], v[60:63], v[108:111], v[188:191]
  ds_read_b128 v[84:87], v1 offset:5120
  v_mfma_f32_16x16x32_bf16 v[192:195], v[48:51], v[112:115], v[192:195]
  ds_read_b64_tr_b16 v[42:43], v6 offset:1024
  v_mfma_f32_16x16x32_bf16 v[196:199], v[52:55], v[112:115], v[196:199]
  s_add_u32 m0, s25, 98304
  v_mfma_f32_16x16x32_bf16 v[200:203], v[56:59], v[112:115], v[200:203]
  buffer_load_dwordx4 v16, s[12:15], s21 offen lds
  ds_read_b128 v[88:91], v1 offset:6144
  v_mfma_f32_16x16x32_bf16 v[204:207], v[60:63], v[112:115], v[204:207]
  ds_read_b64_tr_b16 v[44:45], v7 offset:0
  v_mfma_f32_16x16x32_bf16 v[208:211], v[48:51], v[116:119], v[208:211]
  v_mfma_f32_16x16x32_bf16 v[212:215], v[52:55], v[116:119], v[212:215]
  s_add_u32 m0, s25, 99328
  ds_read_b128 v[92:95], v1 offset:7168
  v_mfma_f32_16x16x32_bf16 v[216:219], v[56:59], v[116:119], v[216:219]
  buffer_load_dwordx4 v17, s[12:15], s21 offen lds
  ds_read_b64_tr_b16 v[46:47], v7 offset:1024
  v_mfma_f32_16x16x32_bf16 v[220:223], v[60:63], v[116:119], v[220:223]
  v_mfma_f32_16x16x32_bf16 v[224:227], v[48:51], v[120:123], v[224:227]
  v_mfma_f32_16x16x32_bf16 v[228:231], v[52:55], v[120:123], v[228:231]
  v_mfma_f32_16x16x32_bf16 v[232:235], v[56:59], v[120:123], v[232:235]
  s_add_u32 s20, s20, 131072
  v_mfma_f32_16x16x32_bf16 v[236:239], v[60:63], v[120:123], v[236:239]
  s_add_u32 s21, s21, s23
  v_mfma_f32_16x16x32_bf16 v[240:243], v[48:51], v[124:127], v[240:243]
  v_mfma_f32_16x16x32_bf16 v[244:247], v[52:55], v[124:127], v[244:247]
  v_mfma_f32_16x16x32_bf16 v[248:251], v[56:59], v[124:127], v[248:251]
  v_mfma_f32_16x16x32_bf16 v[252:255], v[60:63], v[124:127], v[252:255]
  s_sub_u32 s26, s26, 1
  s_cmp_lg_u32 s26, 0
  s_cbranch_scc1 T_KVH_mk_loop
  s_waitcnt vmcnt(12) lgkmcnt(0)
  s_barrier
  v_mfma_f32_16x16x32_bf16 v[128:131], v[32:35], v[64:67], v[128:131]
  ds_read_b128 v[96:99], v1 offset:32768
  v_mfma_f32_16x16x32_bf16 v[132:135], v[36:39], v[64:67], v[132:135]
  ds_read_b64_tr_b16 v[48:49], v4 offset:32768
  v_mfma_f32_16x16x32_bf16 v[136:139], v[40:43], v[64:67], v[136:139]
  v_mfma_f32_16x16x32_bf16 v[140:143], v[44:47], v[64:67], v[140:143]
  ds_read_b128 v[100:103], v1 offset:33792
  v_mfma_f32_16x16x32_bf16 v[144:147], v[32:35], v[68:71], v[144:147]
  ds_read_b64_tr_b16 v[50:51], v4 offset:33792
  v_mfma_f32_16x16x32_bf16 v[148:151], v[36:39], v[68:71], v[148:151]
  v_mfma_f32_16x16x32_bf16 v[152:155], v[40:43], v[68:71], v[152:155]
  ds_read_b128 v[104:107], v1 offset:34816
  v_mfma_f32_16x16x32_bf16 v[156:159], v[44:47], v[68:71], v[156:159]
  ds_read_b64_tr_b16 v[52:53], v5 offset:32768
  v_mfma_f32_16x16x32_bf16 v[160:163], v[32:35], v[72:75], v[160:163]
  v_mfma_f32_16x16x32_bf16 v[164:167], v[36:39], v[72:75], v[164:167]
  ds_read_b128 v[108:111], v1 offset:35840
  v_mfma_f32_16x16x32_bf16 v[168:171], v[40:43], v[72:75], v[168:171]
  ds_read_b64_tr_b16 v[54:55], v5 offset:33792
  v_mfma_f32_16x16x32_bf16 v[172:175], v[44:47], v[72:75], v[172:175]
  v_mfma_f32_16x16x32_bf16 v[176:179], v[32:35], v[76:79], v[176:179]
  ds_read_b128 v[112:115], v1 offset:36864
  v_mfma_f32_16x16x32_bf16 v[180:183], v[36:39], v[76:79], v[180:183]
  ds_read_b64_tr_b16 v[56:57], v6 offset:32768
  v_mfma_f32_16x16x32_bf16 v[184:187], v[40:43], v[76:79], v[184:187]
  v_mfma_f32_16x16x32_bf16 v[188:191], v[44:47], v[76:79], v[188:191]
  ds_read_b128 v[116:119], v1 offset:37888
  v_mfma_f32_16x16x32_bf16 v[192:195], v[32:35], v[80:83], v[192:195]
  ds_read_b64_tr_b16 v[58:59], v6 offset:33792
  v_mfma_f32_16x16x32_bf16 v[196:199], v[36:39], v[80:83], v[196:199]
  v_mfma_f32_16x16x32_bf16 v[200:203], v[40:43], v[80:83], v[200:203]
  ds_read_b128 v[120:123], v1 offset:38912
  v_mfma_f32_16x16x32_bf16 v[204:207], v[44:47], v[80:83], v[204:207]
  ds_read_b64_tr_b16 v[60:61], v7 offset:32768
  v_mfma_f32_16x16x32_bf16 v[208:211], v[32:35], v[84:87], v[208:211]
  v_mfma_f32_16x16x32_bf16 v[212:215], v[36:39], v[84:87], v[212:215]
  ds_read_b128 v[124:127], v1 offset:39936
  v_mfma_f32_16x16x32_bf16 v[216:219], v[40:43], v[84:87], v[216:219]
  ds_read_b64_tr_b16 v[62:63], v7 offset:33792
  v_mfma_f32_16x16x32_bf16 v[220:223], v[44:47], v[84:87], v[220:223]
  v_mfma_f32_16x16x32_bf16 v[224:227], v[32:35], v[88:91], v[224:227]
  v_mfma_f32_16x16x32_bf16 v[228:231], v[36:39], v[88:91], v[228:231]
  v_mfma_f32_16x16x32_bf16 v[232:235], v[40:43], v[88:91], v[232:235]
  v_mfma_f32_16x16x32_bf16 v[236:239], v[44:47], v[88:91], v[236:239]
  v_mfma_f32_16x16x32_bf16 v[240:243], v[32:35], v[92:95], v[240:243]
  v_mfma_f32_16x16x32_bf16 v[244:247], v[36:39], v[92:95], v[244:247]
  v_mfma_f32_16x16x32_bf16 v[248:251], v[40:43], v[92:95], v[248:251]
  v_mfma_f32_16x16x32_bf16 v[252:255], v[44:47], v[92:95], v[252:255]
  s_waitcnt vmcnt(6) lgkmcnt(0)
  s_barrier
  v_mfma_f32_16x16x32_bf16 v[128:131], v[48:51], v[96:99], v[128:131]
  ds_read_b128 v[64:67], v2 offset:0
  v_mfma_f32_16x16x32_bf16 v[132:135], v[52:55], v[96:99], v[132:135]
  ds_read_b64_tr_b16 v[32:33], v8 offset:0
  v_mfma_f32_16x16x32_bf16 v[136:139], v[56:59], v[96:99], v[136:139]
  v_mfma_f32_16x16x32_bf16 v[140:143], v[60:63], v[96:99], v[140:143]
  ds_read_b128 v[68:71], v2 offset:1024
  v_mfma_f32_16x16x32_bf16 v[144:147], v[48:51], v[100:103], v[144:147]
  ds_read_b64_tr_b16 v[34:35], v8 offset:1024
  v_mfma_f32_16x16x32_bf16 v[148:151], v[52:55], v[100:103], v[148:151]
  v_mfma_f32_16x16x32_bf16 v[152:155], v[56:59], v[100:103], v[152:155]
  ds_read_b128 v[72:75], v2 offset:2048
  v_mfma_f32_16x16x32_bf16 v[156:159], v[60:63], v[100:103], v[156:159]
  ds_read_b64_tr_b16 v[36:37], v9 offset:0
  v_mfma_f32_16x16x32_bf16 v[160:163], v[48:51], v[104:107], v[160:163]
  v_mfma_f32_16x16x32_bf16 v[164:167], v[52:55], v[104:107], v[164:167]
  ds_read_b128 v[76:79], v2 offset:3072
  v_mfma_f32_16x16x32_bf16 v[168:171], v[56:59], v[104:107], v[168:171]
  ds_read_b64_tr_b16 v[38:39], v9 offset:1024
  v_mfma_f32_16x16x32_bf16 v[172:175], v[60:63], v[104:107], v[172:175]
  v_mfma_f32_16x16x32_bf16 v[176:179], v[48:51], v[108:111], v[176:179]
  ds_read_b128 v[80:83], v2 offset:4096
  v_mfma_f32_16x16x32_bf16 v[180:183], v[52:55], v[108:111], v[180:183]
  ds_read_b64_tr_b16 v[40:41], v10 offset:0
  v_mfma_f32_16x16x32_bf16 v[184:187], v[56:59], v[108:111], v[184:187]
  v_mfma_f32_16x16x32_bf16 v[188:191], v[60:63], v[108:111], v[188:191]
  ds_read_b128 v[84:87], v2 offset:5120
  v_mfma_f32_16x16x32_bf16 v[192:195], v[48:51], v[112:115], v[192:195]
  ds_read_b64_tr_b16 v[42:43], v10 offset:1024
  v_mfma_f32_16x16x32_bf16 v[196:199], v[52:55], v[112:115], v[196:199]
  v_mfma_f32_16x16x32_bf16 v[200:203], v[56:59], v[112:115], v[200:203]
  ds_read_b128 v[88:91], v2 offset:6144
  v_mfma_f32_16x16x32_bf16 v[204:207], v[60:63], v[112:115], v[204:207]
  ds_read_b64_tr_b16 v[44:45], v11 offset:0
  v_mfma_f32_16x16x32_bf16 v[208:211], v[48:51], v[116:119], v[208:211]
  v_mfma_f32_16x16x32_bf16 v[212:215], v[52:55], v[116:119], v[212:215]
  ds_read_b128 v[92:95], v2 offset:7168
  v_mfma_f32_16x16x32_bf16 v[216:219], v[56:59], v[116:119], v[216:219]
  ds_read_b64_tr_b16 v[46:47], v11 offset:1024
  v_mfma_f32_16x16x32_bf16 v[220:223], v[60:63], v[116:119], v[220:223]
  v_mfma_f32_16x16x32_bf16 v[224:227], v[48:51], v[120:123], v[224:227]
  v_mfma_f32_16x16x32_bf16 v[228:231], v[52:55], v[120:123], v[228:231]
  v_mfma_f32_16x16x32_bf16 v[232:235], v[56:59], v[120:123], v[232:235]
  v_mfma_f32_16x16x32_bf16 v[236:239], v[60:63], v[120:123], v[236:239]
  v_mfma_f32_16x16x32_bf16 v[240:243], v[48:51], v[124:127], v[240:243]
  v_mfma_f32_16x16x32_bf16 v[244:247], v[52:55], v[124:127], v[244:247]
  v_mfma_f32_16x16x32_bf16 v[248:251], v[56:59], v[124:127], v[248:251]
  v_mfma_f32_16x16x32_bf16 v[252:255], v[60:63], v[124:127], v[252:255]
  s_waitcnt vmcnt(0) lgkmcnt(0)
  s_barrier
  v_mfma_f32_16x16x32_bf16 v[128:131], v[32:35], v[64:67], v[128:131]
  ds_read_b128 v[96:99], v2 offset:32768
  v_mfma_f32_16x16x32_bf16 v[132:135], v[36:39], v[64:67], v[132:135]
  ds_read_b64_tr_b16 v[48:49], v8 offset:32768
  v_mfma_f32_16x16x32_bf16 v[136:139], v[40:43], v[64:67], v[136:139]
  v_mfma_f32_16x16x32_bf16 v[140:143], v[44:47], v[64:67], v[140:143]
  ds_read_b128 v[100:103], v2 offset:33792
  v_mfma_f32_16x16x32_bf16 v[144:147], v[32:35], v[68:71], v[144:147]
  ds_read_b64_tr_b16 v[50:51], v8 offset:33792
  v_mfma_f32_16x16x32_bf16 v[148:151], v[36:39], v[68:71], v[148:151]
  v_mfma_f32_16x16x32_bf16 v[152:155], v[40:43], v[68:71], v[152:155]
  ds_read_b128 v[104:107], v2 offset:34816
  v_mfma_f32_16x16x32_bf16 v[156:159], v[44:47], v[68:71], v[156:159]
  ds_read_b64_tr_b16 v[52:53], v9 offset:32768
  v_mfma_f32_16x16x32_bf16 v[160:163], v[32:35], v[72:75], v[160:163]
  v_mfma_f32_16x16x32_bf16 v[164:167], v[36:39], v[72:75], v[164:167]
  ds_read_b128 v[108:111], v2 offset:35840
  v_mfma_f32_16x16x32_bf16 v[168:171], v[40:43], v[72:75], v[168:171]
  ds_read_b64_tr_b16 v[54:55], v9 offset:33792
  v_mfma_f32_16x16x32_bf16 v[172:175], v[44:47], v[72:75], v[172:175]
  v_mfma_f32_16x16x32_bf16 v[176:179], v[32:35], v[76:79], v[176:179]
  ds_read_b128 v[112:115], v2 offset:36864
  v_mfma_f32_16x16x32_bf16 v[180:183], v[36:39], v[76:79], v[180:183]
  ds_read_b64_tr_b16 v[56:57], v10 offset:32768
  v_mfma_f32_16x16x32_bf16 v[184:187], v[40:43], v[76:79], v[184:187]
  v_mfma_f32_16x16x32_bf16 v[188:191], v[44:47], v[76:79], v[188:191]
  ds_read_b128 v[116:119], v2 offset:37888
  v_mfma_f32_16x16x32_bf16 v[192:195], v[32:35], v[80:83], v[192:195]
  ds_read_b64_tr_b16 v[58:59], v10 offset:33792
  v_mfma_f32_16x16x32_bf16 v[196:199], v[36:39], v[80:83], v[196:199]
  v_mfma_f32_16x16x32_bf16 v[200:203], v[40:43], v[80:83], v[200:203]
  ds_read_b128 v[120:123], v2 offset:38912
  v_mfma_f32_16x16x32_bf16 v[204:207], v[44:47], v[80:83], v[204:207]
  ds_read_b64_tr_b16 v[60:61], v11 offset:32768
  v_mfma_f32_16x16x32_bf16 v[208:211], v[32:35], v[84:87], v[208:211]
  v_mfma_f32_16x16x32_bf16 v[212:215], v[36:39], v[84:87], v[212:215]
  ds_read_b128 v[124:127], v2 offset:39936
  v_mfma_f32_16x16x32_bf16 v[216:219], v[40:43], v[84:87], v[216:219]
  ds_read_b64_tr_b16 v[62:63], v11 offset:33792
  v_mfma_f32_16x16x32_bf16 v[220:223], v[44:47], v[84:87], v[220:223]
  v_mfma_f32_16x16x32_bf16 v[224:227], v[32:35], v[88:91], v[224:227]
  v_mfma_f32_16x16x32_bf16 v[228:231], v[36:39], v[88:91], v[228:231]
  v_mfma_f32_16x16x32_bf16 v[232:235], v[40:43], v[88:91], v[232:235]
  v_mfma_f32_16x16x32_bf16 v[236:239], v[44:47], v[88:91], v[236:239]
  v_mfma_f32_16x16x32_bf16 v[240:243], v[32:35], v[92:95], v[240:243]
  v_mfma_f32_16x16x32_bf16 v[244:247], v[36:39], v[92:95], v[244:247]
  v_mfma_f32_16x16x32_bf16 v[248:251], v[40:43], v[92:95], v[248:251]
  v_mfma_f32_16x16x32_bf16 v[252:255], v[44:47], v[92:95], v[252:255]
  s_waitcnt lgkmcnt(0)
  s_barrier
  v_mfma_f32_16x16x32_bf16 v[128:131], v[48:51], v[96:99], v[128:131]
  v_mfma_f32_16x16x32_bf16 v[132:135], v[52:55], v[96:99], v[132:135]
  v_mfma_f32_16x16x32_bf16 v[136:139], v[56:59], v[96:99], v[136:139]
  v_mfma_f32_16x16x32_bf16 v[140:143], v[60:63], v[96:99], v[140:143]
  v_mfma_f32_16x16x32_bf16 v[144:147], v[48:51], v[100:103], v[144:147]
  v_mfma_f32_16x16x32_bf16 v[148:151], v[52:55], v[100:103], v[148:151]
  v_mfma_f32_16x16x32_bf16 v[152:155], v[56:59], v[100:103], v[152:155]
  v_mfma_f32_16x16x32_bf16 v[156:159], v[60:63], v[100:103], v[156:159]
  v_mfma_f32_16x16x32_bf16 v[160:163], v[48:51], v[104:107], v[160:163]
  v_mfma_f32_16x16x32_bf16 v[164:167], v[52:55], v[104:107], v[164:167]
  v_mfma_f32_16x16x32_bf16 v[168:171], v[56:59], v[104:107], v[168:171]
  v_mfma_f32_16x16x32_bf16 v[172:175], v[60:63], v[104:107], v[172:175]
  v_mfma_f32_16x16x32_bf16 v[176:179], v[48:51], v[108:111], v[176:179]
  v_mfma_f32_16x16x32_bf16 v[180:183], v[52:55], v[108:111], v[180:183]
  v_mfma_f32_16x16x32_bf16 v[184:187], v[56:59], v[108:111], v[184:187]
  v_mfma_f32_16x16x32_bf16 v[188:191], v[60:63], v[108:111], v[188:191]
  v_mfma_f32_16x16x32_bf16 v[192:195], v[48:51], v[112:115], v[192:195]
  v_mfma_f32_16x16x32_bf16 v[196:199], v[52:55], v[112:115], v[196:199]
  v_mfma_f32_16x16x32_bf16 v[200:203], v[56:59], v[112:115], v[200:203]
  v_mfma_f32_16x16x32_bf16 v[204:207], v[60:63], v[112:115], v[204:207]
  v_mfma_f32_16x16x32_bf16 v[208:211], v[48:51], v[116:119], v[208:211]
  v_mfma_f32_16x16x32_bf16 v[212:215], v[52:55], v[116:119], v[212:215]
  v_mfma_f32_16x16x32_bf16 v[216:219], v[56:59], v[116:119], v[216:219]
  v_mfma_f32_16x16x32_bf16 v[220:223], v[60:63], v[116:119], v[220:223]
  v_mfma_f32_16x16x32_bf16 v[224:227], v[48:51], v[120:123], v[224:227]
  v_mfma_f32_16x16x32_bf16 v[228:231], v[52:55], v[120:123], v[228:231]
  v_mfma_f32_16x16x32_bf16 v[232:235], v[56:59], v[120:123], v[232:235]
  v_mfma_f32_16x16x32_bf16 v[236:239], v[60:63], v[120:123], v[236:239]
  v_mfma_f32_16x16x32_bf16 v[240:243], v[48:51], v[124:127], v[240:243]
  v_mfma_f32_16x16x32_bf16 v[244:247], v[52:55], v[124:127], v[244:247]
  v_mfma_f32_16x16x32_bf16 v[248:251], v[56:59], v[124:127], v[248:251]
  v_mfma_f32_16x16x32_bf16 v[252:255], v[60:63], v[124:127], v[252:255]
  s_nop 7
  v_and_b32 v20, 63, v0
  v_and_b32 v21, 15, v20
  v_bfe_u32 v22, v20, 4, 1
  v_bfe_u32 v24, v20, 5, 1
  v_lshlrev_b32 v23, 4, v21
  v_lshl_add_u32 v23, v22, 9, v23
  v_lshl_add_u32 v23, v24, 8, v23
  s_lshr_b32 s40, s27, 1
  s_and_b32 s41, s27, 1
  s_lshl_b32 s42, s28, 3
  s_lshl_b32 s43, s40, 2
  s_add_u32 s42, s42, s43
  s_lshl_b32 s42, s42, 18
  s_lshl_b32 s43, s29, 13
  s_add_u32 s42, s42, s43
  s_lshl_b32 s43, s41, 11
  s_add_u32 s42, s42, s43
  s_add_u32 s45, s42, 25165824
  s_add_u32 s46, s45, 0
  v_cvt_pk_bf16_f32 v32, v128, v129
  v_cvt_pk_bf16_f32 v33, v130, v131
  v_cvt_pk_bf16_f32 v34, v132, v133
  v_cvt_pk_bf16_f32 v35, v134, v135
  s_nop 1
  v_permlane16_swap_b32 v32, v34
  v_permlane16_swap_b32 v33, v35
  buffer_store_dwordx4 v[32:35], v23, s[4:7], s46 offen offset:0 sc1
  v_cvt_pk_bf16_f32 v36, v136, v137
  v_cvt_pk_bf16_f32 v37, v138, v139
  v_cvt_pk_bf16_f32 v38, v140, v141
  v_cvt_pk_bf16_f32 v39, v142, v143
  s_nop 1
  v_permlane16_swap_b32 v36, v38
  v_permlane16_swap_b32 v37, v39
  buffer_store_dwordx4 v[36:39], v23, s[4:7], s46 offen offset:1024 sc1
  s_add_u32 s46, s45, 4096
  v_cvt_pk_bf16_f32 v40, v144, v145
  v_cvt_pk_bf16_f32 v41, v146, v147
  v_cvt_pk_bf16_f32 v42, v148, v149
  v_cvt_pk_bf16_f32 v43, v150, v151
  s_nop 1
  v_permlane16_swap_b32 v40, v42
  v_permlane16_swap_b32 v41, v43
  buffer_store_dwordx4 v[40:43], v23, s[4:7], s46 offen offset:0 sc1
  v_cvt_pk_bf16_f32 v44, v152, v153
  v_cvt_pk_bf16_f32 v45, v154, v155
  v_cvt_pk_bf16_f32 v46, v156, v157
  v_cvt_pk_bf16_f32 v47, v158, v159
  s_nop 1
  v_permlane16_swap_b32 v44, v46
  v_permlane16_swap_b32 v45, v47
  buffer_store_dwordx4 v[44:47], v23, s[4:7], s46 offen offset:1024 sc1
  s_add_u32 s46, s45, 262144
  v_cvt_pk_bf16_f32 v32, v160, v161
  v_cvt_pk_bf16_f32 v33, v162, v163
  v_cvt_pk_bf16_f32 v34, v164, v165
  v_cvt_pk_bf16_f32 v35, v166, v167
  s_nop 1
  v_permlane16_swap_b32 v32, v34
  v_permlane16_swap_b32 v33, v35
  buffer_store_dwordx4 v[32:35], v23, s[4:7], s46 offen offset:0 sc1
  v_cvt_pk_bf16_f32 v36, v168, v169
  v_cvt_pk_bf16_f32 v37, v170, v171
  v_cvt_pk_bf16_f32 v38, v172, v173
  v_cvt_pk_bf16_f32 v39, v174, v175
  s_nop 1
  v_permlane16_swap_b32 v36, v38
  v_permlane16_swap_b32 v37, v39
  buffer_store_dwordx4 v[36:39], v23, s[4:7], s46 offen offset:1024 sc1
  s_add_u32 s46, s45, 266240
  v_cvt_pk_bf16_f32 v40, v176, v177
  v_cvt_pk_bf16_f32 v41, v178, v179
  v_cvt_pk_bf16_f32 v42, v180, v181
  v_cvt_pk_bf16_f32 v43, v182, v183
  s_nop 1
  v_permlane16_swap_b32 v40, v42
  v_permlane16_swap_b32 v41, v43
  buffer_store_dwordx4 v[40:43], v23, s[4:7], s46 offen offset:0 sc1
  v_cvt_pk_bf16_f32 v44, v184, v185
  v_cvt_pk_bf16_f32 v45, v186, v187
  v_cvt_pk_bf16_f32 v46, v188, v189
  v_cvt_pk_bf16_f32 v47, v190, v191
  s_nop 1
  v_permlane16_swap_b32 v44, v46
  v_permlane16_swap_b32 v45, v47
  buffer_store_dwordx4 v[44:47], v23, s[4:7], s46 offen offset:1024 sc1
  s_add_u32 s46, s45, 524288
  v_cvt_pk_bf16_f32 v32, v192, v193
  v_cvt_pk_bf16_f32 v33, v194, v195
  v_cvt_pk_bf16_f32 v34, v196, v197
  v_cvt_pk_bf16_f32 v35, v198, v199
  s_nop 1
  v_permlane16_swap_b32 v32, v34
  v_permlane16_swap_b32 v33, v35
  buffer_store_dwordx4 v[32:35], v23, s[4:7], s46 offen offset:0 sc1
  v_cvt_pk_bf16_f32 v36, v200, v201
  v_cvt_pk_bf16_f32 v37, v202, v203
  v_cvt_pk_bf16_f32 v38, v204, v205
  v_cvt_pk_bf16_f32 v39, v206, v207
  s_nop 1
  v_permlane16_swap_b32 v36, v38
  v_permlane16_swap_b32 v37, v39
  buffer_store_dwordx4 v[36:39], v23, s[4:7], s46 offen offset:1024 sc1
  s_add_u32 s46, s45, 528384
  v_cvt_pk_bf16_f32 v40, v208, v209
  v_cvt_pk_bf16_f32 v41, v210, v211
  v_cvt_pk_bf16_f32 v42, v212, v213
  v_cvt_pk_bf16_f32 v43, v214, v215
  s_nop 1
  v_permlane16_swap_b32 v40, v42
  v_permlane16_swap_b32 v41, v43
  buffer_store_dwordx4 v[40:43], v23, s[4:7], s46 offen offset:0 sc1
  v_cvt_pk_bf16_f32 v44, v216, v217
  v_cvt_pk_bf16_f32 v45, v218, v219
  v_cvt_pk_bf16_f32 v46, v220, v221
  v_cvt_pk_bf16_f32 v47, v222, v223
  s_nop 1
  v_permlane16_swap_b32 v44, v46
  v_permlane16_swap_b32 v45, v47
  buffer_store_dwordx4 v[44:47], v23, s[4:7], s46 offen offset:1024 sc1
  s_add_u32 s46, s45, 786432
  v_cvt_pk_bf16_f32 v32, v224, v225
  v_cvt_pk_bf16_f32 v33, v226, v227
  v_cvt_pk_bf16_f32 v34, v228, v229
  v_cvt_pk_bf16_f32 v35, v230, v231
  s_nop 1
  v_permlane16_swap_b32 v32, v34
  v_permlane16_swap_b32 v33, v35
  buffer_store_dwordx4 v[32:35], v23, s[4:7], s46 offen offset:0 sc1
  v_cvt_pk_bf16_f32 v36, v232, v233
  v_cvt_pk_bf16_f32 v37, v234, v235
  v_cvt_pk_bf16_f32 v38, v236, v237
  v_cvt_pk_bf16_f32 v39, v238, v239
  s_nop 1
  v_permlane16_swap_b32 v36, v38
  v_permlane16_swap_b32 v37, v39
  buffer_store_dwordx4 v[36:39], v23, s[4:7], s46 offen offset:1024 sc1
  s_add_u32 s46, s45, 790528
  v_cvt_pk_bf16_f32 v40, v240, v241
  v_cvt_pk_bf16_f32 v41, v242, v243
  v_cvt_pk_bf16_f32 v42, v244, v245
  v_cvt_pk_bf16_f32 v43, v246, v247
  s_nop 1
  v_permlane16_swap_b32 v40, v42
  v_permlane16_swap_b32 v41, v43
  buffer_store_dwordx4 v[40:43], v23, s[4:7], s46 offen offset:0 sc1
  v_cvt_pk_bf16_f32 v44, v248, v249
  v_cvt_pk_bf16_f32 v45, v250, v251
  v_cvt_pk_bf16_f32 v46, v252, v253
  v_cvt_pk_bf16_f32 v47, v254, v255
  s_nop 1
  v_permlane16_swap_b32 v44, v46
  v_permlane16_swap_b32 v45, v47
  buffer_store_dwordx4 v[44:47], v23, s[4:7], s46 offen offset:1024 sc1
  s_branch L_next
T_KVH_v:
  s_load_dwordx2 s[52:53], s[0:1], 32
  s_mov_b32 s33, 64
  s_mov_b32 s34, 8192
  s_mul_i32 s20, s28, 16384
  s_add_u32 s20, s20, 0
  s_lshl_b32 s21, s29, 8
  s_add_u32 s22, s21, 256
  s_mov_b32 s31, 6
  s_waitcnt lgkmcnt(0)
  s_mov_b32 s12, s52
  s_mov_b32 s13, s53
  s_mov_b32 s14, 0x800000
  s_mov_b32 s15, 0x20000
  s_mov_b32 s16, s52
  s_mov_b32 s17, s53
  s_mov_b32 s18, 0x800000
  s_mov_b32 s19, 0x20000
  s_mov_b32 s8, s4
  s_mov_b32 s9, s5
  s_mov_b32 s10, s6
  s_mov_b32 s11, s7
  v_and_b32 v20, 63, v0
  v_and_b32 v21, 15, v20
  v_lshrrev_b32 v22, 4, v20
  v_lshrrev_b32 v23, 3, v20
  v_and_b32 v23, 1, v23
  v_lshlrev_b32 v23, 1, v23
  v_xor_b32 v23, v22, v23
  v_lshlrev_b32 v23, 4, v23
  v_lshlrev_b32 v24, 6, v21
  v_add_u32 v23, v23, v24
  s_lshr_b32 s40, s27, 1
  s_lshl_b32 s40, s40, 13
  v_add_u32 v1, s40, v23
  v_add_u32 v2, 0x10000, v1
  v_and_b32 v23, 3, v20
  v_lshrrev_b32 v24, 2, v20
  v_and_b32 v24, 3, v24
  v_and_b32 v25, 1, v22
  v_lshlrev_b32 v25, 2, v25
  v_or_b32 v25, v25, v24
  v_lshlrev_b32 v26, 3, v22
  v_add_u32 v26, v26, v24
  v_lshlrev_b32 v26, 8, v26
  v_lshlrev_b32 v23, 3, v23
  v_add_u32 v26, v26, v23
  v_add_u32 v26, 0x4000, v26
  s_and_b32 s40, s27, 1
  s_lshl_b32 s40, s40, 2
  s_add_u32 s41, s40, 0
  v_xor_b32 v27, s41, v25
  v_lshlrev_b32 v27, 5, v27
  v_add_u32 v4, v26, v27
  v_add_u32 v8, 0x10000, v4
  s_add_u32 s41, s40, 1
  v_xor_b32 v27, s41, v25
  v_lshlrev_b32 v27, 5, v27
  v_add_u32 v5, v26, v27
  v_add_u32 v9, 0x10000, v5
  s_add_u32 s41, s40, 2
  v_xor_b32 v27, s41, v25
  v_lshlrev_b32 v27, 5, v27
  v_add_u32 v6, v26, v27
  v_add_u32 v10, 0x10000, v6
  s_add_u32 s41, s40, 3
  v_xor_b32 v27, s41, v25
  v_lshlrev_b32 v27, 5, v27
  v_add_u32 v7, v26, v27
  v_add_u32 v11, 0x10000, v7
  v_lshrrev_b32 v23, 2, v20
  s_lshl_b32 s40, s27, 6
  v_add_u32 v23, s40, v23
  v_mul_lo_u32 v23, v23, s33
  v_lshrrev_b32 v24, 5, v20
  v_lshlrev_b32 v24, 1, v24
  v_and_b32 v25, 3, v20
  v_xor_b32 v24, v24, v25
  v_lshlrev_b32 v24, 4, v24
  v_add_u32 v12, v23, v24
  s_lshl_b32 s40, s33, 4
  v_add_u32 v13, s40, v12
  v_add_u32 v14, s40, v13
  v_add_u32 v15, s40, v14
  v_lshrrev_b32 v23, 4, v20
  s_and_b32 s40, s27, 1
  s_lshl_b32 s40, s40, 2
  v_or_b32 v24, s40, v23
  v_and_b32 v25, 15, v20
  v_lshrrev_b32 v26, 1, v25
  v_xor_b32 v26, v26, v24
  v_lshlrev_b32 v26, 5, v26
  v_and_b32 v25, 1, v25
  v_lshlrev_b32 v25, 4, v25
  v_add_u32 v26, v26, v25
  s_lshl_b32 s40, s27, 3
  v_add_u32 v23, s40, v23
  v_mul_lo_u32 v23, v23, s34
  v_add_u32 v16, v23, v26
  s_lshl_b32 s40, s34, 2
  v_add_u32 v17, s40, v16
  s_lshl_b32 s24, s27, 12
  s_lshl_b32 s25, s27, 11
  s_add_u32 s25, s25, 0x4000
  s_lshl_b32 s23, s34, 5
  s_add_u32 m0, s24, 0
  s_nop 0
  buffer_load_dwordx4 v12, s[8:11], s20 offen lds
  s_add_u32 m0, s24, 1024
  s_nop 0
  buffer_load_dwordx4 v13, s[8:11], s20 offen lds
  s_add_u32 m0, s24, 2048
  s_nop 0
  buffer_load_dwordx4 v14, s[8:11], s20 offen lds
  s_add_u32 m0, s24, 3072
  s_nop 0
  buffer_load_dwordx4 v15, s[8:11], s20 offen lds
  s_add_u32 m0, s25, 0
  s_nop 0
  buffer_load_dwordx4 v16, s[12:15], s21 offen lds
  s_add_u32 m0, s25, 1024
  s_nop 0
  buffer_load_dwordx4 v17, s[12:15], s21 offen lds
  s_add_u32 s20, s20, 131072
  s_add_u32 s21, s21, s23
  s_add_u32 m0, s24, 32768
  s_nop 0
  buffer_load_dwordx4 v12, s[8:11], s20 offen lds
  s_add_u32 m0, s24, 33792
  s_nop 0
  buffer_load_dwordx4 v13, s[8:11], s20 offen lds
  s_add_u32 m0, s24, 34816
  s_nop 0
  buffer_load_dwordx4 v14, s[8:11], s20 offen lds
  s_add_u32 m0, s24, 35840
  s_nop 0
  buffer_load_dwordx4 v15, s[8:11], s20 offen lds
  s_add_u32 m0, s25, 32768
  s_nop 0
  buffer_load_dwordx4 v16, s[12:15], s21 offen lds
  s_add_u32 m0, s25, 33792
  s_nop 0
  buffer_load_dwordx4 v17, s[12:15], s21 offen lds
  s_add_u32 s20, s20, 131072
  s_add_u32 s21, s21, s23
  s_add_u32 m0, s24, 65536
  s_nop 0
  buffer_load_dwordx4 v12, s[8:11], s20 offen lds
  s_add_u32 m0, s24, 66560
  s_nop 0
  buffer_load_dwordx4 v13, s[8:11], s20 offen lds
  s_add_u32 m0, s24, 67584
  s_nop 0
  buffer_load_dwordx4 v14, s[8:11], s20 offen lds
  s_add_u32 m0, s24, 68608
  s_nop 0
  buffer_load_dwordx4 v15, s[8:11], s20 offen lds
  s_add_u32 m0, s25, 65536
  s_nop 0
  buffer_load_dwordx4 v16, s[12:15], s21 offen lds
  s_add_u32 m0, s25, 66560
  s_nop 0
  buffer_load_dwordx4 v17, s[12:15], s21 offen lds
  s_add_u32 s20, s20, 131072
  s_add_u32 s21, s21, s23
  s_add_u32 m0, s24, 98304
  s_nop 0
  buffer_load_dwordx4 v12, s[8:11], s20 offen lds
  s_add_u32 m0, s24, 99328
  s_nop 0
  buffer_load_dwordx4 v13, s[8:11], s20 offen lds
  s_add_u32 m0, s24, 100352
  s_nop 0
  buffer_load_dwordx4 v14, s[8:11], s20 offen lds
  s_add_u32 m0, s24, 101376
  s_nop 0
  buffer_load_dwordx4 v15, s[8:11], s20 offen lds
  s_add_u32 m0, s25, 98304
  s_nop 0
  buffer_load_dwordx4 v16, s[12:15], s21 offen lds
  s_add_u32 m0, s25, 99328
  s_nop 0
  buffer_load_dwordx4 v17, s[12:15], s21 offen lds
  s_add_u32 s20, s20, 131072
  s_add_u32 s21, s21, s23
  s_waitcnt vmcnt(18)
  s_barrier
  s_cmp_eq_u32 s76, -1
  s_cbranch_scc1 L_pe_86
  s_cmp_lg_u32 s27, 0
  s_cbranch_scc1 L_pe_86_c
  s_and_b32 s47, s76, 0xffff
  s_add_u32 s47, s47, 117440512
  s_lshr_b32 s48, s76, 16
  s_add_u32 s48, s48, 1
  v_mov_b32 v18, s47
  v_mov_b32 v19, s48
  s_mov_b64 exec, 1
  buffer_atomic_add v19, v18, s[4:7], 0 offen sc1
  s_mov_b64 exec, -1
L_pe_86_c:
  s_mov_b32 s76, -1
L_pe_86:
  ds_read_b128 v[64:67], v1 offset:0
  ds_read_b64_tr_b16 v[32:33], v4 offset:0
  ds_read_b128 v[68:71], v1 offset:1024
  ds_read_b64_tr_b16 v[34:35], v4 offset:1024
  ds_read_b128 v[72:75], v1 offset:2048
  ds_read_b64_tr_b16 v[36:37], v5 offset:0
  ds_read_b128 v[76:79], v1 offset:3072
  ds_read_b64_tr_b16 v[38:39], v5 offset:1024
  ds_read_b128 v[80:83], v1 offset:4096
  ds_read_b64_tr_b16 v[40:41], v6 offset:0
  ds_read_b128 v[84:87], v1 offset:5120
  ds_read_b64_tr_b16 v[42:43], v6 offset:1024
  ds_read_b128 v[88:91], v1 offset:6144
  ds_read_b64_tr_b16 v[44:45], v7 offset:0
  ds_read_b128 v[92:95], v1 offset:7168
  ds_read_b64_tr_b16 v[46:47], v7 offset:1024
  s_waitcnt vmcnt(12) lgkmcnt(0)
  s_barrier
  v_mfma_f32_16x16x32_bf16 v[128:131], v[64:67], v[32:35], 0
  ds_read_b128 v[96:99], v1 offset:32768
  v_mfma_f32_16x16x32_bf16 v[132:135], v[64:67], v[36:39], 0
  s_add_u32 m0, s24, 0
  ds_read_b64_tr_b16 v[48:49], v4 offset:32768
  v_mfma_f32_16x16x32_bf16 v[136:139], v[64:67], v[40:43], 0
  buffer_load_dwordx4 v12, s[8:11], s20 offen lds
  v_mfma_f32_16x16x32_bf16 v[140:143], v[64:67], v[44:47], 0
  ds_read_b128 v[100:103], v1 offset:33792
  v_mfma_f32_16x16x32_bf16 v[144:147], v[68:71], v[32:35], 0
  ds_read_b64_tr_b16 v[50:51], v4 offset:33792
  v_mfma_f32_16x16x32_bf16 v[148:151], v[68:71], v[36:39], 0
  s_add_u32 m0, s24, 1024
  v_mfma_f32_16x16x32_bf16 v[152:155], v[68:71], v[40:43], 0
  buffer_load_dwordx4 v13, s[8:11], s20 offen lds
  ds_read_b128 v[104:107], v1 offset:34816
  v_mfma_f32_16x16x32_bf16 v[156:159], v[68:71], v[44:47], 0
  ds_read_b64_tr_b16 v[52:53], v5 offset:32768
  v_mfma_f32_16x16x32_bf16 v[160:163], v[72:75], v[32:35], 0
  v_mfma_f32_16x16x32_bf16 v[164:167], v[72:75], v[36:39], 0
  s_add_u32 m0, s24, 2048
  ds_read_b128 v[108:111], v1 offset:35840
  v_mfma_f32_16x16x32_bf16 v[168:171], v[72:75], v[40:43], 0
  buffer_load_dwordx4 v14, s[8:11], s20 offen lds
  ds_read_b64_tr_b16 v[54:55], v5 offset:33792
  v_mfma_f32_16x16x32_bf16 v[172:175], v[72:75], v[44:47], 0
  v_mfma_f32_16x16x32_bf16 v[176:179], v[76:79], v[32:35], 0
  ds_read_b128 v[112:115], v1 offset:36864
  v_mfma_f32_16x16x32_bf16 v[180:183], v[76:79], v[36:39], 0
  s_add_u32 m0, s24, 3072
  ds_read_b64_tr_b16 v[56:57], v6 offset:32768
  v_mfma_f32_16x16x32_bf16 v[184:187], v[76:79], v[40:43], 0
  buffer_load_dwordx4 v15, s[8:11], s20 offen lds
  v_mfma_f32_16x16x32_bf16 v[188:191], v[76:79], v[44:47], 0
  ds_read_b128 v[116:119], v1 offset:37888
  v_mfma_f32_16x16x32_bf16 v[192:195], v[80:83], v[32:35], 0
  ds_read_b64_tr_b16 v[58:59], v6 offset:33792
  v_mfma_f32_16x16x32_bf16 v[196:199], v[80:83], v[36:39], 0
  s_add_u32 m0, s25, 0
  v_mfma_f32_16x16x32_bf16 v[200:203], v[80:83], v[40:43], 0
  buffer_load_dwordx4 v16, s[12:15], s21 offen lds
  ds_read_b128 v[120:123], v1 offset:38912
  v_mfma_f32_16x16x32_bf16 v[204:207], v[80:83], v[44:47], 0
  ds_read_b64_tr_b16 v[60:61], v7 offset:32768
  v_mfma_f32_16x16x32_bf16 v[208:211], v[84:87], v[32:35], 0
  v_mfma_f32_16x16x32_bf16 v[212:215], v[84:87], v[36:39], 0
  s_add_u32 m0, s25, 1024
  ds_read_b128 v[124:127], v1 offset:39936
  v_mfma_f32_16x16x32_bf16 v[216:219], v[84:87], v[40:43], 0
  buffer_load_dwordx4 v17, s[12:15], s21 offen lds
  ds_read_b64_tr_b16 v[62:63], v7 offset:33792
  v_mfma_f32_16x16x32_bf16 v[220:223], v[84:87], v[44:47], 0
  v_mfma_f32_16x16x32_bf16 v[224:227], v[88:91], v[32:35], 0
  v_mfma_f32_16x16x32_bf16 v[228:231], v[88:91], v[36:39], 0
  v_mfma_f32_16x16x32_bf16 v[232:235], v[88:91], v[40:43], 0
  s_add_u32 s20, s20, 131072
  v_mfma_f32_16x16x32_bf16 v[236:239], v[88:91], v[44:47], 0
  s_add_u32 s21, s21, s23
  v_mfma_f32_16x16x32_bf16 v[240:243], v[92:95], v[32:35], 0
  v_mfma_f32_16x16x32_bf16 v[244:247], v[92:95], v[36:39], 0
  v_mfma_f32_16x16x32_bf16 v[248:251], v[92:95], v[40:43], 0
  v_mfma_f32_16x16x32_bf16 v[252:255], v[92:95], v[44:47], 0
  s_waitcnt vmcnt(12) lgkmcnt(0)
  s_barrier
  v_mfma_f32_16x16x32_bf16 v[128:131], v[96:99], v[48:51], v[128:131]
  ds_read_b128 v[64:67], v2 offset:0
  v_mfma_f32_16x16x32_bf16 v[132:135], v[96:99], v[52:55], v[132:135]
  s_add_u32 m0, s24, 32768
  ds_read_b64_tr_b16 v[32:33], v8 offset:0
  v_mfma_f32_16x16x32_bf16 v[136:139], v[96:99], v[56:59], v[136:139]
  buffer_load_dwordx4 v12, s[8:11], s20 offen lds
  v_mfma_f32_16x16x32_bf16 v[140:143], v[96:99], v[60:63], v[140:143]
  ds_read_b128 v[68:71], v2 offset:1024
  v_mfma_f32_16x16x32_bf16 v[144:147], v[100:103], v[48:51], v[144:147]
  ds_read_b64_tr_b16 v[34:35], v8 offset:1024
  v_mfma_f32_16x16x32_bf16 v[148:151], v[100:103], v[52:55], v[148:151]
  s_add_u32 m0, s24, 33792
  v_mfma_f32_16x16x32_bf16 v[152:155], v[100:103], v[56:59], v[152:155]
  buffer_load_dwordx4 v13, s[8:11], s20 offen lds
  ds_read_b128 v[72:75], v2 offset:2048
  v_mfma_f32_16x16x32_bf16 v[156:159], v[100:103], v[60:63], v[156:159]
  ds_read_b64_tr_b16 v[36:37], v9 offset:0
  v_mfma_f32_16x16x32_bf16 v[160:163], v[104:107], v[48:51], v[160:163]
  v_mfma_f32_16x16x32_bf16 v[164:167], v[104:107], v[52:55], v[164:167]
  s_add_u32 m0, s24, 34816
  ds_read_b128 v[76:79], v2 offset:3072
  v_mfma_f32_16x16x32_bf16 v[168:171], v[104:107], v[56:59], v[168:171]
  buffer_load_dwordx4 v14, s[8:11], s20 offen lds
  ds_read_b64_tr_b16 v[38:39], v9 offset:1024
  v_mfma_f32_16x16x32_bf16 v[172:175], v[104:107], v[60:63], v[172:175]
  v_mfma_f32_16x16x32_bf16 v[176:179], v[108:111], v[48:51], v[176:179]
  ds_read_b128 v[80:83], v2 offset:4096
  v_mfma_f32_16x16x32_bf16 v[180:183], v[108:111], v[52:55], v[180:183]
  s_add_u32 m0, s24, 35840
  ds_read_b64_tr_b16 v[40:41], v10 offset:0
  v_mfma_f32_16x16x32_bf16 v[184:187], v[108:111], v[56:59], v[184:187]
  buffer_load_dwordx4 v15, s[8:11], s20 offen lds
  v_mfma_f32_16x16x32_bf16 v[188:191], v[108:111], v[60:63], v[188:191]
  ds_read_b128 v[84:87], v2 offset:5120
  v_mfma_f32_16x16x32_bf16 v[192:195], v[112:115], v[48:51], v[192:195]
  ds_read_b64_tr_b16 v[42:43], v10 offset:1024
  v_mfma_f32_16x16x32_bf16 v[196:199], v[112:115], v[52:55], v[196:199]
  s_add_u32 m0, s25, 32768
  v_mfma_f32_16x16x32_bf16 v[200:203], v[112:115], v[56:59], v[200:203]
  buffer_load_dwordx4 v16, s[12:15], s21 offen lds
  ds_read_b128 v[88:91], v2 offset:6144
  v_mfma_f32_16x16x32_bf16 v[204:207], v[112:115], v[60:63], v[204:207]
  ds_read_b64_tr_b16 v[44:45], v11 offset:0
  v_mfma_f32_16x16x32_bf16 v[208:211], v[116:119], v[48:51], v[208:211]
  v_mfma_f32_16x16x32_bf16 v[212:215], v[116:119], v[52:55], v[212:215]
  s_add_u32 m0, s25, 33792
  ds_read_b128 v[92:95], v2 offset:7168
  v_mfma_f32_16x16x32_bf16 v[216:219], v[116:119], v[56:59], v[216:219]
  buffer_load_dwordx4 v17, s[12:15], s21 offen lds
  ds_read_b64_tr_b16 v[46:47], v11 offset:1024
  v_mfma_f32_16x16x32_bf16 v[220:223], v[116:119], v[60:63], v[220:223]
  v_mfma_f32_16x16x32_bf16 v[224:227], v[120:123], v[48:51], v[224:227]
  v_mfma_f32_16x16x32_bf16 v[228:231], v[120:123], v[52:55], v[228:231]
  v_mfma_f32_16x16x32_bf16 v[232:235], v[120:123], v[56:59], v[232:235]
  s_add_u32 s20, s20, 131072
  v_mfma_f32_16x16x32_bf16 v[236:239], v[120:123], v[60:63], v[236:239]
  s_add_u32 s21, s21, s23
  v_mfma_f32_16x16x32_bf16 v[240:243], v[124:127], v[48:51], v[240:243]
  v_mfma_f32_16x16x32_bf16 v[244:247], v[124:127], v[52:55], v[244:247]
  v_mfma_f32_16x16x32_bf16 v[248:251], v[124:127], v[56:59], v[248:251]
  v_mfma_f32_16x16x32_bf16 v[252:255], v[124:127], v[60:63], v[252:255]
  s_waitcnt vmcnt(12) lgkmcnt(0)
  s_barrier
  v_mfma_f32_16x16x32_bf16 v[128:131], v[64:67], v[32:35], v[128:131]
  ds_read_b128 v[96:99], v2 offset:32768
  v_mfma_f32_16x16x32_bf16 v[132:135], v[64:67], v[36:39], v[132:135]
  s_add_u32 m0, s24, 65536
  ds_read_b64_tr_b16 v[48:49], v8 offset:32768
  v_mfma_f32_16x16x32_bf16 v[136:139], v[64:67], v[40:43], v[136:139]
  buffer_load_dwordx4 v12, s[8:11], s20 offen lds
  v_mfma_f32_16x16x32_bf16 v[140:143], v[64:67], v[44:47], v[140:143]
  ds_read_b128 v[100:103], v2 offset:33792
  v_mfma_f32_16x16x32_bf16 v[144:147], v[68:71], v[32:35], v[144:147]
  ds_read_b64_tr_b16 v[50:51], v8 offset:33792
  v_mfma_f32_16x16x32_bf16 v[148:151], v[68:71], v[36:39], v[148:151]
  s_add_u32 m0, s24, 66560
  v_mfma_f32_16x16x32_bf16 v[152:155], v[68:71], v[40:43], v[152:155]
  buffer_load_dwordx4 v13, s[8:11], s20 offen lds
  ds_read_b128 v[104:107], v2 offset:34816
  v_mfma_f32_16x16x32_bf16 v[156:159], v[68:71], v[44:47], v[156:159]
  ds_read_b64_tr_b16 v[52:53], v9 offset:32768
  v_mfma_f32_16x16x32_bf16 v[160:163], v[72:75], v[32:35], v[160:163]
  v_mfma_f32_16x16x32_bf16 v[164:167], v[72:75], v[36:39], v[164:167]
  s_add_u32 m0, s24, 67584
  ds_read_b128 v[108:111], v2 offset:35840
  v_mfma_f32_16x16x32_bf16 v[168:171], v[72:75], v[40:43], v[168:171]
  buffer_load_dwordx4 v14, s[8:11], s20 offen lds
  ds_read_b64_tr_b16 v[54:55], v9 offset:33792
  v_mfma_f32_16x16x32_bf16 v[172:175], v[72:75], v[44:47], v[172:175]
  v_mfma_f32_16x16x32_bf16 v[176:179], v[76:79], v[32:35], v[176:179]
  ds_read_b128 v[112:115], v2 offset:36864
  v_mfma_f32_16x16x32_bf16 v[180:183], v[76:79], v[36:39], v[180:183]
  s_add_u32 m0, s24, 68608
  ds_read_b64_tr_b16 v[56:57], v10 offset:32768
  v_mfma_f32_16x16x32_bf16 v[184:187], v[76:79], v[40:43], v[184:187]
  buffer_load_dwordx4 v15, s[8:11], s20 offen lds
  v_mfma_f32_16x16x32_bf16 v[188:191], v[76:79], v[44:47], v[188:191]
  ds_read_b128 v[116:119], v2 offset:37888
  v_mfma_f32_16x16x32_bf16 v[192:195], v[80:83], v[32:35], v[192:195]
  ds_read_b64_tr_b16 v[58:59], v10 offset:33792
  v_mfma_f32_16x16x32_bf16 v[196:199], v[80:83], v[36:39], v[196:199]
  s_add_u32 m0, s25, 65536
  v_mfma_f32_16x16x32_bf16 v[200:203], v[80:83], v[40:43], v[200:203]
  buffer_load_dwordx4 v16, s[12:15], s21 offen lds
  ds_read_b128 v[120:123], v2 offset:38912
  v_mfma_f32_16x16x32_bf16 v[204:207], v[80:83], v[44:47], v[204:207]
  ds_read_b64_tr_b16 v[60:61], v11 offset:32768
  v_mfma_f32_16x16x32_bf16 v[208:211], v[84:87], v[32:35], v[208:211]
  v_mfma_f32_16x16x32_bf16 v[212:215], v[84:87], v[36:39], v[212:215]
  s_add_u32 m0, s25, 66560
  ds_read_b128 v[124:127], v2 offset:39936
  v_mfma_f32_16x16x32_bf16 v[216:219], v[84:87], v[40:43], v[216:219]
  buffer_load_dwordx4 v17, s[12:15], s21 offen lds
  ds_read_b64_tr_b16 v[62:63], v11 offset:33792
  v_mfma_f32_16x16x32_bf16 v[220:223], v[84:87], v[44:47], v[220:223]
  v_mfma_f32_16x16x32_bf16 v[224:227], v[88:91], v[32:35], v[224:227]
  v_mfma_f32_16x16x32_bf16 v[228:231], v[88:91], v[36:39], v[228:231]
  v_mfma_f32_16x16x32_bf16 v[232:235], v[88:91], v[40:43], v[232:235]
  s_add_u32 s20, s20, 131072
  v_mfma_f32_16x16x32_bf16 v[236:239], v[88:91], v[44:47], v[236:239]
  s_add_u32 s21, s21, s23
  v_mfma_f32_16x16x32_bf16 v[240:243], v[92:95], v[32:35], v[240:243]
  v_mfma_f32_16x16x32_bf16 v[244:247], v[92:95], v[36:39], v[244:247]
  v_mfma_f32_16x16x32_bf16 v[248:251], v[92:95], v[40:43], v[248:251]
  v_mfma_f32_16x16x32_bf16 v[252:255], v[92:95], v[44:47], v[252:255]
  s_waitcnt vmcnt(12) lgkmcnt(0)
  s_barrier
  v_mfma_f32_16x16x32_bf16 v[128:131], v[96:99], v[48:51], v[128:131]
  ds_read_b128 v[64:67], v1 offset:0
  v_mfma_f32_16x16x32_bf16 v[132:135], v[96:99], v[52:55], v[132:135]
  s_add_u32 m0, s24, 98304
  ds_read_b64_tr_b16 v[32:33], v4 offset:0
  v_mfma_f32_16x16x32_bf16 v[136:139], v[96:99], v[56:59], v[136:139]
  buffer_load_dwordx4 v12, s[8:11], s20 offen lds
  v_mfma_f32_16x16x32_bf16 v[140:143], v[96:99], v[60:63], v[140:143]
  ds_read_b128 v[68:71], v1 offset:1024
  v_mfma_f32_16x16x32_bf16 v[144:147], v[100:103], v[48:51], v[144:147]
  ds_read_b64_tr_b16 v[34:35], v4 offset:1024
  v_mfma_f32_16x16x32_bf16 v[148:151], v[100:103], v[52:55], v[148:151]
  s_add_u32 m0, s24, 99328
  v_mfma_f32_16x16x32_bf16 v[152:155], v[100:103], v[56:59], v[152:155]
  buffer_load_dwordx4 v13, s[8:11], s20 offen lds
  ds_read_b128 v[72:75], v1 offset:2048
  v_mfma_f32_16x16x32_bf16 v[156:159], v[100:103], v[60:63], v[156:159]
  ds_read_b64_tr_b16 v[36:37], v5 offset:0
  v_mfma_f32_16x16x32_bf16 v[160:163], v[104:107], v[48:51], v[160:163]
  v_mfma_f32_16x16x32_bf16 v[164:167], v[104:107], v[52:55], v[164:167]
  s_add_u32 m0, s24, 100352
  ds_read_b128 v[76:79], v1 offset:3072
  v_mfma_f32_16x16x32_bf16 v[168:171], v[104:107], v[56:59], v[168:171]
  buffer_load_dwordx4 v14, s[8:11], s20 offen lds
  ds_read_b64_tr_b16 v[38:39], v5 offset:1024
  v_mfma_f32_16x16x32_bf16 v[172:175], v[104:107], v[60:63], v[172:175]
  v_mfma_f32_16x16x32_bf16 v[176:179], v[108:111], v[48:51], v[176:179]
  ds_read_b128 v[80:83], v1 offset:4096
  v_mfma_f32_16x16x32_bf16 v[180:183], v[108:111], v[52:55], v[180:183]
  s_add_u32 m0, s24, 101376
  ds_read_b64_tr_b16 v[40:41], v6 offset:0
  v_mfma_f32_16x16x32_bf16 v[184:187], v[108:111], v[56:59], v[184:187]
  buffer_load_dwordx4 v15, s[8:11], s20 offen lds
  v_mfma_f32_16x16x32_bf16 v[188:191], v[108:111], v[60:63], v[188:191]
  ds_read_b128 v[84:87], v1 offset:5120
  v_mfma_f32_16x16x32_bf16 v[192:195], v[112:115], v[48:51], v[192:195]
  ds_read_b64_tr_b16 v[42:43], v6 offset:1024
  v_mfma_f32_16x16x32_bf16 v[196:199], v[112:115], v[52:55], v[196:199]
  s_add_u32 m0, s25, 98304
  v_mfma_f32_16x16x32_bf16 v[200:203], v[112:115], v[56:59], v[200:203]
  buffer_load_dwordx4 v16, s[12:15], s21 offen lds
  ds_read_b128 v[88:91], v1 offset:6144
  v_mfma_f32_16x16x32_bf16 v[204:207], v[112:115], v[60:63], v[204:207]
  ds_read_b64_tr_b16 v[44:45], v7 offset:0
  v_mfma_f32_16x16x32_bf16 v[208:211], v[116:119], v[48:51], v[208:211]
  v_mfma_f32_16x16x32_bf16 v[212:215], v[116:119], v[52:55], v[212:215]
  s_add_u32 m0, s25, 99328
  ds_read_b128 v[92:95], v1 offset:7168
  v_mfma_f32_16x16x32_bf16 v[216:219], v[116:119], v[56:59], v[216:219]
  buffer_load_dwordx4 v17, s[12:15], s21 offen lds
  ds_read_b64_tr_b16 v[46:47], v7 offset:1024
  v_mfma_f32_16x16x32_bf16 v[220:223], v[116:119], v[60:63], v[220:223]
  v_mfma_f32_16x16x32_bf16 v[224:227], v[120:123], v[48:51], v[224:227]
  v_mfma_f32_16x16x32_bf16 v[228:231], v[120:123], v[52:55], v[228:231]
  v_mfma_f32_16x16x32_bf16 v[232:235], v[120:123], v[56:59], v[232:235]
  s_add_u32 s20, s20, 131072
  v_mfma_f32_16x16x32_bf16 v[236:239], v[120:123], v[60:63], v[236:239]
  s_add_u32 s21, s21, s23
  v_mfma_f32_16x16x32_bf16 v[240:243], v[124:127], v[48:51], v[240:243]
  v_mfma_f32_16x16x32_bf16 v[244:247], v[124:127], v[52:55], v[244:247]
  v_mfma_f32_16x16x32_bf16 v[248:251], v[124:127], v[56:59], v[248:251]
  v_mfma_f32_16x16x32_bf16 v[252:255], v[124:127], v[60:63], v[252:255]
  s_mov_b32 s26, s31
T_KVH_mv_loop:
  s_waitcnt vmcnt(12) lgkmcnt(0)
  s_barrier
  v_mfma_f32_16x16x32_bf16 v[128:131], v[64:67], v[32:35], v[128:131]
  ds_read_b128 v[96:99], v1 offset:32768
  v_mfma_f32_16x16x32_bf16 v[132:135], v[64:67], v[36:39], v[132:135]
  s_add_u32 m0, s24, 0
  ds_read_b64_tr_b16 v[48:49], v4 offset:32768
  v_mfma_f32_16x16x32_bf16 v[136:139], v[64:67], v[40:43], v[136:139]
  buffer_load_dwordx4 v12, s[8:11], s20 offen lds
  v_mfma_f32_16x16x32_bf16 v[140:143], v[64:67], v[44:47], v[140:143]
  ds_read_b128 v[100:103], v1 offset:33792
  v_mfma_f32_16x16x32_bf16 v[144:147], v[68:71], v[32:35], v[144:147]
  ds_read_b64_tr_b16 v[50:51], v4 offset:33792
  v_mfma_f32_16x16x32_bf16 v[148:151], v[68:71], v[36:39], v[148:151]
  s_add_u32 m0, s24, 1024
  v_mfma_f32_16x16x32_bf16 v[152:155], v[68:71], v[40:43], v[152:155]
  buffer_load_dwordx4 v13, s[8:11], s20 offen lds
  ds_read_b128 v[104:107], v1 offset:34816
  v_mfma_f32_16x16x32_bf16 v[156:159], v[68:71], v[44:47], v[156:159]
  ds_read_b64_tr_b16 v[52:53], v5 offset:32768
  v_mfma_f32_16x16x32_bf16 v[160:163], v[72:75], v[32:35], v[160:163]
  v_mfma_f32_16x16x32_bf16 v[164:167], v[72:75], v[36:39], v[164:167]
  s_add_u32 m0, s24, 2048
  ds_read_b128 v[108:111], v1 offset:35840
  v_mfma_f32_16x16x32_bf16 v[168:171], v[72:75], v[40:43], v[168:171]
  buffer_load_dwordx4 v14, s[8:11], s20 offen lds
  ds_read_b64_tr_b16 v[54:55], v5 offset:33792
  v_mfma_f32_16x16x32_bf16 v[172:175], v[72:75], v[44:47], v[172:175]
  v_mfma_f32_16x16x32_bf16 v[176:179], v[76:79], v[32:35], v[176:179]
  ds_read_b128 v[112:115], v1 offset:36864
  v_mfma_f32_16x16x32_bf16 v[180:183], v[76:79], v[36:39], v[180:183]
  s_add_u32 m0, s24, 3072
  ds_read_b64_tr_b16 v[56:57], v6 offset:32768
  v_mfma_f32_16x16x32_bf16 v[184:187], v[76:79], v[40:43], v[184:187]
  buffer_load_dwordx4 v15, s[8:11], s20 offen lds
  v_mfma_f32_16x16x32_bf16 v[188:191], v[76:79], v[44:47], v[188:191]
  ds_read_b128 v[116:119], v1 offset:37888
  v_mfma_f32_16x16x32_bf16 v[192:195], v[80:83], v[32:35], v[192:195]
  ds_read_b64_tr_b16 v[58:59], v6 offset:33792
  v_mfma_f32_16x16x32_bf16 v[196:199], v[80:83], v[36:39], v[196:199]
  s_add_u32 m0, s25, 0
  v_mfma_f32_16x16x32_bf16 v[200:203], v[80:83], v[40:43], v[200:203]
  buffer_load_dwordx4 v16, s[12:15], s21 offen lds
  ds_read_b128 v[120:123], v1 offset:38912
  v_mfma_f32_16x16x32_bf16 v[204:207], v[80:83], v[44:47], v[204:207]
  ds_read_b64_tr_b16 v[60:61], v7 offset:32768
  v_mfma_f32_16x16x32_bf16 v[208:211], v[84:87], v[32:35], v[208:211]
  v_mfma_f32_16x16x32_bf16 v[212:215], v[84:87], v[36:39], v[212:215]
  s_add_u32 m0, s25, 1024
  ds_read_b128 v[124:127], v1 offset:39936
  v_mfma_f32_16x16x32_bf16 v[216:219], v[84:87], v[40:43], v[216:219]
  buffer_load_dwordx4 v17, s[12:15], s21 offen lds
  ds_read_b64_tr_b16 v[62:63], v7 offset:33792
  v_mfma_f32_16x16x32_bf16 v[220:223], v[84:87], v[44:47], v[220:223]
  v_mfma_f32_16x16x32_bf16 v[224:227], v[88:91], v[32:35], v[224:227]
  v_mfma_f32_16x16x32_bf16 v[228:231], v[88:91], v[36:39], v[228:231]
  v_mfma_f32_16x16x32_bf16 v[232:235], v[88:91], v[40:43], v[232:235]
  s_add_u32 s20, s20, 131072
  v_mfma_f32_16x16x32_bf16 v[236:239], v[88:91], v[44:47], v[236:239]
  s_add_u32 s21, s21, s23
  v_mfma_f32_16x16x32_bf16 v[240:243], v[92:95], v[32:35], v[240:243]
  v_mfma_f32_16x16x32_bf16 v[244:247], v[92:95], v[36:39], v[244:247]
  v_mfma_f32_16x16x32_bf16 v[248:251], v[92:95], v[40:43], v[248:251]
  v_mfma_f32_16x16x32_bf16 v[252:255], v[92:95], v[44:47], v[252:255]
  s_waitcnt vmcnt(12) lgkmcnt(0)
  s_barrier
  v_mfma_f32_16x16x32_bf16 v[128:131], v[96:99], v[48:51], v[128:131]
  ds_read_b128 v[64:67], v2 offset:0
  v_mfma_f32_16x16x32_bf16 v[132:135], v[96:99], v[52:55], v[132:135]
  s_add_u32 m0, s24, 32768
  ds_read_b64_tr_b16 v[32:33], v8 offset:0
  v_mfma_f32_16x16x32_bf16 v[136:139], v[96:99], v[56:59], v[136:139]
  buffer_load_dwordx4 v12, s[8:11], s20 offen lds
  v_mfma_f32_16x16x32_bf16 v[140:143], v[96:99], v[60:63], v[140:143]
  ds_read_b128 v[68:71], v2 offset:1024
  v_mfma_f32_16x16x32_bf16 v[144:147], v[100:103], v[48:51], v[144:147]
  ds_read_b64_tr_b16 v[34:35], v8 offset:1024
  v_mfma_f32_16x16x32_bf16 v[148:151], v[100:103], v[52:55], v[148:151]
  s_add_u32 m0, s24, 33792
  v_mfma_f32_16x16x32_bf16 v[152:155], v[100:103], v[56:59], v[152:155]
  buffer_load_dwordx4 v13, s[8:11], s20 offen lds
  ds_read_b128 v[72:75], v2 offset:2048
  v_mfma_f32_16x16x32_bf16 v[156:159], v[100:103], v[60:63], v[156:159]
  ds_read_b64_tr_b16 v[36:37], v9 offset:0
  v_mfma_f32_16x16x32_bf16 v[160:163], v[104:107], v[48:51], v[160:163]
  v_mfma_f32_16x16x32_bf16 v[164:167], v[104:107], v[52:55], v[164:167]
  s_add_u32 m0, s24, 34816
  ds_read_b128 v[76:79], v2 offset:3072
  v_mfma_f32_16x16x32_bf16 v[168:171], v[104:107], v[56:59], v[168:171]
  buffer_load_dwordx4 v14, s[8:11], s20 offen lds
  ds_read_b64_tr_b16 v[38:39], v9 offset:1024
  v_mfma_f32_16x16x32_bf16 v[172:175], v[104:107], v[60:63], v[172:175]
  v_mfma_f32_16x16x32_bf16 v[176:179], v[108:111], v[48:51], v[176:179]
  ds_read_b128 v[80:83], v2 offset:4096
  v_mfma_f32_16x16x32_bf16 v[180:183], v[108:111], v[52:55], v[180:183]
  s_add_u32 m0, s24, 35840
  ds_read_b64_tr_b16 v[40:41], v10 offset:0
  v_mfma_f32_16x16x32_bf16 v[184:187], v[108:111], v[56:59], v[184:187]
  buffer_load_dwordx4 v15, s[8:11], s20 offen lds
  v_mfma_f32_16x16x32_bf16 v[188:191], v[108:111], v[60:63], v[188:191]
  ds_read_b128 v[84:87], v2 offset:5120
  v_mfma_f32_16x16x32_bf16 v[192:195], v[112:115], v[48:51], v[192:195]
  ds_read_b64_tr_b16 v[42:43], v10 offset:1024
  v_mfma_f32_16x16x32_bf16 v[196:199], v[112:115], v[52:55], v[196:199]
  s_add_u32 m0, s25, 32768
  v_mfma_f32_16x16x32_bf16 v[200:203], v[112:115], v[56:59], v[200:203]
  buffer_load_dwordx4 v16, s[12:15], s21 offen lds
  ds_read_b128 v[88:91], v2 offset:6144
  v_mfma_f32_16x16x32_bf16 v[204:207], v[112:115], v[60:63], v[204:207]
  ds_read_b64_tr_b16 v[44:45], v11 offset:0
  v_mfma_f32_16x16x32_bf16 v[208:211], v[116:119], v[48:51], v[208:211]
  v_mfma_f32_16x16x32_bf16 v[212:215], v[116:119], v[52:55], v[212:215]
  s_add_u32 m0, s25, 33792
  ds_read_b128 v[92:95], v2 offset:7168
  v_mfma_f32_16x16x32_bf16 v[216:219], v[116:119], v[56:59], v[216:219]
  buffer_load_dwordx4 v17, s[12:15], s21 offen lds
  ds_read_b64_tr_b16 v[46:47], v11 offset:1024
  v_mfma_f32_16x16x32_bf16 v[220:223], v[116:119], v[60:63], v[220:223]
  v_mfma_f32_16x16x32_bf16 v[224:227], v[120:123], v[48:51], v[224:227]
  v_mfma_f32_16x16x32_bf16 v[228:231], v[120:123], v[52:55], v[228:231]
  v_mfma_f32_16x16x32_bf16 v[232:235], v[120:123], v[56:59], v[232:235]
  s_add_u32 s20, s20, 131072
  v_mfma_f32_16x16x32_bf16 v[236:239], v[120:123], v[60:63], v[236:239]
  s_add_u32 s21, s21, s23
  v_mfma_f32_16x16x32_bf16 v[240:243], v[124:127], v[48:51], v[240:243]
  v_mfma_f32_16x16x32_bf16 v[244:247], v[124:127], v[52:55], v[244:247]
  v_mfma_f32_16x16x32_bf16 v[248:251], v[124:127], v[56:59], v[248:251]
  v_mfma_f32_16x16x32_bf16 v[252:255], v[124:127], v[60:63], v[252:255]
  s_waitcnt vmcnt(12) lgkmcnt(0)
  s_barrier
  v_mfma_f32_16x16x32_bf16 v[128:131], v[64:67], v[32:35], v[128:131]
  ds_read_b128 v[96:99], v2 offset:32768
  v_mfma_f32_16x16x32_bf16 v[132:135], v[64:67], v[36:39], v[132:135]
  s_add_u32 m0, s24, 65536
  ds_read_b64_tr_b16 v[48:49], v8 offset:32768
  v_mfma_f32_16x16x32_bf16 v[136:139], v[64:67], v[40:43], v[136:139]
  buffer_load_dwordx4 v12, s[8:11], s20 offen lds
  v_mfma_f32_16x16x32_bf16 v[140:143], v[64:67], v[44:47], v[140:143]
  ds_read_b128 v[100:103], v2 offset:33792
  v_mfma_f32_16x16x32_bf16 v[144:147], v[68:71], v[32:35], v[144:147]
  ds_read_b64_tr_b16 v[50:51], v8 offset:33792
  v_mfma_f32_16x16x32_bf16 v[148:151], v[68:71], v[36:39], v[148:151]
  s_add_u32 m0, s24, 66560
  v_mfma_f32_16x16x32_bf16 v[152:155], v[68:71], v[40:43], v[152:155]
  buffer_load_dwordx4 v13, s[8:11], s20 offen lds
  ds_read_b128 v[104:107], v2 offset:34816
  v_mfma_f32_16x16x32_bf16 v[156:159], v[68:71], v[44:47], v[156:159]
  ds_read_b64_tr_b16 v[52:53], v9 offset:32768
  v_mfma_f32_16x16x32_bf16 v[160:163], v[72:75], v[32:35], v[160:163]
  v_mfma_f32_16x16x32_bf16 v[164:167], v[72:75], v[36:39], v[164:167]
  s_add_u32 m0, s24, 67584
  ds_read_b128 v[108:111], v2 offset:35840
  v_mfma_f32_16x16x32_bf16 v[168:171], v[72:75], v[40:43], v[168:171]
  buffer_load_dwordx4 v14, s[8:11], s20 offen lds
  ds_read_b64_tr_b16 v[54:55], v9 offset:33792
  v_mfma_f32_16x16x32_bf16 v[172:175], v[72:75], v[44:47], v[172:175]
  v_mfma_f32_16x16x32_bf16 v[176:179], v[76:79], v[32:35], v[176:179]
  ds_read_b128 v[112:115], v2 offset:36864
  v_mfma_f32_16x16x32_bf16 v[180:183], v[76:79], v[36:39], v[180:183]
  s_add_u32 m0, s24, 68608
  ds_read_b64_tr_b16 v[56:57], v10 offset:32768
  v_mfma_f32_16x16x32_bf16 v[184:187], v[76:79], v[40:43], v[184:187]
  buffer_load_dwordx4 v15, s[8:11], s20 offen lds
  v_mfma_f32_16x16x32_bf16 v[188:191], v[76:79], v[44:47], v[188:191]
  ds_read_b128 v[116:119], v2 offset:37888
  v_mfma_f32_16x16x32_bf16 v[192:195], v[80:83], v[32:35], v[192:195]
  ds_read_b64_tr_b16 v[58:59], v10 offset:33792
  v_mfma_f32_16x16x32_bf16 v[196:199], v[80:83], v[36:39], v[196:199]
  s_add_u32 m0, s25, 65536
  v_mfma_f32_16x16x32_bf16 v[200:203], v[80:83], v[40:43], v[200:203]
  buffer_load_dwordx4 v16, s[12:15], s21 offen lds
  ds_read_b128 v[120:123], v2 offset:38912
  v_mfma_f32_16x16x32_bf16 v[204:207], v[80:83], v[44:47], v[204:207]
  ds_read_b64_tr_b16 v[60:61], v11 offset:32768
  v_mfma_f32_16x16x32_bf16 v[208:211], v[84:87], v[32:35], v[208:211]
  v_mfma_f32_16x16x32_bf16 v[212:215], v[84:87], v[36:39], v[212:215]
  s_add_u32 m0, s25, 66560
  ds_read_b128 v[124:127], v2 offset:39936
  v_mfma_f32_16x16x32_bf16 v[216:219], v[84:87], v[40:43], v[216:219]
  buffer_load_dwordx4 v17, s[12:15], s21 offen lds
  ds_read_b64_tr_b16 v[62:63], v11 offset:33792
  v_mfma_f32_16x16x32_bf16 v[220:223], v[84:87], v[44:47], v[220:223]
  v_mfma_f32_16x16x32_bf16 v[224:227], v[88:91], v[32:35], v[224:227]
  v_mfma_f32_16x16x32_bf16 v[228:231], v[88:91], v[36:39], v[228:231]
  v_mfma_f32_16x16x32_bf16 v[232:235], v[88:91], v[40:43], v[232:235]
  s_add_u32 s20, s20, 131072
  v_mfma_f32_16x16x32_bf16 v[236:239], v[88:91], v[44:47], v[236:239]
  s_add_u32 s21, s21, s23
  v_mfma_f32_16x16x32_bf16 v[240:243], v[92:95], v[32:35], v[240:243]
  v_mfma_f32_16x16x32_bf16 v[244:247], v[92:95], v[36:39], v[244:247]
  v_mfma_f32_16x16x32_bf16 v[248:251], v[92:95], v[40:43], v[248:251]
  v_mfma_f32_16x16x32_bf16 v[252:255], v[92:95], v[44:47], v[252:255]
  s_waitcnt vmcnt(12) lgkmcnt(0)
  s_barrier
  v_mfma_f32_16x16x32_bf16 v[128:131], v[96:99], v[48:51], v[128:131]
  ds_read_b128 v[64:67], v1 offset:0
  v_mfma_f32_16x16x32_bf16 v[132:135], v[96:99], v[52:55], v[132:135]
  s_add_u32 m0, s24, 98304
  ds_read_b64_tr_b16 v[32:33], v4 offset:0
  v_mfma_f32_16x16x32_bf16 v[136:139], v[96:99], v[56:59], v[136:139]
  buffer_load_dwordx4 v12, s[8:11], s20 offen lds
  v_mfma_f32_16x16x32_bf16 v[140:143], v[96:99], v[60:63], v[140:143]
  ds_read_b128 v[68:71], v1 offset:1024
  v_mfma_f32_16x16x32_bf16 v[144:147], v[100:103], v[48:51], v[144:147]
  ds_read_b64_tr_b16 v[34:35], v4 offset:1024
  v_mfma_f32_16x16x32_bf16 v[148:151], v[100:103], v[52:55], v[148:151]
  s_add_u32 m0, s24, 99328
  v_mfma_f32_16x16x32_bf16 v[152:155], v[100:103], v[56:59], v[152:155]
  buffer_load_dwordx4 v13, s[8:11], s20 offen lds
  ds_read_b128 v[72:75], v1 offset:2048
  v_mfma_f32_16x16x32_bf16 v[156:159], v[100:103], v[60:63], v[156:159]
  ds_read_b64_tr_b16 v[36:37], v5 offset:0
  v_mfma_f32_16x16x32_bf16 v[160:163], v[104:107], v[48:51], v[160:163]
  v_mfma_f32_16x16x32_bf16 v[164:167], v[104:107], v[52:55], v[164:167]
  s_add_u32 m0, s24, 100352
  ds_read_b128 v[76:79], v1 offset:3072
  v_mfma_f32_16x16x32_bf16 v[168:171], v[104:107], v[56:59], v[168:171]
  buffer_load_dwordx4 v14, s[8:11], s20 offen lds
  ds_read_b64_tr_b16 v[38:39], v5 offset:1024
  v_mfma_f32_16x16x32_bf16 v[172:175], v[104:107], v[60:63], v[172:175]
  v_mfma_f32_16x16x32_bf16 v[176:179], v[108:111], v[48:51], v[176:179]
  ds_read_b128 v[80:83], v1 offset:4096
  v_mfma_f32_16x16x32_bf16 v[180:183], v[108:111], v[52:55], v[180:183]
  s_add_u32 m0, s24, 101376
  ds_read_b64_tr_b16 v[40:41], v6 offset:0
  v_mfma_f32_16x16x32_bf16 v[184:187], v[108:111], v[56:59], v[184:187]
  buffer_load_dwordx4 v15, s[8:11], s20 offen lds
  v_mfma_f32_16x16x32_bf16 v[188:191], v[108:111], v[60:63], v[188:191]
  ds_read_b128 v[84:87], v1 offset:5120
  v_mfma_f32_16x16x32_bf16 v[192:195], v[112:115], v[48:51], v[192:195]
  ds_read_b64_tr_b16 v[42:43], v6 offset:1024
  v_mfma_f32_16x16x32_bf16 v[196:199], v[112:115], v[52:55], v[196:199]
  s_add_u32 m0, s25, 98304
  v_mfma_f32_16x16x32_bf16 v[200:203], v[112:115], v[56:59], v[200:203]
  buffer_load_dwordx4 v16, s[12:15], s21 offen lds
  ds_read_b128 v[88:91], v1 offset:6144
  v_mfma_f32_16x16x32_bf16 v[204:207], v[112:115], v[60:63], v[204:207]
  ds_read_b64_tr_b16 v[44:45], v7 offset:0
  v_mfma_f32_16x16x32_bf16 v[208:211], v[116:119], v[48:51], v[208:211]
  v_mfma_f32_16x16x32_bf16 v[212:215], v[116:119], v[52:55], v[212:215]
  s_add_u32 m0, s25, 99328
  ds_read_b128 v[92:95], v1 offset:7168
  v_mfma_f32_16x16x32_bf16 v[216:219], v[116:119], v[56:59], v[216:219]
  buffer_load_dwordx4 v17, s[12:15], s21 offen lds
  ds_read_b64_tr_b16 v[46:47], v7 offset:1024
  v_mfma_f32_16x16x32_bf16 v[220:223], v[116:119], v[60:63], v[220:223]
  v_mfma_f32_16x16x32_bf16 v[224:227], v[120:123], v[48:51], v[224:227]
  v_mfma_f32_16x16x32_bf16 v[228:231], v[120:123], v[52:55], v[228:231]
  v_mfma_f32_16x16x32_bf16 v[232:235], v[120:123], v[56:59], v[232:235]
  s_add_u32 s20, s20, 131072
  v_mfma_f32_16x16x32_bf16 v[236:239], v[120:123], v[60:63], v[236:239]
  s_add_u32 s21, s21, s23
  v_mfma_f32_16x16x32_bf16 v[240:243], v[124:127], v[48:51], v[240:243]
  v_mfma_f32_16x16x32_bf16 v[244:247], v[124:127], v[52:55], v[244:247]
  v_mfma_f32_16x16x32_bf16 v[248:251], v[124:127], v[56:59], v[248:251]
  v_mfma_f32_16x16x32_bf16 v[252:255], v[124:127], v[60:63], v[252:255]
  s_sub_u32 s26, s26, 1
  s_cmp_lg_u32 s26, 0
  s_cbranch_scc1 T_KVH_mv_loop
  s_waitcnt vmcnt(12) lgkmcnt(0)
  s_barrier
  v_mfma_f32_16x16x32_bf16 v[128:131], v[64:67], v[32:35], v[128:131]
  ds_read_b128 v[96:99], v1 offset:32768
  v_mfma_f32_16x16x32_bf16 v[132:135], v[64:67], v[36:39], v[132:135]
  ds_read_b64_tr_b16 v[48:49], v4 offset:32768
  v_mfma_f32_16x16x32_bf16 v[136:139], v[64:67], v[40:43], v[136:139]
  v_mfma_f32_16x16x32_bf16 v[140:143], v[64:67], v[44:47], v[140:143]
  ds_read_b128 v[100:103], v1 offset:33792
  v_mfma_f32_16x16x32_bf16 v[144:147], v[68:71], v[32:35], v[144:147]
  ds_read_b64_tr_b16 v[50:51], v4 offset:33792
  v_mfma_f32_16x16x32_bf16 v[148:151], v[68:71], v[36:39], v[148:151]
  v_mfma_f32_16x16x32_bf16 v[152:155], v[68:71], v[40:43], v[152:155]
  ds_read_b128 v[104:107], v1 offset:34816
  v_mfma_f32_16x16x32_bf16 v[156:159], v[68:71], v[44:47], v[156:159]
  ds_read_b64_tr_b16 v[52:53], v5 offset:32768
  v_mfma_f32_16x16x32_bf16 v[160:163], v[72:75], v[32:35], v[160:163]
  v_mfma_f32_16x16x32_bf16 v[164:167], v[72:75], v[36:39], v[164:167]
  ds_read_b128 v[108:111], v1 offset:35840
  v_mfma_f32_16x16x32_bf16 v[168:171], v[72:75], v[40:43], v[168:171]
  ds_read_b64_tr_b16 v[54:55], v5 offset:33792
  v_mfma_f32_16x16x32_bf16 v[172:175], v[72:75], v[44:47], v[172:175]
  v_mfma_f32_16x16x32_bf16 v[176:179], v[76:79], v[32:35], v[176:179]
  ds_read_b128 v[112:115], v1 offset:36864
  v_mfma_f32_16x16x32_bf16 v[180:183], v[76:79], v[36:39], v[180:183]
  ds_read_b64_tr_b16 v[56:57], v6 offset:32768
  v_mfma_f32_16x16x32_bf16 v[184:187], v[76:79], v[40:43], v[184:187]
  v_mfma_f32_16x16x32_bf16 v[188:191], v[76:79], v[44:47], v[188:191]
  ds_read_b128 v[116:119], v1 offset:37888
  v_mfma_f32_16x16x32_bf16 v[192:195], v[80:83], v[32:35], v[192:195]
  ds_read_b64_tr_b16 v[58:59], v6 offset:33792
  v_mfma_f32_16x16x32_bf16 v[196:199], v[80:83], v[36:39], v[196:199]
  v_mfma_f32_16x16x32_bf16 v[200:203], v[80:83], v[40:43], v[200:203]
  ds_read_b128 v[120:123], v1 offset:38912
  v_mfma_f32_16x16x32_bf16 v[204:207], v[80:83], v[44:47], v[204:207]
  ds_read_b64_tr_b16 v[60:61], v7 offset:32768
  v_mfma_f32_16x16x32_bf16 v[208:211], v[84:87], v[32:35], v[208:211]
  v_mfma_f32_16x16x32_bf16 v[212:215], v[84:87], v[36:39], v[212:215]
  ds_read_b128 v[124:127], v1 offset:39936
  v_mfma_f32_16x16x32_bf16 v[216:219], v[84:87], v[40:43], v[216:219]
  ds_read_b64_tr_b16 v[62:63], v7 offset:33792
  v_mfma_f32_16x16x32_bf16 v[220:223], v[84:87], v[44:47], v[220:223]
  v_mfma_f32_16x16x32_bf16 v[224:227], v[88:91], v[32:35], v[224:227]
  v_mfma_f32_16x16x32_bf16 v[228:231], v[88:91], v[36:39], v[228:231]
  v_mfma_f32_16x16x32_bf16 v[232:235], v[88:91], v[40:43], v[232:235]
  v_mfma_f32_16x16x32_bf16 v[236:239], v[88:91], v[44:47], v[236:239]
  v_mfma_f32_16x16x32_bf16 v[240:243], v[92:95], v[32:35], v[240:243]
  v_mfma_f32_16x16x32_bf16 v[244:247], v[92:95], v[36:39], v[244:247]
  v_mfma_f32_16x16x32_bf16 v[248:251], v[92:95], v[40:43], v[248:251]
  v_mfma_f32_16x16x32_bf16 v[252:255], v[92:95], v[44:47], v[252:255]
  s_waitcnt vmcnt(6) lgkmcnt(0)
  s_barrier
  v_mfma_f32_16x16x32_bf16 v[128:131], v[96:99], v[48:51], v[128:131]
  ds_read_b128 v[64:67], v2 offset:0
  v_mfma_f32_16x16x32_bf16 v[132:135], v[96:99], v[52:55], v[132:135]
  ds_read_b64_tr_b16 v[32:33], v8 offset:0
  v_mfma_f32_16x16x32_bf16 v[136:139], v[96:99], v[56:59], v[136:139]
  v_mfma_f32_16x16x32_bf16 v[140:143], v[96:99], v[60:63], v[140:143]
  ds_read_b128 v[68:71], v2 offset:1024
  v_mfma_f32_16x16x32_bf16 v[144:147], v[100:103], v[48:51], v[144:147]
  ds_read_b64_tr_b16 v[34:35], v8 offset:1024
  v_mfma_f32_16x16x32_bf16 v[148:151], v[100:103], v[52:55], v[148:151]
  v_mfma_f32_16x16x32_bf16 v[152:155], v[100:103], v[56:59], v[152:155]
  ds_read_b128 v[72:75], v2 offset:2048
  v_mfma_f32_16x16x32_bf16 v[156:159], v[100:103], v[60:63], v[156:159]
  ds_read_b64_tr_b16 v[36:37], v9 offset:0
  v_mfma_f32_16x16x32_bf16 v[160:163], v[104:107], v[48:51], v[160:163]
  v_mfma_f32_16x16x32_bf16 v[164:167], v[104:107], v[52:55], v[164:167]
  ds_read_b128 v[76:79], v2 offset:3072
  v_mfma_f32_16x16x32_bf16 v[168:171], v[104:107], v[56:59], v[168:171]
  ds_read_b64_tr_b16 v[38:39], v9 offset:1024
  v_mfma_f32_16x16x32_bf16 v[172:175], v[104:107], v[60:63], v[172:175]
  v_mfma_f32_16x16x32_bf16 v[176:179], v[108:111], v[48:51], v[176:179]
  ds_read_b128 v[80:83], v2 offset:4096
  v_mfma_f32_16x16x32_bf16 v[180:183], v[108:111], v[52:55], v[180:183]
  ds_read_b64_tr_b16 v[40:41], v10 offset:0
  v_mfma_f32_16x16x32_bf16 v[184:187], v[108:111], v[56:59], v[184:187]
  v_mfma_f32_16x16x32_bf16 v[188:191], v[108:111], v[60:63], v[188:191]
  ds_read_b128 v[84:87], v2 offset:5120
  v_mfma_f32_16x16x32_bf16 v[192:195], v[112:115], v[48:51], v[192:195]
  ds_read_b64_tr_b16 v[42:43], v10 offset:1024
  v_mfma_f32_16x16x32_bf16 v[196:199], v[112:115], v[52:55], v[196:199]
  v_mfma_f32_16x16x32_bf16 v[200:203], v[112:115], v[56:59], v[200:203]
  ds_read_b128 v[88:91], v2 offset:6144
  v_mfma_f32_16x16x32_bf16 v[204:207], v[112:115], v[60:63], v[204:207]
  ds_read_b64_tr_b16 v[44:45], v11 offset:0
  v_mfma_f32_16x16x32_bf16 v[208:211], v[116:119], v[48:51], v[208:211]
  v_mfma_f32_16x16x32_bf16 v[212:215], v[116:119], v[52:55], v[212:215]
  ds_read_b128 v[92:95], v2 offset:7168
  v_mfma_f32_16x16x32_bf16 v[216:219], v[116:119], v[56:59], v[216:219]
  ds_read_b64_tr_b16 v[46:47], v11 offset:1024
  v_mfma_f32_16x16x32_bf16 v[220:223], v[116:119], v[60:63], v[220:223]
  v_mfma_f32_16x16x32_bf16 v[224:227], v[120:123], v[48:51], v[224:227]
  v_mfma_f32_16x16x32_bf16 v[228:231], v[120:123], v[52:55], v[228:231]
  v_mfma_f32_16x16x32_bf16 v[232:235], v[120:123], v[56:59], v[232:235]
  v_mfma_f32_16x16x32_bf16 v[236:239], v[120:123], v[60:63], v[236:239]
  v_mfma_f32_16x16x32_bf16 v[240:243], v[124:127], v[48:51], v[240:243]
  v_mfma_f32_16x16x32_bf16 v[244:247], v[124:127], v[52:55], v[244:247]
  v_mfma_f32_16x16x32_bf16 v[248:251], v[124:127], v[56:59], v[248:251]
  v_mfma_f32_16x16x32_bf16 v[252:255], v[124:127], v[60:63], v[252:255]
  s_waitcnt vmcnt(0) lgkmcnt(0)
  s_barrier
  v_mfma_f32_16x16x32_bf16 v[128:131], v[64:67], v[32:35], v[128:131]
  ds_read_b128 v[96:99], v2 offset:32768
  v_mfma_f32_16x16x32_bf16 v[132:135], v[64:67], v[36:39], v[132:135]
  ds_read_b64_tr_b16 v[48:49], v8 offset:32768
  v_mfma_f32_16x16x32_bf16 v[136:139], v[64:67], v[40:43], v[136:139]
  v_mfma_f32_16x16x32_bf16 v[140:143], v[64:67], v[44:47], v[140:143]
  ds_read_b128 v[100:103], v2 offset:33792
  v_mfma_f32_16x16x32_bf16 v[144:147], v[68:71], v[32:35], v[144:147]
  ds_read_b64_tr_b16 v[50:51], v8 offset:33792
  v_mfma_f32_16x16x32_bf16 v[148:151], v[68:71], v[36:39], v[148:151]
  v_mfma_f32_16x16x32_bf16 v[152:155], v[68:71], v[40:43], v[152:155]
  ds_read_b128 v[104:107], v2 offset:34816
  v_mfma_f32_16x16x32_bf16 v[156:159], v[68:71], v[44:47], v[156:159]
  ds_read_b64_tr_b16 v[52:53], v9 offset:32768
  v_mfma_f32_16x16x32_bf16 v[160:163], v[72:75], v[32:35], v[160:163]
  v_mfma_f32_16x16x32_bf16 v[164:167], v[72:75], v[36:39], v[164:167]
  ds_read_b128 v[108:111], v2 offset:35840
  v_mfma_f32_16x16x32_bf16 v[168:171], v[72:75], v[40:43], v[168:171]
  ds_read_b64_tr_b16 v[54:55], v9 offset:33792
  v_mfma_f32_16x16x32_bf16 v[172:175], v[72:75], v[44:47], v[172:175]
  v_mfma_f32_16x16x32_bf16 v[176:179], v[76:79], v[32:35], v[176:179]
  ds_read_b128 v[112:115], v2 offset:36864
  v_mfma_f32_16x16x32_bf16 v[180:183], v[76:79], v[36:39], v[180:183]
  ds_read_b64_tr_b16 v[56:57], v10 offset:32768
  v_mfma_f32_16x16x32_bf16 v[184:187], v[76:79], v[40:43], v[184:187]
  v_mfma_f32_16x16x32_bf16 v[188:191], v[76:79], v[44:47], v[188:191]
  ds_read_b128 v[116:119], v2 offset:37888
  v_mfma_f32_16x16x32_bf16 v[192:195], v[80:83], v[32:35], v[192:195]
  ds_read_b64_tr_b16 v[58:59], v10 offset:33792
  v_mfma_f32_16x16x32_bf16 v[196:199], v[80:83], v[36:39], v[196:199]
  v_mfma_f32_16x16x32_bf16 v[200:203], v[80:83], v[40:43], v[200:203]
  ds_read_b128 v[120:123], v2 offset:38912
  v_mfma_f32_16x16x32_bf16 v[204:207], v[80:83], v[44:47], v[204:207]
  ds_read_b64_tr_b16 v[60:61], v11 offset:32768
  v_mfma_f32_16x16x32_bf16 v[208:211], v[84:87], v[32:35], v[208:211]
  v_mfma_f32_16x16x32_bf16 v[212:215], v[84:87], v[36:39], v[212:215]
  ds_read_b128 v[124:127], v2 offset:39936
  v_mfma_f32_16x16x32_bf16 v[216:219], v[84:87], v[40:43], v[216:219]
  ds_read_b64_tr_b16 v[62:63], v11 offset:33792
  v_mfma_f32_16x16x32_bf16 v[220:223], v[84:87], v[44:47], v[220:223]
  v_mfma_f32_16x16x32_bf16 v[224:227], v[88:91], v[32:35], v[224:227]
  v_mfma_f32_16x16x32_bf16 v[228:231], v[88:91], v[36:39], v[228:231]
  v_mfma_f32_16x16x32_bf16 v[232:235], v[88:91], v[40:43], v[232:235]
  v_mfma_f32_16x16x32_bf16 v[236:239], v[88:91], v[44:47], v[236:239]
  v_mfma_f32_16x16x32_bf16 v[240:243], v[92:95], v[32:35], v[240:243]
  v_mfma_f32_16x16x32_bf16 v[244:247], v[92:95], v[36:39], v[244:247]
  v_mfma_f32_16x16x32_bf16 v[248:251], v[92:95], v[40:43], v[248:251]
  v_mfma_f32_16x16x32_bf16 v[252:255], v[92:95], v[44:47], v[252:255]
  s_waitcnt lgkmcnt(0)
  s_barrier
  v_mfma_f32_16x16x32_bf16 v[128:131], v[96:99], v[48:51], v[128:131]
  v_mfma_f32_16x16x32_bf16 v[132:135], v[96:99], v[52:55], v[132:135]
  v_mfma_f32_16x16x32_bf16 v[136:139], v[96:99], v[56:59], v[136:139]
  v_mfma_f32_16x16x32_bf16 v[140:143], v[96:99], v[60:63], v[140:143]
  v_mfma_f32_16x16x32_bf16 v[144:147], v[100:103], v[48:51], v[144:147]
  v_mfma_f32_16x16x32_bf16 v[148:151], v[100:103], v[52:55], v[148:151]
  v_mfma_f32_16x16x32_bf16 v[152:155], v[100:103], v[56:59], v[152:155]
  v_mfma_f32_16x16x32_bf16 v[156:159], v[100:103], v[60:63], v[156:159]
  v_mfma_f32_16x16x32_bf16 v[160:163], v[104:107], v[48:51], v[160:163]
  v_mfma_f32_16x16x32_bf16 v[164:167], v[104:107], v[52:55], v[164:167]
  v_mfma_f32_16x16x32_bf16 v[168:171], v[104:107], v[56:59], v[168:171]
  v_mfma_f32_16x16x32_bf16 v[172:175], v[104:107], v[60:63], v[172:175]
  v_mfma_f32_16x16x32_bf16 v[176:179], v[108:111], v[48:51], v[176:179]
  v_mfma_f32_16x16x32_bf16 v[180:183], v[108:111], v[52:55], v[180:183]
  v_mfma_f32_16x16x32_bf16 v[184:187], v[108:111], v[56:59], v[184:187]
  v_mfma_f32_16x16x32_bf16 v[188:191], v[108:111], v[60:63], v[188:191]
  v_mfma_f32_16x16x32_bf16 v[192:195], v[112:115], v[48:51], v[192:195]
  v_mfma_f32_16x16x32_bf16 v[196:199], v[112:115], v[52:55], v[196:199]
  v_mfma_f32_16x16x32_bf16 v[200:203], v[112:115], v[56:59], v[200:203]
  v_mfma_f32_16x16x32_bf16 v[204:207], v[112:115], v[60:63], v[204:207]
  v_mfma_f32_16x16x32_bf16 v[208:211], v[116:119], v[48:51], v[208:211]
  v_mfma_f32_16x16x32_bf16 v[212:215], v[116:119], v[52:55], v[212:215]
  v_mfma_f32_16x16x32_bf16 v[216:219], v[116:119], v[56:59], v[216:219]
  v_mfma_f32_16x16x32_bf16 v[220:223], v[116:119], v[60:63], v[220:223]
  v_mfma_f32_16x16x32_bf16 v[224:227], v[120:123], v[48:51], v[224:227]
  v_mfma_f32_16x16x32_bf16 v[228:231], v[120:123], v[52:55], v[228:231]
  v_mfma_f32_16x16x32_bf16 v[232:235], v[120:123], v[56:59], v[232:235]
  v_mfma_f32_16x16x32_bf16 v[236:239], v[120:123], v[60:63], v[236:239]
  v_mfma_f32_16x16x32_bf16 v[240:243], v[124:127], v[48:51], v[240:243]
  v_mfma_f32_16x16x32_bf16 v[244:247], v[124:127], v[52:55], v[244:247]
  v_mfma_f32_16x16x32_bf16 v[248:251], v[124:127], v[56:59], v[248:251]
  v_mfma_f32_16x16x32_bf16 v[252:255], v[124:127], v[60:63], v[252:255]
  s_nop 7
  v_and_b32 v20, 63, v0
  v_lshlrev_b32 v23, 4, v20
  s_lshr_b32 s40, s27, 1
  s_and_b32 s41, s27, 1
  s_lshl_b32 s42, s28, 3
  s_lshl_b32 s43, s40, 2
  s_add_u32 s42, s42, s43
  s_lshl_b32 s42, s42, 18
  s_lshl_b32 s43, s29, 13
  s_add_u32 s42, s42, s43
  s_lshl_b32 s43, s41, 12
  s_add_u32 s42, s42, s43
  s_add_u32 s45, s42, 41943040
  s_add_u32 s46, s45, 0
  v_cvt_pk_bf16_f32 v32, v128, v129
  v_cvt_pk_bf16_f32 v33, v130, v131
  v_cvt_pk_bf16_f32 v34, v144, v145
  v_cvt_pk_bf16_f32 v35, v146, v147
  buffer_store_dwordx4 v[32:35], v23, s[4:7], s46 offen offset:0 sc1
  v_cvt_pk_bf16_f32 v36, v132, v133
  v_cvt_pk_bf16_f32 v37, v134, v135
  v_cvt_pk_bf16_f32 v38, v148, v149
  v_cvt_pk_bf16_f32 v39, v150, v151
  buffer_store_dwordx4 v[36:39], v23, s[4:7], s46 offen offset:1024 sc1
  v_cvt_pk_bf16_f32 v40, v136, v137
  v_cvt_pk_bf16_f32 v41, v138, v139
  v_cvt_pk_bf16_f32 v42, v152, v153
  v_cvt_pk_bf16_f32 v43, v154, v155
  buffer_store_dwordx4 v[40:43], v23, s[4:7], s46 offen offset:2048 sc1
  v_cvt_pk_bf16_f32 v44, v140, v141
  v_cvt_pk_bf16_f32 v45, v142, v143
  v_cvt_pk_bf16_f32 v46, v156, v157
  v_cvt_pk_bf16_f32 v47, v158, v159
  buffer_store_dwordx4 v[44:47], v23, s[4:7], s46 offen offset:3072 sc1
  s_add_u32 s46, s45, 262144
  v_cvt_pk_bf16_f32 v32, v160, v161
  v_cvt_pk_bf16_f32 v33, v162, v163
  v_cvt_pk_bf16_f32 v34, v176, v177
  v_cvt_pk_bf16_f32 v35, v178, v179
  buffer_store_dwordx4 v[32:35], v23, s[4:7], s46 offen offset:0 sc1
  v_cvt_pk_bf16_f32 v36, v164, v165
  v_cvt_pk_bf16_f32 v37, v166, v167
  v_cvt_pk_bf16_f32 v38, v180, v181
  v_cvt_pk_bf16_f32 v39, v182, v183
  buffer_store_dwordx4 v[36:39], v23, s[4:7], s46 offen offset:1024 sc1
  v_cvt_pk_bf16_f32 v40, v168, v169
  v_cvt_pk_bf16_f32 v41, v170, v171
  v_cvt_pk_bf16_f32 v42, v184, v185
  v_cvt_pk_bf16_f32 v43, v186, v187
  buffer_store_dwordx4 v[40:43], v23, s[4:7], s46 offen offset:2048 sc1
  v_cvt_pk_bf16_f32 v44, v172, v173
  v_cvt_pk_bf16_f32 v45, v174, v175
  v_cvt_pk_bf16_f32 v46, v188, v189
  v_cvt_pk_bf16_f32 v47, v190, v191
  buffer_store_dwordx4 v[44:47], v23, s[4:7], s46 offen offset:3072 sc1
  s_add_u32 s46, s45, 524288
  v_cvt_pk_bf16_f32 v32, v192, v193
  v_cvt_pk_bf16_f32 v33, v194, v195
  v_cvt_pk_bf16_f32 v34, v208, v209
  v_cvt_pk_bf16_f32 v35, v210, v211
  buffer_store_dwordx4 v[32:35], v23, s[4:7], s46 offen offset:0 sc1
  v_cvt_pk_bf16_f32 v36, v196, v197
  v_cvt_pk_bf16_f32 v37, v198, v199
  v_cvt_pk_bf16_f32 v38, v212, v213
  v_cvt_pk_bf16_f32 v39, v214, v215
  buffer_store_dwordx4 v[36:39], v23, s[4:7], s46 offen offset:1024 sc1
  v_cvt_pk_bf16_f32 v40, v200, v201
  v_cvt_pk_bf16_f32 v41, v202, v203
  v_cvt_pk_bf16_f32 v42, v216, v217
  v_cvt_pk_bf16_f32 v43, v218, v219
  buffer_store_dwordx4 v[40:43], v23, s[4:7], s46 offen offset:2048 sc1
  v_cvt_pk_bf16_f32 v44, v204, v205
  v_cvt_pk_bf16_f32 v45, v206, v207
  v_cvt_pk_bf16_f32 v46, v220, v221
  v_cvt_pk_bf16_f32 v47, v222, v223
  buffer_store_dwordx4 v[44:47], v23, s[4:7], s46 offen offset:3072 sc1
  s_add_u32 s46, s45, 786432
  v_cvt_pk_bf16_f32 v32, v224, v225
  v_cvt_pk_bf16_f32 v33, v226, v227
  v_cvt_pk_bf16_f32 v34, v240, v241
  v_cvt_pk_bf16_f32 v35, v242, v243
  buffer_store_dwordx4 v[32:35], v23, s[4:7], s46 offen offset:0 sc1
  v_cvt_pk_bf16_f32 v36, v228, v229
  v_cvt_pk_bf16_f32 v37, v230, v231
  v_cvt_pk_bf16_f32 v38, v244, v245
  v_cvt_pk_bf16_f32 v39, v246, v247
  buffer_store_dwordx4 v[36:39], v23, s[4:7], s46 offen offset:1024 sc1
  v_cvt_pk_bf16_f32 v40, v232, v233
  v_cvt_pk_bf16_f32 v41, v234, v235
  v_cvt_pk_bf16_f32 v42, v248, v249
  v_cvt_pk_bf16_f32 v43, v250, v251
  buffer_store_dwordx4 v[40:43], v23, s[4:7], s46 offen offset:2048 sc1
  v_cvt_pk_bf16_f32 v44, v236, v237
  v_cvt_pk_bf16_f32 v45, v238, v239
  v_cvt_pk_bf16_f32 v46, v252, v253
  v_cvt_pk_bf16_f32 v47, v254, v255
  buffer_store_dwordx4 v[44:47], v23, s[4:7], s46 offen offset:3072 sc1
  s_branch L_next
T_KV:
  s_and_b32 s41, s98, 3
  s_lshl_b32 s29, s96, 2
  s_add_u32 s29, s29, s41
  s_lshl_b32 s35, s28, 7
  s_add_u32 s35, s35, 65536
  s_cmp_ge_u32 s98, 4
  s_cbranch_scc1 T_V
  s_load_dwordx2 s[52:53], s[0:1], 24
  s_mov_b32 s33, 64
  s_mov_b32 s34, 8192
  s_mul_i32 s20, s28, 16384
  s_add_u32 s20, s20, 0
  s_lshl_b32 s21, s29, 9
  s_add_u32 s22, s21, 256
  s_mov_b32 s31, 6
  s_waitcnt lgkmcnt(0)
  s_mov_b32 s12, s52
  s_mov_b32 s13, s53
  s_mov_b32 s14, 0x800000
  s_mov_b32 s15, 0x20000
  s_mov_b32 s16, s52
  s_mov_b32 s17, s53
  s_mov_b32 s18, 0x800000
  s_mov_b32 s19, 0x20000
  s_mov_b32 s8, s4
  s_mov_b32 s9, s5
  s_mov_b32 s10, s6
  s_mov_b32 s11, s7
  s_mov_b32 s32, 25165824
  s_mov_b32 s30, 0
  s_branch G_n
T_Q:
  s_lshl_b32 s29, s96, 2
  s_add_u32 s29, s29, s98
  s_lshl_b32 s35, s28, 7
  s_add_u32 s35, s35, 1024
  s_load_dwordx2 s[52:53], s[0:1], 16
  s_mov_b32 s33, 64
  s_mov_b32 s34, 8192
  s_mul_i32 s20, s28, 16384
  s_add_u32 s20, s20, 0
  s_lshl_b32 s21, s29, 9
  s_add_u32 s22, s21, 256
  s_mov_b32 s31, 6
  s_waitcnt lgkmcnt(0)
  s_mov_b32 s12, s52
  s_mov_b32 s13, s53
  s_mov_b32 s14, 0x800000
  s_mov_b32 s15, 0x20000
  s_mov_b32 s16, s52
  s_mov_b32 s17, s53
  s_mov_b32 s18, 0x800000
  s_mov_b32 s19, 0x20000
  s_mov_b32 s8, s4
  s_mov_b32 s9, s5
  s_mov_b32 s10, s6
  s_mov_b32 s11, s7
  s_mov_b32 s32, 8388608
  s_mov_b32 s30, 0
  s_branch G_n
T_GU:
  s_mul_i32 s29, s96, 7
  s_add_u32 s29, s29, s98
  s_lshl_b32 s35, s28, 7
  s_add_u32 s35, s35, 2048
  s_load_dwordx2 s[52:53], s[0:1], 64
  s_load_dwordx2 s[54:55], s[0:1], 72
  s_mov_b32 s33, 64
  s_mov_b32 s34, 7168
  s_mul_i32 s20, s28, 16384
  s_add_u32 s20, s20, 0
  s_lshl_b32 s21, s29, 8
  s_mov_b32 s22, s21
  s_mov_b32 s31, 6
  s_waitcnt lgkmcnt(0)
  s_mov_b32 s12, s52
  s_mov_b32 s13, s53
  s_mov_b32 s14, 0x700000
  s_mov_b32 s15, 0x20000
  s_mov_b32 s16, s54
  s_mov_b32 s17, s55
  s_mov_b32 s18, 0x700000
  s_mov_b32 s19, 0x20000
  s_mov_b32 s8, s4
  s_mov_b32 s9, s5
  s_mov_b32 s10, s6
  s_mov_b32 s11, s7
  s_mov_b32 s30, 2
  s_branch G_n
T_D:
  s_cmp_eq_u32 s76, -1
  s_cbranch_scc1 L_fp_87
  s_waitcnt vmcnt(0)
  s_barrier
  s_cmp_eq_u32 s76, -1
  s_cbranch_scc1 L_pe_88
  s_cmp_lg_u32 s27, 0
  s_cbranch_scc1 L_pe_88_c
  s_and_b32 s47, s76, 0xffff
  s_add_u32 s47, s47, 117440512
  s_lshr_b32 s48, s76, 16
  s_add_u32 s48, s48, 1
  v_mov_b32 v18, s47
  v_mov_b32 v19, s48
  s_mov_b64 exec, 1
  buffer_atomic_add v19, v18, s[4:7], 0 offen sc1
  s_mov_b64 exec, -1
L_pe_88_c:
  s_mov_b32 s76, -1
L_pe_88:
L_fp_87:
  s_lshr_b32 s28, s98, 0
  s_and_b32 s40, s98, 0
  s_lshl_b32 s29, s96, 0
  s_add_u32 s29, s29, s40
  s_lshl_b32 s35, s28, 7
  s_add_u32 s35, s35, 3072
  s_lshl_b32 s41, s28, 7
  s_add_u32 s41, s41, 117442560
  s_cmp_lg_u32 s27, 0
  s_cbranch_scc1 L_wf_89_w
  s_mov_b32 s99, 100000
L_wf_89_p:
  buffer_load_dword v1, off, s[4:7], s41 sc1
  s_waitcnt vmcnt(0)
  v_readfirstlane_b32 s42, v1
  s_nop 0
  s_cmp_ge_u32 s42, 28
  s_cbranch_scc1 L_wf_89_w
  s_sub_u32 s99, s99, 1
  s_cbranch_scc0 L_wf_89_p
  v_mov_b32 v1, 236
  v_mov_b32 v2, 1
  s_mov_b64 exec, 1
  global_atomic_add v1, v2, s[90:91] sc1
  s_mov_b64 exec, -1
L_wf_89_w:
  s_barrier
  s_load_dwordx2 s[52:53], s[0:1], 80
  s_mov_b32 s33, 64
  s_mov_b32 s34, 2048
  s_mul_i32 s20, s28, 16384
  s_add_u32 s20, s20, 75497472
  s_lshl_b32 s21, s29, 9
  s_add_u32 s22, s21, 256
  s_mov_b32 s31, 26
  s_waitcnt lgkmcnt(0)
  s_mov_b32 s12, s52
  s_mov_b32 s13, s53
  s_mov_b32 s14, 0x700000
  s_mov_b32 s15, 0x20000
  s_mov_b32 s16, s52
  s_mov_b32 s17, s53
  s_mov_b32 s18, 0x700000
  s_mov_b32 s19, 0x20000
  s_mov_b32 s8, s4
  s_mov_b32 s9, s5
  s_mov_b32 s10, s6
  s_mov_b32 s11, s7
  s_mov_b32 s30, 3
G_n:
  v_and_b32 v20, 63, v0
  v_and_b32 v21, 15, v20
  v_lshrrev_b32 v22, 4, v20
  v_lshrrev_b32 v23, 3, v20
  v_and_b32 v23, 1, v23
  v_lshlrev_b32 v23, 1, v23
  v_xor_b32 v23, v22, v23
  v_lshlrev_b32 v23, 4, v23
  v_lshlrev_b32 v24, 6, v21
  v_add_u32 v23, v23, v24
  s_lshr_b32 s40, s27, 1
  s_lshl_b32 s40, s40, 13
  v_add_u32 v1, s40, v23
  v_add_u32 v2, 0x10000, v1
  v_and_b32 v23, 3, v20
  v_lshrrev_b32 v24, 2, v20
  v_and_b32 v24, 3, v24
  v_and_b32 v25, 1, v22
  v_lshlrev_b32 v25, 2, v25
  v_or_b32 v25, v25, v24
  v_lshlrev_b32 v26, 3, v22
  v_add_u32 v26, v26, v24
  v_lshlrev_b32 v26, 8, v26
  v_lshlrev_b32 v23, 3, v23
  v_add_u32 v26, v26, v23
  v_add_u32 v26, 0x4000, v26
  s_and_b32 s40, s27, 1
  s_lshl_b32 s40, s40, 2
  s_add_u32 s41, s40, 0
  v_xor_b32 v27, s41, v25
  v_lshlrev_b32 v27, 5, v27
  v_add_u32 v4, v26, v27
  v_add_u32 v8, 0x10000, v4
  s_add_u32 s41, s40, 1
  v_xor_b32 v27, s41, v25
  v_lshlrev_b32 v27, 5, v27
  v_add_u32 v5, v26, v27
  v_add_u32 v9, 0x10000, v5
  s_add_u32 s41, s40, 2
  v_xor_b32 v27, s41, v25
  v_lshlrev_b32 v27, 5, v27
  v_add_u32 v6, v26, v27
  v_add_u32 v10, 0x10000, v6
  s_add_u32 s41, s40, 3
  v_xor_b32 v27, s41, v25
  v_lshlrev_b32 v27, 5, v27
  v_add_u32 v7, v26, v27
  v_add_u32 v11, 0x10000, v7
  v_lshrrev_b32 v23, 2, v20
  s_lshl_b32 s40, s27, 6
  v_add_u32 v23, s40, v23
  v_mul_lo_u32 v23, v23, s33
  v_lshrrev_b32 v24, 5, v20
  v_lshlrev_b32 v24, 1, v24
  v_and_b32 v25, 3, v20
  v_xor_b32 v24, v24, v25
  v_lshlrev_b32 v24, 4, v24
  v_add_u32 v12, v23, v24
  s_lshl_b32 s40, s33, 4
  v_add_u32 v13, s40, v12
  v_add_u32 v14, s40, v13
  v_add_u32 v15, s40, v14
  v_lshrrev_b32 v23, 4, v20
  s_and_b32 s40, s27, 1
  s_lshl_b32 s40, s40, 2
  v_or_b32 v24, s40, v23
  v_and_b32 v25, 15, v20
  v_lshrrev_b32 v26, 1, v25
  v_xor_b32 v26, v26, v24
  v_lshlrev_b32 v26, 5, v26
  v_and_b32 v25, 1, v25
  v_lshlrev_b32 v25, 4, v25
  v_add_u32 v26, v26, v25
  s_lshl_b32 s40, s27, 3
  v_add_u32 v23, s40, v23
  v_mul_lo_u32 v23, v23, s34
  v_add_u32 v16, v23, v26
  s_lshl_b32 s40, s34, 2
  v_add_u32 v17, s40, v16
  s_lshl_b32 s24, s27, 12
  s_lshl_b32 s25, s27, 11
  s_add_u32 s25, s25, 0x4000
  s_lshl_b32 s23, s34, 5
  s_add_u32 m0, s24, 0
  s_nop 0
  buffer_load_dwordx4 v12, s[8:11], s20 offen lds
  s_add_u32 m0, s24, 1024
  s_nop 0
  buffer_load_dwordx4 v13, s[8:11], s20 offen lds
  s_add_u32 m0, s24, 2048
  s_nop 0
  buffer_load_dwordx4 v14, s[8:11], s20 offen lds
  s_add_u32 m0, s24, 3072
  s_nop 0
  buffer_load_dwordx4 v15, s[8:11], s20 offen lds
  s_add_u32 m0, s25, 0
  s_nop 0
  buffer_load_dwordx4 v16, s[12:15], s21 offen lds
  s_add_u32 m0, s25, 8192
  s_nop 0
  buffer_load_dwordx4 v16, s[16:19], s22 offen lds
  s_add_u32 m0, s25, 1024
  s_nop 0
  buffer_load_dwordx4 v17, s[12:15], s21 offen lds
  s_add_u32 m0, s25, 9216
  s_nop 0
  buffer_load_dwordx4 v17, s[16:19], s22 offen lds
  s_add_u32 s20, s20, 131072
  s_add_u32 s21, s21, s23
  s_add_u32 s22, s22, s23
  s_add_u32 m0, s24, 32768
  s_nop 0
  buffer_load_dwordx4 v12, s[8:11], s20 offen lds
  s_add_u32 m0, s24, 33792
  s_nop 0
  buffer_load_dwordx4 v13, s[8:11], s20 offen lds
  s_add_u32 m0, s24, 34816
  s_nop 0
  buffer_load_dwordx4 v14, s[8:11], s20 offen lds
  s_add_u32 m0, s24, 35840
  s_nop 0
  buffer_load_dwordx4 v15, s[8:11], s20 offen lds
  s_add_u32 m0, s25, 32768
  s_nop 0
  buffer_load_dwordx4 v16, s[12:15], s21 offen lds
  s_add_u32 m0, s25, 40960
  s_nop 0
  buffer_load_dwordx4 v16, s[16:19], s22 offen lds
  s_add_u32 m0, s25, 33792
  s_nop 0
  buffer_load_dwordx4 v17, s[12:15], s21 offen lds
  s_add_u32 m0, s25, 41984
  s_nop 0
  buffer_load_dwordx4 v17, s[16:19], s22 offen lds
  s_add_u32 s20, s20, 131072
  s_add_u32 s21, s21, s23
  s_add_u32 s22, s22, s23
  s_add_u32 m0, s24, 65536
  s_nop 0
  buffer_load_dwordx4 v12, s[8:11], s20 offen lds
  s_add_u32 m0, s24, 66560
  s_nop 0
  buffer_load_dwordx4 v13, s[8:11], s20 offen lds
  s_add_u32 m0, s24, 67584
  s_nop 0
  buffer_load_dwordx4 v14, s[8:11], s20 offen lds
  s_add_u32 m0, s24, 68608
  s_nop 0
  buffer_load_dwordx4 v15, s[8:11], s20 offen lds
  s_add_u32 m0, s25, 65536
  s_nop 0
  buffer_load_dwordx4 v16, s[12:15], s21 offen lds
  s_add_u32 m0, s25, 73728
  s_nop 0
  buffer_load_dwordx4 v16, s[16:19], s22 offen lds
  s_add_u32 m0, s25, 66560
  s_nop 0
  buffer_load_dwordx4 v17, s[12:15], s21 offen lds
  s_add_u32 m0, s25, 74752
  s_nop 0
  buffer_load_dwordx4 v17, s[16:19], s22 offen lds
  s_add_u32 s20, s20, 131072
  s_add_u32 s21, s21, s23
  s_add_u32 s22, s22, s23
  s_waitcnt vmcnt(16)
  s_barrier
  s_cmp_eq_u32 s76, -1
  s_cbranch_scc1 L_pe_90
  s_cmp_lg_u32 s27, 0
  s_cbranch_scc1 L_pe_90_c
  s_and_b32 s47, s76, 0xffff
  s_add_u32 s47, s47, 117440512
  s_lshr_b32 s48, s76, 16
  s_add_u32 s48, s48, 1
  v_mov_b32 v18, s47
  v_mov_b32 v19, s48
  s_mov_b64 exec, 1
  buffer_atomic_add v19, v18, s[4:7], 0 offen sc1
  s_mov_b64 exec, -1
L_pe_90_c:
  s_mov_b32 s76, -1
L_pe_90:
  ds_read_b128 v[96:99], v1 offset:0
  ds_read_b64_tr_b16 v[64:65], v4 offset:0
  ds_read_b64_tr_b16 v[66:67], v4 offset:1024
  ds_read_b128 v[100:103], v1 offset:1024
  ds_read_b64_tr_b16 v[68:69], v5 offset:0
  ds_read_b64_tr_b16 v[70:71], v5 offset:1024
  ds_read_b128 v[104:107], v1 offset:2048
  ds_read_b64_tr_b16 v[72:73], v6 offset:0
  ds_read_b64_tr_b16 v[74:75], v6 offset:1024
  ds_read_b128 v[108:111], v1 offset:3072
  ds_read_b64_tr_b16 v[76:77], v7 offset:0
  ds_read_b64_tr_b16 v[78:79], v7 offset:1024
  ds_read_b128 v[112:115], v1 offset:4096
  ds_read_b64_tr_b16 v[80:81], v4 offset:8192
  ds_read_b64_tr_b16 v[82:83], v4 offset:9216
  ds_read_b128 v[116:119], v1 offset:5120
  ds_read_b64_tr_b16 v[84:85], v5 offset:8192
  ds_read_b64_tr_b16 v[86:87], v5 offset:9216
  ds_read_b128 v[120:123], v1 offset:6144
  ds_read_b64_tr_b16 v[88:89], v6 offset:8192
  ds_read_b64_tr_b16 v[90:91], v6 offset:9216
  ds_read_b128 v[124:127], v1 offset:7168
  ds_read_b64_tr_b16 v[92:93], v7 offset:8192
  ds_read_b64_tr_b16 v[94:95], v7 offset:9216
  s_waitcnt vmcnt(8) lgkmcnt(0)
  s_barrier
  v_mfma_f32_16x16x32_bf16 a[0:3], v[64:67], v[96:99], 0
  ds_read_b128 v[160:163], v1 offset:32768
  v_mfma_f32_16x16x32_bf16 a[4:7], v[68:71], v[96:99], 0
  v_mfma_f32_16x16x32_bf16 a[8:11], v[72:75], v[96:99], 0
  s_add_u32 m0, s24, 98304
  ds_read_b64_tr_b16 v[128:129], v4 offset:32768
  v_mfma_f32_16x16x32_bf16 a[12:15], v[76:79], v[96:99], 0
  buffer_load_dwordx4 v12, s[8:11], s20 offen lds
  v_mfma_f32_16x16x32_bf16 a[16:19], v[80:83], v[96:99], 0
  ds_read_b64_tr_b16 v[130:131], v4 offset:33792
  v_mfma_f32_16x16x32_bf16 a[20:23], v[84:87], v[96:99], 0
  v_mfma_f32_16x16x32_bf16 a[24:27], v[88:91], v[96:99], 0
  ds_read_b128 v[164:167], v1 offset:33792
  v_mfma_f32_16x16x32_bf16 a[28:31], v[92:95], v[96:99], 0
  v_mfma_f32_16x16x32_bf16 a[32:35], v[64:67], v[100:103], 0
  s_add_u32 m0, s24, 99328
  ds_read_b64_tr_b16 v[132:133], v5 offset:32768
  v_mfma_f32_16x16x32_bf16 a[36:39], v[68:71], v[100:103], 0
  buffer_load_dwordx4 v13, s[8:11], s20 offen lds
  v_mfma_f32_16x16x32_bf16 a[40:43], v[72:75], v[100:103], 0
  ds_read_b64_tr_b16 v[134:135], v5 offset:33792
  v_mfma_f32_16x16x32_bf16 a[44:47], v[76:79], v[100:103], 0
  v_mfma_f32_16x16x32_bf16 a[48:51], v[80:83], v[100:103], 0
  ds_read_b128 v[168:171], v1 offset:34816
  v_mfma_f32_16x16x32_bf16 a[52:55], v[84:87], v[100:103], 0
  v_mfma_f32_16x16x32_bf16 a[56:59], v[88:91], v[100:103], 0
  s_add_u32 m0, s24, 100352
  ds_read_b64_tr_b16 v[136:137], v6 offset:32768
  v_mfma_f32_16x16x32_bf16 a[60:63], v[92:95], v[100:103], 0
  buffer_load_dwordx4 v14, s[8:11], s20 offen lds
  v_mfma_f32_16x16x32_bf16 a[64:67], v[64:67], v[104:107], 0
  ds_read_b64_tr_b16 v[138:139], v6 offset:33792
  v_mfma_f32_16x16x32_bf16 a[68:71], v[68:71], v[104:107], 0
  v_mfma_f32_16x16x32_bf16 a[72:75], v[72:75], v[104:107], 0
  ds_read_b128 v[172:175], v1 offset:35840
  v_mfma_f32_16x16x32_bf16 a[76:79], v[76:79], v[104:107], 0
  v_mfma_f32_16x16x32_bf16 a[80:83], v[80:83], v[104:107], 0
  s_add_u32 m0, s24, 101376
  ds_read_b64_tr_b16 v[140:141], v7 offset:32768
  v_mfma_f32_16x16x32_bf16 a[84:87], v[84:87], v[104:107], 0
  buffer_load_dwordx4 v15, s[8:11], s20 offen lds
  v_mfma_f32_16x16x32_bf16 a[88:91], v[88:91], v[104:107], 0
  ds_read_b64_tr_b16 v[142:143], v7 offset:33792
  v_mfma_f32_16x16x32_bf16 a[92:95], v[92:95], v[104:107], 0
  v_mfma_f32_16x16x32_bf16 a[96:99], v[64:67], v[108:111], 0
  ds_read_b128 v[176:179], v1 offset:36864
  v_mfma_f32_16x16x32_bf16 a[100:103], v[68:71], v[108:111], 0
  v_mfma_f32_16x16x32_bf16 a[104:107], v[72:75], v[108:111], 0
  s_add_u32 m0, s25, 98304
  ds_read_b64_tr_b16 v[144:145], v4 offset:40960
  v_mfma_f32_16x16x32_bf16 a[108:111], v[76:79], v[108:111], 0
  buffer_load_dwordx4 v16, s[12:15], s21 offen lds
  v_mfma_f32_16x16x32_bf16 a[112:115], v[80:83], v[108:111], 0
  ds_read_b64_tr_b16 v[146:147], v4 offset:41984
  v_mfma_f32_16x16x32_bf16 a[116:119], v[84:87], v[108:111], 0
  v_mfma_f32_16x16x32_bf16 a[120:123], v[88:91], v[108:111], 0
  ds_read_b128 v[180:183], v1 offset:37888
  v_mfma_f32_16x16x32_bf16 a[124:127], v[92:95], v[108:111], 0
  v_mfma_f32_16x16x32_bf16 a[128:131], v[64:67], v[112:115], 0
  s_add_u32 m0, s25, 106496
  ds_read_b64_tr_b16 v[148:149], v5 offset:40960
  v_mfma_f32_16x16x32_bf16 a[132:135], v[68:71], v[112:115], 0
  buffer_load_dwordx4 v16, s[16:19], s22 offen lds
  v_mfma_f32_16x16x32_bf16 a[136:139], v[72:75], v[112:115], 0
  ds_read_b64_tr_b16 v[150:151], v5 offset:41984
  v_mfma_f32_16x16x32_bf16 a[140:143], v[76:79], v[112:115], 0
  v_mfma_f32_16x16x32_bf16 a[144:147], v[80:83], v[112:115], 0
  ds_read_b128 v[184:187], v1 offset:38912
  v_mfma_f32_16x16x32_bf16 a[148:151], v[84:87], v[112:115], 0
  v_mfma_f32_16x16x32_bf16 a[152:155], v[88:91], v[112:115], 0
  s_add_u32 m0, s25, 99328
  ds_read_b64_tr_b16 v[152:153], v6 offset:40960
  v_mfma_f32_16x16x32_bf16 a[156:159], v[92:95], v[112:115], 0
  buffer_load_dwordx4 v17, s[12:15], s21 offen lds
  v_mfma_f32_16x16x32_bf16 a[160:163], v[64:67], v[116:119], 0
  ds_read_b64_tr_b16 v[154:155], v6 offset:41984
  v_mfma_f32_16x16x32_bf16 a[164:167], v[68:71], v[116:119], 0
  v_mfma_f32_16x16x32_bf16 a[168:171], v[72:75], v[116:119], 0
  ds_read_b128 v[188:191], v1 offset:39936
  v_mfma_f32_16x16x32_bf16 a[172:175], v[76:79], v[116:119], 0
  v_mfma_f32_16x16x32_bf16 a[176:179], v[80:83], v[116:119], 0
  s_add_u32 m0, s25, 107520
  ds_read_b64_tr_b16 v[156:157], v7 offset:40960
  v_mfma_f32_16x16x32_bf16 a[180:183], v[84:87], v[116:119], 0
  buffer_load_dwordx4 v17, s[16:19], s22 offen lds
  v_mfma_f32_16x16x32_bf16 a[184:187], v[88:91], v[116:119], 0
  ds_read_b64_tr_b16 v[158:159], v7 offset:41984
  v_mfma_f32_16x16x32_bf16 a[188:191], v[92:95], v[116:119], 0
  v_mfma_f32_16x16x32_bf16 a[192:195], v[64:67], v[120:123], 0
  v_mfma_f32_16x16x32_bf16 a[196:199], v[68:71], v[120:123], 0
  v_mfma_f32_16x16x32_bf16 a[200:203], v[72:75], v[120:123], 0
  s_add_u32 s20, s20, 131072
  v_mfma_f32_16x16x32_bf16 a[204:207], v[76:79], v[120:123], 0
  s_add_u32 s21, s21, s23
  v_mfma_f32_16x16x32_bf16 a[208:211], v[80:83], v[120:123], 0
  s_add_u32 s22, s22, s23
  v_mfma_f32_16x16x32_bf16 a[212:215], v[84:87], v[120:123], 0
  v_mfma_f32_16x16x32_bf16 a[216:219], v[88:91], v[120:123], 0
  v_mfma_f32_16x16x32_bf16 a[220:223], v[92:95], v[120:123], 0
  v_mfma_f32_16x16x32_bf16 a[224:227], v[64:67], v[124:127], 0
  v_mfma_f32_16x16x32_bf16 a[228:231], v[68:71], v[124:127], 0
  v_mfma_f32_16x16x32_bf16 a[232:235], v[72:75], v[124:127], 0
  v_mfma_f32_16x16x32_bf16 a[236:239], v[76:79], v[124:127], 0
  v_mfma_f32_16x16x32_bf16 a[240:243], v[80:83], v[124:127], 0
  v_mfma_f32_16x16x32_bf16 a[244:247], v[84:87], v[124:127], 0
  v_mfma_f32_16x16x32_bf16 a[248:251], v[88:91], v[124:127], 0
  v_mfma_f32_16x16x32_bf16 a[252:255], v[92:95], v[124:127], 0
  s_waitcnt vmcnt(8) lgkmcnt(0)
  s_barrier
  v_mfma_f32_16x16x32_bf16 a[0:3], v[128:131], v[160:163], a[0:3]
  ds_read_b128 v[96:99], v2 offset:0
  v_mfma_f32_16x16x32_bf16 a[4:7], v[132:135], v[160:163], a[4:7]
  v_mfma_f32_16x16x32_bf16 a[8:11], v[136:139], v[160:163], a[8:11]
  s_add_u32 m0, s24, 0
  ds_read_b64_tr_b16 v[64:65], v8 offset:0
  v_mfma_f32_16x16x32_bf16 a[12:15], v[140:143], v[160:163], a[12:15]
  buffer_load_dwordx4 v12, s[8:11], s20 offen lds
  v_mfma_f32_16x16x32_bf16 a[16:19], v[144:147], v[160:163], a[16:19]
  ds_read_b64_tr_b16 v[66:67], v8 offset:1024
  v_mfma_f32_16x16x32_bf16 a[20:23], v[148:151], v[160:163], a[20:23]
  v_mfma_f32_16x16x32_bf16 a[24:27], v[152:155], v[160:163], a[24:27]
  ds_read_b128 v[100:103], v2 offset:1024
  v_mfma_f32_16x16x32_bf16 a[28:31], v[156:159], v[160:163], a[28:31]
  v_mfma_f32_16x16x32_bf16 a[32:35], v[128:131], v[164:167], a[32:35]
  s_add_u32 m0, s24, 1024
  ds_read_b64_tr_b16 v[68:69], v9 offset:0
  v_mfma_f32_16x16x32_bf16 a[36:39], v[132:135], v[164:167], a[36:39]
  buffer_load_dwordx4 v13, s[8:11], s20 offen lds
  v_mfma_f32_16x16x32_bf16 a[40:43], v[136:139], v[164:167], a[40:43]
  ds_read_b64_tr_b16 v[70:71], v9 offset:1024
  v_mfma_f32_16x16x32_bf16 a[44:47], v[140:143], v[164:167], a[44:47]
  v_mfma_f32_16x16x32_bf16 a[48:51], v[144:147], v[164:167], a[48:51]
  ds_read_b128 v[104:107], v2 offset:2048
  v_mfma_f32_16x16x32_bf16 a[52:55], v[148:151], v[164:167], a[52:55]
  v_mfma_f32_16x16x32_bf16 a[56:59], v[152:155], v[164:167], a[56:59]
  s_add_u32 m0, s24, 2048
  ds_read_b64_tr_b16 v[72:73], v10 offset:0
  v_mfma_f32_16x16x32_bf16 a[60:63], v[156:159], v[164:167], a[60:63]
  buffer_load_dwordx4 v14, s[8:11], s20 offen lds
  v_mfma_f32_16x16x32_bf16 a[64:67], v[128:131], v[168:171], a[64:67]
  ds_read_b64_tr_b16 v[74:75], v10 offset:1024
  v_mfma_f32_16x16x32_bf16 a[68:71], v[132:135], v[168:171], a[68:71]
  v_mfma_f32_16x16x32_bf16 a[72:75], v[136:139], v[168:171], a[72:75]
  ds_read_b128 v[108:111], v2 offset:3072
  v_mfma_f32_16x16x32_bf16 a[76:79], v[140:143], v[168:171], a[76:79]
  v_mfma_f32_16x16x32_bf16 a[80:83], v[144:147], v[168:171], a[80:83]
  s_add_u32 m0, s24, 3072
  ds_read_b64_tr_b16 v[76:77], v11 offset:0
  v_mfma_f32_16x16x32_bf16 a[84:87], v[148:151], v[168:171], a[84:87]
  buffer_load_dwordx4 v15, s[8:11], s20 offen lds
  v_mfma_f32_16x16x32_bf16 a[88:91], v[152:155], v[168:171], a[88:91]
  ds_read_b64_tr_b16 v[78:79], v11 offset:1024
  v_mfma_f32_16x16x32_bf16 a[92:95], v[156:159], v[168:171], a[92:95]
  v_mfma_f32_16x16x32_bf16 a[96:99], v[128:131], v[172:175], a[96:99]
  ds_read_b128 v[112:115], v2 offset:4096
  v_mfma_f32_16x16x32_bf16 a[100:103], v[132:135], v[172:175], a[100:103]
  v_mfma_f32_16x16x32_bf16 a[104:107], v[136:139], v[172:175], a[104:107]
  s_add_u32 m0, s25, 0
  ds_read_b64_tr_b16 v[80:81], v8 offset:8192
  v_mfma_f32_16x16x32_bf16 a[108:111], v[140:143], v[172:175], a[108:111]
  buffer_load_dwordx4 v16, s[12:15], s21 offen lds
  v_mfma_f32_16x16x32_bf16 a[112:115], v[144:147], v[172:175], a[112:115]
  ds_read_b64_tr_b16 v[82:83], v8 offset:9216
  v_mfma_f32_16x16x32_bf16 a[116:119], v[148:151], v[172:175], a[116:119]
  v_mfma_f32_16x16x32_bf16 a[120:123], v[152:155], v[172:175], a[120:123]
  ds_read_b128 v[116:119], v2 offset:5120
  v_mfma_f32_16x16x32_bf16 a[124:127], v[156:159], v[172:175], a[124:127]
  v_mfma_f32_16x16x32_bf16 a[128:131], v[128:131], v[176:179], a[128:131]
  s_add_u32 m0, s25, 8192
  ds_read_b64_tr_b16 v[84:85], v9 offset:8192
  v_mfma_f32_16x16x32_bf16 a[132:135], v[132:135], v[176:179], a[132:135]
  buffer_load_dwordx4 v16, s[16:19], s22 offen lds
  v_mfma_f32_16x16x32_bf16 a[136:139], v[136:139], v[176:179], a[136:139]
  ds_read_b64_tr_b16 v[86:87], v9 offset:9216
  v_mfma_f32_16x16x32_bf16 a[140:143], v[140:143], v[176:179], a[140:143]
  v_mfma_f32_16x16x32_bf16 a[144:147], v[144:147], v[176:179], a[144:147]
  ds_read_b128 v[120:123], v2 offset:6144
  v_mfma_f32_16x16x32_bf16 a[148:151], v[148:151], v[176:179], a[148:151]
  v_mfma_f32_16x16x32_bf16 a[152:155], v[152:155], v[176:179], a[152:155]
  s_add_u32 m0, s25, 1024
  ds_read_b64_tr_b16 v[88:89], v10 offset:8192
  v_mfma_f32_16x16x32_bf16 a[156:159], v[156:159], v[176:179], a[156:159]
  buffer_load_dwordx4 v17, s[12:15], s21 offen lds
  v_mfma_f32_16x16x32_bf16 a[160:163], v[128:131], v[180:183], a[160:163]
  ds_read_b64_tr_b16 v[90:91], v10 offset:9216
  v_mfma_f32_16x16x32_bf16 a[164:167], v[132:135], v[180:183], a[164:167]
  v_mfma_f32_16x16x32_bf16 a[168:171], v[136:139], v[180:183], a[168:171]
  ds_read_b128 v[124:127], v2 offset:7168
  v_mfma_f32_16x16x32_bf16 a[172:175], v[140:143], v[180:183], a[172:175]
  v_mfma_f32_16x16x32_bf16 a[176:179], v[144:147], v[180:183], a[176:179]
  s_add_u32 m0, s25, 9216
  ds_read_b64_tr_b16 v[92:93], v11 offset:8192
  v_mfma_f32_16x16x32_bf16 a[180:183], v[148:151], v[180:183], a[180:183]
  buffer_load_dwordx4 v17, s[16:19], s22 offen lds
  v_mfma_f32_16x16x32_bf16 a[184:187], v[152:155], v[180:183], a[184:187]
  ds_read_b64_tr_b16 v[94:95], v11 offset:9216
  v_mfma_f32_16x16x32_bf16 a[188:191], v[156:159], v[180:183], a[188:191]
  v_mfma_f32_16x16x32_bf16 a[192:195], v[128:131], v[184:187], a[192:195]
  v_mfma_f32_16x16x32_bf16 a[196:199], v[132:135], v[184:187], a[196:199]
  v_mfma_f32_16x16x32_bf16 a[200:203], v[136:139], v[184:187], a[200:203]
  s_add_u32 s20, s20, 131072
  v_mfma_f32_16x16x32_bf16 a[204:207], v[140:143], v[184:187], a[204:207]
  s_add_u32 s21, s21, s23
  v_mfma_f32_16x16x32_bf16 a[208:211], v[144:147], v[184:187], a[208:211]
  s_add_u32 s22, s22, s23
  v_mfma_f32_16x16x32_bf16 a[212:215], v[148:151], v[184:187], a[212:215]
  v_mfma_f32_16x16x32_bf16 a[216:219], v[152:155], v[184:187], a[216:219]
  v_mfma_f32_16x16x32_bf16 a[220:223], v[156:159], v[184:187], a[220:223]
  v_mfma_f32_16x16x32_bf16 a[224:227], v[128:131], v[188:191], a[224:227]
  v_mfma_f32_16x16x32_bf16 a[228:231], v[132:135], v[188:191], a[228:231]
  v_mfma_f32_16x16x32_bf16 a[232:235], v[136:139], v[188:191], a[232:235]
  v_mfma_f32_16x16x32_bf16 a[236:239], v[140:143], v[188:191], a[236:239]
  v_mfma_f32_16x16x32_bf16 a[240:243], v[144:147], v[188:191], a[240:243]
  v_mfma_f32_16x16x32_bf16 a[244:247], v[148:151], v[188:191], a[244:247]
  v_mfma_f32_16x16x32_bf16 a[248:251], v[152:155], v[188:191], a[248:251]
  v_mfma_f32_16x16x32_bf16 a[252:255], v[156:159], v[188:191], a[252:255]
  s_waitcnt vmcnt(8) lgkmcnt(0)
  s_barrier
  v_mfma_f32_16x16x32_bf16 a[0:3], v[64:67], v[96:99], a[0:3]
  ds_read_b128 v[160:163], v2 offset:32768
  v_mfma_f32_16x16x32_bf16 a[4:7], v[68:71], v[96:99], a[4:7]
  v_mfma_f32_16x16x32_bf16 a[8:11], v[72:75], v[96:99], a[8:11]
  s_add_u32 m0, s24, 32768
  ds_read_b64_tr_b16 v[128:129], v8 offset:32768
  v_mfma_f32_16x16x32_bf16 a[12:15], v[76:79], v[96:99], a[12:15]
  buffer_load_dwordx4 v12, s[8:11], s20 offen lds
  v_mfma_f32_16x16x32_bf16 a[16:19], v[80:83], v[96:99], a[16:19]
  ds_read_b64_tr_b16 v[130:131], v8 offset:33792
  v_mfma_f32_16x16x32_bf16 a[20:23], v[84:87], v[96:99], a[20:23]
  v_mfma_f32_16x16x32_bf16 a[24:27], v[88:91], v[96:99], a[24:27]
  ds_read_b128 v[164:167], v2 offset:33792
  v_mfma_f32_16x16x32_bf16 a[28:31], v[92:95], v[96:99], a[28:31]
  v_mfma_f32_16x16x32_bf16 a[32:35], v[64:67], v[100:103], a[32:35]
  s_add_u32 m0, s24, 33792
  ds_read_b64_tr_b16 v[132:133], v9 offset:32768
  v_mfma_f32_16x16x32_bf16 a[36:39], v[68:71], v[100:103], a[36:39]
  buffer_load_dwordx4 v13, s[8:11], s20 offen lds
  v_mfma_f32_16x16x32_bf16 a[40:43], v[72:75], v[100:103], a[40:43]
  ds_read_b64_tr_b16 v[134:135], v9 offset:33792
  v_mfma_f32_16x16x32_bf16 a[44:47], v[76:79], v[100:103], a[44:47]
  v_mfma_f32_16x16x32_bf16 a[48:51], v[80:83], v[100:103], a[48:51]
  ds_read_b128 v[168:171], v2 offset:34816
  v_mfma_f32_16x16x32_bf16 a[52:55], v[84:87], v[100:103], a[52:55]
  v_mfma_f32_16x16x32_bf16 a[56:59], v[88:91], v[100:103], a[56:59]
  s_add_u32 m0, s24, 34816
  ds_read_b64_tr_b16 v[136:137], v10 offset:32768
  v_mfma_f32_16x16x32_bf16 a[60:63], v[92:95], v[100:103], a[60:63]
  buffer_load_dwordx4 v14, s[8:11], s20 offen lds
  v_mfma_f32_16x16x32_bf16 a[64:67], v[64:67], v[104:107], a[64:67]
  ds_read_b64_tr_b16 v[138:139], v10 offset:33792
  v_mfma_f32_16x16x32_bf16 a[68:71], v[68:71], v[104:107], a[68:71]
  v_mfma_f32_16x16x32_bf16 a[72:75], v[72:75], v[104:107], a[72:75]
  ds_read_b128 v[172:175], v2 offset:35840
  v_mfma_f32_16x16x32_bf16 a[76:79], v[76:79], v[104:107], a[76:79]
  v_mfma_f32_16x16x32_bf16 a[80:83], v[80:83], v[104:107], a[80:83]
  s_add_u32 m0, s24, 35840
  ds_read_b64_tr_b16 v[140:141], v11 offset:32768
  v_mfma_f32_16x16x32_bf16 a[84:87], v[84:87], v[104:107], a[84:87]
  buffer_load_dwordx4 v15, s[8:11], s20 offen lds
  v_mfma_f32_16x16x32_bf16 a[88:91], v[88:91], v[104:107], a[88:91]
  ds_read_b64_tr_b16 v[142:143], v11 offset:33792
  v_mfma_f32_16x16x32_bf16 a[92:95], v[92:95], v[104:107], a[92:95]
  v_mfma_f32_16x16x32_bf16 a[96:99], v[64:67], v[108:111], a[96:99]
  ds_read_b128 v[176:179], v2 offset:36864
  v_mfma_f32_16x16x32_bf16 a[100:103], v[68:71], v[108:111], a[100:103]
  v_mfma_f32_16x16x32_bf16 a[104:107], v[72:75], v[108:111], a[104:107]
  s_add_u32 m0, s25, 32768
  ds_read_b64_tr_b16 v[144:145], v8 offset:40960
  v_mfma_f32_16x16x32_bf16 a[108:111], v[76:79], v[108:111], a[108:111]
  buffer_load_dwordx4 v16, s[12:15], s21 offen lds
  v_mfma_f32_16x16x32_bf16 a[112:115], v[80:83], v[108:111], a[112:115]
  ds_read_b64_tr_b16 v[146:147], v8 offset:41984
  v_mfma_f32_16x16x32_bf16 a[116:119], v[84:87], v[108:111], a[116:119]
  v_mfma_f32_16x16x32_bf16 a[120:123], v[88:91], v[108:111], a[120:123]
  ds_read_b128 v[180:183], v2 offset:37888
  v_mfma_f32_16x16x32_bf16 a[124:127], v[92:95], v[108:111], a[124:127]
  v_mfma_f32_16x16x32_bf16 a[128:131], v[64:67], v[112:115], a[128:131]
  s_add_u32 m0, s25, 40960
  ds_read_b64_tr_b16 v[148:149], v9 offset:40960
  v_mfma_f32_16x16x32_bf16 a[132:135], v[68:71], v[112:115], a[132:135]
  buffer_load_dwordx4 v16, s[16:19], s22 offen lds
  v_mfma_f32_16x16x32_bf16 a[136:139], v[72:75], v[112:115], a[136:139]
  ds_read_b64_tr_b16 v[150:151], v9 offset:41984
  v_mfma_f32_16x16x32_bf16 a[140:143], v[76:79], v[112:115], a[140:143]
  v_mfma_f32_16x16x32_bf16 a[144:147], v[80:83], v[112:115], a[144:147]
  ds_read_b128 v[184:187], v2 offset:38912
  v_mfma_f32_16x16x32_bf16 a[148:151], v[84:87], v[112:115], a[148:151]
  v_mfma_f32_16x16x32_bf16 a[152:155], v[88:91], v[112:115], a[152:155]
  s_add_u32 m0, s25, 33792
  ds_read_b64_tr_b16 v[152:153], v10 offset:40960
  v_mfma_f32_16x16x32_bf16 a[156:159], v[92:95], v[112:115], a[156:159]
  buffer_load_dwordx4 v17, s[12:15], s21 offen lds
  v_mfma_f32_16x16x32_bf16 a[160:163], v[64:67], v[116:119], a[160:163]
  ds_read_b64_tr_b16 v[154:155], v10 offset:41984
  v_mfma_f32_16x16x32_bf16 a[164:167], v[68:71], v[116:119], a[164:167]
  v_mfma_f32_16x16x32_bf16 a[168:171], v[72:75], v[116:119], a[168:171]
  ds_read_b128 v[188:191], v2 offset:39936
  v_mfma_f32_16x16x32_bf16 a[172:175], v[76:79], v[116:119], a[172:175]
  v_mfma_f32_16x16x32_bf16 a[176:179], v[80:83], v[116:119], a[176:179]
  s_add_u32 m0, s25, 41984
  ds_read_b64_tr_b16 v[156:157], v11 offset:40960
  v_mfma_f32_16x16x32_bf16 a[180:183], v[84:87], v[116:119], a[180:183]
  buffer_load_dwordx4 v17, s[16:19], s22 offen lds
  v_mfma_f32_16x16x32_bf16 a[184:187], v[88:91], v[116:119], a[184:187]
  ds_read_b64_tr_b16 v[158:159], v11 offset:41984
  v_mfma_f32_16x16x32_bf16 a[188:191], v[92:95], v[116:119], a[188:191]
  v_mfma_f32_16x16x32_bf16 a[192:195], v[64:67], v[120:123], a[192:195]
  v_mfma_f32_16x16x32_bf16 a[196:199], v[68:71], v[120:123], a[196:199]
  v_mfma_f32_16x16x32_bf16 a[200:203], v[72:75], v[120:123], a[200:203]
  s_add_u32 s20, s20, 131072
  v_mfma_f32_16x16x32_bf16 a[204:207], v[76:79], v[120:123], a[204:207]
  s_add_u32 s21, s21, s23
  v_mfma_f32_16x16x32_bf16 a[208:211], v[80:83], v[120:123], a[208:211]
  s_add_u32 s22, s22, s23
  v_mfma_f32_16x16x32_bf16 a[212:215], v[84:87], v[120:123], a[212:215]
  v_mfma_f32_16x16x32_bf16 a[216:219], v[88:91], v[120:123], a[216:219]
  v_mfma_f32_16x16x32_bf16 a[220:223], v[92:95], v[120:123], a[220:223]
  v_mfma_f32_16x16x32_bf16 a[224:227], v[64:67], v[124:127], a[224:227]
  v_mfma_f32_16x16x32_bf16 a[228:231], v[68:71], v[124:127], a[228:231]
  v_mfma_f32_16x16x32_bf16 a[232:235], v[72:75], v[124:127], a[232:235]
  v_mfma_f32_16x16x32_bf16 a[236:239], v[76:79], v[124:127], a[236:239]
  v_mfma_f32_16x16x32_bf16 a[240:243], v[80:83], v[124:127], a[240:243]
  v_mfma_f32_16x16x32_bf16 a[244:247], v[84:87], v[124:127], a[244:247]
  v_mfma_f32_16x16x32_bf16 a[248:251], v[88:91], v[124:127], a[248:251]
  v_mfma_f32_16x16x32_bf16 a[252:255], v[92:95], v[124:127], a[252:255]
  s_waitcnt vmcnt(8) lgkmcnt(0)
  s_barrier
  v_mfma_f32_16x16x32_bf16 a[0:3], v[128:131], v[160:163], a[0:3]
  ds_read_b128 v[96:99], v1 offset:0
  v_mfma_f32_16x16x32_bf16 a[4:7], v[132:135], v[160:163], a[4:7]
  v_mfma_f32_16x16x32_bf16 a[8:11], v[136:139], v[160:163], a[8:11]
  s_add_u32 m0, s24, 65536
  ds_read_b64_tr_b16 v[64:65], v4 offset:0
  v_mfma_f32_16x16x32_bf16 a[12:15], v[140:143], v[160:163], a[12:15]
  buffer_load_dwordx4 v12, s[8:11], s20 offen lds
  v_mfma_f32_16x16x32_bf16 a[16:19], v[144:147], v[160:163], a[16:19]
  ds_read_b64_tr_b16 v[66:67], v4 offset:1024
  v_mfma_f32_16x16x32_bf16 a[20:23], v[148:151], v[160:163], a[20:23]
  v_mfma_f32_16x16x32_bf16 a[24:27], v[152:155], v[160:163], a[24:27]
  ds_read_b128 v[100:103], v1 offset:1024
  v_mfma_f32_16x16x32_bf16 a[28:31], v[156:159], v[160:163], a[28:31]
  v_mfma_f32_16x16x32_bf16 a[32:35], v[128:131], v[164:167], a[32:35]
  s_add_u32 m0, s24, 66560
  ds_read_b64_tr_b16 v[68:69], v5 offset:0
  v_mfma_f32_16x16x32_bf16 a[36:39], v[132:135], v[164:167], a[36:39]
  buffer_load_dwordx4 v13, s[8:11], s20 offen lds
  v_mfma_f32_16x16x32_bf16 a[40:43], v[136:139], v[164:167], a[40:43]
  ds_read_b64_tr_b16 v[70:71], v5 offset:1024
  v_mfma_f32_16x16x32_bf16 a[44:47], v[140:143], v[164:167], a[44:47]
  v_mfma_f32_16x16x32_bf16 a[48:51], v[144:147], v[164:167], a[48:51]
  ds_read_b128 v[104:107], v1 offset:2048
  v_mfma_f32_16x16x32_bf16 a[52:55], v[148:151], v[164:167], a[52:55]
  v_mfma_f32_16x16x32_bf16 a[56:59], v[152:155], v[164:167], a[56:59]
  s_add_u32 m0, s24, 67584
  ds_read_b64_tr_b16 v[72:73], v6 offset:0
  v_mfma_f32_16x16x32_bf16 a[60:63], v[156:159], v[164:167], a[60:63]
  buffer_load_dwordx4 v14, s[8:11], s20 offen lds
  v_mfma_f32_16x16x32_bf16 a[64:67], v[128:131], v[168:171], a[64:67]
  ds_read_b64_tr_b16 v[74:75], v6 offset:1024
  v_mfma_f32_16x16x32_bf16 a[68:71], v[132:135], v[168:171], a[68:71]
  v_mfma_f32_16x16x32_bf16 a[72:75], v[136:139], v[168:171], a[72:75]
  ds_read_b128 v[108:111], v1 offset:3072
  v_mfma_f32_16x16x32_bf16 a[76:79], v[140:143], v[168:171], a[76:79]
  v_mfma_f32_16x16x32_bf16 a[80:83], v[144:147], v[168:171], a[80:83]
  s_add_u32 m0, s24, 68608
  ds_read_b64_tr_b16 v[76:77], v7 offset:0
  v_mfma_f32_16x16x32_bf16 a[84:87], v[148:151], v[168:171], a[84:87]
  buffer_load_dwordx4 v15, s[8:11], s20 offen lds
  v_mfma_f32_16x16x32_bf16 a[88:91], v[152:155], v[168:171], a[88:91]
  ds_read_b64_tr_b16 v[78:79], v7 offset:1024
  v_mfma_f32_16x16x32_bf16 a[92:95], v[156:159], v[168:171], a[92:95]
  v_mfma_f32_16x16x32_bf16 a[96:99], v[128:131], v[172:175], a[96:99]
  ds_read_b128 v[112:115], v1 offset:4096
  v_mfma_f32_16x16x32_bf16 a[100:103], v[132:135], v[172:175], a[100:103]
  v_mfma_f32_16x16x32_bf16 a[104:107], v[136:139], v[172:175], a[104:107]
  s_add_u32 m0, s25, 65536
  ds_read_b64_tr_b16 v[80:81], v4 offset:8192
  v_mfma_f32_16x16x32_bf16 a[108:111], v[140:143], v[172:175], a[108:111]
  buffer_load_dwordx4 v16, s[12:15], s21 offen lds
  v_mfma_f32_16x16x32_bf16 a[112:115], v[144:147], v[172:175], a[112:115]
  ds_read_b64_tr_b16 v[82:83], v4 offset:9216
  v_mfma_f32_16x16x32_bf16 a[116:119], v[148:151], v[172:175], a[116:119]
  v_mfma_f32_16x16x32_bf16 a[120:123], v[152:155], v[172:175], a[120:123]
  ds_read_b128 v[116:119], v1 offset:5120
  v_mfma_f32_16x16x32_bf16 a[124:127], v[156:159], v[172:175], a[124:127]
  v_mfma_f32_16x16x32_bf16 a[128:131], v[128:131], v[176:179], a[128:131]
  s_add_u32 m0, s25, 73728
  ds_read_b64_tr_b16 v[84:85], v5 offset:8192
  v_mfma_f32_16x16x32_bf16 a[132:135], v[132:135], v[176:179], a[132:135]
  buffer_load_dwordx4 v16, s[16:19], s22 offen lds
  v_mfma_f32_16x16x32_bf16 a[136:139], v[136:139], v[176:179], a[136:139]
  ds_read_b64_tr_b16 v[86:87], v5 offset:9216
  v_mfma_f32_16x16x32_bf16 a[140:143], v[140:143], v[176:179], a[140:143]
  v_mfma_f32_16x16x32_bf16 a[144:147], v[144:147], v[176:179], a[144:147]
  ds_read_b128 v[120:123], v1 offset:6144
  v_mfma_f32_16x16x32_bf16 a[148:151], v[148:151], v[176:179], a[148:151]
  v_mfma_f32_16x16x32_bf16 a[152:155], v[152:155], v[176:179], a[152:155]
  s_add_u32 m0, s25, 66560
  ds_read_b64_tr_b16 v[88:89], v6 offset:8192
  v_mfma_f32_16x16x32_bf16 a[156:159], v[156:159], v[176:179], a[156:159]
  buffer_load_dwordx4 v17, s[12:15], s21 offen lds
  v_mfma_f32_16x16x32_bf16 a[160:163], v[128:131], v[180:183], a[160:163]
  ds_read_b64_tr_b16 v[90:91], v6 offset:9216
  v_mfma_f32_16x16x32_bf16 a[164:167], v[132:135], v[180:183], a[164:167]
  v_mfma_f32_16x16x32_bf16 a[168:171], v[136:139], v[180:183], a[168:171]
  ds_read_b128 v[124:127], v1 offset:7168
  v_mfma_f32_16x16x32_bf16 a[172:175], v[140:143], v[180:183], a[172:175]
  v_mfma_f32_16x16x32_bf16 a[176:179], v[144:147], v[180:183], a[176:179]
  s_add_u32 m0, s25, 74752
  ds_read_b64_tr_b16 v[92:93], v7 offset:8192
  v_mfma_f32_16x16x32_bf16 a[180:183], v[148:151], v[180:183], a[180:183]
  buffer_load_dwordx4 v17, s[16:19], s22 offen lds
  v_mfma_f32_16x16x32_bf16 a[184:187], v[152:155], v[180:183], a[184:187]
  ds_read_b64_tr_b16 v[94:95], v7 offset:9216
  v_mfma_f32_16x16x32_bf16 a[188:191], v[156:159], v[180:183], a[188:191]
  v_mfma_f32_16x16x32_bf16 a[192:195], v[128:131], v[184:187], a[192:195]
  v_mfma_f32_16x16x32_bf16 a[196:199], v[132:135], v[184:187], a[196:199]
  v_mfma_f32_16x16x32_bf16 a[200:203], v[136:139], v[184:187], a[200:203]
  s_add_u32 s20, s20, 131072
  v_mfma_f32_16x16x32_bf16 a[204:207], v[140:143], v[184:187], a[204:207]
  s_add_u32 s21, s21, s23
  v_mfma_f32_16x16x32_bf16 a[208:211], v[144:147], v[184:187], a[208:211]
  s_add_u32 s22, s22, s23
  v_mfma_f32_16x16x32_bf16 a[212:215], v[148:151], v[184:187], a[212:215]
  v_mfma_f32_16x16x32_bf16 a[216:219], v[152:155], v[184:187], a[216:219]
  v_mfma_f32_16x16x32_bf16 a[220:223], v[156:159], v[184:187], a[220:223]
  v_mfma_f32_16x16x32_bf16 a[224:227], v[128:131], v[188:191], a[224:227]
  v_mfma_f32_16x16x32_bf16 a[228:231], v[132:135], v[188:191], a[228:231]
  v_mfma_f32_16x16x32_bf16 a[232:235], v[136:139], v[188:191], a[232:235]
  v_mfma_f32_16x16x32_bf16 a[236:239], v[140:143], v[188:191], a[236:239]
  v_mfma_f32_16x16x32_bf16 a[240:243], v[144:147], v[188:191], a[240:243]
  v_mfma_f32_16x16x32_bf16 a[244:247], v[148:151], v[188:191], a[244:247]
  v_mfma_f32_16x16x32_bf16 a[248:251], v[152:155], v[188:191], a[248:251]
  v_mfma_f32_16x16x32_bf16 a[252:255], v[156:159], v[188:191], a[252:255]
  s_mov_b32 s26, s31
G_n_loop:
  s_waitcnt vmcnt(8) lgkmcnt(0)
  s_barrier
  v_mfma_f32_16x16x32_bf16 a[0:3], v[64:67], v[96:99], a[0:3]
  ds_read_b128 v[160:163], v1 offset:32768
  v_mfma_f32_16x16x32_bf16 a[4:7], v[68:71], v[96:99], a[4:7]
  v_mfma_f32_16x16x32_bf16 a[8:11], v[72:75], v[96:99], a[8:11]
  s_add_u32 m0, s24, 98304
  ds_read_b64_tr_b16 v[128:129], v4 offset:32768
  v_mfma_f32_16x16x32_bf16 a[12:15], v[76:79], v[96:99], a[12:15]
  buffer_load_dwordx4 v12, s[8:11], s20 offen lds
  v_mfma_f32_16x16x32_bf16 a[16:19], v[80:83], v[96:99], a[16:19]
  ds_read_b64_tr_b16 v[130:131], v4 offset:33792
  v_mfma_f32_16x16x32_bf16 a[20:23], v[84:87], v[96:99], a[20:23]
  v_mfma_f32_16x16x32_bf16 a[24:27], v[88:91], v[96:99], a[24:27]
  ds_read_b128 v[164:167], v1 offset:33792
  v_mfma_f32_16x16x32_bf16 a[28:31], v[92:95], v[96:99], a[28:31]
  v_mfma_f32_16x16x32_bf16 a[32:35], v[64:67], v[100:103], a[32:35]
  s_add_u32 m0, s24, 99328
  ds_read_b64_tr_b16 v[132:133], v5 offset:32768
  v_mfma_f32_16x16x32_bf16 a[36:39], v[68:71], v[100:103], a[36:39]
  buffer_load_dwordx4 v13, s[8:11], s20 offen lds
  v_mfma_f32_16x16x32_bf16 a[40:43], v[72:75], v[100:103], a[40:43]
  ds_read_b64_tr_b16 v[134:135], v5 offset:33792
  v_mfma_f32_16x16x32_bf16 a[44:47], v[76:79], v[100:103], a[44:47]
  v_mfma_f32_16x16x32_bf16 a[48:51], v[80:83], v[100:103], a[48:51]
  ds_read_b128 v[168:171], v1 offset:34816
  v_mfma_f32_16x16x32_bf16 a[52:55], v[84:87], v[100:103], a[52:55]
  v_mfma_f32_16x16x32_bf16 a[56:59], v[88:91], v[100:103], a[56:59]
  s_add_u32 m0, s24, 100352
  ds_read_b64_tr_b16 v[136:137], v6 offset:32768
  v_mfma_f32_16x16x32_bf16 a[60:63], v[92:95], v[100:103], a[60:63]
  buffer_load_dwordx4 v14, s[8:11], s20 offen lds
  v_mfma_f32_16x16x32_bf16 a[64:67], v[64:67], v[104:107], a[64:67]
  ds_read_b64_tr_b16 v[138:139], v6 offset:33792
  v_mfma_f32_16x16x32_bf16 a[68:71], v[68:71], v[104:107], a[68:71]
  v_mfma_f32_16x16x32_bf16 a[72:75], v[72:75], v[104:107], a[72:75]
  ds_read_b128 v[172:175], v1 offset:35840
  v_mfma_f32_16x16x32_bf16 a[76:79], v[76:79], v[104:107], a[76:79]
  v_mfma_f32_16x16x32_bf16 a[80:83], v[80:83], v[104:107], a[80:83]
  s_add_u32 m0, s24, 101376
  ds_read_b64_tr_b16 v[140:141], v7 offset:32768
  v_mfma_f32_16x16x32_bf16 a[84:87], v[84:87], v[104:107], a[84:87]
  buffer_load_dwordx4 v15, s[8:11], s20 offen lds
  v_mfma_f32_16x16x32_bf16 a[88:91], v[88:91], v[104:107], a[88:91]
  ds_read_b64_tr_b16 v[142:143], v7 offset:33792
  v_mfma_f32_16x16x32_bf16 a[92:95], v[92:95], v[104:107], a[92:95]
  v_mfma_f32_16x16x32_bf16 a[96:99], v[64:67], v[108:111], a[96:99]
  ds_read_b128 v[176:179], v1 offset:36864
  v_mfma_f32_16x16x32_bf16 a[100:103], v[68:71], v[108:111], a[100:103]
  v_mfma_f32_16x16x32_bf16 a[104:107], v[72:75], v[108:111], a[104:107]
  s_add_u32 m0, s25, 98304
  ds_read_b64_tr_b16 v[144:145], v4 offset:40960
  v_mfma_f32_16x16x32_bf16 a[108:111], v[76:79], v[108:111], a[108:111]
  buffer_load_dwordx4 v16, s[12:15], s21 offen lds
  v_mfma_f32_16x16x32_bf16 a[112:115], v[80:83], v[108:111], a[112:115]
  ds_read_b64_tr_b16 v[146:147], v4 offset:41984
  v_mfma_f32_16x16x32_bf16 a[116:119], v[84:87], v[108:111], a[116:119]
  v_mfma_f32_16x16x32_bf16 a[120:123], v[88:91], v[108:111], a[120:123]
  ds_read_b128 v[180:183], v1 offset:37888
  v_mfma_f32_16x16x32_bf16 a[124:127], v[92:95], v[108:111], a[124:127]
  v_mfma_f32_16x16x32_bf16 a[128:131], v[64:67], v[112:115], a[128:131]
  s_add_u32 m0, s25, 106496
  ds_read_b64_tr_b16 v[148:149], v5 offset:40960
  v_mfma_f32_16x16x32_bf16 a[132:135], v[68:71], v[112:115], a[132:135]
  buffer_load_dwordx4 v16, s[16:19], s22 offen lds
  v_mfma_f32_16x16x32_bf16 a[136:139], v[72:75], v[112:115], a[136:139]
  ds_read_b64_tr_b16 v[150:151], v5 offset:41984
  v_mfma_f32_16x16x32_bf16 a[140:143], v[76:79], v[112:115], a[140:143]
  v_mfma_f32_16x16x32_bf16 a[144:147], v[80:83], v[112:115], a[144:147]
  ds_read_b128 v[184:187], v1 offset:38912
  v_mfma_f32_16x16x32_bf16 a[148:151], v[84:87], v[112:115], a[148:151]
  v_mfma_f32_16x16x32_bf16 a[152:155], v[88:91], v[112:115], a[152:155]
  s_add_u32 m0, s25, 99328
  ds_read_b64_tr_b16 v[152:153], v6 offset:40960
  v_mfma_f32_16x16x32_bf16 a[156:159], v[92:95], v[112:115], a[156:159]
  buffer_load_dwordx4 v17, s[12:15], s21 offen lds
  v_mfma_f32_16x16x32_bf16 a[160:163], v[64:67], v[116:119], a[160:163]
  ds_read_b64_tr_b16 v[154:155], v6 offset:41984
  v_mfma_f32_16x16x32_bf16 a[164:167], v[68:71], v[116:119], a[164:167]
  v_mfma_f32_16x16x32_bf16 a[168:171], v[72:75], v[116:119], a[168:171]
  ds_read_b128 v[188:191], v1 offset:39936
  v_mfma_f32_16x16x32_bf16 a[172:175], v[76:79], v[116:119], a[172:175]
  v_mfma_f32_16x16x32_bf16 a[176:179], v[80:83], v[116:119], a[176:179]
  s_add_u32 m0, s25, 107520
  ds_read_b64_tr_b16 v[156:157], v7 offset:40960
  v_mfma_f32_16x16x32_bf16 a[180:183], v[84:87], v[116:119], a[180:183]
  buffer_load_dwordx4 v17, s[16:19], s22 offen lds
  v_mfma_f32_16x16x32_bf16 a[184:187], v[88:91], v[116:119], a[184:187]
  ds_read_b64_tr_b16 v[158:159], v7 offset:41984
  v_mfma_f32_16x16x32_bf16 a[188:191], v[92:95], v[116:119], a[188:191]
  v_mfma_f32_16x16x32_bf16 a[192:195], v[64:67], v[120:123], a[192:195]
  v_mfma_f32_16x16x32_bf16 a[196:199], v[68:71], v[120:123], a[196:199]
  v_mfma_f32_16x16x32_bf16 a[200:203], v[72:75], v[120:123], a[200:203]
  s_add_u32 s20, s20, 131072
  v_mfma_f32_16x16x32_bf16 a[204:207], v[76:79], v[120:123], a[204:207]
  s_add_u32 s21, s21, s23
  v_mfma_f32_16x16x32_bf16 a[208:211], v[80:83], v[120:123], a[208:211]
  s_add_u32 s22, s22, s23
  v_mfma_f32_16x16x32_bf16 a[212:215], v[84:87], v[120:123], a[212:215]
  v_mfma_f32_16x16x32_bf16 a[216:219], v[88:91], v[120:123], a[216:219]
  v_mfma_f32_16x16x32_bf16 a[220:223], v[92:95], v[120:123], a[220:223]
  v_mfma_f32_16x16x32_bf16 a[224:227], v[64:67], v[124:127], a[224:227]
  v_mfma_f32_16x16x32_bf16 a[228:231], v[68:71], v[124:127], a[228:231]
  v_mfma_f32_16x16x32_bf16 a[232:235], v[72:75], v[124:127], a[232:235]
  v_mfma_f32_16x16x32_bf16 a[236:239], v[76:79], v[124:127], a[236:239]
  v_mfma_f32_16x16x32_bf16 a[240:243], v[80:83], v[124:127], a[240:243]
  v_mfma_f32_16x16x32_bf16 a[244:247], v[84:87], v[124:127], a[244:247]
  v_mfma_f32_16x16x32_bf16 a[248:251], v[88:91], v[124:127], a[248:251]
  v_mfma_f32_16x16x32_bf16 a[252:255], v[92:95], v[124:127], a[252:255]
  s_waitcnt vmcnt(8) lgkmcnt(0)
  s_barrier
  v_mfma_f32_16x16x32_bf16 a[0:3], v[128:131], v[160:163], a[0:3]
  ds_read_b128 v[96:99], v2 offset:0
  v_mfma_f32_16x16x32_bf16 a[4:7], v[132:135], v[160:163], a[4:7]
  v_mfma_f32_16x16x32_bf16 a[8:11], v[136:139], v[160:163], a[8:11]
  s_add_u32 m0, s24, 0
  ds_read_b64_tr_b16 v[64:65], v8 offset:0
  v_mfma_f32_16x16x32_bf16 a[12:15], v[140:143], v[160:163], a[12:15]
  buffer_load_dwordx4 v12, s[8:11], s20 offen lds
  v_mfma_f32_16x16x32_bf16 a[16:19], v[144:147], v[160:163], a[16:19]
  ds_read_b64_tr_b16 v[66:67], v8 offset:1024
  v_mfma_f32_16x16x32_bf16 a[20:23], v[148:151], v[160:163], a[20:23]
  v_mfma_f32_16x16x32_bf16 a[24:27], v[152:155], v[160:163], a[24:27]
  ds_read_b128 v[100:103], v2 offset:1024
  v_mfma_f32_16x16x32_bf16 a[28:31], v[156:159], v[160:163], a[28:31]
  v_mfma_f32_16x16x32_bf16 a[32:35], v[128:131], v[164:167], a[32:35]
  s_add_u32 m0, s24, 1024
  ds_read_b64_tr_b16 v[68:69], v9 offset:0
  v_mfma_f32_16x16x32_bf16 a[36:39], v[132:135], v[164:167], a[36:39]
  buffer_load_dwordx4 v13, s[8:11], s20 offen lds
  v_mfma_f32_16x16x32_bf16 a[40:43], v[136:139], v[164:167], a[40:43]
  ds_read_b64_tr_b16 v[70:71], v9 offset:1024
  v_mfma_f32_16x16x32_bf16 a[44:47], v[140:143], v[164:167], a[44:47]
  v_mfma_f32_16x16x32_bf16 a[48:51], v[144:147], v[164:167], a[48:51]
  ds_read_b128 v[104:107], v2 offset:2048
  v_mfma_f32_16x16x32_bf16 a[52:55], v[148:151], v[164:167], a[52:55]
  v_mfma_f32_16x16x32_bf16 a[56:59], v[152:155], v[164:167], a[56:59]
  s_add_u32 m0, s24, 2048
  ds_read_b64_tr_b16 v[72:73], v10 offset:0
  v_mfma_f32_16x16x32_bf16 a[60:63], v[156:159], v[164:167], a[60:63]
  buffer_load_dwordx4 v14, s[8:11], s20 offen lds
  v_mfma_f32_16x16x32_bf16 a[64:67], v[128:131], v[168:171], a[64:67]
  ds_read_b64_tr_b16 v[74:75], v10 offset:1024
  v_mfma_f32_16x16x32_bf16 a[68:71], v[132:135], v[168:171], a[68:71]
  v_mfma_f32_16x16x32_bf16 a[72:75], v[136:139], v[168:171], a[72:75]
  ds_read_b128 v[108:111], v2 offset:3072
  v_mfma_f32_16x16x32_bf16 a[76:79], v[140:143], v[168:171], a[76:79]
  v_mfma_f32_16x16x32_bf16 a[80:83], v[144:147], v[168:171], a[80:83]
  s_add_u32 m0, s24, 3072
  ds_read_b64_tr_b16 v[76:77], v11 offset:0
  v_mfma_f32_16x16x32_bf16 a[84:87], v[148:151], v[168:171], a[84:87]
  buffer_load_dwordx4 v15, s[8:11], s20 offen lds
  v_mfma_f32_16x16x32_bf16 a[88:91], v[152:155], v[168:171], a[88:91]
  ds_read_b64_tr_b16 v[78:79], v11 offset:1024
  v_mfma_f32_16x16x32_bf16 a[92:95], v[156:159], v[168:171], a[92:95]
  v_mfma_f32_16x16x32_bf16 a[96:99], v[128:131], v[172:175], a[96:99]
  ds_read_b128 v[112:115], v2 offset:4096
  v_mfma_f32_16x16x32_bf16 a[100:103], v[132:135], v[172:175], a[100:103]
  v_mfma_f32_16x16x32_bf16 a[104:107], v[136:139], v[172:175], a[104:107]
  s_add_u32 m0, s25, 0
  ds_read_b64_tr_b16 v[80:81], v8 offset:8192
  v_mfma_f32_16x16x32_bf16 a[108:111], v[140:143], v[172:175], a[108:111]
  buffer_load_dwordx4 v16, s[12:15], s21 offen lds
  v_mfma_f32_16x16x32_bf16 a[112:115], v[144:147], v[172:175], a[112:115]
  ds_read_b64_tr_b16 v[82:83], v8 offset:9216
  v_mfma_f32_16x16x32_bf16 a[116:119], v[148:151], v[172:175], a[116:119]
  v_mfma_f32_16x16x32_bf16 a[120:123], v[152:155], v[172:175], a[120:123]
  ds_read_b128 v[116:119], v2 offset:5120
  v_mfma_f32_16x16x32_bf16 a[124:127], v[156:159], v[172:175], a[124:127]
  v_mfma_f32_16x16x32_bf16 a[128:131], v[128:131], v[176:179], a[128:131]
  s_add_u32 m0, s25, 8192
  ds_read_b64_tr_b16 v[84:85], v9 offset:8192
  v_mfma_f32_16x16x32_bf16 a[132:135], v[132:135], v[176:179], a[132:135]
  buffer_load_dwordx4 v16, s[16:19], s22 offen lds
  v_mfma_f32_16x16x32_bf16 a[136:139], v[136:139], v[176:179], a[136:139]
  ds_read_b64_tr_b16 v[86:87], v9 offset:9216
  v_mfma_f32_16x16x32_bf16 a[140:143], v[140:143], v[176:179], a[140:143]
  v_mfma_f32_16x16x32_bf16 a[144:147], v[144:147], v[176:179], a[144:147]
  ds_read_b128 v[120:123], v2 offset:6144
  v_mfma_f32_16x16x32_bf16 a[148:151], v[148:151], v[176:179], a[148:151]
  v_mfma_f32_16x16x32_bf16 a[152:155], v[152:155], v[176:179], a[152:155]
  s_add_u32 m0, s25, 1024
  ds_read_b64_tr_b16 v[88:89], v10 offset:8192
  v_mfma_f32_16x16x32_bf16 a[156:159], v[156:159], v[176:179], a[156:159]
  buffer_load_dwordx4 v17, s[12:15], s21 offen lds
  v_mfma_f32_16x16x32_bf16 a[160:163], v[128:131], v[180:183], a[160:163]
  ds_read_b64_tr_b16 v[90:91], v10 offset:9216
  v_mfma_f32_16x16x32_bf16 a[164:167], v[132:135], v[180:183], a[164:167]
  v_mfma_f32_16x16x32_bf16 a[168:171], v[136:139], v[180:183], a[168:171]
  ds_read_b128 v[124:127], v2 offset:7168
  v_mfma_f32_16x16x32_bf16 a[172:175], v[140:143], v[180:183], a[172:175]
  v_mfma_f32_16x16x32_bf16 a[176:179], v[144:147], v[180:183], a[176:179]
  s_add_u32 m0, s25, 9216
  ds_read_b64_tr_b16 v[92:93], v11 offset:8192
  v_mfma_f32_16x16x32_bf16 a[180:183], v[148:151], v[180:183], a[180:183]
  buffer_load_dwordx4 v17, s[16:19], s22 offen lds
  v_mfma_f32_16x16x32_bf16 a[184:187], v[152:155], v[180:183], a[184:187]
  ds_read_b64_tr_b16 v[94:95], v11 offset:9216
  v_mfma_f32_16x16x32_bf16 a[188:191], v[156:159], v[180:183], a[188:191]
  v_mfma_f32_16x16x32_bf16 a[192:195], v[128:131], v[184:187], a[192:195]
  v_mfma_f32_16x16x32_bf16 a[196:199], v[132:135], v[184:187], a[196:199]
  v_mfma_f32_16x16x32_bf16 a[200:203], v[136:139], v[184:187], a[200:203]
  s_add_u32 s20, s20, 131072
  v_mfma_f32_16x16x32_bf16 a[204:207], v[140:143], v[184:187], a[204:207]
  s_add_u32 s21, s21, s23
  v_mfma_f32_16x16x32_bf16 a[208:211], v[144:147], v[184:187], a[208:211]
  s_add_u32 s22, s22, s23
  v_mfma_f32_16x16x32_bf16 a[212:215], v[148:151], v[184:187], a[212:215]
  v_mfma_f32_16x16x32_bf16 a[216:219], v[152:155], v[184:187], a[216:219]
  v_mfma_f32_16x16x32_bf16 a[220:223], v[156:159], v[184:187], a[220:223]
  v_mfma_f32_16x16x32_bf16 a[224:227], v[128:131], v[188:191], a[224:227]
  v_mfma_f32_16x16x32_bf16 a[228:231], v[132:135], v[188:191], a[228:231]
  v_mfma_f32_16x16x32_bf16 a[232:235], v[136:139], v[188:191], a[232:235]
  v_mfma_f32_16x16x32_bf16 a[236:239], v[140:143], v[188:191], a[236:239]
  v_mfma_f32_16x16x32_bf16 a[240:243], v[144:147], v[188:191], a[240:243]
  v_mfma_f32_16x16x32_bf16 a[244:247], v[148:151], v[188:191], a[244:247]
  v_mfma_f32_16x16x32_bf16 a[248:251], v[152:155], v[188:191], a[248:251]
  v_mfma_f32_16x16x32_bf16 a[252:255], v[156:159], v[188:191], a[252:255]
  s_waitcnt vmcnt(8) lgkmcnt(0)
  s_barrier
  v_mfma_f32_16x16x32_bf16 a[0:3], v[64:67], v[96:99], a[0:3]
  ds_read_b128 v[160:163], v2 offset:32768
  v_mfma_f32_16x16x32_bf16 a[4:7], v[68:71], v[96:99], a[4:7]
  v_mfma_f32_16x16x32_bf16 a[8:11], v[72:75], v[96:99], a[8:11]
  s_add_u32 m0, s24, 32768
  ds_read_b64_tr_b16 v[128:129], v8 offset:32768
  v_mfma_f32_16x16x32_bf16 a[12:15], v[76:79], v[96:99], a[12:15]
  buffer_load_dwordx4 v12, s[8:11], s20 offen lds
  v_mfma_f32_16x16x32_bf16 a[16:19], v[80:83], v[96:99], a[16:19]
  ds_read_b64_tr_b16 v[130:131], v8 offset:33792
  v_mfma_f32_16x16x32_bf16 a[20:23], v[84:87], v[96:99], a[20:23]
  v_mfma_f32_16x16x32_bf16 a[24:27], v[88:91], v[96:99], a[24:27]
  ds_read_b128 v[164:167], v2 offset:33792
  v_mfma_f32_16x16x32_bf16 a[28:31], v[92:95], v[96:99], a[28:31]
  v_mfma_f32_16x16x32_bf16 a[32:35], v[64:67], v[100:103], a[32:35]
  s_add_u32 m0, s24, 33792
  ds_read_b64_tr_b16 v[132:133], v9 offset:32768
  v_mfma_f32_16x16x32_bf16 a[36:39], v[68:71], v[100:103], a[36:39]
  buffer_load_dwordx4 v13, s[8:11], s20 offen lds
  v_mfma_f32_16x16x32_bf16 a[40:43], v[72:75], v[100:103], a[40:43]
  ds_read_b64_tr_b16 v[134:135], v9 offset:33792
  v_mfma_f32_16x16x32_bf16 a[44:47], v[76:79], v[100:103], a[44:47]
  v_mfma_f32_16x16x32_bf16 a[48:51], v[80:83], v[100:103], a[48:51]
  ds_read_b128 v[168:171], v2 offset:34816
  v_mfma_f32_16x16x32_bf16 a[52:55], v[84:87], v[100:103], a[52:55]
  v_mfma_f32_16x16x32_bf16 a[56:59], v[88:91], v[100:103], a[56:59]
  s_add_u32 m0, s24, 34816
  ds_read_b64_tr_b16 v[136:137], v10 offset:32768
  v_mfma_f32_16x16x32_bf16 a[60:63], v[92:95], v[100:103], a[60:63]
  buffer_load_dwordx4 v14, s[8:11], s20 offen lds
  v_mfma_f32_16x16x32_bf16 a[64:67], v[64:67], v[104:107], a[64:67]
  ds_read_b64_tr_b16 v[138:139], v10 offset:33792
  v_mfma_f32_16x16x32_bf16 a[68:71], v[68:71], v[104:107], a[68:71]
  v_mfma_f32_16x16x32_bf16 a[72:75], v[72:75], v[104:107], a[72:75]
  ds_read_b128 v[172:175], v2 offset:35840
  v_mfma_f32_16x16x32_bf16 a[76:79], v[76:79], v[104:107], a[76:79]
  v_mfma_f32_16x16x32_bf16 a[80:83], v[80:83], v[104:107], a[80:83]
  s_add_u32 m0, s24, 35840
  ds_read_b64_tr_b16 v[140:141], v11 offset:32768
  v_mfma_f32_16x16x32_bf16 a[84:87], v[84:87], v[104:107], a[84:87]
  buffer_load_dwordx4 v15, s[8:11], s20 offen lds
  v_mfma_f32_16x16x32_bf16 a[88:91], v[88:91], v[104:107], a[88:91]
  ds_read_b64_tr_b16 v[142:143], v11 offset:33792
  v_mfma_f32_16x16x32_bf16 a[92:95], v[92:95], v[104:107], a[92:95]
  v_mfma_f32_16x16x32_bf16 a[96:99], v[64:67], v[108:111], a[96:99]
  ds_read_b128 v[176:179], v2 offset:36864
  v_mfma_f32_16x16x32_bf16 a[100:103], v[68:71], v[108:111], a[100:103]
  v_mfma_f32_16x16x32_bf16 a[104:107], v[72:75], v[108:111], a[104:107]
  s_add_u32 m0, s25, 32768
  ds_read_b64_tr_b16 v[144:145], v8 offset:40960
  v_mfma_f32_16x16x32_bf16 a[108:111], v[76:79], v[108:111], a[108:111]
  buffer_load_dwordx4 v16, s[12:15], s21 offen lds
  v_mfma_f32_16x16x32_bf16 a[112:115], v[80:83], v[108:111], a[112:115]
  ds_read_b64_tr_b16 v[146:147], v8 offset:41984
  v_mfma_f32_16x16x32_bf16 a[116:119], v[84:87], v[108:111], a[116:119]
  v_mfma_f32_16x16x32_bf16 a[120:123], v[88:91], v[108:111], a[120:123]
  ds_read_b128 v[180:183], v2 offset:37888
  v_mfma_f32_16x16x32_bf16 a[124:127], v[92:95], v[108:111], a[124:127]
  v_mfma_f32_16x16x32_bf16 a[128:131], v[64:67], v[112:115], a[128:131]
  s_add_u32 m0, s25, 40960
  ds_read_b64_tr_b16 v[148:149], v9 offset:40960
  v_mfma_f32_16x16x32_bf16 a[132:135], v[68:71], v[112:115], a[132:135]
  buffer_load_dwordx4 v16, s[16:19], s22 offen lds
  v_mfma_f32_16x16x32_bf16 a[136:139], v[72:75], v[112:115], a[136:139]
  ds_read_b64_tr_b16 v[150:151], v9 offset:41984
  v_mfma_f32_16x16x32_bf16 a[140:143], v[76:79], v[112:115], a[140:143]
  v_mfma_f32_16x16x32_bf16 a[144:147], v[80:83], v[112:115], a[144:147]
  ds_read_b128 v[184:187], v2 offset:38912
  v_mfma_f32_16x16x32_bf16 a[148:151], v[84:87], v[112:115], a[148:151]
  v_mfma_f32_16x16x32_bf16 a[152:155], v[88:91], v[112:115], a[152:155]
  s_add_u32 m0, s25, 33792
  ds_read_b64_tr_b16 v[152:153], v10 offset:40960
  v_mfma_f32_16x16x32_bf16 a[156:159], v[92:95], v[112:115], a[156:159]
  buffer_load_dwordx4 v17, s[12:15], s21 offen lds
  v_mfma_f32_16x16x32_bf16 a[160:163], v[64:67], v[116:119], a[160:163]
  ds_read_b64_tr_b16 v[154:155], v10 offset:41984
  v_mfma_f32_16x16x32_bf16 a[164:167], v[68:71], v[116:119], a[164:167]
  v_mfma_f32_16x16x32_bf16 a[168:171], v[72:75], v[116:119], a[168:171]
  ds_read_b128 v[188:191], v2 offset:39936
  v_mfma_f32_16x16x32_bf16 a[172:175], v[76:79], v[116:119], a[172:175]
  v_mfma_f32_16x16x32_bf16 a[176:179], v[80:83], v[116:119], a[176:179]
  s_add_u32 m0, s25, 41984
  ds_read_b64_tr_b16 v[156:157], v11 offset:40960
  v_mfma_f32_16x16x32_bf16 a[180:183], v[84:87], v[116:119], a[180:183]
  buffer_load_dwordx4 v17, s[16:19], s22 offen lds
  v_mfma_f32_16x16x32_bf16 a[184:187], v[88:91], v[116:119], a[184:187]
  ds_read_b64_tr_b16 v[158:159], v11 offset:41984
  v_mfma_f32_16x16x32_bf16 a[188:191], v[92:95], v[116:119], a[188:191]
  v_mfma_f32_16x16x32_bf16 a[192:195], v[64:67], v[120:123], a[192:195]
  v_mfma_f32_16x16x32_bf16 a[196:199], v[68:71], v[120:123], a[196:199]
  v_mfma_f32_16x16x32_bf16 a[200:203], v[72:75], v[120:123], a[200:203]
  s_add_u32 s20, s20, 131072
  v_mfma_f32_16x16x32_bf16 a[204:207], v[76:79], v[120:123], a[204:207]
  s_add_u32 s21, s21, s23
  v_mfma_f32_16x16x32_bf16 a[208:211], v[80:83], v[120:123], a[208:211]
  s_add_u32 s22, s22, s23
  v_mfma_f32_16x16x32_bf16 a[212:215], v[84:87], v[120:123], a[212:215]
  v_mfma_f32_16x16x32_bf16 a[216:219], v[88:91], v[120:123], a[216:219]
  v_mfma_f32_16x16x32_bf16 a[220:223], v[92:95], v[120:123], a[220:223]
  v_mfma_f32_16x16x32_bf16 a[224:227], v[64:67], v[124:127], a[224:227]
  v_mfma_f32_16x16x32_bf16 a[228:231], v[68:71], v[124:127], a[228:231]
  v_mfma_f32_16x16x32_bf16 a[232:235], v[72:75], v[124:127], a[232:235]
  v_mfma_f32_16x16x32_bf16 a[236:239], v[76:79], v[124:127], a[236:239]
  v_mfma_f32_16x16x32_bf16 a[240:243], v[80:83], v[124:127], a[240:243]
  v_mfma_f32_16x16x32_bf16 a[244:247], v[84:87], v[124:127], a[244:247]
  v_mfma_f32_16x16x32_bf16 a[248:251], v[88:91], v[124:127], a[248:251]
  v_mfma_f32_16x16x32_bf16 a[252:255], v[92:95], v[124:127], a[252:255]
  s_waitcnt vmcnt(8) lgkmcnt(0)
  s_barrier
  v_mfma_f32_16x16x32_bf16 a[0:3], v[128:131], v[160:163], a[0:3]
  ds_read_b128 v[96:99], v1 offset:0
  v_mfma_f32_16x16x32_bf16 a[4:7], v[132:135], v[160:163], a[4:7]
  v_mfma_f32_16x16x32_bf16 a[8:11], v[136:139], v[160:163], a[8:11]
  s_add_u32 m0, s24, 65536
  ds_read_b64_tr_b16 v[64:65], v4 offset:0
  v_mfma_f32_16x16x32_bf16 a[12:15], v[140:143], v[160:163], a[12:15]
  buffer_load_dwordx4 v12, s[8:11], s20 offen lds
  v_mfma_f32_16x16x32_bf16 a[16:19], v[144:147], v[160:163], a[16:19]
  ds_read_b64_tr_b16 v[66:67], v4 offset:1024
  v_mfma_f32_16x16x32_bf16 a[20:23], v[148:151], v[160:163], a[20:23]
  v_mfma_f32_16x16x32_bf16 a[24:27], v[152:155], v[160:163], a[24:27]
  ds_read_b128 v[100:103], v1 offset:1024
  v_mfma_f32_16x16x32_bf16 a[28:31], v[156:159], v[160:163], a[28:31]
  v_mfma_f32_16x16x32_bf16 a[32:35], v[128:131], v[164:167], a[32:35]
  s_add_u32 m0, s24, 66560
  ds_read_b64_tr_b16 v[68:69], v5 offset:0
  v_mfma_f32_16x16x32_bf16 a[36:39], v[132:135], v[164:167], a[36:39]
  buffer_load_dwordx4 v13, s[8:11], s20 offen lds
  v_mfma_f32_16x16x32_bf16 a[40:43], v[136:139], v[164:167], a[40:43]
  ds_read_b64_tr_b16 v[70:71], v5 offset:1024
  v_mfma_f32_16x16x32_bf16 a[44:47], v[140:143], v[164:167], a[44:47]
  v_mfma_f32_16x16x32_bf16 a[48:51], v[144:147], v[164:167], a[48:51]
  ds_read_b128 v[104:107], v1 offset:2048
  v_mfma_f32_16x16x32_bf16 a[52:55], v[148:151], v[164:167], a[52:55]
  v_mfma_f32_16x16x32_bf16 a[56:59], v[152:155], v[164:167], a[56:59]
  s_add_u32 m0, s24, 67584
  ds_read_b64_tr_b16 v[72:73], v6 offset:0
  v_mfma_f32_16x16x32_bf16 a[60:63], v[156:159], v[164:167], a[60:63]
  buffer_load_dwordx4 v14, s[8:11], s20 offen lds
  v_mfma_f32_16x16x32_bf16 a[64:67], v[128:131], v[168:171], a[64:67]
  ds_read_b64_tr_b16 v[74:75], v6 offset:1024
  v_mfma_f32_16x16x32_bf16 a[68:71], v[132:135], v[168:171], a[68:71]
  v_mfma_f32_16x16x32_bf16 a[72:75], v[136:139], v[168:171], a[72:75]
  ds_read_b128 v[108:111], v1 offset:3072
  v_mfma_f32_16x16x32_bf16 a[76:79], v[140:143], v[168:171], a[76:79]
  v_mfma_f32_16x16x32_bf16 a[80:83], v[144:147], v[168:171], a[80:83]
  s_add_u32 m0, s24, 68608
  ds_read_b64_tr_b16 v[76:77], v7 offset:0
  v_mfma_f32_16x16x32_bf16 a[84:87], v[148:151], v[168:171], a[84:87]
  buffer_load_dwordx4 v15, s[8:11], s20 offen lds
  v_mfma_f32_16x16x32_bf16 a[88:91], v[152:155], v[168:171], a[88:91]
  ds_read_b64_tr_b16 v[78:79], v7 offset:1024
  v_mfma_f32_16x16x32_bf16 a[92:95], v[156:159], v[168:171], a[92:95]
  v_mfma_f32_16x16x32_bf16 a[96:99], v[128:131], v[172:175], a[96:99]
  ds_read_b128 v[112:115], v1 offset:4096
  v_mfma_f32_16x16x32_bf16 a[100:103], v[132:135], v[172:175], a[100:103]
  v_mfma_f32_16x16x32_bf16 a[104:107], v[136:139], v[172:175], a[104:107]
  s_add_u32 m0, s25, 65536
  ds_read_b64_tr_b16 v[80:81], v4 offset:8192
  v_mfma_f32_16x16x32_bf16 a[108:111], v[140:143], v[172:175], a[108:111]
  buffer_load_dwordx4 v16, s[12:15], s21 offen lds
  v_mfma_f32_16x16x32_bf16 a[112:115], v[144:147], v[172:175], a[112:115]
  ds_read_b64_tr_b16 v[82:83], v4 offset:9216
  v_mfma_f32_16x16x32_bf16 a[116:119], v[148:151], v[172:175], a[116:119]
  v_mfma_f32_16x16x32_bf16 a[120:123], v[152:155], v[172:175], a[120:123]
  ds_read_b128 v[116:119], v1 offset:5120
  v_mfma_f32_16x16x32_bf16 a[124:127], v[156:159], v[172:175], a[124:127]
  v_mfma_f32_16x16x32_bf16 a[128:131], v[128:131], v[176:179], a[128:131]
  s_add_u32 m0, s25, 73728
  ds_read_b64_tr_b16 v[84:85], v5 offset:8192
  v_mfma_f32_16x16x32_bf16 a[132:135], v[132:135], v[176:179], a[132:135]
  buffer_load_dwordx4 v16, s[16:19], s22 offen lds
  v_mfma_f32_16x16x32_bf16 a[136:139], v[136:139], v[176:179], a[136:139]
  ds_read_b64_tr_b16 v[86:87], v5 offset:9216
  v_mfma_f32_16x16x32_bf16 a[140:143], v[140:143], v[176:179], a[140:143]
  v_mfma_f32_16x16x32_bf16 a[144:147], v[144:147], v[176:179], a[144:147]
  ds_read_b128 v[120:123], v1 offset:6144
  v_mfma_f32_16x16x32_bf16 a[148:151], v[148:151], v[176:179], a[148:151]
  v_mfma_f32_16x16x32_bf16 a[152:155], v[152:155], v[176:179], a[152:155]
  s_add_u32 m0, s25, 66560
  ds_read_b64_tr_b16 v[88:89], v6 offset:8192
  v_mfma_f32_16x16x32_bf16 a[156:159], v[156:159], v[176:179], a[156:159]
  buffer_load_dwordx4 v17, s[12:15], s21 offen lds
  v_mfma_f32_16x16x32_bf16 a[160:163], v[128:131], v[180:183], a[160:163]
  ds_read_b64_tr_b16 v[90:91], v6 offset:9216
  v_mfma_f32_16x16x32_bf16 a[164:167], v[132:135], v[180:183], a[164:167]
  v_mfma_f32_16x16x32_bf16 a[168:171], v[136:139], v[180:183], a[168:171]
  ds_read_b128 v[124:127], v1 offset:7168
  v_mfma_f32_16x16x32_bf16 a[172:175], v[140:143], v[180:183], a[172:175]
  v_mfma_f32_16x16x32_bf16 a[176:179], v[144:147], v[180:183], a[176:179]
  s_add_u32 m0, s25, 74752
  ds_read_b64_tr_b16 v[92:93], v7 offset:8192
  v_mfma_f32_16x16x32_bf16 a[180:183], v[148:151], v[180:183], a[180:183]
  buffer_load_dwordx4 v17, s[16:19], s22 offen lds
  v_mfma_f32_16x16x32_bf16 a[184:187], v[152:155], v[180:183], a[184:187]
  ds_read_b64_tr_b16 v[94:95], v7 offset:9216
  v_mfma_f32_16x16x32_bf16 a[188:191], v[156:159], v[180:183], a[188:191]
  v_mfma_f32_16x16x32_bf16 a[192:195], v[128:131], v[184:187], a[192:195]
  v_mfma_f32_16x16x32_bf16 a[196:199], v[132:135], v[184:187], a[196:199]
  v_mfma_f32_16x16x32_bf16 a[200:203], v[136:139], v[184:187], a[200:203]
  s_add_u32 s20, s20, 131072
  v_mfma_f32_16x16x32_bf16 a[204:207], v[140:143], v[184:187], a[204:207]
  s_add_u32 s21, s21, s23
  v_mfma_f32_16x16x32_bf16 a[208:211], v[144:147], v[184:187], a[208:211]
  s_add_u32 s22, s22, s23
  v_mfma_f32_16x16x32_bf16 a[212:215], v[148:151], v[184:187], a[212:215]
  v_mfma_f32_16x16x32_bf16 a[216:219], v[152:155], v[184:187], a[216:219]
  v_mfma_f32_16x16x32_bf16 a[220:223], v[156:159], v[184:187], a[220:223]
  v_mfma_f32_16x16x32_bf16 a[224:227], v[128:131], v[188:191], a[224:227]
  v_mfma_f32_16x16x32_bf16 a[228:231], v[132:135], v[188:191], a[228:231]
  v_mfma_f32_16x16x32_bf16 a[232:235], v[136:139], v[188:191], a[232:235]
  v_mfma_f32_16x16x32_bf16 a[236:239], v[140:143], v[188:191], a[236:239]
  v_mfma_f32_16x16x32_bf16 a[240:243], v[144:147], v[188:191], a[240:243]
  v_mfma_f32_16x16x32_bf16 a[244:247], v[148:151], v[188:191], a[244:247]
  v_mfma_f32_16x16x32_bf16 a[248:251], v[152:155], v[188:191], a[248:251]
  v_mfma_f32_16x16x32_bf16 a[252:255], v[156:159], v[188:191], a[252:255]
  s_sub_u32 s26, s26, 1
  s_cmp_lg_u32 s26, 0
  s_cbranch_scc1 G_n_loop
  s_waitcnt vmcnt(8) lgkmcnt(0)
  s_barrier
  v_mfma_f32_16x16x32_bf16 a[0:3], v[64:67], v[96:99], a[0:3]
  ds_read_b128 v[160:163], v1 offset:32768
  v_mfma_f32_16x16x32_bf16 a[4:7], v[68:71], v[96:99], a[4:7]
  v_mfma_f32_16x16x32_bf16 a[8:11], v[72:75], v[96:99], a[8:11]
  s_add_u32 m0, s24, 98304
  ds_read_b64_tr_b16 v[128:129], v4 offset:32768
  v_mfma_f32_16x16x32_bf16 a[12:15], v[76:79], v[96:99], a[12:15]
  buffer_load_dwordx4 v12, s[8:11], s20 offen lds
  v_mfma_f32_16x16x32_bf16 a[16:19], v[80:83], v[96:99], a[16:19]
  ds_read_b64_tr_b16 v[130:131], v4 offset:33792
  v_mfma_f32_16x16x32_bf16 a[20:23], v[84:87], v[96:99], a[20:23]
  v_mfma_f32_16x16x32_bf16 a[24:27], v[88:91], v[96:99], a[24:27]
  ds_read_b128 v[164:167], v1 offset:33792
  v_mfma_f32_16x16x32_bf16 a[28:31], v[92:95], v[96:99], a[28:31]
  v_mfma_f32_16x16x32_bf16 a[32:35], v[64:67], v[100:103], a[32:35]
  s_add_u32 m0, s24, 99328
  ds_read_b64_tr_b16 v[132:133], v5 offset:32768
  v_mfma_f32_16x16x32_bf16 a[36:39], v[68:71], v[100:103], a[36:39]
  buffer_load_dwordx4 v13, s[8:11], s20 offen lds
  v_mfma_f32_16x16x32_bf16 a[40:43], v[72:75], v[100:103], a[40:43]
  ds_read_b64_tr_b16 v[134:135], v5 offset:33792
  v_mfma_f32_16x16x32_bf16 a[44:47], v[76:79], v[100:103], a[44:47]
  v_mfma_f32_16x16x32_bf16 a[48:51], v[80:83], v[100:103], a[48:51]
  ds_read_b128 v[168:171], v1 offset:34816
  v_mfma_f32_16x16x32_bf16 a[52:55], v[84:87], v[100:103], a[52:55]
  v_mfma_f32_16x16x32_bf16 a[56:59], v[88:91], v[100:103], a[56:59]
  s_add_u32 m0, s24, 100352
  ds_read_b64_tr_b16 v[136:137], v6 offset:32768
  v_mfma_f32_16x16x32_bf16 a[60:63], v[92:95], v[100:103], a[60:63]
  buffer_load_dwordx4 v14, s[8:11], s20 offen lds
  v_mfma_f32_16x16x32_bf16 a[64:67], v[64:67], v[104:107], a[64:67]
  ds_read_b64_tr_b16 v[138:139], v6 offset:33792
  v_mfma_f32_16x16x32_bf16 a[68:71], v[68:71], v[104:107], a[68:71]
  v_mfma_f32_16x16x32_bf16 a[72:75], v[72:75], v[104:107], a[72:75]
  ds_read_b128 v[172:175], v1 offset:35840
  v_mfma_f32_16x16x32_bf16 a[76:79], v[76:79], v[104:107], a[76:79]
  v_mfma_f32_16x16x32_bf16 a[80:83], v[80:83], v[104:107], a[80:83]
  s_add_u32 m0, s24, 101376
  ds_read_b64_tr_b16 v[140:141], v7 offset:32768
  v_mfma_f32_16x16x32_bf16 a[84:87], v[84:87], v[104:107], a[84:87]
  buffer_load_dwordx4 v15, s[8:11], s20 offen lds
  v_mfma_f32_16x16x32_bf16 a[88:91], v[88:91], v[104:107], a[88:91]
  ds_read_b64_tr_b16 v[142:143], v7 offset:33792
  v_mfma_f32_16x16x32_bf16 a[92:95], v[92:95], v[104:107], a[92:95]
  v_mfma_f32_16x16x32_bf16 a[96:99], v[64:67], v[108:111], a[96:99]
  ds_read_b128 v[176:179], v1 offset:36864
  v_mfma_f32_16x16x32_bf16 a[100:103], v[68:71], v[108:111], a[100:103]
  v_mfma_f32_16x16x32_bf16 a[104:107], v[72:75], v[108:111], a[104:107]
  s_add_u32 m0, s25, 98304
  ds_read_b64_tr_b16 v[144:145], v4 offset:40960
  v_mfma_f32_16x16x32_bf16 a[108:111], v[76:79], v[108:111], a[108:111]
  buffer_load_dwordx4 v16, s[12:15], s21 offen lds
  v_mfma_f32_16x16x32_bf16 a[112:115], v[80:83], v[108:111], a[112:115]
  ds_read_b64_tr_b16 v[146:147], v4 offset:41984
  v_mfma_f32_16x16x32_bf16 a[116:119], v[84:87], v[108:111], a[116:119]
  v_mfma_f32_16x16x32_bf16 a[120:123], v[88:91], v[108:111], a[120:123]
  ds_read_b128 v[180:183], v1 offset:37888
  v_mfma_f32_16x16x32_bf16 a[124:127], v[92:95], v[108:111], a[124:127]
  v_mfma_f32_16x16x32_bf16 a[128:131], v[64:67], v[112:115], a[128:131]
  s_add_u32 m0, s25, 106496
  ds_read_b64_tr_b16 v[148:149], v5 offset:40960
  v_mfma_f32_16x16x32_bf16 a[132:135], v[68:71], v[112:115], a[132:135]
  buffer_load_dwordx4 v16, s[16:19], s22 offen lds
  v_mfma_f32_16x16x32_bf16 a[136:139], v[72:75], v[112:115], a[136:139]
  ds_read_b64_tr_b16 v[150:151], v5 offset:41984
  v_mfma_f32_16x16x32_bf16 a[140:143], v[76:79], v[112:115], a[140:143]
  v_mfma_f32_16x16x32_bf16 a[144:147], v[80:83], v[112:115], a[144:147]
  ds_read_b128 v[184:187], v1 offset:38912
  v_mfma_f32_16x16x32_bf16 a[148:151], v[84:87], v[112:115], a[148:151]
  v_mfma_f32_16x16x32_bf16 a[152:155], v[88:91], v[112:115], a[152:155]
  s_add_u32 m0, s25, 99328
  ds_read_b64_tr_b16 v[152:153], v6 offset:40960
  v_mfma_f32_16x16x32_bf16 a[156:159], v[92:95], v[112:115], a[156:159]
  buffer_load_dwordx4 v17, s[12:15], s21 offen lds
  v_mfma_f32_16x16x32_bf16 a[160:163], v[64:67], v[116:119], a[160:163]
  ds_read_b64_tr_b16 v[154:155], v6 offset:41984
  v_mfma_f32_16x16x32_bf16 a[164:167], v[68:71], v[116:119], a[164:167]
  v_mfma_f32_16x16x32_bf16 a[168:171], v[72:75], v[116:119], a[168:171]
  ds_read_b128 v[188:191], v1 offset:39936
  v_mfma_f32_16x16x32_bf16 a[172:175], v[76:79], v[116:119], a[172:175]
  v_mfma_f32_16x16x32_bf16 a[176:179], v[80:83], v[116:119], a[176:179]
  s_add_u32 m0, s25, 107520
  ds_read_b64_tr_b16 v[156:157], v7 offset:40960
  v_mfma_f32_16x16x32_bf16 a[180:183], v[84:87], v[116:119], a[180:183]
  buffer_load_dwordx4 v17, s[16:19], s22 offen lds
  v_mfma_f32_16x16x32_bf16 a[184:187], v[88:91], v[116:119], a[184:187]
  ds_read_b64_tr_b16 v[158:159], v7 offset:41984
  v_mfma_f32_16x16x32_bf16 a[188:191], v[92:95], v[116:119], a[188:191]
  v_mfma_f32_16x16x32_bf16 a[192:195], v[64:67], v[120:123], a[192:195]
  v_mfma_f32_16x16x32_bf16 a[196:199], v[68:71], v[120:123], a[196:199]
  v_mfma_f32_16x16x32_bf16 a[200:203], v[72:75], v[120:123], a[200:203]
  s_add_u32 s20, s20, 131072
  v_mfma_f32_16x16x32_bf16 a[204:207], v[76:79], v[120:123], a[204:207]
  s_add_u32 s21, s21, s23
  v_mfma_f32_16x16x32_bf16 a[208:211], v[80:83], v[120:123], a[208:211]
  s_add_u32 s22, s22, s23
  v_mfma_f32_16x16x32_bf16 a[212:215], v[84:87], v[120:123], a[212:215]
  v_mfma_f32_16x16x32_bf16 a[216:219], v[88:91], v[120:123], a[216:219]
  v_mfma_f32_16x16x32_bf16 a[220:223], v[92:95], v[120:123], a[220:223]
  v_mfma_f32_16x16x32_bf16 a[224:227], v[64:67], v[124:127], a[224:227]
  v_mfma_f32_16x16x32_bf16 a[228:231], v[68:71], v[124:127], a[228:231]
  v_mfma_f32_16x16x32_bf16 a[232:235], v[72:75], v[124:127], a[232:235]
  v_mfma_f32_16x16x32_bf16 a[236:239], v[76:79], v[124:127], a[236:239]
  v_mfma_f32_16x16x32_bf16 a[240:243], v[80:83], v[124:127], a[240:243]
  v_mfma_f32_16x16x32_bf16 a[244:247], v[84:87], v[124:127], a[244:247]
  v_mfma_f32_16x16x32_bf16 a[248:251], v[88:91], v[124:127], a[248:251]
  v_mfma_f32_16x16x32_bf16 a[252:255], v[92:95], v[124:127], a[252:255]
  s_waitcnt vmcnt(8) lgkmcnt(0)
  s_barrier
  v_mfma_f32_16x16x32_bf16 a[0:3], v[128:131], v[160:163], a[0:3]
  ds_read_b128 v[96:99], v2 offset:0
  v_mfma_f32_16x16x32_bf16 a[4:7], v[132:135], v[160:163], a[4:7]
  v_mfma_f32_16x16x32_bf16 a[8:11], v[136:139], v[160:163], a[8:11]
  ds_read_b64_tr_b16 v[64:65], v8 offset:0
  v_mfma_f32_16x16x32_bf16 a[12:15], v[140:143], v[160:163], a[12:15]
  v_mfma_f32_16x16x32_bf16 a[16:19], v[144:147], v[160:163], a[16:19]
  ds_read_b64_tr_b16 v[66:67], v8 offset:1024
  v_mfma_f32_16x16x32_bf16 a[20:23], v[148:151], v[160:163], a[20:23]
  v_mfma_f32_16x16x32_bf16 a[24:27], v[152:155], v[160:163], a[24:27]
  ds_read_b128 v[100:103], v2 offset:1024
  v_mfma_f32_16x16x32_bf16 a[28:31], v[156:159], v[160:163], a[28:31]
  v_mfma_f32_16x16x32_bf16 a[32:35], v[128:131], v[164:167], a[32:35]
  ds_read_b64_tr_b16 v[68:69], v9 offset:0
  v_mfma_f32_16x16x32_bf16 a[36:39], v[132:135], v[164:167], a[36:39]
  v_mfma_f32_16x16x32_bf16 a[40:43], v[136:139], v[164:167], a[40:43]
  ds_read_b64_tr_b16 v[70:71], v9 offset:1024
  v_mfma_f32_16x16x32_bf16 a[44:47], v[140:143], v[164:167], a[44:47]
  v_mfma_f32_16x16x32_bf16 a[48:51], v[144:147], v[164:167], a[48:51]
  ds_read_b128 v[104:107], v2 offset:2048
  v_mfma_f32_16x16x32_bf16 a[52:55], v[148:151], v[164:167], a[52:55]
  v_mfma_f32_16x16x32_bf16 a[56:59], v[152:155], v[164:167], a[56:59]
  ds_read_b64_tr_b16 v[72:73], v10 offset:0
  v_mfma_f32_16x16x32_bf16 a[60:63], v[156:159], v[164:167], a[60:63]
  v_mfma_f32_16x16x32_bf16 a[64:67], v[128:131], v[168:171], a[64:67]
  ds_read_b64_tr_b16 v[74:75], v10 offset:1024
  v_mfma_f32_16x16x32_bf16 a[68:71], v[132:135], v[168:171], a[68:71]
  v_mfma_f32_16x16x32_bf16 a[72:75], v[136:139], v[168:171], a[72:75]
  ds_read_b128 v[108:111], v2 offset:3072
  v_mfma_f32_16x16x32_bf16 a[76:79], v[140:143], v[168:171], a[76:79]
  v_mfma_f32_16x16x32_bf16 a[80:83], v[144:147], v[168:171], a[80:83]
  ds_read_b64_tr_b16 v[76:77], v11 offset:0
  v_mfma_f32_16x16x32_bf16 a[84:87], v[148:151], v[168:171], a[84:87]
  v_mfma_f32_16x16x32_bf16 a[88:91], v[152:155], v[168:171], a[88:91]
  ds_read_b64_tr_b16 v[78:79], v11 offset:1024
  v_mfma_f32_16x16x32_bf16 a[92:95], v[156:159], v[168:171], a[92:95]
  v_mfma_f32_16x16x32_bf16 a[96:99], v[128:131], v[172:175], a[96:99]
  ds_read_b128 v[112:115], v2 offset:4096
  v_mfma_f32_16x16x32_bf16 a[100:103], v[132:135], v[172:175], a[100:103]
  v_mfma_f32_16x16x32_bf16 a[104:107], v[136:139], v[172:175], a[104:107]
  ds_read_b64_tr_b16 v[80:81], v8 offset:8192
  v_mfma_f32_16x16x32_bf16 a[108:111], v[140:143], v[172:175], a[108:111]
  v_mfma_f32_16x16x32_bf16 a[112:115], v[144:147], v[172:175], a[112:115]
  ds_read_b64_tr_b16 v[82:83], v8 offset:9216
  v_mfma_f32_16x16x32_bf16 a[116:119], v[148:151], v[172:175], a[116:119]
  v_mfma_f32_16x16x32_bf16 a[120:123], v[152:155], v[172:175], a[120:123]
  ds_read_b128 v[116:119], v2 offset:5120
  v_mfma_f32_16x16x32_bf16 a[124:127], v[156:159], v[172:175], a[124:127]
  v_mfma_f32_16x16x32_bf16 a[128:131], v[128:131], v[176:179], a[128:131]
  ds_read_b64_tr_b16 v[84:85], v9 offset:8192
  v_mfma_f32_16x16x32_bf16 a[132:135], v[132:135], v[176:179], a[132:135]
  v_mfma_f32_16x16x32_bf16 a[136:139], v[136:139], v[176:179], a[136:139]
  ds_read_b64_tr_b16 v[86:87], v9 offset:9216
  v_mfma_f32_16x16x32_bf16 a[140:143], v[140:143], v[176:179], a[140:143]
  v_mfma_f32_16x16x32_bf16 a[144:147], v[144:147], v[176:179], a[144:147]
  ds_read_b128 v[120:123], v2 offset:6144
  v_mfma_f32_16x16x32_bf16 a[148:151], v[148:151], v[176:179], a[148:151]
  v_mfma_f32_16x16x32_bf16 a[152:155], v[152:155], v[176:179], a[152:155]
  ds_read_b64_tr_b16 v[88:89], v10 offset:8192
  v_mfma_f32_16x16x32_bf16 a[156:159], v[156:159], v[176:179], a[156:159]
  v_mfma_f32_16x16x32_bf16 a[160:163], v[128:131], v[180:183], a[160:163]
  ds_read_b64_tr_b16 v[90:91], v10 offset:9216
  v_mfma_f32_16x16x32_bf16 a[164:167], v[132:135], v[180:183], a[164:167]
  v_mfma_f32_16x16x32_bf16 a[168:171], v[136:139], v[180:183], a[168:171]
  ds_read_b128 v[124:127], v2 offset:7168
  v_mfma_f32_16x16x32_bf16 a[172:175], v[140:143], v[180:183], a[172:175]
  v_mfma_f32_16x16x32_bf16 a[176:179], v[144:147], v[180:183], a[176:179]
  ds_read_b64_tr_b16 v[92:93], v11 offset:8192
  v_mfma_f32_16x16x32_bf16 a[180:183], v[148:151], v[180:183], a[180:183]
  v_mfma_f32_16x16x32_bf16 a[184:187], v[152:155], v[180:183], a[184:187]
  ds_read_b64_tr_b16 v[94:95], v11 offset:9216
  v_mfma_f32_16x16x32_bf16 a[188:191], v[156:159], v[180:183], a[188:191]
  v_mfma_f32_16x16x32_bf16 a[192:195], v[128:131], v[184:187], a[192:195]
  v_mfma_f32_16x16x32_bf16 a[196:199], v[132:135], v[184:187], a[196:199]
  v_mfma_f32_16x16x32_bf16 a[200:203], v[136:139], v[184:187], a[200:203]
  v_mfma_f32_16x16x32_bf16 a[204:207], v[140:143], v[184:187], a[204:207]
  v_mfma_f32_16x16x32_bf16 a[208:211], v[144:147], v[184:187], a[208:211]
  v_mfma_f32_16x16x32_bf16 a[212:215], v[148:151], v[184:187], a[212:215]
  v_mfma_f32_16x16x32_bf16 a[216:219], v[152:155], v[184:187], a[216:219]
  v_mfma_f32_16x16x32_bf16 a[220:223], v[156:159], v[184:187], a[220:223]
  v_mfma_f32_16x16x32_bf16 a[224:227], v[128:131], v[188:191], a[224:227]
  v_mfma_f32_16x16x32_bf16 a[228:231], v[132:135], v[188:191], a[228:231]
  v_mfma_f32_16x16x32_bf16 a[232:235], v[136:139], v[188:191], a[232:235]
  v_mfma_f32_16x16x32_bf16 a[236:239], v[140:143], v[188:191], a[236:239]
  v_mfma_f32_16x16x32_bf16 a[240:243], v[144:147], v[188:191], a[240:243]
  v_mfma_f32_16x16x32_bf16 a[244:247], v[148:151], v[188:191], a[244:247]
  v_mfma_f32_16x16x32_bf16 a[248:251], v[152:155], v[188:191], a[248:251]
  v_mfma_f32_16x16x32_bf16 a[252:255], v[156:159], v[188:191], a[252:255]
  s_waitcnt vmcnt(0) lgkmcnt(0)
  s_barrier
  v_mfma_f32_16x16x32_bf16 a[0:3], v[64:67], v[96:99], a[0:3]
  ds_read_b128 v[160:163], v2 offset:32768
  v_mfma_f32_16x16x32_bf16 a[4:7], v[68:71], v[96:99], a[4:7]
  v_mfma_f32_16x16x32_bf16 a[8:11], v[72:75], v[96:99], a[8:11]
  ds_read_b64_tr_b16 v[128:129], v8 offset:32768
  v_mfma_f32_16x16x32_bf16 a[12:15], v[76:79], v[96:99], a[12:15]
  v_mfma_f32_16x16x32_bf16 a[16:19], v[80:83], v[96:99], a[16:19]
  ds_read_b64_tr_b16 v[130:131], v8 offset:33792
  v_mfma_f32_16x16x32_bf16 a[20:23], v[84:87], v[96:99], a[20:23]
  v_mfma_f32_16x16x32_bf16 a[24:27], v[88:91], v[96:99], a[24:27]
  ds_read_b128 v[164:167], v2 offset:33792
  v_mfma_f32_16x16x32_bf16 a[28:31], v[92:95], v[96:99], a[28:31]
  v_mfma_f32_16x16x32_bf16 a[32:35], v[64:67], v[100:103], a[32:35]
  ds_read_b64_tr_b16 v[132:133], v9 offset:32768
  v_mfma_f32_16x16x32_bf16 a[36:39], v[68:71], v[100:103], a[36:39]
  v_mfma_f32_16x16x32_bf16 a[40:43], v[72:75], v[100:103], a[40:43]
  ds_read_b64_tr_b16 v[134:135], v9 offset:33792
  v_mfma_f32_16x16x32_bf16 a[44:47], v[76:79], v[100:103], a[44:47]
  v_mfma_f32_16x16x32_bf16 a[48:51], v[80:83], v[100:103], a[48:51]
  ds_read_b128 v[168:171], v2 offset:34816
  v_mfma_f32_16x16x32_bf16 a[52:55], v[84:87], v[100:103], a[52:55]
  v_mfma_f32_16x16x32_bf16 a[56:59], v[88:91], v[100:103], a[56:59]
  ds_read_b64_tr_b16 v[136:137], v10 offset:32768
  v_mfma_f32_16x16x32_bf16 a[60:63], v[92:95], v[100:103], a[60:63]
  v_mfma_f32_16x16x32_bf16 a[64:67], v[64:67], v[104:107], a[64:67]
  ds_read_b64_tr_b16 v[138:139], v10 offset:33792
  v_mfma_f32_16x16x32_bf16 a[68:71], v[68:71], v[104:107], a[68:71]
  v_mfma_f32_16x16x32_bf16 a[72:75], v[72:75], v[104:107], a[72:75]
  ds_read_b128 v[172:175], v2 offset:35840
  v_mfma_f32_16x16x32_bf16 a[76:79], v[76:79], v[104:107], a[76:79]
  v_mfma_f32_16x16x32_bf16 a[80:83], v[80:83], v[104:107], a[80:83]
  ds_read_b64_tr_b16 v[140:141], v11 offset:32768
  v_mfma_f32_16x16x32_bf16 a[84:87], v[84:87], v[104:107], a[84:87]
  v_mfma_f32_16x16x32_bf16 a[88:91], v[88:91], v[104:107], a[88:91]
  ds_read_b64_tr_b16 v[142:143], v11 offset:33792
  v_mfma_f32_16x16x32_bf16 a[92:95], v[92:95], v[104:107], a[92:95]
  v_mfma_f32_16x16x32_bf16 a[96:99], v[64:67], v[108:111], a[96:99]
  ds_read_b128 v[176:179], v2 offset:36864
  v_mfma_f32_16x16x32_bf16 a[100:103], v[68:71], v[108:111], a[100:103]
  v_mfma_f32_16x16x32_bf16 a[104:107], v[72:75], v[108:111], a[104:107]
  ds_read_b64_tr_b16 v[144:145], v8 offset:40960
  v_mfma_f32_16x16x32_bf16 a[108:111], v[76:79], v[108:111], a[108:111]
  v_mfma_f32_16x16x32_bf16 a[112:115], v[80:83], v[108:111], a[112:115]
  ds_read_b64_tr_b16 v[146:147], v8 offset:41984
  v_mfma_f32_16x16x32_bf16 a[116:119], v[84:87], v[108:111], a[116:119]
  v_mfma_f32_16x16x32_bf16 a[120:123], v[88:91], v[108:111], a[120:123]
  ds_read_b128 v[180:183], v2 offset:37888
  v_mfma_f32_16x16x32_bf16 a[124:127], v[92:95], v[108:111], a[124:127]
  v_mfma_f32_16x16x32_bf16 a[128:131], v[64:67], v[112:115], a[128:131]
  ds_read_b64_tr_b16 v[148:149], v9 offset:40960
  v_mfma_f32_16x16x32_bf16 a[132:135], v[68:71], v[112:115], a[132:135]
  v_mfma_f32_16x16x32_bf16 a[136:139], v[72:75], v[112:115], a[136:139]
  ds_read_b64_tr_b16 v[150:151], v9 offset:41984
  v_mfma_f32_16x16x32_bf16 a[140:143], v[76:79], v[112:115], a[140:143]
  v_mfma_f32_16x16x32_bf16 a[144:147], v[80:83], v[112:115], a[144:147]
  ds_read_b128 v[184:187], v2 offset:38912
  v_mfma_f32_16x16x32_bf16 a[148:151], v[84:87], v[112:115], a[148:151]
  v_mfma_f32_16x16x32_bf16 a[152:155], v[88:91], v[112:115], a[152:155]
  ds_read_b64_tr_b16 v[152:153], v10 offset:40960
  v_mfma_f32_16x16x32_bf16 a[156:159], v[92:95], v[112:115], a[156:159]
  v_mfma_f32_16x16x32_bf16 a[160:163], v[64:67], v[116:119], a[160:163]
  ds_read_b64_tr_b16 v[154:155], v10 offset:41984
  v_mfma_f32_16x16x32_bf16 a[164:167], v[68:71], v[116:119], a[164:167]
  v_mfma_f32_16x16x32_bf16 a[168:171], v[72:75], v[116:119], a[168:171]
  ds_read_b128 v[188:191], v2 offset:39936
  v_mfma_f32_16x16x32_bf16 a[172:175], v[76:79], v[116:119], a[172:175]
  v_mfma_f32_16x16x32_bf16 a[176:179], v[80:83], v[116:119], a[176:179]
  ds_read_b64_tr_b16 v[156:157], v11 offset:40960
  v_mfma_f32_16x16x32_bf16 a[180:183], v[84:87], v[116:119], a[180:183]
  v_mfma_f32_16x16x32_bf16 a[184:187], v[88:91], v[116:119], a[184:187]
  ds_read_b64_tr_b16 v[158:159], v11 offset:41984
  v_mfma_f32_16x16x32_bf16 a[188:191], v[92:95], v[116:119], a[188:191]
  v_mfma_f32_16x16x32_bf16 a[192:195], v[64:67], v[120:123], a[192:195]
  v_mfma_f32_16x16x32_bf16 a[196:199], v[68:71], v[120:123], a[196:199]
  v_mfma_f32_16x16x32_bf16 a[200:203], v[72:75], v[120:123], a[200:203]
  v_mfma_f32_16x16x32_bf16 a[204:207], v[76:79], v[120:123], a[204:207]
  v_mfma_f32_16x16x32_bf16 a[208:211], v[80:83], v[120:123], a[208:211]
  v_mfma_f32_16x16x32_bf16 a[212:215], v[84:87], v[120:123], a[212:215]
  v_mfma_f32_16x16x32_bf16 a[216:219], v[88:91], v[120:123], a[216:219]
  v_mfma_f32_16x16x32_bf16 a[220:223], v[92:95], v[120:123], a[220:223]
  v_mfma_f32_16x16x32_bf16 a[224:227], v[64:67], v[124:127], a[224:227]
  v_mfma_f32_16x16x32_bf16 a[228:231], v[68:71], v[124:127], a[228:231]
  v_mfma_f32_16x16x32_bf16 a[232:235], v[72:75], v[124:127], a[232:235]
  v_mfma_f32_16x16x32_bf16 a[236:239], v[76:79], v[124:127], a[236:239]
  v_mfma_f32_16x16x32_bf16 a[240:243], v[80:83], v[124:127], a[240:243]
  v_mfma_f32_16x16x32_bf16 a[244:247], v[84:87], v[124:127], a[244:247]
  v_mfma_f32_16x16x32_bf16 a[248:251], v[88:91], v[124:127], a[248:251]
  v_mfma_f32_16x16x32_bf16 a[252:255], v[92:95], v[124:127], a[252:255]
  s_waitcnt lgkmcnt(0)
  s_barrier
  v_mfma_f32_16x16x32_bf16 a[0:3], v[128:131], v[160:163], a[0:3]
  v_mfma_f32_16x16x32_bf16 a[4:7], v[132:135], v[160:163], a[4:7]
  v_mfma_f32_16x16x32_bf16 a[8:11], v[136:139], v[160:163], a[8:11]
  v_mfma_f32_16x16x32_bf16 a[12:15], v[140:143], v[160:163], a[12:15]
  v_mfma_f32_16x16x32_bf16 a[16:19], v[144:147], v[160:163], a[16:19]
  v_mfma_f32_16x16x32_bf16 a[20:23], v[148:151], v[160:163], a[20:23]
  v_mfma_f32_16x16x32_bf16 a[24:27], v[152:155], v[160:163], a[24:27]
  v_mfma_f32_16x16x32_bf16 a[28:31], v[156:159], v[160:163], a[28:31]
  v_mfma_f32_16x16x32_bf16 a[32:35], v[128:131], v[164:167], a[32:35]
  v_mfma_f32_16x16x32_bf16 a[36:39], v[132:135], v[164:167], a[36:39]
  v_mfma_f32_16x16x32_bf16 a[40:43], v[136:139], v[164:167], a[40:43]
  v_mfma_f32_16x16x32_bf16 a[44:47], v[140:143], v[164:167], a[44:47]
  v_mfma_f32_16x16x32_bf16 a[48:51], v[144:147], v[164:167], a[48:51]
  v_mfma_f32_16x16x32_bf16 a[52:55], v[148:151], v[164:167], a[52:55]
  v_mfma_f32_16x16x32_bf16 a[56:59], v[152:155], v[164:167], a[56:59]
  v_mfma_f32_16x16x32_bf16 a[60:63], v[156:159], v[164:167], a[60:63]
  v_mfma_f32_16x16x32_bf16 a[64:67], v[128:131], v[168:171], a[64:67]
  v_mfma_f32_16x16x32_bf16 a[68:71], v[132:135], v[168:171], a[68:71]
  v_mfma_f32_16x16x32_bf16 a[72:75], v[136:139], v[168:171], a[72:75]
  v_mfma_f32_16x16x32_bf16 a[76:79], v[140:143], v[168:171], a[76:79]
  v_mfma_f32_16x16x32_bf16 a[80:83], v[144:147], v[168:171], a[80:83]
  v_mfma_f32_16x16x32_bf16 a[84:87], v[148:151], v[168:171], a[84:87]
  v_mfma_f32_16x16x32_bf16 a[88:91], v[152:155], v[168:171], a[88:91]
  v_mfma_f32_16x16x32_bf16 a[92:95], v[156:159], v[168:171], a[92:95]
  v_mfma_f32_16x16x32_bf16 a[96:99], v[128:131], v[172:175], a[96:99]
  v_mfma_f32_16x16x32_bf16 a[100:103], v[132:135], v[172:175], a[100:103]
  v_mfma_f32_16x16x32_bf16 a[104:107], v[136:139], v[172:175], a[104:107]
  v_mfma_f32_16x16x32_bf16 a[108:111], v[140:143], v[172:175], a[108:111]
  v_mfma_f32_16x16x32_bf16 a[112:115], v[144:147], v[172:175], a[112:115]
  v_mfma_f32_16x16x32_bf16 a[116:119], v[148:151], v[172:175], a[116:119]
  v_mfma_f32_16x16x32_bf16 a[120:123], v[152:155], v[172:175], a[120:123]
  v_mfma_f32_16x16x32_bf16 a[124:127], v[156:159], v[172:175], a[124:127]
  v_mfma_f32_16x16x32_bf16 a[128:131], v[128:131], v[176:179], a[128:131]
  v_mfma_f32_16x16x32_bf16 a[132:135], v[132:135], v[176:179], a[132:135]
  v_mfma_f32_16x16x32_bf16 a[136:139], v[136:139], v[176:179], a[136:139]
  v_mfma_f32_16x16x32_bf16 a[140:143], v[140:143], v[176:179], a[140:143]
  v_mfma_f32_16x16x32_bf16 a[144:147], v[144:147], v[176:179], a[144:147]
  v_mfma_f32_16x16x32_bf16 a[148:151], v[148:151], v[176:179], a[148:151]
  v_mfma_f32_16x16x32_bf16 a[152:155], v[152:155], v[176:179], a[152:155]
  v_mfma_f32_16x16x32_bf16 a[156:159], v[156:159], v[176:179], a[156:159]
  v_mfma_f32_16x16x32_bf16 a[160:163], v[128:131], v[180:183], a[160:163]
  v_mfma_f32_16x16x32_bf16 a[164:167], v[132:135], v[180:183], a[164:167]
  v_mfma_f32_16x16x32_bf16 a[168:171], v[136:139], v[180:183], a[168:171]
  v_mfma_f32_16x16x32_bf16 a[172:175], v[140:143], v[180:183], a[172:175]
  v_mfma_f32_16x16x32_bf16 a[176:179], v[144:147], v[180:183], a[176:179]
  v_mfma_f32_16x16x32_bf16 a[180:183], v[148:151], v[180:183], a[180:183]
  v_mfma_f32_16x16x32_bf16 a[184:187], v[152:155], v[180:183], a[184:187]
  v_mfma_f32_16x16x32_bf16 a[188:191], v[156:159], v[180:183], a[188:191]
  v_mfma_f32_16x16x32_bf16 a[192:195], v[128:131], v[184:187], a[192:195]
  v_mfma_f32_16x16x32_bf16 a[196:199], v[132:135], v[184:187], a[196:199]
  v_mfma_f32_16x16x32_bf16 a[200:203], v[136:139], v[184:187], a[200:203]
  v_mfma_f32_16x16x32_bf16 a[204:207], v[140:143], v[184:187], a[204:207]
  v_mfma_f32_16x16x32_bf16 a[208:211], v[144:147], v[184:187], a[208:211]
  v_mfma_f32_16x16x32_bf16 a[212:215], v[148:151], v[184:187], a[212:215]
  v_mfma_f32_16x16x32_bf16 a[216:219], v[152:155], v[184:187], a[216:219]
  v_mfma_f32_16x16x32_bf16 a[220:223], v[156:159], v[184:187], a[220:223]
  v_mfma_f32_16x16x32_bf16 a[224:227], v[128:131], v[188:191], a[224:227]
  v_mfma_f32_16x16x32_bf16 a[228:231], v[132:135], v[188:191], a[228:231]
  v_mfma_f32_16x16x32_bf16 a[232:235], v[136:139], v[188:191], a[232:235]
  v_mfma_f32_16x16x32_bf16 a[236:239], v[140:143], v[188:191], a[236:239]
  v_mfma_f32_16x16x32_bf16 a[240:243], v[144:147], v[188:191], a[240:243]
  v_mfma_f32_16x16x32_bf16 a[244:247], v[148:151], v[188:191], a[244:247]
  v_mfma_f32_16x16x32_bf16 a[248:251], v[152:155], v[188:191], a[248:251]
  v_mfma_f32_16x16x32_bf16 a[252:255], v[156:159], v[188:191], a[252:255]
  s_nop 7
  s_cmp_eq_u32 s30, 3
  s_cbranch_scc1 L_te_91
  s_cmp_lg_u32 s27, 0
  s_cbranch_scc1 L_te_91
  s_lshl_b32 s47, s96, 7
  s_add_u32 s47, s47, 117449728
  v_mov_b32 v252, s47
  v_mov_b32 v253, 1
  s_mov_b64 exec, 1
  buffer_atomic_add v253, v252, s[4:7], 0 offen sc0 sc1
  s_mov_b64 exec, -1
L_te_91:
  s_cmp_eq_u32 s30, 2
  s_cbranch_scc1 G_egu
  s_cmp_eq_u32 s30, 3
  s_cbranch_scc1 G_ed
  v_and_b32 v20, 63, v0
  v_and_b32 v21, 15, v20
  v_bfe_u32 v22, v20, 4, 1
  v_bfe_u32 v24, v20, 5, 1
  v_lshlrev_b32 v23, 4, v21
  v_lshl_add_u32 v23, v22, 9, v23
  v_lshl_add_u32 v23, v24, 8, v23
  s_lshr_b32 s40, s27, 1
  s_and_b32 s41, s27, 1
  s_lshl_b32 s42, s28, 3
  s_lshl_b32 s43, s40, 2
  s_add_u32 s42, s42, s43
  s_lshl_b32 s42, s42, 18
  s_lshl_b32 s43, s29, 14
  s_add_u32 s42, s42, s43
  s_lshl_b32 s43, s41, 11
  s_add_u32 s42, s42, s43
  s_add_u32 s45, s42, s32
  s_add_u32 s46, s45, 0
  v_accvgpr_read_b32 v32, a0
  v_accvgpr_read_b32 v33, a1
  v_accvgpr_read_b32 v34, a2
  v_accvgpr_read_b32 v35, a3
  v_accvgpr_read_b32 v36, a4
  v_accvgpr_read_b32 v37, a5
  v_accvgpr_read_b32 v38, a6
  v_accvgpr_read_b32 v39, a7
  v_cvt_pk_bf16_f32 v40, v32, v33
  v_cvt_pk_bf16_f32 v41, v34, v35
  v_cvt_pk_bf16_f32 v42, v36, v37
  v_cvt_pk_bf16_f32 v43, v38, v39
  s_nop 1
  v_permlane16_swap_b32 v40, v42
  v_permlane16_swap_b32 v41, v43
  buffer_store_dwordx4 v[40:43], v23, s[4:7], s46 offen offset:0 sc1
  v_accvgpr_read_b32 v48, a8
  v_accvgpr_read_b32 v49, a9
  v_accvgpr_read_b32 v50, a10
  v_accvgpr_read_b32 v51, a11
  v_accvgpr_read_b32 v52, a12
  v_accvgpr_read_b32 v53, a13
  v_accvgpr_read_b32 v54, a14
  v_accvgpr_read_b32 v55, a15
  v_cvt_pk_bf16_f32 v56, v48, v49
  v_cvt_pk_bf16_f32 v57, v50, v51
  v_cvt_pk_bf16_f32 v58, v52, v53
  v_cvt_pk_bf16_f32 v59, v54, v55
  s_nop 1
  v_permlane16_swap_b32 v56, v58
  v_permlane16_swap_b32 v57, v59
  buffer_store_dwordx4 v[56:59], v23, s[4:7], s46 offen offset:1024 sc1
  s_add_u32 s46, s45, 8192
  v_accvgpr_read_b32 v32, a16
  v_accvgpr_read_b32 v33, a17
  v_accvgpr_read_b32 v34, a18
  v_accvgpr_read_b32 v35, a19
  v_accvgpr_read_b32 v36, a20
  v_accvgpr_read_b32 v37, a21
  v_accvgpr_read_b32 v38, a22
  v_accvgpr_read_b32 v39, a23
  v_cvt_pk_bf16_f32 v40, v32, v33
  v_cvt_pk_bf16_f32 v41, v34, v35
  v_cvt_pk_bf16_f32 v42, v36, v37
  v_cvt_pk_bf16_f32 v43, v38, v39
  s_nop 1
  v_permlane16_swap_b32 v40, v42
  v_permlane16_swap_b32 v41, v43
  buffer_store_dwordx4 v[40:43], v23, s[4:7], s46 offen offset:0 sc1
  v_accvgpr_read_b32 v48, a24
  v_accvgpr_read_b32 v49, a25
  v_accvgpr_read_b32 v50, a26
  v_accvgpr_read_b32 v51, a27
  v_accvgpr_read_b32 v52, a28
  v_accvgpr_read_b32 v53, a29
  v_accvgpr_read_b32 v54, a30
  v_accvgpr_read_b32 v55, a31
  v_cvt_pk_bf16_f32 v56, v48, v49
  v_cvt_pk_bf16_f32 v57, v50, v51
  v_cvt_pk_bf16_f32 v58, v52, v53
  v_cvt_pk_bf16_f32 v59, v54, v55
  s_nop 1
  v_permlane16_swap_b32 v56, v58
  v_permlane16_swap_b32 v57, v59
  buffer_store_dwordx4 v[56:59], v23, s[4:7], s46 offen offset:1024 sc1
  s_add_u32 s46, s45, 4096
  v_accvgpr_read_b32 v32, a32
  v_accvgpr_read_b32 v33, a33
  v_accvgpr_read_b32 v34, a34
  v_accvgpr_read_b32 v35, a35
  v_accvgpr_read_b32 v36, a36
  v_accvgpr_read_b32 v37, a37
  v_accvgpr_read_b32 v38, a38
  v_accvgpr_read_b32 v39, a39
  v_cvt_pk_bf16_f32 v40, v32, v33
  v_cvt_pk_bf16_f32 v41, v34, v35
  v_cvt_pk_bf16_f32 v42, v36, v37
  v_cvt_pk_bf16_f32 v43, v38, v39
  s_nop 1
  v_permlane16_swap_b32 v40, v42
  v_permlane16_swap_b32 v41, v43
  buffer_store_dwordx4 v[40:43], v23, s[4:7], s46 offen offset:0 sc1
  v_accvgpr_read_b32 v48, a40
  v_accvgpr_read_b32 v49, a41
  v_accvgpr_read_b32 v50, a42
  v_accvgpr_read_b32 v51, a43
  v_accvgpr_read_b32 v52, a44
  v_accvgpr_read_b32 v53, a45
  v_accvgpr_read_b32 v54, a46
  v_accvgpr_read_b32 v55, a47
  v_cvt_pk_bf16_f32 v56, v48, v49
  v_cvt_pk_bf16_f32 v57, v50, v51
  v_cvt_pk_bf16_f32 v58, v52, v53
  v_cvt_pk_bf16_f32 v59, v54, v55
  s_nop 1
  v_permlane16_swap_b32 v56, v58
  v_permlane16_swap_b32 v57, v59
  buffer_store_dwordx4 v[56:59], v23, s[4:7], s46 offen offset:1024 sc1
  s_add_u32 s46, s45, 12288
  v_accvgpr_read_b32 v32, a48
  v_accvgpr_read_b32 v33, a49
  v_accvgpr_read_b32 v34, a50
  v_accvgpr_read_b32 v35, a51
  v_accvgpr_read_b32 v36, a52
  v_accvgpr_read_b32 v37, a53
  v_accvgpr_read_b32 v38, a54
  v_accvgpr_read_b32 v39, a55
  v_cvt_pk_bf16_f32 v40, v32, v33
  v_cvt_pk_bf16_f32 v41, v34, v35
  v_cvt_pk_bf16_f32 v42, v36, v37
  v_cvt_pk_bf16_f32 v43, v38, v39
  s_nop 1
  v_permlane16_swap_b32 v40, v42
  v_permlane16_swap_b32 v41, v43
  buffer_store_dwordx4 v[40:43], v23, s[4:7], s46 offen offset:0 sc1
  v_accvgpr_read_b32 v48, a56
  v_accvgpr_read_b32 v49, a57
  v_accvgpr_read_b32 v50, a58
  v_accvgpr_read_b32 v51, a59
  v_accvgpr_read_b32 v52, a60
  v_accvgpr_read_b32 v53, a61
  v_accvgpr_read_b32 v54, a62
  v_accvgpr_read_b32 v55, a63
  v_cvt_pk_bf16_f32 v56, v48, v49
  v_cvt_pk_bf16_f32 v57, v50, v51
  v_cvt_pk_bf16_f32 v58, v52, v53
  v_cvt_pk_bf16_f32 v59, v54, v55
  s_nop 1
  v_permlane16_swap_b32 v56, v58
  v_permlane16_swap_b32 v57, v59
  buffer_store_dwordx4 v[56:59], v23, s[4:7], s46 offen offset:1024 sc1
  s_add_u32 s46, s45, 262144
  v_accvgpr_read_b32 v32, a64
  v_accvgpr_read_b32 v33, a65
  v_accvgpr_read_b32 v34, a66
  v_accvgpr_read_b32 v35, a67
  v_accvgpr_read_b32 v36, a68
  v_accvgpr_read_b32 v37, a69
  v_accvgpr_read_b32 v38, a70
  v_accvgpr_read_b32 v39, a71
  v_cvt_pk_bf16_f32 v40, v32, v33
  v_cvt_pk_bf16_f32 v41, v34, v35
  v_cvt_pk_bf16_f32 v42, v36, v37
  v_cvt_pk_bf16_f32 v43, v38, v39
  s_nop 1
  v_permlane16_swap_b32 v40, v42
  v_permlane16_swap_b32 v41, v43
  buffer_store_dwordx4 v[40:43], v23, s[4:7], s46 offen offset:0 sc1
  v_accvgpr_read_b32 v48, a72
  v_accvgpr_read_b32 v49, a73
  v_accvgpr_read_b32 v50, a74
  v_accvgpr_read_b32 v51, a75
  v_accvgpr_read_b32 v52, a76
  v_accvgpr_read_b32 v53, a77
  v_accvgpr_read_b32 v54, a78
  v_accvgpr_read_b32 v55, a79
  v_cvt_pk_bf16_f32 v56, v48, v49
  v_cvt_pk_bf16_f32 v57, v50, v51
  v_cvt_pk_bf16_f32 v58, v52, v53
  v_cvt_pk_bf16_f32 v59, v54, v55
  s_nop 1
  v_permlane16_swap_b32 v56, v58
  v_permlane16_swap_b32 v57, v59
  buffer_store_dwordx4 v[56:59], v23, s[4:7], s46 offen offset:1024 sc1
  s_add_u32 s46, s45, 270336
  v_accvgpr_read_b32 v32, a80
  v_accvgpr_read_b32 v33, a81
  v_accvgpr_read_b32 v34, a82
  v_accvgpr_read_b32 v35, a83
  v_accvgpr_read_b32 v36, a84
  v_accvgpr_read_b32 v37, a85
  v_accvgpr_read_b32 v38, a86
  v_accvgpr_read_b32 v39, a87
  v_cvt_pk_bf16_f32 v40, v32, v33
  v_cvt_pk_bf16_f32 v41, v34, v35
  v_cvt_pk_bf16_f32 v42, v36, v37
  v_cvt_pk_bf16_f32 v43, v38, v39
  s_nop 1
  v_permlane16_swap_b32 v40, v42
  v_permlane16_swap_b32 v41, v43
  buffer_store_dwordx4 v[40:43], v23, s[4:7], s46 offen offset:0 sc1
  v_accvgpr_read_b32 v48, a88
  v_accvgpr_read_b32 v49, a89
  v_accvgpr_read_b32 v50, a90
  v_accvgpr_read_b32 v51, a91
  v_accvgpr_read_b32 v52, a92
  v_accvgpr_read_b32 v53, a93
  v_accvgpr_read_b32 v54, a94
  v_accvgpr_read_b32 v55, a95
  v_cvt_pk_bf16_f32 v56, v48, v49
  v_cvt_pk_bf16_f32 v57, v50, v51
  v_cvt_pk_bf16_f32 v58, v52, v53
  v_cvt_pk_bf16_f32 v59, v54, v55
  s_nop 1
  v_permlane16_swap_b32 v56, v58
  v_permlane16_swap_b32 v57, v59
  buffer_store_dwordx4 v[56:59], v23, s[4:7], s46 offen offset:1024 sc1
  s_add_u32 s46, s45, 266240
  v_accvgpr_read_b32 v32, a96
  v_accvgpr_read_b32 v33, a97
  v_accvgpr_read_b32 v34, a98
  v_accvgpr_read_b32 v35, a99
  v_accvgpr_read_b32 v36, a100
  v_accvgpr_read_b32 v37, a101
  v_accvgpr_read_b32 v38, a102
  v_accvgpr_read_b32 v39, a103
  v_cvt_pk_bf16_f32 v40, v32, v33
  v_cvt_pk_bf16_f32 v41, v34, v35
  v_cvt_pk_bf16_f32 v42, v36, v37
  v_cvt_pk_bf16_f32 v43, v38, v39
  s_nop 1
  v_permlane16_swap_b32 v40, v42
  v_permlane16_swap_b32 v41, v43
  buffer_store_dwordx4 v[40:43], v23, s[4:7], s46 offen offset:0 sc1
  v_accvgpr_read_b32 v48, a104
  v_accvgpr_read_b32 v49, a105
  v_accvgpr_read_b32 v50, a106
  v_accvgpr_read_b32 v51, a107
  v_accvgpr_read_b32 v52, a108
  v_accvgpr_read_b32 v53, a109
  v_accvgpr_read_b32 v54, a110
  v_accvgpr_read_b32 v55, a111
  v_cvt_pk_bf16_f32 v56, v48, v49
  v_cvt_pk_bf16_f32 v57, v50, v51
  v_cvt_pk_bf16_f32 v58, v52, v53
  v_cvt_pk_bf16_f32 v59, v54, v55
  s_nop 1
  v_permlane16_swap_b32 v56, v58
  v_permlane16_swap_b32 v57, v59
  buffer_store_dwordx4 v[56:59], v23, s[4:7], s46 offen offset:1024 sc1
  s_add_u32 s46, s45, 274432
  v_accvgpr_read_b32 v32, a112
  v_accvgpr_read_b32 v33, a113
  v_accvgpr_read_b32 v34, a114
  v_accvgpr_read_b32 v35, a115
  v_accvgpr_read_b32 v36, a116
  v_accvgpr_read_b32 v37, a117
  v_accvgpr_read_b32 v38, a118
  v_accvgpr_read_b32 v39, a119
  v_cvt_pk_bf16_f32 v40, v32, v33
  v_cvt_pk_bf16_f32 v41, v34, v35
  v_cvt_pk_bf16_f32 v42, v36, v37
  v_cvt_pk_bf16_f32 v43, v38, v39
  s_nop 1
  v_permlane16_swap_b32 v40, v42
  v_permlane16_swap_b32 v41, v43
  buffer_store_dwordx4 v[40:43], v23, s[4:7], s46 offen offset:0 sc1
  v_accvgpr_read_b32 v48, a120
  v_accvgpr_read_b32 v49, a121
  v_accvgpr_read_b32 v50, a122
  v_accvgpr_read_b32 v51, a123
  v_accvgpr_read_b32 v52, a124
  v_accvgpr_read_b32 v53, a125
  v_accvgpr_read_b32 v54, a126
  v_accvgpr_read_b32 v55, a127
  v_cvt_pk_bf16_f32 v56, v48, v49
  v_cvt_pk_bf16_f32 v57, v50, v51
  v_cvt_pk_bf16_f32 v58, v52, v53
  v_cvt_pk_bf16_f32 v59, v54, v55
  s_nop 1
  v_permlane16_swap_b32 v56, v58
  v_permlane16_swap_b32 v57, v59
  buffer_store_dwordx4 v[56:59], v23, s[4:7], s46 offen offset:1024 sc1
  s_add_u32 s46, s45, 524288
  v_accvgpr_read_b32 v32, a128
  v_accvgpr_read_b32 v33, a129
  v_accvgpr_read_b32 v34, a130
  v_accvgpr_read_b32 v35, a131
  v_accvgpr_read_b32 v36, a132
  v_accvgpr_read_b32 v37, a133
  v_accvgpr_read_b32 v38, a134
  v_accvgpr_read_b32 v39, a135
  v_cvt_pk_bf16_f32 v40, v32, v33
  v_cvt_pk_bf16_f32 v41, v34, v35
  v_cvt_pk_bf16_f32 v42, v36, v37
  v_cvt_pk_bf16_f32 v43, v38, v39
  s_nop 1
  v_permlane16_swap_b32 v40, v42
  v_permlane16_swap_b32 v41, v43
  buffer_store_dwordx4 v[40:43], v23, s[4:7], s46 offen offset:0 sc1
  v_accvgpr_read_b32 v48, a136
  v_accvgpr_read_b32 v49, a137
  v_accvgpr_read_b32 v50, a138
  v_accvgpr_read_b32 v51, a139
  v_accvgpr_read_b32 v52, a140
  v_accvgpr_read_b32 v53, a141
  v_accvgpr_read_b32 v54, a142
  v_accvgpr_read_b32 v55, a143
  v_cvt_pk_bf16_f32 v56, v48, v49
  v_cvt_pk_bf16_f32 v57, v50, v51
  v_cvt_pk_bf16_f32 v58, v52, v53
  v_cvt_pk_bf16_f32 v59, v54, v55
  s_nop 1
  v_permlane16_swap_b32 v56, v58
  v_permlane16_swap_b32 v57, v59
  buffer_store_dwordx4 v[56:59], v23, s[4:7], s46 offen offset:1024 sc1
  s_add_u32 s46, s45, 532480
  v_accvgpr_read_b32 v32, a144
  v_accvgpr_read_b32 v33, a145
  v_accvgpr_read_b32 v34, a146
  v_accvgpr_read_b32 v35, a147
  v_accvgpr_read_b32 v36, a148
  v_accvgpr_read_b32 v37, a149
  v_accvgpr_read_b32 v38, a150
  v_accvgpr_read_b32 v39, a151
  v_cvt_pk_bf16_f32 v40, v32, v33
  v_cvt_pk_bf16_f32 v41, v34, v35
  v_cvt_pk_bf16_f32 v42, v36, v37
  v_cvt_pk_bf16_f32 v43, v38, v39
  s_nop 1
  v_permlane16_swap_b32 v40, v42
  v_permlane16_swap_b32 v41, v43
  buffer_store_dwordx4 v[40:43], v23, s[4:7], s46 offen offset:0 sc1
  v_accvgpr_read_b32 v48, a152
  v_accvgpr_read_b32 v49, a153
  v_accvgpr_read_b32 v50, a154
  v_accvgpr_read_b32 v51, a155
  v_accvgpr_read_b32 v52, a156
  v_accvgpr_read_b32 v53, a157
  v_accvgpr_read_b32 v54, a158
  v_accvgpr_read_b32 v55, a159
  v_cvt_pk_bf16_f32 v56, v48, v49
  v_cvt_pk_bf16_f32 v57, v50, v51
  v_cvt_pk_bf16_f32 v58, v52, v53
  v_cvt_pk_bf16_f32 v59, v54, v55
  s_nop 1
  v_permlane16_swap_b32 v56, v58
  v_permlane16_swap_b32 v57, v59
  buffer_store_dwordx4 v[56:59], v23, s[4:7], s46 offen offset:1024 sc1
  s_add_u32 s46, s45, 528384
  v_accvgpr_read_b32 v32, a160
  v_accvgpr_read_b32 v33, a161
  v_accvgpr_read_b32 v34, a162
  v_accvgpr_read_b32 v35, a163
  v_accvgpr_read_b32 v36, a164
  v_accvgpr_read_b32 v37, a165
  v_accvgpr_read_b32 v38, a166
  v_accvgpr_read_b32 v39, a167
  v_cvt_pk_bf16_f32 v40, v32, v33
  v_cvt_pk_bf16_f32 v41, v34, v35
  v_cvt_pk_bf16_f32 v42, v36, v37
  v_cvt_pk_bf16_f32 v43, v38, v39
  s_nop 1
  v_permlane16_swap_b32 v40, v42
  v_permlane16_swap_b32 v41, v43
  buffer_store_dwordx4 v[40:43], v23, s[4:7], s46 offen offset:0 sc1
  v_accvgpr_read_b32 v48, a168
  v_accvgpr_read_b32 v49, a169
  v_accvgpr_read_b32 v50, a170
  v_accvgpr_read_b32 v51, a171
  v_accvgpr_read_b32 v52, a172
  v_accvgpr_read_b32 v53, a173
  v_accvgpr_read_b32 v54, a174
  v_accvgpr_read_b32 v55, a175
  v_cvt_pk_bf16_f32 v56, v48, v49
  v_cvt_pk_bf16_f32 v57, v50, v51
  v_cvt_pk_bf16_f32 v58, v52, v53
  v_cvt_pk_bf16_f32 v59, v54, v55
  s_nop 1
  v_permlane16_swap_b32 v56, v58
  v_permlane16_swap_b32 v57, v59
  buffer_store_dwordx4 v[56:59], v23, s[4:7], s46 offen offset:1024 sc1
  s_add_u32 s46, s45, 536576
  v_accvgpr_read_b32 v32, a176
  v_accvgpr_read_b32 v33, a177
  v_accvgpr_read_b32 v34, a178
  v_accvgpr_read_b32 v35, a179
  v_accvgpr_read_b32 v36, a180
  v_accvgpr_read_b32 v37, a181
  v_accvgpr_read_b32 v38, a182
  v_accvgpr_read_b32 v39, a183
  v_cvt_pk_bf16_f32 v40, v32, v33
  v_cvt_pk_bf16_f32 v41, v34, v35
  v_cvt_pk_bf16_f32 v42, v36, v37
  v_cvt_pk_bf16_f32 v43, v38, v39
  s_nop 1
  v_permlane16_swap_b32 v40, v42
  v_permlane16_swap_b32 v41, v43
  buffer_store_dwordx4 v[40:43], v23, s[4:7], s46 offen offset:0 sc1
  v_accvgpr_read_b32 v48, a184
  v_accvgpr_read_b32 v49, a185
  v_accvgpr_read_b32 v50, a186
  v_accvgpr_read_b32 v51, a187
  v_accvgpr_read_b32 v52, a188
  v_accvgpr_read_b32 v53, a189
  v_accvgpr_read_b32 v54, a190
  v_accvgpr_read_b32 v55, a191
  v_cvt_pk_bf16_f32 v56, v48, v49
  v_cvt_pk_bf16_f32 v57, v50, v51
  v_cvt_pk_bf16_f32 v58, v52, v53
  v_cvt_pk_bf16_f32 v59, v54, v55
  s_nop 1
  v_permlane16_swap_b32 v56, v58
  v_permlane16_swap_b32 v57, v59
  buffer_store_dwordx4 v[56:59], v23, s[4:7], s46 offen offset:1024 sc1
  s_add_u32 s46, s45, 786432
  v_accvgpr_read_b32 v32, a192
  v_accvgpr_read_b32 v33, a193
  v_accvgpr_read_b32 v34, a194
  v_accvgpr_read_b32 v35, a195
  v_accvgpr_read_b32 v36, a196
  v_accvgpr_read_b32 v37, a197
  v_accvgpr_read_b32 v38, a198
  v_accvgpr_read_b32 v39, a199
  v_cvt_pk_bf16_f32 v40, v32, v33
  v_cvt_pk_bf16_f32 v41, v34, v35
  v_cvt_pk_bf16_f32 v42, v36, v37
  v_cvt_pk_bf16_f32 v43, v38, v39
  s_nop 1
  v_permlane16_swap_b32 v40, v42
  v_permlane16_swap_b32 v41, v43
  buffer_store_dwordx4 v[40:43], v23, s[4:7], s46 offen offset:0 sc1
  v_accvgpr_read_b32 v48, a200
  v_accvgpr_read_b32 v49, a201
  v_accvgpr_read_b32 v50, a202
  v_accvgpr_read_b32 v51, a203
  v_accvgpr_read_b32 v52, a204
  v_accvgpr_read_b32 v53, a205
  v_accvgpr_read_b32 v54, a206
  v_accvgpr_read_b32 v55, a207
  v_cvt_pk_bf16_f32 v56, v48, v49
  v_cvt_pk_bf16_f32 v57, v50, v51
  v_cvt_pk_bf16_f32 v58, v52, v53
  v_cvt_pk_bf16_f32 v59, v54, v55
  s_nop 1
  v_permlane16_swap_b32 v56, v58
  v_permlane16_swap_b32 v57, v59
  buffer_store_dwordx4 v[56:59], v23, s[4:7], s46 offen offset:1024 sc1
  s_add_u32 s46, s45, 794624
  v_accvgpr_read_b32 v32, a208
  v_accvgpr_read_b32 v33, a209
  v_accvgpr_read_b32 v34, a210
  v_accvgpr_read_b32 v35, a211
  v_accvgpr_read_b32 v36, a212
  v_accvgpr_read_b32 v37, a213
  v_accvgpr_read_b32 v38, a214
  v_accvgpr_read_b32 v39, a215
  v_cvt_pk_bf16_f32 v40, v32, v33
  v_cvt_pk_bf16_f32 v41, v34, v35
  v_cvt_pk_bf16_f32 v42, v36, v37
  v_cvt_pk_bf16_f32 v43, v38, v39
  s_nop 1
  v_permlane16_swap_b32 v40, v42
  v_permlane16_swap_b32 v41, v43
  buffer_store_dwordx4 v[40:43], v23, s[4:7], s46 offen offset:0 sc1
  v_accvgpr_read_b32 v48, a216
  v_accvgpr_read_b32 v49, a217
  v_accvgpr_read_b32 v50, a218
  v_accvgpr_read_b32 v51, a219
  v_accvgpr_read_b32 v52, a220
  v_accvgpr_read_b32 v53, a221
  v_accvgpr_read_b32 v54, a222
  v_accvgpr_read_b32 v55, a223
  v_cvt_pk_bf16_f32 v56, v48, v49
  v_cvt_pk_bf16_f32 v57, v50, v51
  v_cvt_pk_bf16_f32 v58, v52, v53
  v_cvt_pk_bf16_f32 v59, v54, v55
  s_nop 1
  v_permlane16_swap_b32 v56, v58
  v_permlane16_swap_b32 v57, v59
  buffer_store_dwordx4 v[56:59], v23, s[4:7], s46 offen offset:1024 sc1
  s_add_u32 s46, s45, 790528
  v_accvgpr_read_b32 v32, a224
  v_accvgpr_read_b32 v33, a225
  v_accvgpr_read_b32 v34, a226
  v_accvgpr_read_b32 v35, a227
  v_accvgpr_read_b32 v36, a228
  v_accvgpr_read_b32 v37, a229
  v_accvgpr_read_b32 v38, a230
  v_accvgpr_read_b32 v39, a231
  v_cvt_pk_bf16_f32 v40, v32, v33
  v_cvt_pk_bf16_f32 v41, v34, v35
  v_cvt_pk_bf16_f32 v42, v36, v37
  v_cvt_pk_bf16_f32 v43, v38, v39
  s_nop 1
  v_permlane16_swap_b32 v40, v42
  v_permlane16_swap_b32 v41, v43
  buffer_store_dwordx4 v[40:43], v23, s[4:7], s46 offen offset:0 sc1
  v_accvgpr_read_b32 v48, a232
  v_accvgpr_read_b32 v49, a233
  v_accvgpr_read_b32 v50, a234
  v_accvgpr_read_b32 v51, a235
  v_accvgpr_read_b32 v52, a236
  v_accvgpr_read_b32 v53, a237
  v_accvgpr_read_b32 v54, a238
  v_accvgpr_read_b32 v55, a239
  v_cvt_pk_bf16_f32 v56, v48, v49
  v_cvt_pk_bf16_f32 v57, v50, v51
  v_cvt_pk_bf16_f32 v58, v52, v53
  v_cvt_pk_bf16_f32 v59, v54, v55
  s_nop 1
  v_permlane16_swap_b32 v56, v58
  v_permlane16_swap_b32 v57, v59
  buffer_store_dwordx4 v[56:59], v23, s[4:7], s46 offen offset:1024 sc1
  s_add_u32 s46, s45, 798720
  v_accvgpr_read_b32 v32, a240
  v_accvgpr_read_b32 v33, a241
  v_accvgpr_read_b32 v34, a242
  v_accvgpr_read_b32 v35, a243
  v_accvgpr_read_b32 v36, a244
  v_accvgpr_read_b32 v37, a245
  v_accvgpr_read_b32 v38, a246
  v_accvgpr_read_b32 v39, a247
  v_cvt_pk_bf16_f32 v40, v32, v33
  v_cvt_pk_bf16_f32 v41, v34, v35
  v_cvt_pk_bf16_f32 v42, v36, v37
  v_cvt_pk_bf16_f32 v43, v38, v39
  s_nop 1
  v_permlane16_swap_b32 v40, v42
  v_permlane16_swap_b32 v41, v43
  buffer_store_dwordx4 v[40:43], v23, s[4:7], s46 offen offset:0 sc1
  v_accvgpr_read_b32 v48, a248
  v_accvgpr_read_b32 v49, a249
  v_accvgpr_read_b32 v50, a250
  v_accvgpr_read_b32 v51, a251
  v_accvgpr_read_b32 v52, a252
  v_accvgpr_read_b32 v53, a253
  v_accvgpr_read_b32 v54, a254
  v_accvgpr_read_b32 v55, a255
  v_cvt_pk_bf16_f32 v56, v48, v49
  v_cvt_pk_bf16_f32 v57, v50, v51
  v_cvt_pk_bf16_f32 v58, v52, v53
  v_cvt_pk_bf16_f32 v59, v54, v55
  s_nop 1
  v_permlane16_swap_b32 v56, v58
  v_permlane16_swap_b32 v57, v59
  buffer_store_dwordx4 v[56:59], v23, s[4:7], s46 offen offset:1024 sc1
  s_xor_b32 s79, s79, 4
  s_mov_b32 s76, s35
  s_cmp_lg_u32 s27, 0
  s_cbranch_scc1 L_next_b
  v_mov_b32 v1, s79
  s_mov_b64 exec, 1
  s_waitcnt vmcnt(32)
  ds_write_b32 v1, v253
  s_waitcnt lgkmcnt(0)
  s_mov_b64 exec, -1
  s_branch L_next_b
G_egu:
  v_and_b32 v20, 63, v0
  v_and_b32 v21, 15, v20
  v_bfe_u32 v22, v20, 4, 1
  v_bfe_u32 v24, v20, 5, 1
  v_lshlrev_b32 v23, 6, v21
  v_lshl_add_u32 v23, v22, 5, v23
  v_lshl_add_u32 v23, v24, 4, v23
  s_lshr_b32 s40, s27, 1
  s_and_b32 s41, s27, 1
  s_lshl_b32 s42, s28, 14
  s_lshl_b32 s43, s40, 13
  s_add_u32 s42, s42, s43
  s_lshl_b32 s43, s29, 19
  s_add_u32 s42, s42, s43
  s_lshl_b32 s43, s41, 18
  s_add_u32 s42, s42, s43
  s_add_u32 s45, s42, 75497472
  s_add_u32 s46, s45, 0x20000
  v_accvgpr_read_b32 v32, a0
  v_accvgpr_read_b32 v40, a16
  v_accvgpr_read_b32 v33, a1
  v_accvgpr_read_b32 v41, a17
  v_accvgpr_read_b32 v34, a2
  v_accvgpr_read_b32 v42, a18
  v_accvgpr_read_b32 v35, a3
  v_accvgpr_read_b32 v43, a19
  v_accvgpr_read_b32 v36, a4
  v_accvgpr_read_b32 v44, a20
  v_accvgpr_read_b32 v37, a5
  v_accvgpr_read_b32 v45, a21
  v_accvgpr_read_b32 v38, a6
  v_accvgpr_read_b32 v46, a22
  v_accvgpr_read_b32 v39, a7
  v_accvgpr_read_b32 v47, a23
  v_max_f32 v32, 0, v32
  v_max_f32 v33, 0, v33
  v_max_f32 v34, 0, v34
  v_max_f32 v35, 0, v35
  v_max_f32 v36, 0, v36
  v_max_f32 v37, 0, v37
  v_max_f32 v38, 0, v38
  v_max_f32 v39, 0, v39
  v_mul_f32 v32, v32, v40
  v_mul_f32 v33, v33, v41
  v_mul_f32 v34, v34, v42
  v_mul_f32 v35, v35, v43
  v_mul_f32 v36, v36, v44
  v_mul_f32 v37, v37, v45
  v_mul_f32 v38, v38, v46
  v_mul_f32 v39, v39, v47
  v_cvt_pk_bf16_f32 v48, v32, v33
  v_cvt_pk_bf16_f32 v49, v34, v35
  v_cvt_pk_bf16_f32 v50, v36, v37
  v_cvt_pk_bf16_f32 v51, v38, v39
  s_nop 1
  v_permlane16_swap_b32 v48, v50
  v_permlane16_swap_b32 v49, v51
  buffer_store_dwordx4 v[48:51], v23, s[4:7], s45 offen offset:0 sc1
  v_accvgpr_read_b32 v56, a8
  v_accvgpr_read_b32 v64, a24
  v_accvgpr_read_b32 v57, a9
  v_accvgpr_read_b32 v65, a25
  v_accvgpr_read_b32 v58, a10
  v_accvgpr_read_b32 v66, a26
  v_accvgpr_read_b32 v59, a11
  v_accvgpr_read_b32 v67, a27
  v_accvgpr_read_b32 v60, a12
  v_accvgpr_read_b32 v68, a28
  v_accvgpr_read_b32 v61, a13
  v_accvgpr_read_b32 v69, a29
  v_accvgpr_read_b32 v62, a14
  v_accvgpr_read_b32 v70, a30
  v_accvgpr_read_b32 v63, a15
  v_accvgpr_read_b32 v71, a31
  v_max_f32 v56, 0, v56
  v_max_f32 v57, 0, v57
  v_max_f32 v58, 0, v58
  v_max_f32 v59, 0, v59
  v_max_f32 v60, 0, v60
  v_max_f32 v61, 0, v61
  v_max_f32 v62, 0, v62
  v_max_f32 v63, 0, v63
  v_mul_f32 v56, v56, v64
  v_mul_f32 v57, v57, v65
  v_mul_f32 v58, v58, v66
  v_mul_f32 v59, v59, v67
  v_mul_f32 v60, v60, v68
  v_mul_f32 v61, v61, v69
  v_mul_f32 v62, v62, v70
  v_mul_f32 v63, v63, v71
  v_cvt_pk_bf16_f32 v72, v56, v57
  v_cvt_pk_bf16_f32 v73, v58, v59
  v_cvt_pk_bf16_f32 v74, v60, v61
  v_cvt_pk_bf16_f32 v75, v62, v63
  s_nop 1
  v_permlane16_swap_b32 v72, v74
  v_permlane16_swap_b32 v73, v75
  buffer_store_dwordx4 v[72:75], v23, s[4:7], s46 offen offset:0 sc1
  v_accvgpr_read_b32 v32, a32
  v_accvgpr_read_b32 v40, a48
  v_accvgpr_read_b32 v33, a33
  v_accvgpr_read_b32 v41, a49
  v_accvgpr_read_b32 v34, a34
  v_accvgpr_read_b32 v42, a50
  v_accvgpr_read_b32 v35, a35
  v_accvgpr_read_b32 v43, a51
  v_accvgpr_read_b32 v36, a36
  v_accvgpr_read_b32 v44, a52
  v_accvgpr_read_b32 v37, a37
  v_accvgpr_read_b32 v45, a53
  v_accvgpr_read_b32 v38, a38
  v_accvgpr_read_b32 v46, a54
  v_accvgpr_read_b32 v39, a39
  v_accvgpr_read_b32 v47, a55
  v_max_f32 v32, 0, v32
  v_max_f32 v33, 0, v33
  v_max_f32 v34, 0, v34
  v_max_f32 v35, 0, v35
  v_max_f32 v36, 0, v36
  v_max_f32 v37, 0, v37
  v_max_f32 v38, 0, v38
  v_max_f32 v39, 0, v39
  v_mul_f32 v32, v32, v40
  v_mul_f32 v33, v33, v41
  v_mul_f32 v34, v34, v42
  v_mul_f32 v35, v35, v43
  v_mul_f32 v36, v36, v44
  v_mul_f32 v37, v37, v45
  v_mul_f32 v38, v38, v46
  v_mul_f32 v39, v39, v47
  v_cvt_pk_bf16_f32 v48, v32, v33
  v_cvt_pk_bf16_f32 v49, v34, v35
  v_cvt_pk_bf16_f32 v50, v36, v37
  v_cvt_pk_bf16_f32 v51, v38, v39
  s_nop 1
  v_permlane16_swap_b32 v48, v50
  v_permlane16_swap_b32 v49, v51
  buffer_store_dwordx4 v[48:51], v23, s[4:7], s45 offen offset:1024 sc1
  v_accvgpr_read_b32 v56, a40
  v_accvgpr_read_b32 v64, a56
  v_accvgpr_read_b32 v57, a41
  v_accvgpr_read_b32 v65, a57
  v_accvgpr_read_b32 v58, a42
  v_accvgpr_read_b32 v66, a58
  v_accvgpr_read_b32 v59, a43
  v_accvgpr_read_b32 v67, a59
  v_accvgpr_read_b32 v60, a44
  v_accvgpr_read_b32 v68, a60
  v_accvgpr_read_b32 v61, a45
  v_accvgpr_read_b32 v69, a61
  v_accvgpr_read_b32 v62, a46
  v_accvgpr_read_b32 v70, a62
  v_accvgpr_read_b32 v63, a47
  v_accvgpr_read_b32 v71, a63
  v_max_f32 v56, 0, v56
  v_max_f32 v57, 0, v57
  v_max_f32 v58, 0, v58
  v_max_f32 v59, 0, v59
  v_max_f32 v60, 0, v60
  v_max_f32 v61, 0, v61
  v_max_f32 v62, 0, v62
  v_max_f32 v63, 0, v63
  v_mul_f32 v56, v56, v64
  v_mul_f32 v57, v57, v65
  v_mul_f32 v58, v58, v66
  v_mul_f32 v59, v59, v67
  v_mul_f32 v60, v60, v68
  v_mul_f32 v61, v61, v69
  v_mul_f32 v62, v62, v70
  v_mul_f32 v63, v63, v71
  v_cvt_pk_bf16_f32 v72, v56, v57
  v_cvt_pk_bf16_f32 v73, v58, v59
  v_cvt_pk_bf16_f32 v74, v60, v61
  v_cvt_pk_bf16_f32 v75, v62, v63
  s_nop 1
  v_permlane16_swap_b32 v72, v74
  v_permlane16_swap_b32 v73, v75
  buffer_store_dwordx4 v[72:75], v23, s[4:7], s46 offen offset:1024 sc1
  v_accvgpr_read_b32 v32, a64
  v_accvgpr_read_b32 v40, a80
  v_accvgpr_read_b32 v33, a65
  v_accvgpr_read_b32 v41, a81
  v_accvgpr_read_b32 v34, a66
  v_accvgpr_read_b32 v42, a82
  v_accvgpr_read_b32 v35, a67
  v_accvgpr_read_b32 v43, a83
  v_accvgpr_read_b32 v36, a68
  v_accvgpr_read_b32 v44, a84
  v_accvgpr_read_b32 v37, a69
  v_accvgpr_read_b32 v45, a85
  v_accvgpr_read_b32 v38, a70
  v_accvgpr_read_b32 v46, a86
  v_accvgpr_read_b32 v39, a71
  v_accvgpr_read_b32 v47, a87
  v_max_f32 v32, 0, v32
  v_max_f32 v33, 0, v33
  v_max_f32 v34, 0, v34
  v_max_f32 v35, 0, v35
  v_max_f32 v36, 0, v36
  v_max_f32 v37, 0, v37
  v_max_f32 v38, 0, v38
  v_max_f32 v39, 0, v39
  v_mul_f32 v32, v32, v40
  v_mul_f32 v33, v33, v41
  v_mul_f32 v34, v34, v42
  v_mul_f32 v35, v35, v43
  v_mul_f32 v36, v36, v44
  v_mul_f32 v37, v37, v45
  v_mul_f32 v38, v38, v46
  v_mul_f32 v39, v39, v47
  v_cvt_pk_bf16_f32 v48, v32, v33
  v_cvt_pk_bf16_f32 v49, v34, v35
  v_cvt_pk_bf16_f32 v50, v36, v37
  v_cvt_pk_bf16_f32 v51, v38, v39
  s_nop 1
  v_permlane16_swap_b32 v48, v50
  v_permlane16_swap_b32 v49, v51
  buffer_store_dwordx4 v[48:51], v23, s[4:7], s45 offen offset:2048 sc1
  v_accvgpr_read_b32 v56, a72
  v_accvgpr_read_b32 v64, a88
  v_accvgpr_read_b32 v57, a73
  v_accvgpr_read_b32 v65, a89
  v_accvgpr_read_b32 v58, a74
  v_accvgpr_read_b32 v66, a90
  v_accvgpr_read_b32 v59, a75
  v_accvgpr_read_b32 v67, a91
  v_accvgpr_read_b32 v60, a76
  v_accvgpr_read_b32 v68, a92
  v_accvgpr_read_b32 v61, a77
  v_accvgpr_read_b32 v69, a93
  v_accvgpr_read_b32 v62, a78
  v_accvgpr_read_b32 v70, a94
  v_accvgpr_read_b32 v63, a79
  v_accvgpr_read_b32 v71, a95
  v_max_f32 v56, 0, v56
  v_max_f32 v57, 0, v57
  v_max_f32 v58, 0, v58
  v_max_f32 v59, 0, v59
  v_max_f32 v60, 0, v60
  v_max_f32 v61, 0, v61
  v_max_f32 v62, 0, v62
  v_max_f32 v63, 0, v63
  v_mul_f32 v56, v56, v64
  v_mul_f32 v57, v57, v65
  v_mul_f32 v58, v58, v66
  v_mul_f32 v59, v59, v67
  v_mul_f32 v60, v60, v68
  v_mul_f32 v61, v61, v69
  v_mul_f32 v62, v62, v70
  v_mul_f32 v63, v63, v71
  v_cvt_pk_bf16_f32 v72, v56, v57
  v_cvt_pk_bf16_f32 v73, v58, v59
  v_cvt_pk_bf16_f32 v74, v60, v61
  v_cvt_pk_bf16_f32 v75, v62, v63
  s_nop 1
  v_permlane16_swap_b32 v72, v74
  v_permlane16_swap_b32 v73, v75
  buffer_store_dwordx4 v[72:75], v23, s[4:7], s46 offen offset:2048 sc1
  v_accvgpr_read_b32 v32, a96
  v_accvgpr_read_b32 v40, a112
  v_accvgpr_read_b32 v33, a97
  v_accvgpr_read_b32 v41, a113
  v_accvgpr_read_b32 v34, a98
  v_accvgpr_read_b32 v42, a114
  v_accvgpr_read_b32 v35, a99
  v_accvgpr_read_b32 v43, a115
  v_accvgpr_read_b32 v36, a100
  v_accvgpr_read_b32 v44, a116
  v_accvgpr_read_b32 v37, a101
  v_accvgpr_read_b32 v45, a117
  v_accvgpr_read_b32 v38, a102
  v_accvgpr_read_b32 v46, a118
  v_accvgpr_read_b32 v39, a103
  v_accvgpr_read_b32 v47, a119
  v_max_f32 v32, 0, v32
  v_max_f32 v33, 0, v33
  v_max_f32 v34, 0, v34
  v_max_f32 v35, 0, v35
  v_max_f32 v36, 0, v36
  v_max_f32 v37, 0, v37
  v_max_f32 v38, 0, v38
  v_max_f32 v39, 0, v39
  v_mul_f32 v32, v32, v40
  v_mul_f32 v33, v33, v41
  v_mul_f32 v34, v34, v42
  v_mul_f32 v35, v35, v43
  v_mul_f32 v36, v36, v44
  v_mul_f32 v37, v37, v45
  v_mul_f32 v38, v38, v46
  v_mul_f32 v39, v39, v47
  v_cvt_pk_bf16_f32 v48, v32, v33
  v_cvt_pk_bf16_f32 v49, v34, v35
  v_cvt_pk_bf16_f32 v50, v36, v37
  v_cvt_pk_bf16_f32 v51, v38, v39
  s_nop 1
  v_permlane16_swap_b32 v48, v50
  v_permlane16_swap_b32 v49, v51
  buffer_store_dwordx4 v[48:51], v23, s[4:7], s45 offen offset:3072 sc1
  v_accvgpr_read_b32 v56, a104
  v_accvgpr_read_b32 v64, a120
  v_accvgpr_read_b32 v57, a105
  v_accvgpr_read_b32 v65, a121
  v_accvgpr_read_b32 v58, a106
  v_accvgpr_read_b32 v66, a122
  v_accvgpr_read_b32 v59, a107
  v_accvgpr_read_b32 v67, a123
  v_accvgpr_read_b32 v60, a108
  v_accvgpr_read_b32 v68, a124
  v_accvgpr_read_b32 v61, a109
  v_accvgpr_read_b32 v69, a125
  v_accvgpr_read_b32 v62, a110
  v_accvgpr_read_b32 v70, a126
  v_accvgpr_read_b32 v63, a111
  v_accvgpr_read_b32 v71, a127
  v_max_f32 v56, 0, v56
  v_max_f32 v57, 0, v57
  v_max_f32 v58, 0, v58
  v_max_f32 v59, 0, v59
  v_max_f32 v60, 0, v60
  v_max_f32 v61, 0, v61
  v_max_f32 v62, 0, v62
  v_max_f32 v63, 0, v63
  v_mul_f32 v56, v56, v64
  v_mul_f32 v57, v57, v65
  v_mul_f32 v58, v58, v66
  v_mul_f32 v59, v59, v67
  v_mul_f32 v60, v60, v68
  v_mul_f32 v61, v61, v69
  v_mul_f32 v62, v62, v70
  v_mul_f32 v63, v63, v71
  v_cvt_pk_bf16_f32 v72, v56, v57
  v_cvt_pk_bf16_f32 v73, v58, v59
  v_cvt_pk_bf16_f32 v74, v60, v61
  v_cvt_pk_bf16_f32 v75, v62, v63
  s_nop 1
  v_permlane16_swap_b32 v72, v74
  v_permlane16_swap_b32 v73, v75
  buffer_store_dwordx4 v[72:75], v23, s[4:7], s46 offen offset:3072 sc1
  s_add_u32 s45, s45, 4096
  s_add_u32 s46, s46, 4096
  v_accvgpr_read_b32 v32, a128
  v_accvgpr_read_b32 v40, a144
  v_accvgpr_read_b32 v33, a129
  v_accvgpr_read_b32 v41, a145
  v_accvgpr_read_b32 v34, a130
  v_accvgpr_read_b32 v42, a146
  v_accvgpr_read_b32 v35, a131
  v_accvgpr_read_b32 v43, a147
  v_accvgpr_read_b32 v36, a132
  v_accvgpr_read_b32 v44, a148
  v_accvgpr_read_b32 v37, a133
  v_accvgpr_read_b32 v45, a149
  v_accvgpr_read_b32 v38, a134
  v_accvgpr_read_b32 v46, a150
  v_accvgpr_read_b32 v39, a135
  v_accvgpr_read_b32 v47, a151
  v_max_f32 v32, 0, v32
  v_max_f32 v33, 0, v33
  v_max_f32 v34, 0, v34
  v_max_f32 v35, 0, v35
  v_max_f32 v36, 0, v36
  v_max_f32 v37, 0, v37
  v_max_f32 v38, 0, v38
  v_max_f32 v39, 0, v39
  v_mul_f32 v32, v32, v40
  v_mul_f32 v33, v33, v41
  v_mul_f32 v34, v34, v42
  v_mul_f32 v35, v35, v43
  v_mul_f32 v36, v36, v44
  v_mul_f32 v37, v37, v45
  v_mul_f32 v38, v38, v46
  v_mul_f32 v39, v39, v47
  v_cvt_pk_bf16_f32 v48, v32, v33
  v_cvt_pk_bf16_f32 v49, v34, v35
  v_cvt_pk_bf16_f32 v50, v36, v37
  v_cvt_pk_bf16_f32 v51, v38, v39
  s_nop 1
  v_permlane16_swap_b32 v48, v50
  v_permlane16_swap_b32 v49, v51
  buffer_store_dwordx4 v[48:51], v23, s[4:7], s45 offen offset:0 sc1
  v_accvgpr_read_b32 v56, a136
  v_accvgpr_read_b32 v64, a152
  v_accvgpr_read_b32 v57, a137
  v_accvgpr_read_b32 v65, a153
  v_accvgpr_read_b32 v58, a138
  v_accvgpr_read_b32 v66, a154
  v_accvgpr_read_b32 v59, a139
  v_accvgpr_read_b32 v67, a155
  v_accvgpr_read_b32 v60, a140
  v_accvgpr_read_b32 v68, a156
  v_accvgpr_read_b32 v61, a141
  v_accvgpr_read_b32 v69, a157
  v_accvgpr_read_b32 v62, a142
  v_accvgpr_read_b32 v70, a158
  v_accvgpr_read_b32 v63, a143
  v_accvgpr_read_b32 v71, a159
  v_max_f32 v56, 0, v56
  v_max_f32 v57, 0, v57
  v_max_f32 v58, 0, v58
  v_max_f32 v59, 0, v59
  v_max_f32 v60, 0, v60
  v_max_f32 v61, 0, v61
  v_max_f32 v62, 0, v62
  v_max_f32 v63, 0, v63
  v_mul_f32 v56, v56, v64
  v_mul_f32 v57, v57, v65
  v_mul_f32 v58, v58, v66
  v_mul_f32 v59, v59, v67
  v_mul_f32 v60, v60, v68
  v_mul_f32 v61, v61, v69
  v_mul_f32 v62, v62, v70
  v_mul_f32 v63, v63, v71
  v_cvt_pk_bf16_f32 v72, v56, v57
  v_cvt_pk_bf16_f32 v73, v58, v59
  v_cvt_pk_bf16_f32 v74, v60, v61
  v_cvt_pk_bf16_f32 v75, v62, v63
  s_nop 1
  v_permlane16_swap_b32 v72, v74
  v_permlane16_swap_b32 v73, v75
  buffer_store_dwordx4 v[72:75], v23, s[4:7], s46 offen offset:0 sc1
  v_accvgpr_read_b32 v32, a160
  v_accvgpr_read_b32 v40, a176
  v_accvgpr_read_b32 v33, a161
  v_accvgpr_read_b32 v41, a177
  v_accvgpr_read_b32 v34, a162
  v_accvgpr_read_b32 v42, a178
  v_accvgpr_read_b32 v35, a163
  v_accvgpr_read_b32 v43, a179
  v_accvgpr_read_b32 v36, a164
  v_accvgpr_read_b32 v44, a180
  v_accvgpr_read_b32 v37, a165
  v_accvgpr_read_b32 v45, a181
  v_accvgpr_read_b32 v38, a166
  v_accvgpr_read_b32 v46, a182
  v_accvgpr_read_b32 v39, a167
  v_accvgpr_read_b32 v47, a183
  v_max_f32 v32, 0, v32
  v_max_f32 v33, 0, v33
  v_max_f32 v34, 0, v34
  v_max_f32 v35, 0, v35
  v_max_f32 v36, 0, v36
  v_max_f32 v37, 0, v37
  v_max_f32 v38, 0, v38
  v_max_f32 v39, 0, v39
  v_mul_f32 v32, v32, v40
  v_mul_f32 v33, v33, v41
  v_mul_f32 v34, v34, v42
  v_mul_f32 v35, v35, v43
  v_mul_f32 v36, v36, v44
  v_mul_f32 v37, v37, v45
  v_mul_f32 v38, v38, v46
  v_mul_f32 v39, v39, v47
  v_cvt_pk_bf16_f32 v48, v32, v33
  v_cvt_pk_bf16_f32 v49, v34, v35
  v_cvt_pk_bf16_f32 v50, v36, v37
  v_cvt_pk_bf16_f32 v51, v38, v39
  s_nop 1
  v_permlane16_swap_b32 v48, v50
  v_permlane16_swap_b32 v49, v51
  buffer_store_dwordx4 v[48:51], v23, s[4:7], s45 offen offset:1024 sc1
  v_accvgpr_read_b32 v56, a168
  v_accvgpr_read_b32 v64, a184
  v_accvgpr_read_b32 v57, a169
  v_accvgpr_read_b32 v65, a185
  v_accvgpr_read_b32 v58, a170
  v_accvgpr_read_b32 v66, a186
  v_accvgpr_read_b32 v59, a171
  v_accvgpr_read_b32 v67, a187
  v_accvgpr_read_b32 v60, a172
  v_accvgpr_read_b32 v68, a188
  v_accvgpr_read_b32 v61, a173
  v_accvgpr_read_b32 v69, a189
  v_accvgpr_read_b32 v62, a174
  v_accvgpr_read_b32 v70, a190
  v_accvgpr_read_b32 v63, a175
  v_accvgpr_read_b32 v71, a191
  v_max_f32 v56, 0, v56
  v_max_f32 v57, 0, v57
  v_max_f32 v58, 0, v58
  v_max_f32 v59, 0, v59
  v_max_f32 v60, 0, v60
  v_max_f32 v61, 0, v61
  v_max_f32 v62, 0, v62
  v_max_f32 v63, 0, v63
  v_mul_f32 v56, v56, v64
  v_mul_f32 v57, v57, v65
  v_mul_f32 v58, v58, v66
  v_mul_f32 v59, v59, v67
  v_mul_f32 v60, v60, v68
  v_mul_f32 v61, v61, v69
  v_mul_f32 v62, v62, v70
  v_mul_f32 v63, v63, v71
  v_cvt_pk_bf16_f32 v72, v56, v57
  v_cvt_pk_bf16_f32 v73, v58, v59
  v_cvt_pk_bf16_f32 v74, v60, v61
  v_cvt_pk_bf16_f32 v75, v62, v63
  s_nop 1
  v_permlane16_swap_b32 v72, v74
  v_permlane16_swap_b32 v73, v75
  buffer_store_dwordx4 v[72:75], v23, s[4:7], s46 offen offset:1024 sc1
  v_accvgpr_read_b32 v32, a192
  v_accvgpr_read_b32 v40, a208
  v_accvgpr_read_b32 v33, a193
  v_accvgpr_read_b32 v41, a209
  v_accvgpr_read_b32 v34, a194
  v_accvgpr_read_b32 v42, a210
  v_accvgpr_read_b32 v35, a195
  v_accvgpr_read_b32 v43, a211
  v_accvgpr_read_b32 v36, a196
  v_accvgpr_read_b32 v44, a212
  v_accvgpr_read_b32 v37, a197
  v_accvgpr_read_b32 v45, a213
  v_accvgpr_read_b32 v38, a198
  v_accvgpr_read_b32 v46, a214
  v_accvgpr_read_b32 v39, a199
  v_accvgpr_read_b32 v47, a215
  v_max_f32 v32, 0, v32
  v_max_f32 v33, 0, v33
  v_max_f32 v34, 0, v34
  v_max_f32 v35, 0, v35
  v_max_f32 v36, 0, v36
  v_max_f32 v37, 0, v37
  v_max_f32 v38, 0, v38
  v_max_f32 v39, 0, v39
  v_mul_f32 v32, v32, v40
  v_mul_f32 v33, v33, v41
  v_mul_f32 v34, v34, v42
  v_mul_f32 v35, v35, v43
  v_mul_f32 v36, v36, v44
  v_mul_f32 v37, v37, v45
  v_mul_f32 v38, v38, v46
  v_mul_f32 v39, v39, v47
  v_cvt_pk_bf16_f32 v48, v32, v33
  v_cvt_pk_bf16_f32 v49, v34, v35
  v_cvt_pk_bf16_f32 v50, v36, v37
  v_cvt_pk_bf16_f32 v51, v38, v39
  s_nop 1
  v_permlane16_swap_b32 v48, v50
  v_permlane16_swap_b32 v49, v51
  buffer_store_dwordx4 v[48:51], v23, s[4:7], s45 offen offset:2048 sc1
  v_accvgpr_read_b32 v56, a200
  v_accvgpr_read_b32 v64, a216
  v_accvgpr_read_b32 v57, a201
  v_accvgpr_read_b32 v65, a217
  v_accvgpr_read_b32 v58, a202
  v_accvgpr_read_b32 v66, a218
  v_accvgpr_read_b32 v59, a203
  v_accvgpr_read_b32 v67, a219
  v_accvgpr_read_b32 v60, a204
  v_accvgpr_read_b32 v68, a220
  v_accvgpr_read_b32 v61, a205
  v_accvgpr_read_b32 v69, a221
  v_accvgpr_read_b32 v62, a206
  v_accvgpr_read_b32 v70, a222
  v_accvgpr_read_b32 v63, a207
  v_accvgpr_read_b32 v71, a223
  v_max_f32 v56, 0, v56
  v_max_f32 v57, 0, v57
  v_max_f32 v58, 0, v58
  v_max_f32 v59, 0, v59
  v_max_f32 v60, 0, v60
  v_max_f32 v61, 0, v61
  v_max_f32 v62, 0, v62
  v_max_f32 v63, 0, v63
  v_mul_f32 v56, v56, v64
  v_mul_f32 v57, v57, v65
  v_mul_f32 v58, v58, v66
  v_mul_f32 v59, v59, v67
  v_mul_f32 v60, v60, v68
  v_mul_f32 v61, v61, v69
  v_mul_f32 v62, v62, v70
  v_mul_f32 v63, v63, v71
  v_cvt_pk_bf16_f32 v72, v56, v57
  v_cvt_pk_bf16_f32 v73, v58, v59
  v_cvt_pk_bf16_f32 v74, v60, v61
  v_cvt_pk_bf16_f32 v75, v62, v63
  s_nop 1
  v_permlane16_swap_b32 v72, v74
  v_permlane16_swap_b32 v73, v75
  buffer_store_dwordx4 v[72:75], v23, s[4:7], s46 offen offset:2048 sc1
  v_accvgpr_read_b32 v32, a224
  v_accvgpr_read_b32 v40, a240
  v_accvgpr_read_b32 v33, a225
  v_accvgpr_read_b32 v41, a241
  v_accvgpr_read_b32 v34, a226
  v_accvgpr_read_b32 v42, a242
  v_accvgpr_read_b32 v35, a227
  v_accvgpr_read_b32 v43, a243
  v_accvgpr_read_b32 v36, a228
  v_accvgpr_read_b32 v44, a244
  v_accvgpr_read_b32 v37, a229
  v_accvgpr_read_b32 v45, a245
  v_accvgpr_read_b32 v38, a230
  v_accvgpr_read_b32 v46, a246
  v_accvgpr_read_b32 v39, a231
  v_accvgpr_read_b32 v47, a247
  v_max_f32 v32, 0, v32
  v_max_f32 v33, 0, v33
  v_max_f32 v34, 0, v34
  v_max_f32 v35, 0, v35
  v_max_f32 v36, 0, v36
  v_max_f32 v37, 0, v37
  v_max_f32 v38, 0, v38
  v_max_f32 v39, 0, v39
  v_mul_f32 v32, v32, v40
  v_mul_f32 v33, v33, v41
  v_mul_f32 v34, v34, v42
  v_mul_f32 v35, v35, v43
  v_mul_f32 v36, v36, v44
  v_mul_f32 v37, v37, v45
  v_mul_f32 v38, v38, v46
  v_mul_f32 v39, v39, v47
  v_cvt_pk_bf16_f32 v48, v32, v33
  v_cvt_pk_bf16_f32 v49, v34, v35
  v_cvt_pk_bf16_f32 v50, v36, v37
  v_cvt_pk_bf16_f32 v51, v38, v39
  s_nop 1
  v_permlane16_swap_b32 v48, v50
  v_permlane16_swap_b32 v49, v51
  buffer_store_dwordx4 v[48:51], v23, s[4:7], s45 offen offset:3072 sc1
  v_accvgpr_read_b32 v56, a232
  v_accvgpr_read_b32 v64, a248
  v_accvgpr_read_b32 v57, a233
  v_accvgpr_read_b32 v65, a249
  v_accvgpr_read_b32 v58, a234
  v_accvgpr_read_b32 v66, a250
  v_accvgpr_read_b32 v59, a235
  v_accvgpr_read_b32 v67, a251
  v_accvgpr_read_b32 v60, a236
  v_accvgpr_read_b32 v68, a252
  v_accvgpr_read_b32 v61, a237
  v_accvgpr_read_b32 v69, a253
  v_accvgpr_read_b32 v62, a238
  v_accvgpr_read_b32 v70, a254
  v_accvgpr_read_b32 v63, a239
  v_accvgpr_read_b32 v71, a255
  v_max_f32 v56, 0, v56
  v_max_f32 v57, 0, v57
  v_max_f32 v58, 0, v58
  v_max_f32 v59, 0, v59
  v_max_f32 v60, 0, v60
  v_max_f32 v61, 0, v61
  v_max_f32 v62, 0, v62
  v_max_f32 v63, 0, v63
  v_mul_f32 v56, v56, v64
  v_mul_f32 v57, v57, v65
  v_mul_f32 v58, v58, v66
  v_mul_f32 v59, v59, v67
  v_mul_f32 v60, v60, v68
  v_mul_f32 v61, v61, v69
  v_mul_f32 v62, v62, v70
  v_mul_f32 v63, v63, v71
  v_cvt_pk_bf16_f32 v72, v56, v57
  v_cvt_pk_bf16_f32 v73, v58, v59
  v_cvt_pk_bf16_f32 v74, v60, v61
  v_cvt_pk_bf16_f32 v75, v62, v63
  s_nop 1
  v_permlane16_swap_b32 v72, v74
  v_permlane16_swap_b32 v73, v75
  buffer_store_dwordx4 v[72:75], v23, s[4:7], s46 offen offset:3072 sc1
  s_xor_b32 s79, s79, 4
  s_mov_b32 s76, s35
  s_cmp_lg_u32 s27, 0
  s_cbranch_scc1 L_next_b
  v_mov_b32 v1, s79
  s_mov_b64 exec, 1
  s_waitcnt vmcnt(16)
  ds_write_b32 v1, v253
  s_waitcnt lgkmcnt(0)
  s_mov_b64 exec, -1
  s_branch L_next_b
G_ed:
  v_and_b32 v20, 63, v0
  v_and_b32 v21, 15, v20
  v_bfe_u32 v22, v20, 4, 1
  v_bfe_u32 v24, v20, 5, 1
  s_lshr_b32 s40, s27, 1
  s_and_b32 s41, s27, 1
  s_lshl_b32 s42, s28, 8
  s_lshl_b32 s43, s40, 7
  s_add_u32 s42, s42, s43
  s_mul_i32 s42, s42, 2048
  v_mul_u32_u24 v23, 2048, v21
  v_lshl_add_u32 v23, v22, 5, v23
  v_lshl_add_u32 v23, v24, 4, v23
  s_lshl_b32 s43, s29, 9
  s_add_u32 s42, s42, s43
  s_lshl_b32 s43, s41, 7
  s_add_u32 s42, s42, s43
  s_add_u32 s45, s42, 4194304
  v_accvgpr_read_b32 v32, a0
  v_accvgpr_read_b32 v33, a1
  v_accvgpr_read_b32 v34, a2
  v_accvgpr_read_b32 v35, a3
  v_accvgpr_read_b32 v36, a4
  v_accvgpr_read_b32 v37, a5
  v_accvgpr_read_b32 v38, a6
  v_accvgpr_read_b32 v39, a7
  v_mul_f32 v40, 0xbfb8aa3b, v32
  v_mul_f32 v41, 0xbfb8aa3b, v33
  v_mul_f32 v42, 0xbfb8aa3b, v34
  v_mul_f32 v43, 0xbfb8aa3b, v35
  v_mul_f32 v44, 0xbfb8aa3b, v36
  v_mul_f32 v45, 0xbfb8aa3b, v37
  v_mul_f32 v46, 0xbfb8aa3b, v38
  v_mul_f32 v47, 0xbfb8aa3b, v39
  v_exp_f32 v40, v40
  v_exp_f32 v41, v41
  v_exp_f32 v42, v42
  v_exp_f32 v43, v43
  v_exp_f32 v44, v44
  v_exp_f32 v45, v45
  v_exp_f32 v46, v46
  v_exp_f32 v47, v47
  v_add_f32 v40, 1.0, v40
  v_add_f32 v41, 1.0, v41
  v_add_f32 v42, 1.0, v42
  v_add_f32 v43, 1.0, v43
  v_add_f32 v44, 1.0, v44
  v_add_f32 v45, 1.0, v45
  v_add_f32 v46, 1.0, v46
  v_add_f32 v47, 1.0, v47
  v_rcp_f32 v40, v40
  v_rcp_f32 v41, v41
  v_rcp_f32 v42, v42
  v_rcp_f32 v43, v43
  v_rcp_f32 v44, v44
  v_rcp_f32 v45, v45
  v_rcp_f32 v46, v46
  v_rcp_f32 v47, v47
  v_mul_f32 v32, v32, v40
  v_mul_f32 v33, v33, v41
  v_mul_f32 v34, v34, v42
  v_mul_f32 v35, v35, v43
  v_mul_f32 v36, v36, v44
  v_mul_f32 v37, v37, v45
  v_mul_f32 v38, v38, v46
  v_mul_f32 v39, v39, v47
  v_cvt_pk_bf16_f32 v48, v32, v33
  v_cvt_pk_bf16_f32 v49, v34, v35
  v_cvt_pk_bf16_f32 v50, v36, v37
  v_cvt_pk_bf16_f32 v51, v38, v39
  s_nop 1
  v_permlane16_swap_b32 v48, v50
  v_permlane16_swap_b32 v49, v51
  buffer_store_dwordx4 v[48:51], v23, s[4:7], s45 offen offset:0 sc1
  v_accvgpr_read_b32 v56, a8
  v_accvgpr_read_b32 v57, a9
  v_accvgpr_read_b32 v58, a10
  v_accvgpr_read_b32 v59, a11
  v_accvgpr_read_b32 v60, a12
  v_accvgpr_read_b32 v61, a13
  v_accvgpr_read_b32 v62, a14
  v_accvgpr_read_b32 v63, a15
  v_mul_f32 v64, 0xbfb8aa3b, v56
  v_mul_f32 v65, 0xbfb8aa3b, v57
  v_mul_f32 v66, 0xbfb8aa3b, v58
  v_mul_f32 v67, 0xbfb8aa3b, v59
  v_mul_f32 v68, 0xbfb8aa3b, v60
  v_mul_f32 v69, 0xbfb8aa3b, v61
  v_mul_f32 v70, 0xbfb8aa3b, v62
  v_mul_f32 v71, 0xbfb8aa3b, v63
  v_exp_f32 v64, v64
  v_exp_f32 v65, v65
  v_exp_f32 v66, v66
  v_exp_f32 v67, v67
  v_exp_f32 v68, v68
  v_exp_f32 v69, v69
  v_exp_f32 v70, v70
  v_exp_f32 v71, v71
  v_add_f32 v64, 1.0, v64
  v_add_f32 v65, 1.0, v65
  v_add_f32 v66, 1.0, v66
  v_add_f32 v67, 1.0, v67
  v_add_f32 v68, 1.0, v68
  v_add_f32 v69, 1.0, v69
  v_add_f32 v70, 1.0, v70
  v_add_f32 v71, 1.0, v71
  v_rcp_f32 v64, v64
  v_rcp_f32 v65, v65
  v_rcp_f32 v66, v66
  v_rcp_f32 v67, v67
  v_rcp_f32 v68, v68
  v_rcp_f32 v69, v69
  v_rcp_f32 v70, v70
  v_rcp_f32 v71, v71
  v_mul_f32 v56, v56, v64
  v_mul_f32 v57, v57, v65
  v_mul_f32 v58, v58, v66
  v_mul_f32 v59, v59, v67
  v_mul_f32 v60, v60, v68
  v_mul_f32 v61, v61, v69
  v_mul_f32 v62, v62, v70
  v_mul_f32 v63, v63, v71
  v_cvt_pk_bf16_f32 v72, v56, v57
  v_cvt_pk_bf16_f32 v73, v58, v59
  v_cvt_pk_bf16_f32 v74, v60, v61
  v_cvt_pk_bf16_f32 v75, v62, v63
  s_nop 1
  v_permlane16_swap_b32 v72, v74
  v_permlane16_swap_b32 v73, v75
  buffer_store_dwordx4 v[72:75], v23, s[4:7], s45 offen offset:64 sc1
  v_accvgpr_read_b32 v32, a16
  v_accvgpr_read_b32 v33, a17
  v_accvgpr_read_b32 v34, a18
  v_accvgpr_read_b32 v35, a19
  v_accvgpr_read_b32 v36, a20
  v_accvgpr_read_b32 v37, a21
  v_accvgpr_read_b32 v38, a22
  v_accvgpr_read_b32 v39, a23
  v_mul_f32 v40, 0xbfb8aa3b, v32
  v_mul_f32 v41, 0xbfb8aa3b, v33
  v_mul_f32 v42, 0xbfb8aa3b, v34
  v_mul_f32 v43, 0xbfb8aa3b, v35
  v_mul_f32 v44, 0xbfb8aa3b, v36
  v_mul_f32 v45, 0xbfb8aa3b, v37
  v_mul_f32 v46, 0xbfb8aa3b, v38
  v_mul_f32 v47, 0xbfb8aa3b, v39
  v_exp_f32 v40, v40
  v_exp_f32 v41, v41
  v_exp_f32 v42, v42
  v_exp_f32 v43, v43
  v_exp_f32 v44, v44
  v_exp_f32 v45, v45
  v_exp_f32 v46, v46
  v_exp_f32 v47, v47
  v_add_f32 v40, 1.0, v40
  v_add_f32 v41, 1.0, v41
  v_add_f32 v42, 1.0, v42
  v_add_f32 v43, 1.0, v43
  v_add_f32 v44, 1.0, v44
  v_add_f32 v45, 1.0, v45
  v_add_f32 v46, 1.0, v46
  v_add_f32 v47, 1.0, v47
  v_rcp_f32 v40, v40
  v_rcp_f32 v41, v41
  v_rcp_f32 v42, v42
  v_rcp_f32 v43, v43
  v_rcp_f32 v44, v44
  v_rcp_f32 v45, v45
  v_rcp_f32 v46, v46
  v_rcp_f32 v47, v47
  v_mul_f32 v32, v32, v40
  v_mul_f32 v33, v33, v41
  v_mul_f32 v34, v34, v42
  v_mul_f32 v35, v35, v43
  v_mul_f32 v36, v36, v44
  v_mul_f32 v37, v37, v45
  v_mul_f32 v38, v38, v46
  v_mul_f32 v39, v39, v47
  v_cvt_pk_bf16_f32 v48, v32, v33
  v_cvt_pk_bf16_f32 v49, v34, v35
  v_cvt_pk_bf16_f32 v50, v36, v37
  v_cvt_pk_bf16_f32 v51, v38, v39
  s_nop 1
  v_permlane16_swap_b32 v48, v50
  v_permlane16_swap_b32 v49, v51
  buffer_store_dwordx4 v[48:51], v23, s[4:7], s45 offen offset:256 sc1
  v_accvgpr_read_b32 v56, a24
  v_accvgpr_read_b32 v57, a25
  v_accvgpr_read_b32 v58, a26
  v_accvgpr_read_b32 v59, a27
  v_accvgpr_read_b32 v60, a28
  v_accvgpr_read_b32 v61, a29
  v_accvgpr_read_b32 v62, a30
  v_accvgpr_read_b32 v63, a31
  v_mul_f32 v64, 0xbfb8aa3b, v56
  v_mul_f32 v65, 0xbfb8aa3b, v57
  v_mul_f32 v66, 0xbfb8aa3b, v58
  v_mul_f32 v67, 0xbfb8aa3b, v59
  v_mul_f32 v68, 0xbfb8aa3b, v60
  v_mul_f32 v69, 0xbfb8aa3b, v61
  v_mul_f32 v70, 0xbfb8aa3b, v62
  v_mul_f32 v71, 0xbfb8aa3b, v63
  v_exp_f32 v64, v64
  v_exp_f32 v65, v65
  v_exp_f32 v66, v66
  v_exp_f32 v67, v67
  v_exp_f32 v68, v68
  v_exp_f32 v69, v69
  v_exp_f32 v70, v70
  v_exp_f32 v71, v71
  v_add_f32 v64, 1.0, v64
  v_add_f32 v65, 1.0, v65
  v_add_f32 v66, 1.0, v66
  v_add_f32 v67, 1.0, v67
  v_add_f32 v68, 1.0, v68
  v_add_f32 v69, 1.0, v69
  v_add_f32 v70, 1.0, v70
  v_add_f32 v71, 1.0, v71
  v_rcp_f32 v64, v64
  v_rcp_f32 v65, v65
  v_rcp_f32 v66, v66
  v_rcp_f32 v67, v67
  v_rcp_f32 v68, v68
  v_rcp_f32 v69, v69
  v_rcp_f32 v70, v70
  v_rcp_f32 v71, v71
  v_mul_f32 v56, v56, v64
  v_mul_f32 v57, v57, v65
  v_mul_f32 v58, v58, v66
  v_mul_f32 v59, v59, v67
  v_mul_f32 v60, v60, v68
  v_mul_f32 v61, v61, v69
  v_mul_f32 v62, v62, v70
  v_mul_f32 v63, v63, v71
  v_cvt_pk_bf16_f32 v72, v56, v57
  v_cvt_pk_bf16_f32 v73, v58, v59
  v_cvt_pk_bf16_f32 v74, v60, v61
  v_cvt_pk_bf16_f32 v75, v62, v63
  s_nop 1
  v_permlane16_swap_b32 v72, v74
  v_permlane16_swap_b32 v73, v75
  buffer_store_dwordx4 v[72:75], v23, s[4:7], s45 offen offset:320 sc1
  s_add_u32 s45, s45, 32768
  v_accvgpr_read_b32 v32, a32
  v_accvgpr_read_b32 v33, a33
  v_accvgpr_read_b32 v34, a34
  v_accvgpr_read_b32 v35, a35
  v_accvgpr_read_b32 v36, a36
  v_accvgpr_read_b32 v37, a37
  v_accvgpr_read_b32 v38, a38
  v_accvgpr_read_b32 v39, a39
  v_mul_f32 v40, 0xbfb8aa3b, v32
  v_mul_f32 v41, 0xbfb8aa3b, v33
  v_mul_f32 v42, 0xbfb8aa3b, v34
  v_mul_f32 v43, 0xbfb8aa3b, v35
  v_mul_f32 v44, 0xbfb8aa3b, v36
  v_mul_f32 v45, 0xbfb8aa3b, v37
  v_mul_f32 v46, 0xbfb8aa3b, v38
  v_mul_f32 v47, 0xbfb8aa3b, v39
  v_exp_f32 v40, v40
  v_exp_f32 v41, v41
  v_exp_f32 v42, v42
  v_exp_f32 v43, v43
  v_exp_f32 v44, v44
  v_exp_f32 v45, v45
  v_exp_f32 v46, v46
  v_exp_f32 v47, v47
  v_add_f32 v40, 1.0, v40
  v_add_f32 v41, 1.0, v41
  v_add_f32 v42, 1.0, v42
  v_add_f32 v43, 1.0, v43
  v_add_f32 v44, 1.0, v44
  v_add_f32 v45, 1.0, v45
  v_add_f32 v46, 1.0, v46
  v_add_f32 v47, 1.0, v47
  v_rcp_f32 v40, v40
  v_rcp_f32 v41, v41
  v_rcp_f32 v42, v42
  v_rcp_f32 v43, v43
  v_rcp_f32 v44, v44
  v_rcp_f32 v45, v45
  v_rcp_f32 v46, v46
  v_rcp_f32 v47, v47
  v_mul_f32 v32, v32, v40
  v_mul_f32 v33, v33, v41
  v_mul_f32 v34, v34, v42
  v_mul_f32 v35, v35, v43
  v_mul_f32 v36, v36, v44
  v_mul_f32 v37, v37, v45
  v_mul_f32 v38, v38, v46
  v_mul_f32 v39, v39, v47
  v_cvt_pk_bf16_f32 v48, v32, v33
  v_cvt_pk_bf16_f32 v49, v34, v35
  v_cvt_pk_bf16_f32 v50, v36, v37
  v_cvt_pk_bf16_f32 v51, v38, v39
  s_nop 1
  v_permlane16_swap_b32 v48, v50
  v_permlane16_swap_b32 v49, v51
  buffer_store_dwordx4 v[48:51], v23, s[4:7], s45 offen offset:0 sc1
  v_accvgpr_read_b32 v56, a40
  v_accvgpr_read_b32 v57, a41
  v_accvgpr_read_b32 v58, a42
  v_accvgpr_read_b32 v59, a43
  v_accvgpr_read_b32 v60, a44
  v_accvgpr_read_b32 v61, a45
  v_accvgpr_read_b32 v62, a46
  v_accvgpr_read_b32 v63, a47
  v_mul_f32 v64, 0xbfb8aa3b, v56
  v_mul_f32 v65, 0xbfb8aa3b, v57
  v_mul_f32 v66, 0xbfb8aa3b, v58
  v_mul_f32 v67, 0xbfb8aa3b, v59
  v_mul_f32 v68, 0xbfb8aa3b, v60
  v_mul_f32 v69, 0xbfb8aa3b, v61
  v_mul_f32 v70, 0xbfb8aa3b, v62
  v_mul_f32 v71, 0xbfb8aa3b, v63
  v_exp_f32 v64, v64
  v_exp_f32 v65, v65
  v_exp_f32 v66, v66
  v_exp_f32 v67, v67
  v_exp_f32 v68, v68
  v_exp_f32 v69, v69
  v_exp_f32 v70, v70
  v_exp_f32 v71, v71
  v_add_f32 v64, 1.0, v64
  v_add_f32 v65, 1.0, v65
  v_add_f32 v66, 1.0, v66
  v_add_f32 v67, 1.0, v67
  v_add_f32 v68, 1.0, v68
  v_add_f32 v69, 1.0, v69
  v_add_f32 v70, 1.0, v70
  v_add_f32 v71, 1.0, v71
  v_rcp_f32 v64, v64
  v_rcp_f32 v65, v65
  v_rcp_f32 v66, v66
  v_rcp_f32 v67, v67
  v_rcp_f32 v68, v68
  v_rcp_f32 v69, v69
  v_rcp_f32 v70, v70
  v_rcp_f32 v71, v71
  v_mul_f32 v56, v56, v64
  v_mul_f32 v57, v57, v65
  v_mul_f32 v58, v58, v66
  v_mul_f32 v59, v59, v67
  v_mul_f32 v60, v60, v68
  v_mul_f32 v61, v61, v69
  v_mul_f32 v62, v62, v70
  v_mul_f32 v63, v63, v71
  v_cvt_pk_bf16_f32 v72, v56, v57
  v_cvt_pk_bf16_f32 v73, v58, v59
  v_cvt_pk_bf16_f32 v74, v60, v61
  v_cvt_pk_bf16_f32 v75, v62, v63
  s_nop 1
  v_permlane16_swap_b32 v72, v74
  v_permlane16_swap_b32 v73, v75
  buffer_store_dwordx4 v[72:75], v23, s[4:7], s45 offen offset:64 sc1
  v_accvgpr_read_b32 v32, a48
  v_accvgpr_read_b32 v33, a49
  v_accvgpr_read_b32 v34, a50
  v_accvgpr_read_b32 v35, a51
  v_accvgpr_read_b32 v36, a52
  v_accvgpr_read_b32 v37, a53
  v_accvgpr_read_b32 v38, a54
  v_accvgpr_read_b32 v39, a55
  v_mul_f32 v40, 0xbfb8aa3b, v32
  v_mul_f32 v41, 0xbfb8aa3b, v33
  v_mul_f32 v42, 0xbfb8aa3b, v34
  v_mul_f32 v43, 0xbfb8aa3b, v35
  v_mul_f32 v44, 0xbfb8aa3b, v36
  v_mul_f32 v45, 0xbfb8aa3b, v37
  v_mul_f32 v46, 0xbfb8aa3b, v38
  v_mul_f32 v47, 0xbfb8aa3b, v39
  v_exp_f32 v40, v40
  v_exp_f32 v41, v41
  v_exp_f32 v42, v42
  v_exp_f32 v43, v43
  v_exp_f32 v44, v44
  v_exp_f32 v45, v45
  v_exp_f32 v46, v46
  v_exp_f32 v47, v47
  v_add_f32 v40, 1.0, v40
  v_add_f32 v41, 1.0, v41
  v_add_f32 v42, 1.0, v42
  v_add_f32 v43, 1.0, v43
  v_add_f32 v44, 1.0, v44
  v_add_f32 v45, 1.0, v45
  v_add_f32 v46, 1.0, v46
  v_add_f32 v47, 1.0, v47
  v_rcp_f32 v40, v40
  v_rcp_f32 v41, v41
  v_rcp_f32 v42, v42
  v_rcp_f32 v43, v43
  v_rcp_f32 v44, v44
  v_rcp_f32 v45, v45
  v_rcp_f32 v46, v46
  v_rcp_f32 v47, v47
  v_mul_f32 v32, v32, v40
  v_mul_f32 v33, v33, v41
  v_mul_f32 v34, v34, v42
  v_mul_f32 v35, v35, v43
  v_mul_f32 v36, v36, v44
  v_mul_f32 v37, v37, v45
  v_mul_f32 v38, v38, v46
  v_mul_f32 v39, v39, v47
  v_cvt_pk_bf16_f32 v48, v32, v33
  v_cvt_pk_bf16_f32 v49, v34, v35
  v_cvt_pk_bf16_f32 v50, v36, v37
  v_cvt_pk_bf16_f32 v51, v38, v39
  s_nop 1
  v_permlane16_swap_b32 v48, v50
  v_permlane16_swap_b32 v49, v51
  buffer_store_dwordx4 v[48:51], v23, s[4:7], s45 offen offset:256 sc1
  v_accvgpr_read_b32 v56, a56
  v_accvgpr_read_b32 v57, a57
  v_accvgpr_read_b32 v58, a58
  v_accvgpr_read_b32 v59, a59
  v_accvgpr_read_b32 v60, a60
  v_accvgpr_read_b32 v61, a61
  v_accvgpr_read_b32 v62, a62
  v_accvgpr_read_b32 v63, a63
  v_mul_f32 v64, 0xbfb8aa3b, v56
  v_mul_f32 v65, 0xbfb8aa3b, v57
  v_mul_f32 v66, 0xbfb8aa3b, v58
  v_mul_f32 v67, 0xbfb8aa3b, v59
  v_mul_f32 v68, 0xbfb8aa3b, v60
  v_mul_f32 v69, 0xbfb8aa3b, v61
  v_mul_f32 v70, 0xbfb8aa3b, v62
  v_mul_f32 v71, 0xbfb8aa3b, v63
  v_exp_f32 v64, v64
  v_exp_f32 v65, v65
  v_exp_f32 v66, v66
  v_exp_f32 v67, v67
  v_exp_f32 v68, v68
  v_exp_f32 v69, v69
  v_exp_f32 v70, v70
  v_exp_f32 v71, v71
  v_add_f32 v64, 1.0, v64
  v_add_f32 v65, 1.0, v65
  v_add_f32 v66, 1.0, v66
  v_add_f32 v67, 1.0, v67
  v_add_f32 v68, 1.0, v68
  v_add_f32 v69, 1.0, v69
  v_add_f32 v70, 1.0, v70
  v_add_f32 v71, 1.0, v71
  v_rcp_f32 v64, v64
  v_rcp_f32 v65, v65
  v_rcp_f32 v66, v66
  v_rcp_f32 v67, v67
  v_rcp_f32 v68, v68
  v_rcp_f32 v69, v69
  v_rcp_f32 v70, v70
  v_rcp_f32 v71, v71
  v_mul_f32 v56, v56, v64
  v_mul_f32 v57, v57, v65
  v_mul_f32 v58, v58, v66
  v_mul_f32 v59, v59, v67
  v_mul_f32 v60, v60, v68
  v_mul_f32 v61, v61, v69
  v_mul_f32 v62, v62, v70
  v_mul_f32 v63, v63, v71
  v_cvt_pk_bf16_f32 v72, v56, v57
  v_cvt_pk_bf16_f32 v73, v58, v59
  v_cvt_pk_bf16_f32 v74, v60, v61
  v_cvt_pk_bf16_f32 v75, v62, v63
  s_nop 1
  v_permlane16_swap_b32 v72, v74
  v_permlane16_swap_b32 v73, v75
  buffer_store_dwordx4 v[72:75], v23, s[4:7], s45 offen offset:320 sc1
  s_add_u32 s45, s45, 32768
  v_accvgpr_read_b32 v32, a64
  v_accvgpr_read_b32 v33, a65
  v_accvgpr_read_b32 v34, a66
  v_accvgpr_read_b32 v35, a67
  v_accvgpr_read_b32 v36, a68
  v_accvgpr_read_b32 v37, a69
  v_accvgpr_read_b32 v38, a70
  v_accvgpr_read_b32 v39, a71
  v_mul_f32 v40, 0xbfb8aa3b, v32
  v_mul_f32 v41, 0xbfb8aa3b, v33
  v_mul_f32 v42, 0xbfb8aa3b, v34
  v_mul_f32 v43, 0xbfb8aa3b, v35
  v_mul_f32 v44, 0xbfb8aa3b, v36
  v_mul_f32 v45, 0xbfb8aa3b, v37
  v_mul_f32 v46, 0xbfb8aa3b, v38
  v_mul_f32 v47, 0xbfb8aa3b, v39
  v_exp_f32 v40, v40
  v_exp_f32 v41, v41
  v_exp_f32 v42, v42
  v_exp_f32 v43, v43
  v_exp_f32 v44, v44
  v_exp_f32 v45, v45
  v_exp_f32 v46, v46
  v_exp_f32 v47, v47
  v_add_f32 v40, 1.0, v40
  v_add_f32 v41, 1.0, v41
  v_add_f32 v42, 1.0, v42
  v_add_f32 v43, 1.0, v43
  v_add_f32 v44, 1.0, v44
  v_add_f32 v45, 1.0, v45
  v_add_f32 v46, 1.0, v46
  v_add_f32 v47, 1.0, v47
  v_rcp_f32 v40, v40
  v_rcp_f32 v41, v41
  v_rcp_f32 v42, v42
  v_rcp_f32 v43, v43
  v_rcp_f32 v44, v44
  v_rcp_f32 v45, v45
  v_rcp_f32 v46, v46
  v_rcp_f32 v47, v47
  v_mul_f32 v32, v32, v40
  v_mul_f32 v33, v33, v41
  v_mul_f32 v34, v34, v42
  v_mul_f32 v35, v35, v43
  v_mul_f32 v36, v36, v44
  v_mul_f32 v37, v37, v45
  v_mul_f32 v38, v38, v46
  v_mul_f32 v39, v39, v47
  v_cvt_pk_bf16_f32 v48, v32, v33
  v_cvt_pk_bf16_f32 v49, v34, v35
  v_cvt_pk_bf16_f32 v50, v36, v37
  v_cvt_pk_bf16_f32 v51, v38, v39
  s_nop 1
  v_permlane16_swap_b32 v48, v50
  v_permlane16_swap_b32 v49, v51
  buffer_store_dwordx4 v[48:51], v23, s[4:7], s45 offen offset:0 sc1
  v_accvgpr_read_b32 v56, a72
  v_accvgpr_read_b32 v57, a73
  v_accvgpr_read_b32 v58, a74
  v_accvgpr_read_b32 v59, a75
  v_accvgpr_read_b32 v60, a76
  v_accvgpr_read_b32 v61, a77
  v_accvgpr_read_b32 v62, a78
  v_accvgpr_read_b32 v63, a79
  v_mul_f32 v64, 0xbfb8aa3b, v56
  v_mul_f32 v65, 0xbfb8aa3b, v57
  v_mul_f32 v66, 0xbfb8aa3b, v58
  v_mul_f32 v67, 0xbfb8aa3b, v59
  v_mul_f32 v68, 0xbfb8aa3b, v60
  v_mul_f32 v69, 0xbfb8aa3b, v61
  v_mul_f32 v70, 0xbfb8aa3b, v62
  v_mul_f32 v71, 0xbfb8aa3b, v63
  v_exp_f32 v64, v64
  v_exp_f32 v65, v65
  v_exp_f32 v66, v66
  v_exp_f32 v67, v67
  v_exp_f32 v68, v68
  v_exp_f32 v69, v69
  v_exp_f32 v70, v70
  v_exp_f32 v71, v71
  v_add_f32 v64, 1.0, v64
  v_add_f32 v65, 1.0, v65
  v_add_f32 v66, 1.0, v66
  v_add_f32 v67, 1.0, v67
  v_add_f32 v68, 1.0, v68
  v_add_f32 v69, 1.0, v69
  v_add_f32 v70, 1.0, v70
  v_add_f32 v71, 1.0, v71
  v_rcp_f32 v64, v64
  v_rcp_f32 v65, v65
  v_rcp_f32 v66, v66
  v_rcp_f32 v67, v67
  v_rcp_f32 v68, v68
  v_rcp_f32 v69, v69
  v_rcp_f32 v70, v70
  v_rcp_f32 v71, v71
  v_mul_f32 v56, v56, v64
  v_mul_f32 v57, v57, v65
  v_mul_f32 v58, v58, v66
  v_mul_f32 v59, v59, v67
  v_mul_f32 v60, v60, v68
  v_mul_f32 v61, v61, v69
  v_mul_f32 v62, v62, v70
  v_mul_f32 v63, v63, v71
  v_cvt_pk_bf16_f32 v72, v56, v57
  v_cvt_pk_bf16_f32 v73, v58, v59
  v_cvt_pk_bf16_f32 v74, v60, v61
  v_cvt_pk_bf16_f32 v75, v62, v63
  s_nop 1
  v_permlane16_swap_b32 v72, v74
  v_permlane16_swap_b32 v73, v75
  buffer_store_dwordx4 v[72:75], v23, s[4:7], s45 offen offset:64 sc1
  v_accvgpr_read_b32 v32, a80
  v_accvgpr_read_b32 v33, a81
  v_accvgpr_read_b32 v34, a82
  v_accvgpr_read_b32 v35, a83
  v_accvgpr_read_b32 v36, a84
  v_accvgpr_read_b32 v37, a85
  v_accvgpr_read_b32 v38, a86
  v_accvgpr_read_b32 v39, a87
  v_mul_f32 v40, 0xbfb8aa3b, v32
  v_mul_f32 v41, 0xbfb8aa3b, v33
  v_mul_f32 v42, 0xbfb8aa3b, v34
  v_mul_f32 v43, 0xbfb8aa3b, v35
  v_mul_f32 v44, 0xbfb8aa3b, v36
  v_mul_f32 v45, 0xbfb8aa3b, v37
  v_mul_f32 v46, 0xbfb8aa3b, v38
  v_mul_f32 v47, 0xbfb8aa3b, v39
  v_exp_f32 v40, v40
  v_exp_f32 v41, v41
  v_exp_f32 v42, v42
  v_exp_f32 v43, v43
  v_exp_f32 v44, v44
  v_exp_f32 v45, v45
  v_exp_f32 v46, v46
  v_exp_f32 v47, v47
  v_add_f32 v40, 1.0, v40
  v_add_f32 v41, 1.0, v41
  v_add_f32 v42, 1.0, v42
  v_add_f32 v43, 1.0, v43
  v_add_f32 v44, 1.0, v44
  v_add_f32 v45, 1.0, v45
  v_add_f32 v46, 1.0, v46
  v_add_f32 v47, 1.0, v47
  v_rcp_f32 v40, v40
  v_rcp_f32 v41, v41
  v_rcp_f32 v42, v42
  v_rcp_f32 v43, v43
  v_rcp_f32 v44, v44
  v_rcp_f32 v45, v45
  v_rcp_f32 v46, v46
  v_rcp_f32 v47, v47
  v_mul_f32 v32, v32, v40
  v_mul_f32 v33, v33, v41
  v_mul_f32 v34, v34, v42
  v_mul_f32 v35, v35, v43
  v_mul_f32 v36, v36, v44
  v_mul_f32 v37, v37, v45
  v_mul_f32 v38, v38, v46
  v_mul_f32 v39, v39, v47
  v_cvt_pk_bf16_f32 v48, v32, v33
  v_cvt_pk_bf16_f32 v49, v34, v35
  v_cvt_pk_bf16_f32 v50, v36, v37
  v_cvt_pk_bf16_f32 v51, v38, v39
  s_nop 1
  v_permlane16_swap_b32 v48, v50
  v_permlane16_swap_b32 v49, v51
  buffer_store_dwordx4 v[48:51], v23, s[4:7], s45 offen offset:256 sc1
  v_accvgpr_read_b32 v56, a88
  v_accvgpr_read_b32 v57, a89
  v_accvgpr_read_b32 v58, a90
  v_accvgpr_read_b32 v59, a91
  v_accvgpr_read_b32 v60, a92
  v_accvgpr_read_b32 v61, a93
  v_accvgpr_read_b32 v62, a94
  v_accvgpr_read_b32 v63, a95
  v_mul_f32 v64, 0xbfb8aa3b, v56
  v_mul_f32 v65, 0xbfb8aa3b, v57
  v_mul_f32 v66, 0xbfb8aa3b, v58
  v_mul_f32 v67, 0xbfb8aa3b, v59
  v_mul_f32 v68, 0xbfb8aa3b, v60
  v_mul_f32 v69, 0xbfb8aa3b, v61
  v_mul_f32 v70, 0xbfb8aa3b, v62
  v_mul_f32 v71, 0xbfb8aa3b, v63
  v_exp_f32 v64, v64
  v_exp_f32 v65, v65
  v_exp_f32 v66, v66
  v_exp_f32 v67, v67
  v_exp_f32 v68, v68
  v_exp_f32 v69, v69
  v_exp_f32 v70, v70
  v_exp_f32 v71, v71
  v_add_f32 v64, 1.0, v64
  v_add_f32 v65, 1.0, v65
  v_add_f32 v66, 1.0, v66
  v_add_f32 v67, 1.0, v67
  v_add_f32 v68, 1.0, v68
  v_add_f32 v69, 1.0, v69
  v_add_f32 v70, 1.0, v70
  v_add_f32 v71, 1.0, v71
  v_rcp_f32 v64, v64
  v_rcp_f32 v65, v65
  v_rcp_f32 v66, v66
  v_rcp_f32 v67, v67
  v_rcp_f32 v68, v68
  v_rcp_f32 v69, v69
  v_rcp_f32 v70, v70
  v_rcp_f32 v71, v71
  v_mul_f32 v56, v56, v64
  v_mul_f32 v57, v57, v65
  v_mul_f32 v58, v58, v66
  v_mul_f32 v59, v59, v67
  v_mul_f32 v60, v60, v68
  v_mul_f32 v61, v61, v69
  v_mul_f32 v62, v62, v70
  v_mul_f32 v63, v63, v71
  v_cvt_pk_bf16_f32 v72, v56, v57
  v_cvt_pk_bf16_f32 v73, v58, v59
  v_cvt_pk_bf16_f32 v74, v60, v61
  v_cvt_pk_bf16_f32 v75, v62, v63
  s_nop 1
  v_permlane16_swap_b32 v72, v74
  v_permlane16_swap_b32 v73, v75
  buffer_store_dwordx4 v[72:75], v23, s[4:7], s45 offen offset:320 sc1
  s_add_u32 s45, s45, 32768
  v_accvgpr_read_b32 v32, a96
  v_accvgpr_read_b32 v33, a97
  v_accvgpr_read_b32 v34, a98
  v_accvgpr_read_b32 v35, a99
  v_accvgpr_read_b32 v36, a100
  v_accvgpr_read_b32 v37, a101
  v_accvgpr_read_b32 v38, a102
  v_accvgpr_read_b32 v39, a103
  v_mul_f32 v40, 0xbfb8aa3b, v32
  v_mul_f32 v41, 0xbfb8aa3b, v33
  v_mul_f32 v42, 0xbfb8aa3b, v34
  v_mul_f32 v43, 0xbfb8aa3b, v35
  v_mul_f32 v44, 0xbfb8aa3b, v36
  v_mul_f32 v45, 0xbfb8aa3b, v37
  v_mul_f32 v46, 0xbfb8aa3b, v38
  v_mul_f32 v47, 0xbfb8aa3b, v39
  v_exp_f32 v40, v40
  v_exp_f32 v41, v41
  v_exp_f32 v42, v42
  v_exp_f32 v43, v43
  v_exp_f32 v44, v44
  v_exp_f32 v45, v45
  v_exp_f32 v46, v46
  v_exp_f32 v47, v47
  v_add_f32 v40, 1.0, v40
  v_add_f32 v41, 1.0, v41
  v_add_f32 v42, 1.0, v42
  v_add_f32 v43, 1.0, v43
  v_add_f32 v44, 1.0, v44
  v_add_f32 v45, 1.0, v45
  v_add_f32 v46, 1.0, v46
  v_add_f32 v47, 1.0, v47
  v_rcp_f32 v40, v40
  v_rcp_f32 v41, v41
  v_rcp_f32 v42, v42
  v_rcp_f32 v43, v43
  v_rcp_f32 v44, v44
  v_rcp_f32 v45, v45
  v_rcp_f32 v46, v46
  v_rcp_f32 v47, v47
  v_mul_f32 v32, v32, v40
  v_mul_f32 v33, v33, v41
  v_mul_f32 v34, v34, v42
  v_mul_f32 v35, v35, v43
  v_mul_f32 v36, v36, v44
  v_mul_f32 v37, v37, v45
  v_mul_f32 v38, v38, v46
  v_mul_f32 v39, v39, v47
  v_cvt_pk_bf16_f32 v48, v32, v33
  v_cvt_pk_bf16_f32 v49, v34, v35
  v_cvt_pk_bf16_f32 v50, v36, v37
  v_cvt_pk_bf16_f32 v51, v38, v39
  s_nop 1
  v_permlane16_swap_b32 v48, v50
  v_permlane16_swap_b32 v49, v51
  buffer_store_dwordx4 v[48:51], v23, s[4:7], s45 offen offset:0 sc1
  v_accvgpr_read_b32 v56, a104
  v_accvgpr_read_b32 v57, a105
  v_accvgpr_read_b32 v58, a106
  v_accvgpr_read_b32 v59, a107
  v_accvgpr_read_b32 v60, a108
  v_accvgpr_read_b32 v61, a109
  v_accvgpr_read_b32 v62, a110
  v_accvgpr_read_b32 v63, a111
  v_mul_f32 v64, 0xbfb8aa3b, v56
  v_mul_f32 v65, 0xbfb8aa3b, v57
  v_mul_f32 v66, 0xbfb8aa3b, v58
  v_mul_f32 v67, 0xbfb8aa3b, v59
  v_mul_f32 v68, 0xbfb8aa3b, v60
  v_mul_f32 v69, 0xbfb8aa3b, v61
  v_mul_f32 v70, 0xbfb8aa3b, v62
  v_mul_f32 v71, 0xbfb8aa3b, v63
  v_exp_f32 v64, v64
  v_exp_f32 v65, v65
  v_exp_f32 v66, v66
  v_exp_f32 v67, v67
  v_exp_f32 v68, v68
  v_exp_f32 v69, v69
  v_exp_f32 v70, v70
  v_exp_f32 v71, v71
  v_add_f32 v64, 1.0, v64
  v_add_f32 v65, 1.0, v65
  v_add_f32 v66, 1.0, v66
  v_add_f32 v67, 1.0, v67
  v_add_f32 v68, 1.0, v68
  v_add_f32 v69, 1.0, v69
  v_add_f32 v70, 1.0, v70
  v_add_f32 v71, 1.0, v71
  v_rcp_f32 v64, v64
  v_rcp_f32 v65, v65
  v_rcp_f32 v66, v66
  v_rcp_f32 v67, v67
  v_rcp_f32 v68, v68
  v_rcp_f32 v69, v69
  v_rcp_f32 v70, v70
  v_rcp_f32 v71, v71
  v_mul_f32 v56, v56, v64
  v_mul_f32 v57, v57, v65
  v_mul_f32 v58, v58, v66
  v_mul_f32 v59, v59, v67
  v_mul_f32 v60, v60, v68
  v_mul_f32 v61, v61, v69
  v_mul_f32 v62, v62, v70
  v_mul_f32 v63, v63, v71
  v_cvt_pk_bf16_f32 v72, v56, v57
  v_cvt_pk_bf16_f32 v73, v58, v59
  v_cvt_pk_bf16_f32 v74, v60, v61
  v_cvt_pk_bf16_f32 v75, v62, v63
  s_nop 1
  v_permlane16_swap_b32 v72, v74
  v_permlane16_swap_b32 v73, v75
  buffer_store_dwordx4 v[72:75], v23, s[4:7], s45 offen offset:64 sc1
  v_accvgpr_read_b32 v32, a112
  v_accvgpr_read_b32 v33, a113
  v_accvgpr_read_b32 v34, a114
  v_accvgpr_read_b32 v35, a115
  v_accvgpr_read_b32 v36, a116
  v_accvgpr_read_b32 v37, a117
  v_accvgpr_read_b32 v38, a118
  v_accvgpr_read_b32 v39, a119
  v_mul_f32 v40, 0xbfb8aa3b, v32
  v_mul_f32 v41, 0xbfb8aa3b, v33
  v_mul_f32 v42, 0xbfb8aa3b, v34
  v_mul_f32 v43, 0xbfb8aa3b, v35
  v_mul_f32 v44, 0xbfb8aa3b, v36
  v_mul_f32 v45, 0xbfb8aa3b, v37
  v_mul_f32 v46, 0xbfb8aa3b, v38
  v_mul_f32 v47, 0xbfb8aa3b, v39
  v_exp_f32 v40, v40
  v_exp_f32 v41, v41
  v_exp_f32 v42, v42
  v_exp_f32 v43, v43
  v_exp_f32 v44, v44
  v_exp_f32 v45, v45
  v_exp_f32 v46, v46
  v_exp_f32 v47, v47
  v_add_f32 v40, 1.0, v40
  v_add_f32 v41, 1.0, v41
  v_add_f32 v42, 1.0, v42
  v_add_f32 v43, 1.0, v43
  v_add_f32 v44, 1.0, v44
  v_add_f32 v45, 1.0, v45
  v_add_f32 v46, 1.0, v46
  v_add_f32 v47, 1.0, v47
  v_rcp_f32 v40, v40
  v_rcp_f32 v41, v41
  v_rcp_f32 v42, v42
  v_rcp_f32 v43, v43
  v_rcp_f32 v44, v44
  v_rcp_f32 v45, v45
  v_rcp_f32 v46, v46
  v_rcp_f32 v47, v47
  v_mul_f32 v32, v32, v40
  v_mul_f32 v33, v33, v41
  v_mul_f32 v34, v34, v42
  v_mul_f32 v35, v35, v43
  v_mul_f32 v36, v36, v44
  v_mul_f32 v37, v37, v45
  v_mul_f32 v38, v38, v46
  v_mul_f32 v39, v39, v47
  v_cvt_pk_bf16_f32 v48, v32, v33
  v_cvt_pk_bf16_f32 v49, v34, v35
  v_cvt_pk_bf16_f32 v50, v36, v37
  v_cvt_pk_bf16_f32 v51, v38, v39
  s_nop 1
  v_permlane16_swap_b32 v48, v50
  v_permlane16_swap_b32 v49, v51
  buffer_store_dwordx4 v[48:51], v23, s[4:7], s45 offen offset:256 sc1
  v_accvgpr_read_b32 v56, a120
  v_accvgpr_read_b32 v57, a121
  v_accvgpr_read_b32 v58, a122
  v_accvgpr_read_b32 v59, a123
  v_accvgpr_read_b32 v60, a124
  v_accvgpr_read_b32 v61, a125
  v_accvgpr_read_b32 v62, a126
  v_accvgpr_read_b32 v63, a127
  v_mul_f32 v64, 0xbfb8aa3b, v56
  v_mul_f32 v65, 0xbfb8aa3b, v57
  v_mul_f32 v66, 0xbfb8aa3b, v58
  v_mul_f32 v67, 0xbfb8aa3b, v59
  v_mul_f32 v68, 0xbfb8aa3b, v60
  v_mul_f32 v69, 0xbfb8aa3b, v61
  v_mul_f32 v70, 0xbfb8aa3b, v62
  v_mul_f32 v71, 0xbfb8aa3b, v63
  v_exp_f32 v64, v64
  v_exp_f32 v65, v65
  v_exp_f32 v66, v66
  v_exp_f32 v67, v67
  v_exp_f32 v68, v68
  v_exp_f32 v69, v69
  v_exp_f32 v70, v70
  v_exp_f32 v71, v71
  v_add_f32 v64, 1.0, v64
  v_add_f32 v65, 1.0, v65
  v_add_f32 v66, 1.0, v66
  v_add_f32 v67, 1.0, v67
  v_add_f32 v68, 1.0, v68
  v_add_f32 v69, 1.0, v69
  v_add_f32 v70, 1.0, v70
  v_add_f32 v71, 1.0, v71
  v_rcp_f32 v64, v64
  v_rcp_f32 v65, v65
  v_rcp_f32 v66, v66
  v_rcp_f32 v67, v67
  v_rcp_f32 v68, v68
  v_rcp_f32 v69, v69
  v_rcp_f32 v70, v70
  v_rcp_f32 v71, v71
  v_mul_f32 v56, v56, v64
  v_mul_f32 v57, v57, v65
  v_mul_f32 v58, v58, v66
  v_mul_f32 v59, v59, v67
  v_mul_f32 v60, v60, v68
  v_mul_f32 v61, v61, v69
  v_mul_f32 v62, v62, v70
  v_mul_f32 v63, v63, v71
  v_cvt_pk_bf16_f32 v72, v56, v57
  v_cvt_pk_bf16_f32 v73, v58, v59
  v_cvt_pk_bf16_f32 v74, v60, v61
  v_cvt_pk_bf16_f32 v75, v62, v63
  s_nop 1
  v_permlane16_swap_b32 v72, v74
  v_permlane16_swap_b32 v73, v75
  buffer_store_dwordx4 v[72:75], v23, s[4:7], s45 offen offset:320 sc1
  s_add_u32 s45, s45, 32768
  v_accvgpr_read_b32 v32, a128
  v_accvgpr_read_b32 v33, a129
  v_accvgpr_read_b32 v34, a130
  v_accvgpr_read_b32 v35, a131
  v_accvgpr_read_b32 v36, a132
  v_accvgpr_read_b32 v37, a133
  v_accvgpr_read_b32 v38, a134
  v_accvgpr_read_b32 v39, a135
  v_mul_f32 v40, 0xbfb8aa3b, v32
  v_mul_f32 v41, 0xbfb8aa3b, v33
  v_mul_f32 v42, 0xbfb8aa3b, v34
  v_mul_f32 v43, 0xbfb8aa3b, v35
  v_mul_f32 v44, 0xbfb8aa3b, v36
  v_mul_f32 v45, 0xbfb8aa3b, v37
  v_mul_f32 v46, 0xbfb8aa3b, v38
  v_mul_f32 v47, 0xbfb8aa3b, v39
  v_exp_f32 v40, v40
  v_exp_f32 v41, v41
  v_exp_f32 v42, v42
  v_exp_f32 v43, v43
  v_exp_f32 v44, v44
  v_exp_f32 v45, v45
  v_exp_f32 v46, v46
  v_exp_f32 v47, v47
  v_add_f32 v40, 1.0, v40
  v_add_f32 v41, 1.0, v41
  v_add_f32 v42, 1.0, v42
  v_add_f32 v43, 1.0, v43
  v_add_f32 v44, 1.0, v44
  v_add_f32 v45, 1.0, v45
  v_add_f32 v46, 1.0, v46
  v_add_f32 v47, 1.0, v47
  v_rcp_f32 v40, v40
  v_rcp_f32 v41, v41
  v_rcp_f32 v42, v42
  v_rcp_f32 v43, v43
  v_rcp_f32 v44, v44
  v_rcp_f32 v45, v45
  v_rcp_f32 v46, v46
  v_rcp_f32 v47, v47
  v_mul_f32 v32, v32, v40
  v_mul_f32 v33, v33, v41
  v_mul_f32 v34, v34, v42
  v_mul_f32 v35, v35, v43
  v_mul_f32 v36, v36, v44
  v_mul_f32 v37, v37, v45
  v_mul_f32 v38, v38, v46
  v_mul_f32 v39, v39, v47
  v_cvt_pk_bf16_f32 v48, v32, v33
  v_cvt_pk_bf16_f32 v49, v34, v35
  v_cvt_pk_bf16_f32 v50, v36, v37
  v_cvt_pk_bf16_f32 v51, v38, v39
  s_nop 1
  v_permlane16_swap_b32 v48, v50
  v_permlane16_swap_b32 v49, v51
  buffer_store_dwordx4 v[48:51], v23, s[4:7], s45 offen offset:0 sc1
  v_accvgpr_read_b32 v56, a136
  v_accvgpr_read_b32 v57, a137
  v_accvgpr_read_b32 v58, a138
  v_accvgpr_read_b32 v59, a139
  v_accvgpr_read_b32 v60, a140
  v_accvgpr_read_b32 v61, a141
  v_accvgpr_read_b32 v62, a142
  v_accvgpr_read_b32 v63, a143
  v_mul_f32 v64, 0xbfb8aa3b, v56
  v_mul_f32 v65, 0xbfb8aa3b, v57
  v_mul_f32 v66, 0xbfb8aa3b, v58
  v_mul_f32 v67, 0xbfb8aa3b, v59
  v_mul_f32 v68, 0xbfb8aa3b, v60
  v_mul_f32 v69, 0xbfb8aa3b, v61
  v_mul_f32 v70, 0xbfb8aa3b, v62
  v_mul_f32 v71, 0xbfb8aa3b, v63
  v_exp_f32 v64, v64
  v_exp_f32 v65, v65
  v_exp_f32 v66, v66
  v_exp_f32 v67, v67
  v_exp_f32 v68, v68
  v_exp_f32 v69, v69
  v_exp_f32 v70, v70
  v_exp_f32 v71, v71
  v_add_f32 v64, 1.0, v64
  v_add_f32 v65, 1.0, v65
  v_add_f32 v66, 1.0, v66
  v_add_f32 v67, 1.0, v67
  v_add_f32 v68, 1.0, v68
  v_add_f32 v69, 1.0, v69
  v_add_f32 v70, 1.0, v70
  v_add_f32 v71, 1.0, v71
  v_rcp_f32 v64, v64
  v_rcp_f32 v65, v65
  v_rcp_f32 v66, v66
  v_rcp_f32 v67, v67
  v_rcp_f32 v68, v68
  v_rcp_f32 v69, v69
  v_rcp_f32 v70, v70
  v_rcp_f32 v71, v71
  v_mul_f32 v56, v56, v64
  v_mul_f32 v57, v57, v65
  v_mul_f32 v58, v58, v66
  v_mul_f32 v59, v59, v67
  v_mul_f32 v60, v60, v68
  v_mul_f32 v61, v61, v69
  v_mul_f32 v62, v62, v70
  v_mul_f32 v63, v63, v71
  v_cvt_pk_bf16_f32 v72, v56, v57
  v_cvt_pk_bf16_f32 v73, v58, v59
  v_cvt_pk_bf16_f32 v74, v60, v61
  v_cvt_pk_bf16_f32 v75, v62, v63
  s_nop 1
  v_permlane16_swap_b32 v72, v74
  v_permlane16_swap_b32 v73, v75
  buffer_store_dwordx4 v[72:75], v23, s[4:7], s45 offen offset:64 sc1
  v_accvgpr_read_b32 v32, a144
  v_accvgpr_read_b32 v33, a145
  v_accvgpr_read_b32 v34, a146
  v_accvgpr_read_b32 v35, a147
  v_accvgpr_read_b32 v36, a148
  v_accvgpr_read_b32 v37, a149
  v_accvgpr_read_b32 v38, a150
  v_accvgpr_read_b32 v39, a151
  v_mul_f32 v40, 0xbfb8aa3b, v32
  v_mul_f32 v41, 0xbfb8aa3b, v33
  v_mul_f32 v42, 0xbfb8aa3b, v34
  v_mul_f32 v43, 0xbfb8aa3b, v35
  v_mul_f32 v44, 0xbfb8aa3b, v36
  v_mul_f32 v45, 0xbfb8aa3b, v37
  v_mul_f32 v46, 0xbfb8aa3b, v38
  v_mul_f32 v47, 0xbfb8aa3b, v39
  v_exp_f32 v40, v40
  v_exp_f32 v41, v41
  v_exp_f32 v42, v42
  v_exp_f32 v43, v43
  v_exp_f32 v44, v44
  v_exp_f32 v45, v45
  v_exp_f32 v46, v46
  v_exp_f32 v47, v47
  v_add_f32 v40, 1.0, v40
  v_add_f32 v41, 1.0, v41
  v_add_f32 v42, 1.0, v42
  v_add_f32 v43, 1.0, v43
  v_add_f32 v44, 1.0, v44
  v_add_f32 v45, 1.0, v45
  v_add_f32 v46, 1.0, v46
  v_add_f32 v47, 1.0, v47
  v_rcp_f32 v40, v40
  v_rcp_f32 v41, v41
  v_rcp_f32 v42, v42
  v_rcp_f32 v43, v43
  v_rcp_f32 v44, v44
  v_rcp_f32 v45, v45
  v_rcp_f32 v46, v46
  v_rcp_f32 v47, v47
  v_mul_f32 v32, v32, v40
  v_mul_f32 v33, v33, v41
  v_mul_f32 v34, v34, v42
  v_mul_f32 v35, v35, v43
  v_mul_f32 v36, v36, v44
  v_mul_f32 v37, v37, v45
  v_mul_f32 v38, v38, v46
  v_mul_f32 v39, v39, v47
  v_cvt_pk_bf16_f32 v48, v32, v33
  v_cvt_pk_bf16_f32 v49, v34, v35
  v_cvt_pk_bf16_f32 v50, v36, v37
  v_cvt_pk_bf16_f32 v51, v38, v39
  s_nop 1
  v_permlane16_swap_b32 v48, v50
  v_permlane16_swap_b32 v49, v51
  buffer_store_dwordx4 v[48:51], v23, s[4:7], s45 offen offset:256 sc1
  v_accvgpr_read_b32 v56, a152
  v_accvgpr_read_b32 v57, a153
  v_accvgpr_read_b32 v58, a154
  v_accvgpr_read_b32 v59, a155
  v_accvgpr_read_b32 v60, a156
  v_accvgpr_read_b32 v61, a157
  v_accvgpr_read_b32 v62, a158
  v_accvgpr_read_b32 v63, a159
  v_mul_f32 v64, 0xbfb8aa3b, v56
  v_mul_f32 v65, 0xbfb8aa3b, v57
  v_mul_f32 v66, 0xbfb8aa3b, v58
  v_mul_f32 v67, 0xbfb8aa3b, v59
  v_mul_f32 v68, 0xbfb8aa3b, v60
  v_mul_f32 v69, 0xbfb8aa3b, v61
  v_mul_f32 v70, 0xbfb8aa3b, v62
  v_mul_f32 v71, 0xbfb8aa3b, v63
  v_exp_f32 v64, v64
  v_exp_f32 v65, v65
  v_exp_f32 v66, v66
  v_exp_f32 v67, v67
  v_exp_f32 v68, v68
  v_exp_f32 v69, v69
  v_exp_f32 v70, v70
  v_exp_f32 v71, v71
  v_add_f32 v64, 1.0, v64
  v_add_f32 v65, 1.0, v65
  v_add_f32 v66, 1.0, v66
  v_add_f32 v67, 1.0, v67
  v_add_f32 v68, 1.0, v68
  v_add_f32 v69, 1.0, v69
  v_add_f32 v70, 1.0, v70
  v_add_f32 v71, 1.0, v71
  v_rcp_f32 v64, v64
  v_rcp_f32 v65, v65
  v_rcp_f32 v66, v66
  v_rcp_f32 v67, v67
  v_rcp_f32 v68, v68
  v_rcp_f32 v69, v69
  v_rcp_f32 v70, v70
  v_rcp_f32 v71, v71
  v_mul_f32 v56, v56, v64
  v_mul_f32 v57, v57, v65
  v_mul_f32 v58, v58, v66
  v_mul_f32 v59, v59, v67
  v_mul_f32 v60, v60, v68
  v_mul_f32 v61, v61, v69
  v_mul_f32 v62, v62, v70
  v_mul_f32 v63, v63, v71
  v_cvt_pk_bf16_f32 v72, v56, v57
  v_cvt_pk_bf16_f32 v73, v58, v59
  v_cvt_pk_bf16_f32 v74, v60, v61
  v_cvt_pk_bf16_f32 v75, v62, v63
  s_nop 1
  v_permlane16_swap_b32 v72, v74
  v_permlane16_swap_b32 v73, v75
  buffer_store_dwordx4 v[72:75], v23, s[4:7], s45 offen offset:320 sc1
  s_add_u32 s45, s45, 32768
  v_accvgpr_read_b32 v32, a160
  v_accvgpr_read_b32 v33, a161
  v_accvgpr_read_b32 v34, a162
  v_accvgpr_read_b32 v35, a163
  v_accvgpr_read_b32 v36, a164
  v_accvgpr_read_b32 v37, a165
  v_accvgpr_read_b32 v38, a166
  v_accvgpr_read_b32 v39, a167
  v_mul_f32 v40, 0xbfb8aa3b, v32
  v_mul_f32 v41, 0xbfb8aa3b, v33
  v_mul_f32 v42, 0xbfb8aa3b, v34
  v_mul_f32 v43, 0xbfb8aa3b, v35
  v_mul_f32 v44, 0xbfb8aa3b, v36
  v_mul_f32 v45, 0xbfb8aa3b, v37
  v_mul_f32 v46, 0xbfb8aa3b, v38
  v_mul_f32 v47, 0xbfb8aa3b, v39
  v_exp_f32 v40, v40
  v_exp_f32 v41, v41
  v_exp_f32 v42, v42
  v_exp_f32 v43, v43
  v_exp_f32 v44, v44
  v_exp_f32 v45, v45
  v_exp_f32 v46, v46
  v_exp_f32 v47, v47
  v_add_f32 v40, 1.0, v40
  v_add_f32 v41, 1.0, v41
  v_add_f32 v42, 1.0, v42
  v_add_f32 v43, 1.0, v43
  v_add_f32 v44, 1.0, v44
  v_add_f32 v45, 1.0, v45
  v_add_f32 v46, 1.0, v46
  v_add_f32 v47, 1.0, v47
  v_rcp_f32 v40, v40
  v_rcp_f32 v41, v41
  v_rcp_f32 v42, v42
  v_rcp_f32 v43, v43
  v_rcp_f32 v44, v44
  v_rcp_f32 v45, v45
  v_rcp_f32 v46, v46
  v_rcp_f32 v47, v47
  v_mul_f32 v32, v32, v40
  v_mul_f32 v33, v33, v41
  v_mul_f32 v34, v34, v42
  v_mul_f32 v35, v35, v43
  v_mul_f32 v36, v36, v44
  v_mul_f32 v37, v37, v45
  v_mul_f32 v38, v38, v46
  v_mul_f32 v39, v39, v47
  v_cvt_pk_bf16_f32 v48, v32, v33
  v_cvt_pk_bf16_f32 v49, v34, v35
  v_cvt_pk_bf16_f32 v50, v36, v37
  v_cvt_pk_bf16_f32 v51, v38, v39
  s_nop 1
  v_permlane16_swap_b32 v48, v50
  v_permlane16_swap_b32 v49, v51
  buffer_store_dwordx4 v[48:51], v23, s[4:7], s45 offen offset:0 sc1
  v_accvgpr_read_b32 v56, a168
  v_accvgpr_read_b32 v57, a169
  v_accvgpr_read_b32 v58, a170
  v_accvgpr_read_b32 v59, a171
  v_accvgpr_read_b32 v60, a172
  v_accvgpr_read_b32 v61, a173
  v_accvgpr_read_b32 v62, a174
  v_accvgpr_read_b32 v63, a175
  v_mul_f32 v64, 0xbfb8aa3b, v56
  v_mul_f32 v65, 0xbfb8aa3b, v57
  v_mul_f32 v66, 0xbfb8aa3b, v58
  v_mul_f32 v67, 0xbfb8aa3b, v59
  v_mul_f32 v68, 0xbfb8aa3b, v60
  v_mul_f32 v69, 0xbfb8aa3b, v61
  v_mul_f32 v70, 0xbfb8aa3b, v62
  v_mul_f32 v71, 0xbfb8aa3b, v63
  v_exp_f32 v64, v64
  v_exp_f32 v65, v65
  v_exp_f32 v66, v66
  v_exp_f32 v67, v67
  v_exp_f32 v68, v68
  v_exp_f32 v69, v69
  v_exp_f32 v70, v70
  v_exp_f32 v71, v71
  v_add_f32 v64, 1.0, v64
  v_add_f32 v65, 1.0, v65
  v_add_f32 v66, 1.0, v66
  v_add_f32 v67, 1.0, v67
  v_add_f32 v68, 1.0, v68
  v_add_f32 v69, 1.0, v69
  v_add_f32 v70, 1.0, v70
  v_add_f32 v71, 1.0, v71
  v_rcp_f32 v64, v64
  v_rcp_f32 v65, v65
  v_rcp_f32 v66, v66
  v_rcp_f32 v67, v67
  v_rcp_f32 v68, v68
  v_rcp_f32 v69, v69
  v_rcp_f32 v70, v70
  v_rcp_f32 v71, v71
  v_mul_f32 v56, v56, v64
  v_mul_f32 v57, v57, v65
  v_mul_f32 v58, v58, v66
  v_mul_f32 v59, v59, v67
  v_mul_f32 v60, v60, v68
  v_mul_f32 v61, v61, v69
  v_mul_f32 v62, v62, v70
  v_mul_f32 v63, v63, v71
  v_cvt_pk_bf16_f32 v72, v56, v57
  v_cvt_pk_bf16_f32 v73, v58, v59
  v_cvt_pk_bf16_f32 v74, v60, v61
  v_cvt_pk_bf16_f32 v75, v62, v63
  s_nop 1
  v_permlane16_swap_b32 v72, v74
  v_permlane16_swap_b32 v73, v75
  buffer_store_dwordx4 v[72:75], v23, s[4:7], s45 offen offset:64 sc1
  v_accvgpr_read_b32 v32, a176
  v_accvgpr_read_b32 v33, a177
  v_accvgpr_read_b32 v34, a178
  v_accvgpr_read_b32 v35, a179
  v_accvgpr_read_b32 v36, a180
  v_accvgpr_read_b32 v37, a181
  v_accvgpr_read_b32 v38, a182
  v_accvgpr_read_b32 v39, a183
  v_mul_f32 v40, 0xbfb8aa3b, v32
  v_mul_f32 v41, 0xbfb8aa3b, v33
  v_mul_f32 v42, 0xbfb8aa3b, v34
  v_mul_f32 v43, 0xbfb8aa3b, v35
  v_mul_f32 v44, 0xbfb8aa3b, v36
  v_mul_f32 v45, 0xbfb8aa3b, v37
  v_mul_f32 v46, 0xbfb8aa3b, v38
  v_mul_f32 v47, 0xbfb8aa3b, v39
  v_exp_f32 v40, v40
  v_exp_f32 v41, v41
  v_exp_f32 v42, v42
  v_exp_f32 v43, v43
  v_exp_f32 v44, v44
  v_exp_f32 v45, v45
  v_exp_f32 v46, v46
  v_exp_f32 v47, v47
  v_add_f32 v40, 1.0, v40
  v_add_f32 v41, 1.0, v41
  v_add_f32 v42, 1.0, v42
  v_add_f32 v43, 1.0, v43
  v_add_f32 v44, 1.0, v44
  v_add_f32 v45, 1.0, v45
  v_add_f32 v46, 1.0, v46
  v_add_f32 v47, 1.0, v47
  v_rcp_f32 v40, v40
  v_rcp_f32 v41, v41
  v_rcp_f32 v42, v42
  v_rcp_f32 v43, v43
  v_rcp_f32 v44, v44
  v_rcp_f32 v45, v45
  v_rcp_f32 v46, v46
  v_rcp_f32 v47, v47
  v_mul_f32 v32, v32, v40
  v_mul_f32 v33, v33, v41
  v_mul_f32 v34, v34, v42
  v_mul_f32 v35, v35, v43
  v_mul_f32 v36, v36, v44
  v_mul_f32 v37, v37, v45
  v_mul_f32 v38, v38, v46
  v_mul_f32 v39, v39, v47
  v_cvt_pk_bf16_f32 v48, v32, v33
  v_cvt_pk_bf16_f32 v49, v34, v35
  v_cvt_pk_bf16_f32 v50, v36, v37
  v_cvt_pk_bf16_f32 v51, v38, v39
  s_nop 1
  v_permlane16_swap_b32 v48, v50
  v_permlane16_swap_b32 v49, v51
  buffer_store_dwordx4 v[48:51], v23, s[4:7], s45 offen offset:256 sc1
  v_accvgpr_read_b32 v56, a184
  v_accvgpr_read_b32 v57, a185
  v_accvgpr_read_b32 v58, a186
  v_accvgpr_read_b32 v59, a187
  v_accvgpr_read_b32 v60, a188
  v_accvgpr_read_b32 v61, a189
  v_accvgpr_read_b32 v62, a190
  v_accvgpr_read_b32 v63, a191
  v_mul_f32 v64, 0xbfb8aa3b, v56
  v_mul_f32 v65, 0xbfb8aa3b, v57
  v_mul_f32 v66, 0xbfb8aa3b, v58
  v_mul_f32 v67, 0xbfb8aa3b, v59
  v_mul_f32 v68, 0xbfb8aa3b, v60
  v_mul_f32 v69, 0xbfb8aa3b, v61
  v_mul_f32 v70, 0xbfb8aa3b, v62
  v_mul_f32 v71, 0xbfb8aa3b, v63
  v_exp_f32 v64, v64
  v_exp_f32 v65, v65
  v_exp_f32 v66, v66
  v_exp_f32 v67, v67
  v_exp_f32 v68, v68
  v_exp_f32 v69, v69
  v_exp_f32 v70, v70
  v_exp_f32 v71, v71
  v_add_f32 v64, 1.0, v64
  v_add_f32 v65, 1.0, v65
  v_add_f32 v66, 1.0, v66
  v_add_f32 v67, 1.0, v67
  v_add_f32 v68, 1.0, v68
  v_add_f32 v69, 1.0, v69
  v_add_f32 v70, 1.0, v70
  v_add_f32 v71, 1.0, v71
  v_rcp_f32 v64, v64
  v_rcp_f32 v65, v65
  v_rcp_f32 v66, v66
  v_rcp_f32 v67, v67
  v_rcp_f32 v68, v68
  v_rcp_f32 v69, v69
  v_rcp_f32 v70, v70
  v_rcp_f32 v71, v71
  v_mul_f32 v56, v56, v64
  v_mul_f32 v57, v57, v65
  v_mul_f32 v58, v58, v66
  v_mul_f32 v59, v59, v67
  v_mul_f32 v60, v60, v68
  v_mul_f32 v61, v61, v69
  v_mul_f32 v62, v62, v70
  v_mul_f32 v63, v63, v71
  v_cvt_pk_bf16_f32 v72, v56, v57
  v_cvt_pk_bf16_f32 v73, v58, v59
  v_cvt_pk_bf16_f32 v74, v60, v61
  v_cvt_pk_bf16_f32 v75, v62, v63
  s_nop 1
  v_permlane16_swap_b32 v72, v74
  v_permlane16_swap_b32 v73, v75
  buffer_store_dwordx4 v[72:75], v23, s[4:7], s45 offen offset:320 sc1
  s_add_u32 s45, s45, 32768
  v_accvgpr_read_b32 v32, a192
  v_accvgpr_read_b32 v33, a193
  v_accvgpr_read_b32 v34, a194
  v_accvgpr_read_b32 v35, a195
  v_accvgpr_read_b32 v36, a196
  v_accvgpr_read_b32 v37, a197
  v_accvgpr_read_b32 v38, a198
  v_accvgpr_read_b32 v39, a199
  v_mul_f32 v40, 0xbfb8aa3b, v32
  v_mul_f32 v41, 0xbfb8aa3b, v33
  v_mul_f32 v42, 0xbfb8aa3b, v34
  v_mul_f32 v43, 0xbfb8aa3b, v35
  v_mul_f32 v44, 0xbfb8aa3b, v36
  v_mul_f32 v45, 0xbfb8aa3b, v37
  v_mul_f32 v46, 0xbfb8aa3b, v38
  v_mul_f32 v47, 0xbfb8aa3b, v39
  v_exp_f32 v40, v40
  v_exp_f32 v41, v41
  v_exp_f32 v42, v42
  v_exp_f32 v43, v43
  v_exp_f32 v44, v44
  v_exp_f32 v45, v45
  v_exp_f32 v46, v46
  v_exp_f32 v47, v47
  v_add_f32 v40, 1.0, v40
  v_add_f32 v41, 1.0, v41
  v_add_f32 v42, 1.0, v42
  v_add_f32 v43, 1.0, v43
  v_add_f32 v44, 1.0, v44
  v_add_f32 v45, 1.0, v45
  v_add_f32 v46, 1.0, v46
  v_add_f32 v47, 1.0, v47
  v_rcp_f32 v40, v40
  v_rcp_f32 v41, v41
  v_rcp_f32 v42, v42
  v_rcp_f32 v43, v43
  v_rcp_f32 v44, v44
  v_rcp_f32 v45, v45
  v_rcp_f32 v46, v46
  v_rcp_f32 v47, v47
  v_mul_f32 v32, v32, v40
  v_mul_f32 v33, v33, v41
  v_mul_f32 v34, v34, v42
  v_mul_f32 v35, v35, v43
  v_mul_f32 v36, v36, v44
  v_mul_f32 v37, v37, v45
  v_mul_f32 v38, v38, v46
  v_mul_f32 v39, v39, v47
  v_cvt_pk_bf16_f32 v48, v32, v33
  v_cvt_pk_bf16_f32 v49, v34, v35
  v_cvt_pk_bf16_f32 v50, v36, v37
  v_cvt_pk_bf16_f32 v51, v38, v39
  s_nop 1
  v_permlane16_swap_b32 v48, v50
  v_permlane16_swap_b32 v49, v51
  buffer_store_dwordx4 v[48:51], v23, s[4:7], s45 offen offset:0 sc1
  v_accvgpr_read_b32 v56, a200
  v_accvgpr_read_b32 v57, a201
  v_accvgpr_read_b32 v58, a202
  v_accvgpr_read_b32 v59, a203
  v_accvgpr_read_b32 v60, a204
  v_accvgpr_read_b32 v61, a205
  v_accvgpr_read_b32 v62, a206
  v_accvgpr_read_b32 v63, a207
  v_mul_f32 v64, 0xbfb8aa3b, v56
  v_mul_f32 v65, 0xbfb8aa3b, v57
  v_mul_f32 v66, 0xbfb8aa3b, v58
  v_mul_f32 v67, 0xbfb8aa3b, v59
  v_mul_f32 v68, 0xbfb8aa3b, v60
  v_mul_f32 v69, 0xbfb8aa3b, v61
  v_mul_f32 v70, 0xbfb8aa3b, v62
  v_mul_f32 v71, 0xbfb8aa3b, v63
  v_exp_f32 v64, v64
  v_exp_f32 v65, v65
  v_exp_f32 v66, v66
  v_exp_f32 v67, v67
  v_exp_f32 v68, v68
  v_exp_f32 v69, v69
  v_exp_f32 v70, v70
  v_exp_f32 v71, v71
  v_add_f32 v64, 1.0, v64
  v_add_f32 v65, 1.0, v65
  v_add_f32 v66, 1.0, v66
  v_add_f32 v67, 1.0, v67
  v_add_f32 v68, 1.0, v68
  v_add_f32 v69, 1.0, v69
  v_add_f32 v70, 1.0, v70
  v_add_f32 v71, 1.0, v71
  v_rcp_f32 v64, v64
  v_rcp_f32 v65, v65
  v_rcp_f32 v66, v66
  v_rcp_f32 v67, v67
  v_rcp_f32 v68, v68
  v_rcp_f32 v69, v69
  v_rcp_f32 v70, v70
  v_rcp_f32 v71, v71
  v_mul_f32 v56, v56, v64
  v_mul_f32 v57, v57, v65
  v_mul_f32 v58, v58, v66
  v_mul_f32 v59, v59, v67
  v_mul_f32 v60, v60, v68
  v_mul_f32 v61, v61, v69
  v_mul_f32 v62, v62, v70
  v_mul_f32 v63, v63, v71
  v_cvt_pk_bf16_f32 v72, v56, v57
  v_cvt_pk_bf16_f32 v73, v58, v59
  v_cvt_pk_bf16_f32 v74, v60, v61
  v_cvt_pk_bf16_f32 v75, v62, v63
  s_nop 1
  v_permlane16_swap_b32 v72, v74
  v_permlane16_swap_b32 v73, v75
  buffer_store_dwordx4 v[72:75], v23, s[4:7], s45 offen offset:64 sc1
  v_accvgpr_read_b32 v32, a208
  v_accvgpr_read_b32 v33, a209
  v_accvgpr_read_b32 v34, a210
  v_accvgpr_read_b32 v35, a211
  v_accvgpr_read_b32 v36, a212
  v_accvgpr_read_b32 v37, a213
  v_accvgpr_read_b32 v38, a214
  v_accvgpr_read_b32 v39, a215
  v_mul_f32 v40, 0xbfb8aa3b, v32
  v_mul_f32 v41, 0xbfb8aa3b, v33
  v_mul_f32 v42, 0xbfb8aa3b, v34
  v_mul_f32 v43, 0xbfb8aa3b, v35
  v_mul_f32 v44, 0xbfb8aa3b, v36
  v_mul_f32 v45, 0xbfb8aa3b, v37
  v_mul_f32 v46, 0xbfb8aa3b, v38
  v_mul_f32 v47, 0xbfb8aa3b, v39
  v_exp_f32 v40, v40
  v_exp_f32 v41, v41
  v_exp_f32 v42, v42
  v_exp_f32 v43, v43
  v_exp_f32 v44, v44
  v_exp_f32 v45, v45
  v_exp_f32 v46, v46
  v_exp_f32 v47, v47
  v_add_f32 v40, 1.0, v40
  v_add_f32 v41, 1.0, v41
  v_add_f32 v42, 1.0, v42
  v_add_f32 v43, 1.0, v43
  v_add_f32 v44, 1.0, v44
  v_add_f32 v45, 1.0, v45
  v_add_f32 v46, 1.0, v46
  v_add_f32 v47, 1.0, v47
  v_rcp_f32 v40, v40
  v_rcp_f32 v41, v41
  v_rcp_f32 v42, v42
  v_rcp_f32 v43, v43
  v_rcp_f32 v44, v44
  v_rcp_f32 v45, v45
  v_rcp_f32 v46, v46
  v_rcp_f32 v47, v47
  v_mul_f32 v32, v32, v40
  v_mul_f32 v33, v33, v41
  v_mul_f32 v34, v34, v42
  v_mul_f32 v35, v35, v43
  v_mul_f32 v36, v36, v44
  v_mul_f32 v37, v37, v45
  v_mul_f32 v38, v38, v46
  v_mul_f32 v39, v39, v47
  v_cvt_pk_bf16_f32 v48, v32, v33
  v_cvt_pk_bf16_f32 v49, v34, v35
  v_cvt_pk_bf16_f32 v50, v36, v37
  v_cvt_pk_bf16_f32 v51, v38, v39
  s_nop 1
  v_permlane16_swap_b32 v48, v50
  v_permlane16_swap_b32 v49, v51
  buffer_store_dwordx4 v[48:51], v23, s[4:7], s45 offen offset:256 sc1
  v_accvgpr_read_b32 v56, a216
  v_accvgpr_read_b32 v57, a217
  v_accvgpr_read_b32 v58, a218
  v_accvgpr_read_b32 v59, a219
  v_accvgpr_read_b32 v60, a220
  v_accvgpr_read_b32 v61, a221
  v_accvgpr_read_b32 v62, a222
  v_accvgpr_read_b32 v63, a223
  v_mul_f32 v64, 0xbfb8aa3b, v56
  v_mul_f32 v65, 0xbfb8aa3b, v57
  v_mul_f32 v66, 0xbfb8aa3b, v58
  v_mul_f32 v67, 0xbfb8aa3b, v59
  v_mul_f32 v68, 0xbfb8aa3b, v60
  v_mul_f32 v69, 0xbfb8aa3b, v61
  v_mul_f32 v70, 0xbfb8aa3b, v62
  v_mul_f32 v71, 0xbfb8aa3b, v63
  v_exp_f32 v64, v64
  v_exp_f32 v65, v65
  v_exp_f32 v66, v66
  v_exp_f32 v67, v67
  v_exp_f32 v68, v68
  v_exp_f32 v69, v69
  v_exp_f32 v70, v70
  v_exp_f32 v71, v71
  v_add_f32 v64, 1.0, v64
  v_add_f32 v65, 1.0, v65
  v_add_f32 v66, 1.0, v66
  v_add_f32 v67, 1.0, v67
  v_add_f32 v68, 1.0, v68
  v_add_f32 v69, 1.0, v69
  v_add_f32 v70, 1.0, v70
  v_add_f32 v71, 1.0, v71
  v_rcp_f32 v64, v64
  v_rcp_f32 v65, v65
  v_rcp_f32 v66, v66
  v_rcp_f32 v67, v67
  v_rcp_f32 v68, v68
  v_rcp_f32 v69, v69
  v_rcp_f32 v70, v70
  v_rcp_f32 v71, v71
  v_mul_f32 v56, v56, v64
  v_mul_f32 v57, v57, v65
  v_mul_f32 v58, v58, v66
  v_mul_f32 v59, v59, v67
  v_mul_f32 v60, v60, v68
  v_mul_f32 v61, v61, v69
  v_mul_f32 v62, v62, v70
  v_mul_f32 v63, v63, v71
  v_cvt_pk_bf16_f32 v72, v56, v57
  v_cvt_pk_bf16_f32 v73, v58, v59
  v_cvt_pk_bf16_f32 v74, v60, v61
  v_cvt_pk_bf16_f32 v75, v62, v63
  s_nop 1
  v_permlane16_swap_b32 v72, v74
  v_permlane16_swap_b32 v73, v75
  buffer_store_dwordx4 v[72:75], v23, s[4:7], s45 offen offset:320 sc1
  s_add_u32 s45, s45, 32768
  v_accvgpr_read_b32 v32, a224
  v_accvgpr_read_b32 v33, a225
  v_accvgpr_read_b32 v34, a226
  v_accvgpr_read_b32 v35, a227
  v_accvgpr_read_b32 v36, a228
  v_accvgpr_read_b32 v37, a229
  v_accvgpr_read_b32 v38, a230
  v_accvgpr_read_b32 v39, a231
  v_mul_f32 v40, 0xbfb8aa3b, v32
  v_mul_f32 v41, 0xbfb8aa3b, v33
  v_mul_f32 v42, 0xbfb8aa3b, v34
  v_mul_f32 v43, 0xbfb8aa3b, v35
  v_mul_f32 v44, 0xbfb8aa3b, v36
  v_mul_f32 v45, 0xbfb8aa3b, v37
  v_mul_f32 v46, 0xbfb8aa3b, v38
  v_mul_f32 v47, 0xbfb8aa3b, v39
  v_exp_f32 v40, v40
  v_exp_f32 v41, v41
  v_exp_f32 v42, v42
  v_exp_f32 v43, v43
  v_exp_f32 v44, v44
  v_exp_f32 v45, v45
  v_exp_f32 v46, v46
  v_exp_f32 v47, v47
  v_add_f32 v40, 1.0, v40
  v_add_f32 v41, 1.0, v41
  v_add_f32 v42, 1.0, v42
  v_add_f32 v43, 1.0, v43
  v_add_f32 v44, 1.0, v44
  v_add_f32 v45, 1.0, v45
  v_add_f32 v46, 1.0, v46
  v_add_f32 v47, 1.0, v47
  v_rcp_f32 v40, v40
  v_rcp_f32 v41, v41
  v_rcp_f32 v42, v42
  v_rcp_f32 v43, v43
  v_rcp_f32 v44, v44
  v_rcp_f32 v45, v45
  v_rcp_f32 v46, v46
  v_rcp_f32 v47, v47
  v_mul_f32 v32, v32, v40
  v_mul_f32 v33, v33, v41
  v_mul_f32 v34, v34, v42
  v_mul_f32 v35, v35, v43
  v_mul_f32 v36, v36, v44
  v_mul_f32 v37, v37, v45
  v_mul_f32 v38, v38, v46
  v_mul_f32 v39, v39, v47
  v_cvt_pk_bf16_f32 v48, v32, v33
  v_cvt_pk_bf16_f32 v49, v34, v35
  v_cvt_pk_bf16_f32 v50, v36, v37
  v_cvt_pk_bf16_f32 v51, v38, v39
  s_nop 1
  v_permlane16_swap_b32 v48, v50
  v_permlane16_swap_b32 v49, v51
  buffer_store_dwordx4 v[48:51], v23, s[4:7], s45 offen offset:0 sc1
  v_accvgpr_read_b32 v56, a232
  v_accvgpr_read_b32 v57, a233
  v_accvgpr_read_b32 v58, a234
  v_accvgpr_read_b32 v59, a235
  v_accvgpr_read_b32 v60, a236
  v_accvgpr_read_b32 v61, a237
  v_accvgpr_read_b32 v62, a238
  v_accvgpr_read_b32 v63, a239
  v_mul_f32 v64, 0xbfb8aa3b, v56
  v_mul_f32 v65, 0xbfb8aa3b, v57
  v_mul_f32 v66, 0xbfb8aa3b, v58
  v_mul_f32 v67, 0xbfb8aa3b, v59
  v_mul_f32 v68, 0xbfb8aa3b, v60
  v_mul_f32 v69, 0xbfb8aa3b, v61
  v_mul_f32 v70, 0xbfb8aa3b, v62
  v_mul_f32 v71, 0xbfb8aa3b, v63
  v_exp_f32 v64, v64
  v_exp_f32 v65, v65
  v_exp_f32 v66, v66
  v_exp_f32 v67, v67
  v_exp_f32 v68, v68
  v_exp_f32 v69, v69
  v_exp_f32 v70, v70
  v_exp_f32 v71, v71
  v_add_f32 v64, 1.0, v64
  v_add_f32 v65, 1.0, v65
  v_add_f32 v66, 1.0, v66
  v_add_f32 v67, 1.0, v67
  v_add_f32 v68, 1.0, v68
  v_add_f32 v69, 1.0, v69
  v_add_f32 v70, 1.0, v70
  v_add_f32 v71, 1.0, v71
  v_rcp_f32 v64, v64
  v_rcp_f32 v65, v65
  v_rcp_f32 v66, v66
  v_rcp_f32 v67, v67
  v_rcp_f32 v68, v68
  v_rcp_f32 v69, v69
  v_rcp_f32 v70, v70
  v_rcp_f32 v71, v71
  v_mul_f32 v56, v56, v64
  v_mul_f32 v57, v57, v65
  v_mul_f32 v58, v58, v66
  v_mul_f32 v59, v59, v67
  v_mul_f32 v60, v60, v68
  v_mul_f32 v61, v61, v69
  v_mul_f32 v62, v62, v70
  v_mul_f32 v63, v63, v71
  v_cvt_pk_bf16_f32 v72, v56, v57
  v_cvt_pk_bf16_f32 v73, v58, v59
  v_cvt_pk_bf16_f32 v74, v60, v61
  v_cvt_pk_bf16_f32 v75, v62, v63
  s_nop 1
  v_permlane16_swap_b32 v72, v74
  v_permlane16_swap_b32 v73, v75
  buffer_store_dwordx4 v[72:75], v23, s[4:7], s45 offen offset:64 sc1
  v_accvgpr_read_b32 v32, a240
  v_accvgpr_read_b32 v33, a241
  v_accvgpr_read_b32 v34, a242
  v_accvgpr_read_b32 v35, a243
  v_accvgpr_read_b32 v36, a244
  v_accvgpr_read_b32 v37, a245
  v_accvgpr_read_b32 v38, a246
  v_accvgpr_read_b32 v39, a247
  v_mul_f32 v40, 0xbfb8aa3b, v32
  v_mul_f32 v41, 0xbfb8aa3b, v33
  v_mul_f32 v42, 0xbfb8aa3b, v34
  v_mul_f32 v43, 0xbfb8aa3b, v35
  v_mul_f32 v44, 0xbfb8aa3b, v36
  v_mul_f32 v45, 0xbfb8aa3b, v37
  v_mul_f32 v46, 0xbfb8aa3b, v38
  v_mul_f32 v47, 0xbfb8aa3b, v39
  v_exp_f32 v40, v40
  v_exp_f32 v41, v41
  v_exp_f32 v42, v42
  v_exp_f32 v43, v43
  v_exp_f32 v44, v44
  v_exp_f32 v45, v45
  v_exp_f32 v46, v46
  v_exp_f32 v47, v47
  v_add_f32 v40, 1.0, v40
  v_add_f32 v41, 1.0, v41
  v_add_f32 v42, 1.0, v42
  v_add_f32 v43, 1.0, v43
  v_add_f32 v44, 1.0, v44
  v_add_f32 v45, 1.0, v45
  v_add_f32 v46, 1.0, v46
  v_add_f32 v47, 1.0, v47
  v_rcp_f32 v40, v40
  v_rcp_f32 v41, v41
  v_rcp_f32 v42, v42
  v_rcp_f32 v43, v43
  v_rcp_f32 v44, v44
  v_rcp_f32 v45, v45
  v_rcp_f32 v46, v46
  v_rcp_f32 v47, v47
  v_mul_f32 v32, v32, v40
  v_mul_f32 v33, v33, v41
  v_mul_f32 v34, v34, v42
  v_mul_f32 v35, v35, v43
  v_mul_f32 v36, v36, v44
  v_mul_f32 v37, v37, v45
  v_mul_f32 v38, v38, v46
  v_mul_f32 v39, v39, v47
  v_cvt_pk_bf16_f32 v48, v32, v33
  v_cvt_pk_bf16_f32 v49, v34, v35
  v_cvt_pk_bf16_f32 v50, v36, v37
  v_cvt_pk_bf16_f32 v51, v38, v39
  s_nop 1
  v_permlane16_swap_b32 v48, v50
  v_permlane16_swap_b32 v49, v51
  buffer_store_dwordx4 v[48:51], v23, s[4:7], s45 offen offset:256 sc1
  v_accvgpr_read_b32 v56, a248
  v_accvgpr_read_b32 v57, a249
  v_accvgpr_read_b32 v58, a250
  v_accvgpr_read_b32 v59, a251
  v_accvgpr_read_b32 v60, a252
  v_accvgpr_read_b32 v61, a253
  v_accvgpr_read_b32 v62, a254
  v_accvgpr_read_b32 v63, a255
  v_mul_f32 v64, 0xbfb8aa3b, v56
  v_mul_f32 v65, 0xbfb8aa3b, v57
  v_mul_f32 v66, 0xbfb8aa3b, v58
  v_mul_f32 v67, 0xbfb8aa3b, v59
  v_mul_f32 v68, 0xbfb8aa3b, v60
  v_mul_f32 v69, 0xbfb8aa3b, v61
  v_mul_f32 v70, 0xbfb8aa3b, v62
  v_mul_f32 v71, 0xbfb8aa3b, v63
  v_exp_f32 v64, v64
  v_exp_f32 v65, v65
  v_exp_f32 v66, v66
  v_exp_f32 v67, v67
  v_exp_f32 v68, v68
  v_exp_f32 v69, v69
  v_exp_f32 v70, v70
  v_exp_f32 v71, v71
  v_add_f32 v64, 1.0, v64
  v_add_f32 v65, 1.0, v65
  v_add_f32 v66, 1.0, v66
  v_add_f32 v67, 1.0, v67
  v_add_f32 v68, 1.0, v68
  v_add_f32 v69, 1.0, v69
  v_add_f32 v70, 1.0, v70
  v_add_f32 v71, 1.0, v71
  v_rcp_f32 v64, v64
  v_rcp_f32 v65, v65
  v_rcp_f32 v66, v66
  v_rcp_f32 v67, v67
  v_rcp_f32 v68, v68
  v_rcp_f32 v69, v69
  v_rcp_f32 v70, v70
  v_rcp_f32 v71, v71
  v_mul_f32 v56, v56, v64
  v_mul_f32 v57, v57, v65
  v_mul_f32 v58, v58, v66
  v_mul_f32 v59, v59, v67
  v_mul_f32 v60, v60, v68
  v_mul_f32 v61, v61, v69
  v_mul_f32 v62, v62, v70
  v_mul_f32 v63, v63, v71
  v_cvt_pk_bf16_f32 v72, v56, v57
  v_cvt_pk_bf16_f32 v73, v58, v59
  v_cvt_pk_bf16_f32 v74, v60, v61
  v_cvt_pk_bf16_f32 v75, v62, v63
  s_nop 1
  v_permlane16_swap_b32 v72, v74
  v_permlane16_swap_b32 v73, v75
  buffer_store_dwordx4 v[72:75], v23, s[4:7], s45 offen offset:320 sc1
  s_add_u32 s45, s45, 32768
  s_branch L_next
T_V:
  s_load_dwordx2 s[52:53], s[0:1], 32
  s_mov_b32 s33, 64
  s_mov_b32 s34, 8192
  s_mul_i32 s20, s28, 16384
  s_add_u32 s20, s20, 0
  s_lshl_b32 s21, s29, 9
  s_add_u32 s22, s21, 256
  s_mov_b32 s31, 6
  s_waitcnt lgkmcnt(0)
  s_mov_b32 s12, s52
  s_mov_b32 s13, s53
  s_mov_b32 s14, 0x800000
  s_mov_b32 s15, 0x20000
  s_mov_b32 s16, s52
  s_mov_b32 s17, s53
  s_mov_b32 s18, 0x800000
  s_mov_b32 s19, 0x20000
  s_mov_b32 s8, s4
  s_mov_b32 s9, s5
  s_mov_b32 s10, s6
  s_mov_b32 s11, s7
  v_and_b32 v20, 63, v0
  v_and_b32 v21, 15, v20
  v_lshrrev_b32 v22, 4, v20
  v_lshrrev_b32 v23, 3, v20
  v_and_b32 v23, 1, v23
  v_lshlrev_b32 v23, 1, v23
  v_xor_b32 v23, v22, v23
  v_lshlrev_b32 v23, 4, v23
  v_lshlrev_b32 v24, 6, v21
  v_add_u32 v23, v23, v24
  s_lshr_b32 s40, s27, 1
  s_lshl_b32 s40, s40, 13
  v_add_u32 v1, s40, v23
  v_add_u32 v2, 0x10000, v1
  v_and_b32 v23, 3, v20
  v_lshrrev_b32 v24, 2, v20
  v_and_b32 v24, 3, v24
  v_and_b32 v25, 1, v22
  v_lshlrev_b32 v25, 2, v25
  v_or_b32 v25, v25, v24
  v_lshlrev_b32 v26, 3, v22
  v_add_u32 v26, v26, v24
  v_lshlrev_b32 v26, 8, v26
  v_lshlrev_b32 v23, 3, v23
  v_add_u32 v26, v26, v23
  v_add_u32 v26, 0x4000, v26
  s_and_b32 s40, s27, 1
  s_lshl_b32 s40, s40, 2
  s_add_u32 s41, s40, 0
  v_xor_b32 v27, s41, v25
  v_lshlrev_b32 v27, 5, v27
  v_add_u32 v4, v26, v27
  v_add_u32 v8, 0x10000, v4
  s_add_u32 s41, s40, 1
  v_xor_b32 v27, s41, v25
  v_lshlrev_b32 v27, 5, v27
  v_add_u32 v5, v26, v27
  v_add_u32 v9, 0x10000, v5
  s_add_u32 s41, s40, 2
  v_xor_b32 v27, s41, v25
  v_lshlrev_b32 v27, 5, v27
  v_add_u32 v6, v26, v27
  v_add_u32 v10, 0x10000, v6
  s_add_u32 s41, s40, 3
  v_xor_b32 v27, s41, v25
  v_lshlrev_b32 v27, 5, v27
  v_add_u32 v7, v26, v27
  v_add_u32 v11, 0x10000, v7
  v_lshrrev_b32 v23, 2, v20
  s_lshl_b32 s40, s27, 6
  v_add_u32 v23, s40, v23
  v_mul_lo_u32 v23, v23, s33
  v_lshrrev_b32 v24, 5, v20
  v_lshlrev_b32 v24, 1, v24
  v_and_b32 v25, 3, v20
  v_xor_b32 v24, v24, v25
  v_lshlrev_b32 v24, 4, v24
  v_add_u32 v12, v23, v24
  s_lshl_b32 s40, s33, 4
  v_add_u32 v13, s40, v12
  v_add_u32 v14, s40, v13
  v_add_u32 v15, s40, v14
  v_lshrrev_b32 v23, 4, v20
  s_and_b32 s40, s27, 1
  s_lshl_b32 s40, s40, 2
  v_or_b32 v24, s40, v23
  v_and_b32 v25, 15, v20
  v_lshrrev_b32 v26, 1, v25
  v_xor_b32 v26, v26, v24
  v_lshlrev_b32 v26, 5, v26
  v_and_b32 v25, 1, v25
  v_lshlrev_b32 v25, 4, v25
  v_add_u32 v26, v26, v25
  s_lshl_b32 s40, s27, 3
  v_add_u32 v23, s40, v23
  v_mul_lo_u32 v23, v23, s34
  v_add_u32 v16, v23, v26
  s_lshl_b32 s40, s34, 2
  v_add_u32 v17, s40, v16
  s_lshl_b32 s24, s27, 12
  s_lshl_b32 s25, s27, 11
  s_add_u32 s25, s25, 0x4000
  s_lshl_b32 s23, s34, 5
  s_add_u32 m0, s24, 0
  s_nop 0
  buffer_load_dwordx4 v12, s[8:11], s20 offen lds
  s_add_u32 m0, s24, 1024
  s_nop 0
  buffer_load_dwordx4 v13, s[8:11], s20 offen lds
  s_add_u32 m0, s24, 2048
  s_nop 0
  buffer_load_dwordx4 v14, s[8:11], s20 offen lds
  s_add_u32 m0, s24, 3072
  s_nop 0
  buffer_load_dwordx4 v15, s[8:11], s20 offen lds
  s_add_u32 m0, s25, 0
  s_nop 0
  buffer_load_dwordx4 v16, s[12:15], s21 offen lds
  s_add_u32 m0, s25, 8192
  s_nop 0
  buffer_load_dwordx4 v16, s[16:19], s22 offen lds
  s_add_u32 m0, s25, 1024
  s_nop 0
  buffer_load_dwordx4 v17, s[12:15], s21 offen lds
  s_add_u32 m0, s25, 9216
  s_nop 0
  buffer_load_dwordx4 v17, s[16:19], s22 offen lds
  s_add_u32 s20, s20, 131072
  s_add_u32 s21, s21, s23
  s_add_u32 s22, s22, s23
  s_add_u32 m0, s24, 32768
  s_nop 0
  buffer_load_dwordx4 v12, s[8:11], s20 offen lds
  s_add_u32 m0, s24, 33792
  s_nop 0
  buffer_load_dwordx4 v13, s[8:11], s20 offen lds
  s_add_u32 m0, s24, 34816
  s_nop 0
  buffer_load_dwordx4 v14, s[8:11], s20 offen lds
  s_add_u32 m0, s24, 35840
  s_nop 0
  buffer_load_dwordx4 v15, s[8:11], s20 offen lds
  s_add_u32 m0, s25, 32768
  s_nop 0
  buffer_load_dwordx4 v16, s[12:15], s21 offen lds
  s_add_u32 m0, s25, 40960
  s_nop 0
  buffer_load_dwordx4 v16, s[16:19], s22 offen lds
  s_add_u32 m0, s25, 33792
  s_nop 0
  buffer_load_dwordx4 v17, s[12:15], s21 offen lds
  s_add_u32 m0, s25, 41984
  s_nop 0
  buffer_load_dwordx4 v17, s[16:19], s22 offen lds
  s_add_u32 s20, s20, 131072
  s_add_u32 s21, s21, s23
  s_add_u32 s22, s22, s23
  s_add_u32 m0, s24, 65536
  s_nop 0
  buffer_load_dwordx4 v12, s[8:11], s20 offen lds
  s_add_u32 m0, s24, 66560
  s_nop 0
  buffer_load_dwordx4 v13, s[8:11], s20 offen lds
  s_add_u32 m0, s24, 67584
  s_nop 0
  buffer_load_dwordx4 v14, s[8:11], s20 offen lds
  s_add_u32 m0, s24, 68608
  s_nop 0
  buffer_load_dwordx4 v15, s[8:11], s20 offen lds
  s_add_u32 m0, s25, 65536
  s_nop 0
  buffer_load_dwordx4 v16, s[12:15], s21 offen lds
  s_add_u32 m0, s25, 73728
  s_nop 0
  buffer_load_dwordx4 v16, s[16:19], s22 offen lds
  s_add_u32 m0, s25, 66560
  s_nop 0
  buffer_load_dwordx4 v17, s[12:15], s21 offen lds
  s_add_u32 m0, s25, 74752
  s_nop 0
  buffer_load_dwordx4 v17, s[16:19], s22 offen lds
  s_add_u32 s20, s20, 131072
  s_add_u32 s21, s21, s23
  s_add_u32 s22, s22, s23
  s_waitcnt vmcnt(16)
  s_barrier
  s_cmp_eq_u32 s76, -1
  s_cbranch_scc1 L_pe_94
  s_cmp_lg_u32 s27, 0
  s_cbranch_scc1 L_pe_94_c
  s_and_b32 s47, s76, 0xffff
  s_add_u32 s47, s47, 117440512
  s_lshr_b32 s48, s76, 16
  s_add_u32 s48, s48, 1
  v_mov_b32 v18, s47
  v_mov_b32 v19, s48
  s_mov_b64 exec, 1
  buffer_atomic_add v19, v18, s[4:7], 0 offen sc1
  s_mov_b64 exec, -1
L_pe_94_c:
  s_mov_b32 s76, -1
L_pe_94:
  ds_read_b128 v[96:99], v1 offset:0
  ds_read_b64_tr_b16 v[64:65], v4 offset:0
  ds_read_b64_tr_b16 v[66:67], v4 offset:1024
  ds_read_b128 v[100:103], v1 offset:1024
  ds_read_b64_tr_b16 v[68:69], v5 offset:0
  ds_read_b64_tr_b16 v[70:71], v5 offset:1024
  ds_read_b128 v[104:107], v1 offset:2048
  ds_read_b64_tr_b16 v[72:73], v6 offset:0
  ds_read_b64_tr_b16 v[74:75], v6 offset:1024
  ds_read_b128 v[108:111], v1 offset:3072
  ds_read_b64_tr_b16 v[76:77], v7 offset:0
  ds_read_b64_tr_b16 v[78:79], v7 offset:1024
  ds_read_b128 v[112:115], v1 offset:4096
  ds_read_b64_tr_b16 v[80:81], v4 offset:8192
  ds_read_b64_tr_b16 v[82:83], v4 offset:9216
  ds_read_b128 v[116:119], v1 offset:5120
  ds_read_b64_tr_b16 v[84:85], v5 offset:8192
  ds_read_b64_tr_b16 v[86:87], v5 offset:9216
  ds_read_b128 v[120:123], v1 offset:6144
  ds_read_b64_tr_b16 v[88:89], v6 offset:8192
  ds_read_b64_tr_b16 v[90:91], v6 offset:9216
  ds_read_b128 v[124:127], v1 offset:7168
  ds_read_b64_tr_b16 v[92:93], v7 offset:8192
  ds_read_b64_tr_b16 v[94:95], v7 offset:9216
  s_waitcnt vmcnt(8) lgkmcnt(0)
  s_barrier
  v_mfma_f32_16x16x32_bf16 a[0:3], v[96:99], v[64:67], 0
  ds_read_b128 v[160:163], v1 offset:32768
  v_mfma_f32_16x16x32_bf16 a[4:7], v[96:99], v[68:71], 0
  v_mfma_f32_16x16x32_bf16 a[8:11], v[96:99], v[72:75], 0
  s_add_u32 m0, s24, 98304
  ds_read_b64_tr_b16 v[128:129], v4 offset:32768
  v_mfma_f32_16x16x32_bf16 a[12:15], v[96:99], v[76:79], 0
  buffer_load_dwordx4 v12, s[8:11], s20 offen lds
  v_mfma_f32_16x16x32_bf16 a[16:19], v[96:99], v[80:83], 0
  ds_read_b64_tr_b16 v[130:131], v4 offset:33792
  v_mfma_f32_16x16x32_bf16 a[20:23], v[96:99], v[84:87], 0
  v_mfma_f32_16x16x32_bf16 a[24:27], v[96:99], v[88:91], 0
  ds_read_b128 v[164:167], v1 offset:33792
  v_mfma_f32_16x16x32_bf16 a[28:31], v[96:99], v[92:95], 0
  v_mfma_f32_16x16x32_bf16 a[32:35], v[100:103], v[64:67], 0
  s_add_u32 m0, s24, 99328
  ds_read_b64_tr_b16 v[132:133], v5 offset:32768
  v_mfma_f32_16x16x32_bf16 a[36:39], v[100:103], v[68:71], 0
  buffer_load_dwordx4 v13, s[8:11], s20 offen lds
  v_mfma_f32_16x16x32_bf16 a[40:43], v[100:103], v[72:75], 0
  ds_read_b64_tr_b16 v[134:135], v5 offset:33792
  v_mfma_f32_16x16x32_bf16 a[44:47], v[100:103], v[76:79], 0
  v_mfma_f32_16x16x32_bf16 a[48:51], v[100:103], v[80:83], 0
  ds_read_b128 v[168:171], v1 offset:34816
  v_mfma_f32_16x16x32_bf16 a[52:55], v[100:103], v[84:87], 0
  v_mfma_f32_16x16x32_bf16 a[56:59], v[100:103], v[88:91], 0
  s_add_u32 m0, s24, 100352
  ds_read_b64_tr_b16 v[136:137], v6 offset:32768
  v_mfma_f32_16x16x32_bf16 a[60:63], v[100:103], v[92:95], 0
  buffer_load_dwordx4 v14, s[8:11], s20 offen lds
  v_mfma_f32_16x16x32_bf16 a[64:67], v[104:107], v[64:67], 0
  ds_read_b64_tr_b16 v[138:139], v6 offset:33792
  v_mfma_f32_16x16x32_bf16 a[68:71], v[104:107], v[68:71], 0
  v_mfma_f32_16x16x32_bf16 a[72:75], v[104:107], v[72:75], 0
  ds_read_b128 v[172:175], v1 offset:35840
  v_mfma_f32_16x16x32_bf16 a[76:79], v[104:107], v[76:79], 0
  v_mfma_f32_16x16x32_bf16 a[80:83], v[104:107], v[80:83], 0
  s_add_u32 m0, s24, 101376
  ds_read_b64_tr_b16 v[140:141], v7 offset:32768
  v_mfma_f32_16x16x32_bf16 a[84:87], v[104:107], v[84:87], 0
  buffer_load_dwordx4 v15, s[8:11], s20 offen lds
  v_mfma_f32_16x16x32_bf16 a[88:91], v[104:107], v[88:91], 0
  ds_read_b64_tr_b16 v[142:143], v7 offset:33792
  v_mfma_f32_16x16x32_bf16 a[92:95], v[104:107], v[92:95], 0
  v_mfma_f32_16x16x32_bf16 a[96:99], v[108:111], v[64:67], 0
  ds_read_b128 v[176:179], v1 offset:36864
  v_mfma_f32_16x16x32_bf16 a[100:103], v[108:111], v[68:71], 0
  v_mfma_f32_16x16x32_bf16 a[104:107], v[108:111], v[72:75], 0
  s_add_u32 m0, s25, 98304
  ds_read_b64_tr_b16 v[144:145], v4 offset:40960
  v_mfma_f32_16x16x32_bf16 a[108:111], v[108:111], v[76:79], 0
  buffer_load_dwordx4 v16, s[12:15], s21 offen lds
  v_mfma_f32_16x16x32_bf16 a[112:115], v[108:111], v[80:83], 0
  ds_read_b64_tr_b16 v[146:147], v4 offset:41984
  v_mfma_f32_16x16x32_bf16 a[116:119], v[108:111], v[84:87], 0
  v_mfma_f32_16x16x32_bf16 a[120:123], v[108:111], v[88:91], 0
  ds_read_b128 v[180:183], v1 offset:37888
  v_mfma_f32_16x16x32_bf16 a[124:127], v[108:111], v[92:95], 0
  v_mfma_f32_16x16x32_bf16 a[128:131], v[112:115], v[64:67], 0
  s_add_u32 m0, s25, 106496
  ds_read_b64_tr_b16 v[148:149], v5 offset:40960
  v_mfma_f32_16x16x32_bf16 a[132:135], v[112:115], v[68:71], 0
  buffer_load_dwordx4 v16, s[16:19], s22 offen lds
  v_mfma_f32_16x16x32_bf16 a[136:139], v[112:115], v[72:75], 0
  ds_read_b64_tr_b16 v[150:151], v5 offset:41984
  v_mfma_f32_16x16x32_bf16 a[140:143], v[112:115], v[76:79], 0
  v_mfma_f32_16x16x32_bf16 a[144:147], v[112:115], v[80:83], 0
  ds_read_b128 v[184:187], v1 offset:38912
  v_mfma_f32_16x16x32_bf16 a[148:151], v[112:115], v[84:87], 0
  v_mfma_f32_16x16x32_bf16 a[152:155], v[112:115], v[88:91], 0
  s_add_u32 m0, s25, 99328
  ds_read_b64_tr_b16 v[152:153], v6 offset:40960
  v_mfma_f32_16x16x32_bf16 a[156:159], v[112:115], v[92:95], 0
  buffer_load_dwordx4 v17, s[12:15], s21 offen lds
  v_mfma_f32_16x16x32_bf16 a[160:163], v[116:119], v[64:67], 0
  ds_read_b64_tr_b16 v[154:155], v6 offset:41984
  v_mfma_f32_16x16x32_bf16 a[164:167], v[116:119], v[68:71], 0
  v_mfma_f32_16x16x32_bf16 a[168:171], v[116:119], v[72:75], 0
  ds_read_b128 v[188:191], v1 offset:39936
  v_mfma_f32_16x16x32_bf16 a[172:175], v[116:119], v[76:79], 0
  v_mfma_f32_16x16x32_bf16 a[176:179], v[116:119], v[80:83], 0
  s_add_u32 m0, s25, 107520
  ds_read_b64_tr_b16 v[156:157], v7 offset:40960
  v_mfma_f32_16x16x32_bf16 a[180:183], v[116:119], v[84:87], 0
  buffer_load_dwordx4 v17, s[16:19], s22 offen lds
  v_mfma_f32_16x16x32_bf16 a[184:187], v[116:119], v[88:91], 0
  ds_read_b64_tr_b16 v[158:159], v7 offset:41984
  v_mfma_f32_16x16x32_bf16 a[188:191], v[116:119], v[92:95], 0
  v_mfma_f32_16x16x32_bf16 a[192:195], v[120:123], v[64:67], 0
  v_mfma_f32_16x16x32_bf16 a[196:199], v[120:123], v[68:71], 0
  v_mfma_f32_16x16x32_bf16 a[200:203], v[120:123], v[72:75], 0
  s_add_u32 s20, s20, 131072
  v_mfma_f32_16x16x32_bf16 a[204:207], v[120:123], v[76:79], 0
  s_add_u32 s21, s21, s23
  v_mfma_f32_16x16x32_bf16 a[208:211], v[120:123], v[80:83], 0
  s_add_u32 s22, s22, s23
  v_mfma_f32_16x16x32_bf16 a[212:215], v[120:123], v[84:87], 0
  v_mfma_f32_16x16x32_bf16 a[216:219], v[120:123], v[88:91], 0
  v_mfma_f32_16x16x32_bf16 a[220:223], v[120:123], v[92:95], 0
  v_mfma_f32_16x16x32_bf16 a[224:227], v[124:127], v[64:67], 0
  v_mfma_f32_16x16x32_bf16 a[228:231], v[124:127], v[68:71], 0
  v_mfma_f32_16x16x32_bf16 a[232:235], v[124:127], v[72:75], 0
  v_mfma_f32_16x16x32_bf16 a[236:239], v[124:127], v[76:79], 0
  v_mfma_f32_16x16x32_bf16 a[240:243], v[124:127], v[80:83], 0
  v_mfma_f32_16x16x32_bf16 a[244:247], v[124:127], v[84:87], 0
  v_mfma_f32_16x16x32_bf16 a[248:251], v[124:127], v[88:91], 0
  v_mfma_f32_16x16x32_bf16 a[252:255], v[124:127], v[92:95], 0
  s_waitcnt vmcnt(8) lgkmcnt(0)
  s_barrier
  v_mfma_f32_16x16x32_bf16 a[0:3], v[160:163], v[128:131], a[0:3]
  ds_read_b128 v[96:99], v2 offset:0
  v_mfma_f32_16x16x32_bf16 a[4:7], v[160:163], v[132:135], a[4:7]
  v_mfma_f32_16x16x32_bf16 a[8:11], v[160:163], v[136:139], a[8:11]
  s_add_u32 m0, s24, 0
  ds_read_b64_tr_b16 v[64:65], v8 offset:0
  v_mfma_f32_16x16x32_bf16 a[12:15], v[160:163], v[140:143], a[12:15]
  buffer_load_dwordx4 v12, s[8:11], s20 offen lds
  v_mfma_f32_16x16x32_bf16 a[16:19], v[160:163], v[144:147], a[16:19]
  ds_read_b64_tr_b16 v[66:67], v8 offset:1024
  v_mfma_f32_16x16x32_bf16 a[20:23], v[160:163], v[148:151], a[20:23]
  v_mfma_f32_16x16x32_bf16 a[24:27], v[160:163], v[152:155], a[24:27]
  ds_read_b128 v[100:103], v2 offset:1024
  v_mfma_f32_16x16x32_bf16 a[28:31], v[160:163], v[156:159], a[28:31]
  v_mfma_f32_16x16x32_bf16 a[32:35], v[164:167], v[128:131], a[32:35]
  s_add_u32 m0, s24, 1024
  ds_read_b64_tr_b16 v[68:69], v9 offset:0
  v_mfma_f32_16x16x32_bf16 a[36:39], v[164:167], v[132:135], a[36:39]
  buffer_load_dwordx4 v13, s[8:11], s20 offen lds
  v_mfma_f32_16x16x32_bf16 a[40:43], v[164:167], v[136:139], a[40:43]
  ds_read_b64_tr_b16 v[70:71], v9 offset:1024
  v_mfma_f32_16x16x32_bf16 a[44:47], v[164:167], v[140:143], a[44:47]
  v_mfma_f32_16x16x32_bf16 a[48:51], v[164:167], v[144:147], a[48:51]
  ds_read_b128 v[104:107], v2 offset:2048
  v_mfma_f32_16x16x32_bf16 a[52:55], v[164:167], v[148:151], a[52:55]
  v_mfma_f32_16x16x32_bf16 a[56:59], v[164:167], v[152:155], a[56:59]
  s_add_u32 m0, s24, 2048
  ds_read_b64_tr_b16 v[72:73], v10 offset:0
  v_mfma_f32_16x16x32_bf16 a[60:63], v[164:167], v[156:159], a[60:63]
  buffer_load_dwordx4 v14, s[8:11], s20 offen lds
  v_mfma_f32_16x16x32_bf16 a[64:67], v[168:171], v[128:131], a[64:67]
  ds_read_b64_tr_b16 v[74:75], v10 offset:1024
  v_mfma_f32_16x16x32_bf16 a[68:71], v[168:171], v[132:135], a[68:71]
  v_mfma_f32_16x16x32_bf16 a[72:75], v[168:171], v[136:139], a[72:75]
  ds_read_b128 v[108:111], v2 offset:3072
  v_mfma_f32_16x16x32_bf16 a[76:79], v[168:171], v[140:143], a[76:79]
  v_mfma_f32_16x16x32_bf16 a[80:83], v[168:171], v[144:147], a[80:83]
  s_add_u32 m0, s24, 3072
  ds_read_b64_tr_b16 v[76:77], v11 offset:0
  v_mfma_f32_16x16x32_bf16 a[84:87], v[168:171], v[148:151], a[84:87]
  buffer_load_dwordx4 v15, s[8:11], s20 offen lds
  v_mfma_f32_16x16x32_bf16 a[88:91], v[168:171], v[152:155], a[88:91]
  ds_read_b64_tr_b16 v[78:79], v11 offset:1024
  v_mfma_f32_16x16x32_bf16 a[92:95], v[168:171], v[156:159], a[92:95]
  v_mfma_f32_16x16x32_bf16 a[96:99], v[172:175], v[128:131], a[96:99]
  ds_read_b128 v[112:115], v2 offset:4096
  v_mfma_f32_16x16x32_bf16 a[100:103], v[172:175], v[132:135], a[100:103]
  v_mfma_f32_16x16x32_bf16 a[104:107], v[172:175], v[136:139], a[104:107]
  s_add_u32 m0, s25, 0
  ds_read_b64_tr_b16 v[80:81], v8 offset:8192
  v_mfma_f32_16x16x32_bf16 a[108:111], v[172:175], v[140:143], a[108:111]
  buffer_load_dwordx4 v16, s[12:15], s21 offen lds
  v_mfma_f32_16x16x32_bf16 a[112:115], v[172:175], v[144:147], a[112:115]
  ds_read_b64_tr_b16 v[82:83], v8 offset:9216
  v_mfma_f32_16x16x32_bf16 a[116:119], v[172:175], v[148:151], a[116:119]
  v_mfma_f32_16x16x32_bf16 a[120:123], v[172:175], v[152:155], a[120:123]
  ds_read_b128 v[116:119], v2 offset:5120
  v_mfma_f32_16x16x32_bf16 a[124:127], v[172:175], v[156:159], a[124:127]
  v_mfma_f32_16x16x32_bf16 a[128:131], v[176:179], v[128:131], a[128:131]
  s_add_u32 m0, s25, 8192
  ds_read_b64_tr_b16 v[84:85], v9 offset:8192
  v_mfma_f32_16x16x32_bf16 a[132:135], v[176:179], v[132:135], a[132:135]
  buffer_load_dwordx4 v16, s[16:19], s22 offen lds
  v_mfma_f32_16x16x32_bf16 a[136:139], v[176:179], v[136:139], a[136:139]
  ds_read_b64_tr_b16 v[86:87], v9 offset:9216
  v_mfma_f32_16x16x32_bf16 a[140:143], v[176:179], v[140:143], a[140:143]
  v_mfma_f32_16x16x32_bf16 a[144:147], v[176:179], v[144:147], a[144:147]
  ds_read_b128 v[120:123], v2 offset:6144
  v_mfma_f32_16x16x32_bf16 a[148:151], v[176:179], v[148:151], a[148:151]
  v_mfma_f32_16x16x32_bf16 a[152:155], v[176:179], v[152:155], a[152:155]
  s_add_u32 m0, s25, 1024
  ds_read_b64_tr_b16 v[88:89], v10 offset:8192
  v_mfma_f32_16x16x32_bf16 a[156:159], v[176:179], v[156:159], a[156:159]
  buffer_load_dwordx4 v17, s[12:15], s21 offen lds
  v_mfma_f32_16x16x32_bf16 a[160:163], v[180:183], v[128:131], a[160:163]
  ds_read_b64_tr_b16 v[90:91], v10 offset:9216
  v_mfma_f32_16x16x32_bf16 a[164:167], v[180:183], v[132:135], a[164:167]
  v_mfma_f32_16x16x32_bf16 a[168:171], v[180:183], v[136:139], a[168:171]
  ds_read_b128 v[124:127], v2 offset:7168
  v_mfma_f32_16x16x32_bf16 a[172:175], v[180:183], v[140:143], a[172:175]
  v_mfma_f32_16x16x32_bf16 a[176:179], v[180:183], v[144:147], a[176:179]
  s_add_u32 m0, s25, 9216
  ds_read_b64_tr_b16 v[92:93], v11 offset:8192
  v_mfma_f32_16x16x32_bf16 a[180:183], v[180:183], v[148:151], a[180:183]
  buffer_load_dwordx4 v17, s[16:19], s22 offen lds
  v_mfma_f32_16x16x32_bf16 a[184:187], v[180:183], v[152:155], a[184:187]
  ds_read_b64_tr_b16 v[94:95], v11 offset:9216
  v_mfma_f32_16x16x32_bf16 a[188:191], v[180:183], v[156:159], a[188:191]
  v_mfma_f32_16x16x32_bf16 a[192:195], v[184:187], v[128:131], a[192:195]
  v_mfma_f32_16x16x32_bf16 a[196:199], v[184:187], v[132:135], a[196:199]
  v_mfma_f32_16x16x32_bf16 a[200:203], v[184:187], v[136:139], a[200:203]
  s_add_u32 s20, s20, 131072
  v_mfma_f32_16x16x32_bf16 a[204:207], v[184:187], v[140:143], a[204:207]
  s_add_u32 s21, s21, s23
  v_mfma_f32_16x16x32_bf16 a[208:211], v[184:187], v[144:147], a[208:211]
  s_add_u32 s22, s22, s23
  v_mfma_f32_16x16x32_bf16 a[212:215], v[184:187], v[148:151], a[212:215]
  v_mfma_f32_16x16x32_bf16 a[216:219], v[184:187], v[152:155], a[216:219]
  v_mfma_f32_16x16x32_bf16 a[220:223], v[184:187], v[156:159], a[220:223]
  v_mfma_f32_16x16x32_bf16 a[224:227], v[188:191], v[128:131], a[224:227]
  v_mfma_f32_16x16x32_bf16 a[228:231], v[188:191], v[132:135], a[228:231]
  v_mfma_f32_16x16x32_bf16 a[232:235], v[188:191], v[136:139], a[232:235]
  v_mfma_f32_16x16x32_bf16 a[236:239], v[188:191], v[140:143], a[236:239]
  v_mfma_f32_16x16x32_bf16 a[240:243], v[188:191], v[144:147], a[240:243]
  v_mfma_f32_16x16x32_bf16 a[244:247], v[188:191], v[148:151], a[244:247]
  v_mfma_f32_16x16x32_bf16 a[248:251], v[188:191], v[152:155], a[248:251]
  v_mfma_f32_16x16x32_bf16 a[252:255], v[188:191], v[156:159], a[252:255]
  s_waitcnt vmcnt(8) lgkmcnt(0)
  s_barrier
  v_mfma_f32_16x16x32_bf16 a[0:3], v[96:99], v[64:67], a[0:3]
  ds_read_b128 v[160:163], v2 offset:32768
  v_mfma_f32_16x16x32_bf16 a[4:7], v[96:99], v[68:71], a[4:7]
  v_mfma_f32_16x16x32_bf16 a[8:11], v[96:99], v[72:75], a[8:11]
  s_add_u32 m0, s24, 32768
  ds_read_b64_tr_b16 v[128:129], v8 offset:32768
  v_mfma_f32_16x16x32_bf16 a[12:15], v[96:99], v[76:79], a[12:15]
  buffer_load_dwordx4 v12, s[8:11], s20 offen lds
  v_mfma_f32_16x16x32_bf16 a[16:19], v[96:99], v[80:83], a[16:19]
  ds_read_b64_tr_b16 v[130:131], v8 offset:33792
  v_mfma_f32_16x16x32_bf16 a[20:23], v[96:99], v[84:87], a[20:23]
  v_mfma_f32_16x16x32_bf16 a[24:27], v[96:99], v[88:91], a[24:27]
  ds_read_b128 v[164:167], v2 offset:33792
  v_mfma_f32_16x16x32_bf16 a[28:31], v[96:99], v[92:95], a[28:31]
  v_mfma_f32_16x16x32_bf16 a[32:35], v[100:103], v[64:67], a[32:35]
  s_add_u32 m0, s24, 33792
  ds_read_b64_tr_b16 v[132:133], v9 offset:32768
  v_mfma_f32_16x16x32_bf16 a[36:39], v[100:103], v[68:71], a[36:39]
  buffer_load_dwordx4 v13, s[8:11], s20 offen lds
  v_mfma_f32_16x16x32_bf16 a[40:43], v[100:103], v[72:75], a[40:43]
  ds_read_b64_tr_b16 v[134:135], v9 offset:33792
  v_mfma_f32_16x16x32_bf16 a[44:47], v[100:103], v[76:79], a[44:47]
  v_mfma_f32_16x16x32_bf16 a[48:51], v[100:103], v[80:83], a[48:51]
  ds_read_b128 v[168:171], v2 offset:34816
  v_mfma_f32_16x16x32_bf16 a[52:55], v[100:103], v[84:87], a[52:55]
  v_mfma_f32_16x16x32_bf16 a[56:59], v[100:103], v[88:91], a[56:59]
  s_add_u32 m0, s24, 34816
  ds_read_b64_tr_b16 v[136:137], v10 offset:32768
  v_mfma_f32_16x16x32_bf16 a[60:63], v[100:103], v[92:95], a[60:63]
  buffer_load_dwordx4 v14, s[8:11], s20 offen lds
  v_mfma_f32_16x16x32_bf16 a[64:67], v[104:107], v[64:67], a[64:67]
  ds_read_b64_tr_b16 v[138:139], v10 offset:33792
  v_mfma_f32_16x16x32_bf16 a[68:71], v[104:107], v[68:71], a[68:71]
  v_mfma_f32_16x16x32_bf16 a[72:75], v[104:107], v[72:75], a[72:75]
  ds_read_b128 v[172:175], v2 offset:35840
  v_mfma_f32_16x16x32_bf16 a[76:79], v[104:107], v[76:79], a[76:79]
  v_mfma_f32_16x16x32_bf16 a[80:83], v[104:107], v[80:83], a[80:83]
  s_add_u32 m0, s24, 35840
  ds_read_b64_tr_b16 v[140:141], v11 offset:32768
  v_mfma_f32_16x16x32_bf16 a[84:87], v[104:107], v[84:87], a[84:87]
  buffer_load_dwordx4 v15, s[8:11], s20 offen lds
  v_mfma_f32_16x16x32_bf16 a[88:91], v[104:107], v[88:91], a[88:91]
  ds_read_b64_tr_b16 v[142:143], v11 offset:33792
  v_mfma_f32_16x16x32_bf16 a[92:95], v[104:107], v[92:95], a[92:95]
  v_mfma_f32_16x16x32_bf16 a[96:99], v[108:111], v[64:67], a[96:99]
  ds_read_b128 v[176:179], v2 offset:36864
  v_mfma_f32_16x16x32_bf16 a[100:103], v[108:111], v[68:71], a[100:103]
  v_mfma_f32_16x16x32_bf16 a[104:107], v[108:111], v[72:75], a[104:107]
  s_add_u32 m0, s25, 32768
  ds_read_b64_tr_b16 v[144:145], v8 offset:40960
  v_mfma_f32_16x16x32_bf16 a[108:111], v[108:111], v[76:79], a[108:111]
  buffer_load_dwordx4 v16, s[12:15], s21 offen lds
  v_mfma_f32_16x16x32_bf16 a[112:115], v[108:111], v[80:83], a[112:115]
  ds_read_b64_tr_b16 v[146:147], v8 offset:41984
  v_mfma_f32_16x16x32_bf16 a[116:119], v[108:111], v[84:87], a[116:119]
  v_mfma_f32_16x16x32_bf16 a[120:123], v[108:111], v[88:91], a[120:123]
  ds_read_b128 v[180:183], v2 offset:37888
  v_mfma_f32_16x16x32_bf16 a[124:127], v[108:111], v[92:95], a[124:127]
  v_mfma_f32_16x16x32_bf16 a[128:131], v[112:115], v[64:67], a[128:131]
  s_add_u32 m0, s25, 40960
  ds_read_b64_tr_b16 v[148:149], v9 offset:40960
  v_mfma_f32_16x16x32_bf16 a[132:135], v[112:115], v[68:71], a[132:135]
  buffer_load_dwordx4 v16, s[16:19], s22 offen lds
  v_mfma_f32_16x16x32_bf16 a[136:139], v[112:115], v[72:75], a[136:139]
  ds_read_b64_tr_b16 v[150:151], v9 offset:41984
  v_mfma_f32_16x16x32_bf16 a[140:143], v[112:115], v[76:79], a[140:143]
  v_mfma_f32_16x16x32_bf16 a[144:147], v[112:115], v[80:83], a[144:147]
  ds_read_b128 v[184:187], v2 offset:38912
  v_mfma_f32_16x16x32_bf16 a[148:151], v[112:115], v[84:87], a[148:151]
  v_mfma_f32_16x16x32_bf16 a[152:155], v[112:115], v[88:91], a[152:155]
  s_add_u32 m0, s25, 33792
  ds_read_b64_tr_b16 v[152:153], v10 offset:40960
  v_mfma_f32_16x16x32_bf16 a[156:159], v[112:115], v[92:95], a[156:159]
  buffer_load_dwordx4 v17, s[12:15], s21 offen lds
  v_mfma_f32_16x16x32_bf16 a[160:163], v[116:119], v[64:67], a[160:163]
  ds_read_b64_tr_b16 v[154:155], v10 offset:41984
  v_mfma_f32_16x16x32_bf16 a[164:167], v[116:119], v[68:71], a[164:167]
  v_mfma_f32_16x16x32_bf16 a[168:171], v[116:119], v[72:75], a[168:171]
  ds_read_b128 v[188:191], v2 offset:39936
  v_mfma_f32_16x16x32_bf16 a[172:175], v[116:119], v[76:79], a[172:175]
  v_mfma_f32_16x16x32_bf16 a[176:179], v[116:119], v[80:83], a[176:179]
  s_add_u32 m0, s25, 41984
  ds_read_b64_tr_b16 v[156:157], v11 offset:40960
  v_mfma_f32_16x16x32_bf16 a[180:183], v[116:119], v[84:87], a[180:183]
  buffer_load_dwordx4 v17, s[16:19], s22 offen lds
  v_mfma_f32_16x16x32_bf16 a[184:187], v[116:119], v[88:91], a[184:187]
  ds_read_b64_tr_b16 v[158:159], v11 offset:41984
  v_mfma_f32_16x16x32_bf16 a[188:191], v[116:119], v[92:95], a[188:191]
  v_mfma_f32_16x16x32_bf16 a[192:195], v[120:123], v[64:67], a[192:195]
  v_mfma_f32_16x16x32_bf16 a[196:199], v[120:123], v[68:71], a[196:199]
  v_mfma_f32_16x16x32_bf16 a[200:203], v[120:123], v[72:75], a[200:203]
  s_add_u32 s20, s20, 131072
  v_mfma_f32_16x16x32_bf16 a[204:207], v[120:123], v[76:79], a[204:207]
  s_add_u32 s21, s21, s23
  v_mfma_f32_16x16x32_bf16 a[208:211], v[120:123], v[80:83], a[208:211]
  s_add_u32 s22, s22, s23
  v_mfma_f32_16x16x32_bf16 a[212:215], v[120:123], v[84:87], a[212:215]
  v_mfma_f32_16x16x32_bf16 a[216:219], v[120:123], v[88:91], a[216:219]
  v_mfma_f32_16x16x32_bf16 a[220:223], v[120:123], v[92:95], a[220:223]
  v_mfma_f32_16x16x32_bf16 a[224:227], v[124:127], v[64:67], a[224:227]
  v_mfma_f32_16x16x32_bf16 a[228:231], v[124:127], v[68:71], a[228:231]
  v_mfma_f32_16x16x32_bf16 a[232:235], v[124:127], v[72:75], a[232:235]
  v_mfma_f32_16x16x32_bf16 a[236:239], v[124:127], v[76:79], a[236:239]
  v_mfma_f32_16x16x32_bf16 a[240:243], v[124:127], v[80:83], a[240:243]
  v_mfma_f32_16x16x32_bf16 a[244:247], v[124:127], v[84:87], a[244:247]
  v_mfma_f32_16x16x32_bf16 a[248:251], v[124:127], v[88:91], a[248:251]
  v_mfma_f32_16x16x32_bf16 a[252:255], v[124:127], v[92:95], a[252:255]
  s_waitcnt vmcnt(8) lgkmcnt(0)
  s_barrier
  v_mfma_f32_16x16x32_bf16 a[0:3], v[160:163], v[128:131], a[0:3]
  ds_read_b128 v[96:99], v1 offset:0
  v_mfma_f32_16x16x32_bf16 a[4:7], v[160:163], v[132:135], a[4:7]
  v_mfma_f32_16x16x32_bf16 a[8:11], v[160:163], v[136:139], a[8:11]
  s_add_u32 m0, s24, 65536
  ds_read_b64_tr_b16 v[64:65], v4 offset:0
  v_mfma_f32_16x16x32_bf16 a[12:15], v[160:163], v[140:143], a[12:15]
  buffer_load_dwordx4 v12, s[8:11], s20 offen lds
  v_mfma_f32_16x16x32_bf16 a[16:19], v[160:163], v[144:147], a[16:19]
  ds_read_b64_tr_b16 v[66:67], v4 offset:1024
  v_mfma_f32_16x16x32_bf16 a[20:23], v[160:163], v[148:151], a[20:23]
  v_mfma_f32_16x16x32_bf16 a[24:27], v[160:163], v[152:155], a[24:27]
  ds_read_b128 v[100:103], v1 offset:1024
  v_mfma_f32_16x16x32_bf16 a[28:31], v[160:163], v[156:159], a[28:31]
  v_mfma_f32_16x16x32_bf16 a[32:35], v[164:167], v[128:131], a[32:35]
  s_add_u32 m0, s24, 66560
  ds_read_b64_tr_b16 v[68:69], v5 offset:0
  v_mfma_f32_16x16x32_bf16 a[36:39], v[164:167], v[132:135], a[36:39]
  buffer_load_dwordx4 v13, s[8:11], s20 offen lds
  v_mfma_f32_16x16x32_bf16 a[40:43], v[164:167], v[136:139], a[40:43]
  ds_read_b64_tr_b16 v[70:71], v5 offset:1024
  v_mfma_f32_16x16x32_bf16 a[44:47], v[164:167], v[140:143], a[44:47]
  v_mfma_f32_16x16x32_bf16 a[48:51], v[164:167], v[144:147], a[48:51]
  ds_read_b128 v[104:107], v1 offset:2048
  v_mfma_f32_16x16x32_bf16 a[52:55], v[164:167], v[148:151], a[52:55]
  v_mfma_f32_16x16x32_bf16 a[56:59], v[164:167], v[152:155], a[56:59]
  s_add_u32 m0, s24, 67584
  ds_read_b64_tr_b16 v[72:73], v6 offset:0
  v_mfma_f32_16x16x32_bf16 a[60:63], v[164:167], v[156:159], a[60:63]
  buffer_load_dwordx4 v14, s[8:11], s20 offen lds
  v_mfma_f32_16x16x32_bf16 a[64:67], v[168:171], v[128:131], a[64:67]
  ds_read_b64_tr_b16 v[74:75], v6 offset:1024
  v_mfma_f32_16x16x32_bf16 a[68:71], v[168:171], v[132:135], a[68:71]
  v_mfma_f32_16x16x32_bf16 a[72:75], v[168:171], v[136:139], a[72:75]
  ds_read_b128 v[108:111], v1 offset:3072
  v_mfma_f32_16x16x32_bf16 a[76:79], v[168:171], v[140:143], a[76:79]
  v_mfma_f32_16x16x32_bf16 a[80:83], v[168:171], v[144:147], a[80:83]
  s_add_u32 m0, s24, 68608
  ds_read_b64_tr_b16 v[76:77], v7 offset:0
  v_mfma_f32_16x16x32_bf16 a[84:87], v[168:171], v[148:151], a[84:87]
  buffer_load_dwordx4 v15, s[8:11], s20 offen lds
  v_mfma_f32_16x16x32_bf16 a[88:91], v[168:171], v[152:155], a[88:91]
  ds_read_b64_tr_b16 v[78:79], v7 offset:1024
  v_mfma_f32_16x16x32_bf16 a[92:95], v[168:171], v[156:159], a[92:95]
  v_mfma_f32_16x16x32_bf16 a[96:99], v[172:175], v[128:131], a[96:99]
  ds_read_b128 v[112:115], v1 offset:4096
  v_mfma_f32_16x16x32_bf16 a[100:103], v[172:175], v[132:135], a[100:103]
  v_mfma_f32_16x16x32_bf16 a[104:107], v[172:175], v[136:139], a[104:107]
  s_add_u32 m0, s25, 65536
  ds_read_b64_tr_b16 v[80:81], v4 offset:8192
  v_mfma_f32_16x16x32_bf16 a[108:111], v[172:175], v[140:143], a[108:111]
  buffer_load_dwordx4 v16, s[12:15], s21 offen lds
  v_mfma_f32_16x16x32_bf16 a[112:115], v[172:175], v[144:147], a[112:115]
  ds_read_b64_tr_b16 v[82:83], v4 offset:9216
  v_mfma_f32_16x16x32_bf16 a[116:119], v[172:175], v[148:151], a[116:119]
  v_mfma_f32_16x16x32_bf16 a[120:123], v[172:175], v[152:155], a[120:123]
  ds_read_b128 v[116:119], v1 offset:5120
  v_mfma_f32_16x16x32_bf16 a[124:127], v[172:175], v[156:159], a[124:127]
  v_mfma_f32_16x16x32_bf16 a[128:131], v[176:179], v[128:131], a[128:131]
  s_add_u32 m0, s25, 73728
  ds_read_b64_tr_b16 v[84:85], v5 offset:8192
  v_mfma_f32_16x16x32_bf16 a[132:135], v[176:179], v[132:135], a[132:135]
  buffer_load_dwordx4 v16, s[16:19], s22 offen lds
  v_mfma_f32_16x16x32_bf16 a[136:139], v[176:179], v[136:139], a[136:139]
  ds_read_b64_tr_b16 v[86:87], v5 offset:9216
  v_mfma_f32_16x16x32_bf16 a[140:143], v[176:179], v[140:143], a[140:143]
  v_mfma_f32_16x16x32_bf16 a[144:147], v[176:179], v[144:147], a[144:147]
  ds_read_b128 v[120:123], v1 offset:6144
  v_mfma_f32_16x16x32_bf16 a[148:151], v[176:179], v[148:151], a[148:151]
  v_mfma_f32_16x16x32_bf16 a[152:155], v[176:179], v[152:155], a[152:155]
  s_add_u32 m0, s25, 66560
  ds_read_b64_tr_b16 v[88:89], v6 offset:8192
  v_mfma_f32_16x16x32_bf16 a[156:159], v[176:179], v[156:159], a[156:159]
  buffer_load_dwordx4 v17, s[12:15], s21 offen lds
  v_mfma_f32_16x16x32_bf16 a[160:163], v[180:183], v[128:131], a[160:163]
  ds_read_b64_tr_b16 v[90:91], v6 offset:9216
  v_mfma_f32_16x16x32_bf16 a[164:167], v[180:183], v[132:135], a[164:167]
  v_mfma_f32_16x16x32_bf16 a[168:171], v[180:183], v[136:139], a[168:171]
  ds_read_b128 v[124:127], v1 offset:7168
  v_mfma_f32_16x16x32_bf16 a[172:175], v[180:183], v[140:143], a[172:175]
  v_mfma_f32_16x16x32_bf16 a[176:179], v[180:183], v[144:147], a[176:179]
  s_add_u32 m0, s25, 74752
  ds_read_b64_tr_b16 v[92:93], v7 offset:8192
  v_mfma_f32_16x16x32_bf16 a[180:183], v[180:183], v[148:151], a[180:183]
  buffer_load_dwordx4 v17, s[16:19], s22 offen lds
  v_mfma_f32_16x16x32_bf16 a[184:187], v[180:183], v[152:155], a[184:187]
  ds_read_b64_tr_b16 v[94:95], v7 offset:9216
  v_mfma_f32_16x16x32_bf16 a[188:191], v[180:183], v[156:159], a[188:191]
  v_mfma_f32_16x16x32_bf16 a[192:195], v[184:187], v[128:131], a[192:195]
  v_mfma_f32_16x16x32_bf16 a[196:199], v[184:187], v[132:135], a[196:199]
  v_mfma_f32_16x16x32_bf16 a[200:203], v[184:187], v[136:139], a[200:203]
  s_add_u32 s20, s20, 131072
  v_mfma_f32_16x16x32_bf16 a[204:207], v[184:187], v[140:143], a[204:207]
  s_add_u32 s21, s21, s23
  v_mfma_f32_16x16x32_bf16 a[208:211], v[184:187], v[144:147], a[208:211]
  s_add_u32 s22, s22, s23
  v_mfma_f32_16x16x32_bf16 a[212:215], v[184:187], v[148:151], a[212:215]
  v_mfma_f32_16x16x32_bf16 a[216:219], v[184:187], v[152:155], a[216:219]
  v_mfma_f32_16x16x32_bf16 a[220:223], v[184:187], v[156:159], a[220:223]
  v_mfma_f32_16x16x32_bf16 a[224:227], v[188:191], v[128:131], a[224:227]
  v_mfma_f32_16x16x32_bf16 a[228:231], v[188:191], v[132:135], a[228:231]
  v_mfma_f32_16x16x32_bf16 a[232:235], v[188:191], v[136:139], a[232:235]
  v_mfma_f32_16x16x32_bf16 a[236:239], v[188:191], v[140:143], a[236:239]
  v_mfma_f32_16x16x32_bf16 a[240:243], v[188:191], v[144:147], a[240:243]
  v_mfma_f32_16x16x32_bf16 a[244:247], v[188:191], v[148:151], a[244:247]
  v_mfma_f32_16x16x32_bf16 a[248:251], v[188:191], v[152:155], a[248:251]
  v_mfma_f32_16x16x32_bf16 a[252:255], v[188:191], v[156:159], a[252:255]
  s_mov_b32 s26, s31
G_s_loop:
  s_waitcnt vmcnt(8) lgkmcnt(0)
  s_barrier
  v_mfma_f32_16x16x32_bf16 a[0:3], v[96:99], v[64:67], a[0:3]
  ds_read_b128 v[160:163], v1 offset:32768
  v_mfma_f32_16x16x32_bf16 a[4:7], v[96:99], v[68:71], a[4:7]
  v_mfma_f32_16x16x32_bf16 a[8:11], v[96:99], v[72:75], a[8:11]
  s_add_u32 m0, s24, 98304
  ds_read_b64_tr_b16 v[128:129], v4 offset:32768
  v_mfma_f32_16x16x32_bf16 a[12:15], v[96:99], v[76:79], a[12:15]
  buffer_load_dwordx4 v12, s[8:11], s20 offen lds
  v_mfma_f32_16x16x32_bf16 a[16:19], v[96:99], v[80:83], a[16:19]
  ds_read_b64_tr_b16 v[130:131], v4 offset:33792
  v_mfma_f32_16x16x32_bf16 a[20:23], v[96:99], v[84:87], a[20:23]
  v_mfma_f32_16x16x32_bf16 a[24:27], v[96:99], v[88:91], a[24:27]
  ds_read_b128 v[164:167], v1 offset:33792
  v_mfma_f32_16x16x32_bf16 a[28:31], v[96:99], v[92:95], a[28:31]
  v_mfma_f32_16x16x32_bf16 a[32:35], v[100:103], v[64:67], a[32:35]
  s_add_u32 m0, s24, 99328
  ds_read_b64_tr_b16 v[132:133], v5 offset:32768
  v_mfma_f32_16x16x32_bf16 a[36:39], v[100:103], v[68:71], a[36:39]
  buffer_load_dwordx4 v13, s[8:11], s20 offen lds
  v_mfma_f32_16x16x32_bf16 a[40:43], v[100:103], v[72:75], a[40:43]
  ds_read_b64_tr_b16 v[134:135], v5 offset:33792
  v_mfma_f32_16x16x32_bf16 a[44:47], v[100:103], v[76:79], a[44:47]
  v_mfma_f32_16x16x32_bf16 a[48:51], v[100:103], v[80:83], a[48:51]
  ds_read_b128 v[168:171], v1 offset:34816
  v_mfma_f32_16x16x32_bf16 a[52:55], v[100:103], v[84:87], a[52:55]
  v_mfma_f32_16x16x32_bf16 a[56:59], v[100:103], v[88:91], a[56:59]
  s_add_u32 m0, s24, 100352
  ds_read_b64_tr_b16 v[136:137], v6 offset:32768
  v_mfma_f32_16x16x32_bf16 a[60:63], v[100:103], v[92:95], a[60:63]
  buffer_load_dwordx4 v14, s[8:11], s20 offen lds
  v_mfma_f32_16x16x32_bf16 a[64:67], v[104:107], v[64:67], a[64:67]
  ds_read_b64_tr_b16 v[138:139], v6 offset:33792
  v_mfma_f32_16x16x32_bf16 a[68:71], v[104:107], v[68:71], a[68:71]
  v_mfma_f32_16x16x32_bf16 a[72:75], v[104:107], v[72:75], a[72:75]
  ds_read_b128 v[172:175], v1 offset:35840
  v_mfma_f32_16x16x32_bf16 a[76:79], v[104:107], v[76:79], a[76:79]
  v_mfma_f32_16x16x32_bf16 a[80:83], v[104:107], v[80:83], a[80:83]
  s_add_u32 m0, s24, 101376
  ds_read_b64_tr_b16 v[140:141], v7 offset:32768
  v_mfma_f32_16x16x32_bf16 a[84:87], v[104:107], v[84:87], a[84:87]
  buffer_load_dwordx4 v15, s[8:11], s20 offen lds
  v_mfma_f32_16x16x32_bf16 a[88:91], v[104:107], v[88:91], a[88:91]
  ds_read_b64_tr_b16 v[142:143], v7 offset:33792
  v_mfma_f32_16x16x32_bf16 a[92:95], v[104:107], v[92:95], a[92:95]
  v_mfma_f32_16x16x32_bf16 a[96:99], v[108:111], v[64:67], a[96:99]
  ds_read_b128 v[176:179], v1 offset:36864
  v_mfma_f32_16x16x32_bf16 a[100:103], v[108:111], v[68:71], a[100:103]
  v_mfma_f32_16x16x32_bf16 a[104:107], v[108:111], v[72:75], a[104:107]
  s_add_u32 m0, s25, 98304
  ds_read_b64_tr_b16 v[144:145], v4 offset:40960
  v_mfma_f32_16x16x32_bf16 a[108:111], v[108:111], v[76:79], a[108:111]
  buffer_load_dwordx4 v16, s[12:15], s21 offen lds
  v_mfma_f32_16x16x32_bf16 a[112:115], v[108:111], v[80:83], a[112:115]
  ds_read_b64_tr_b16 v[146:147], v4 offset:41984
  v_mfma_f32_16x16x32_bf16 a[116:119], v[108:111], v[84:87], a[116:119]
  v_mfma_f32_16x16x32_bf16 a[120:123], v[108:111], v[88:91], a[120:123]
  ds_read_b128 v[180:183], v1 offset:37888
  v_mfma_f32_16x16x32_bf16 a[124:127], v[108:111], v[92:95], a[124:127]
  v_mfma_f32_16x16x32_bf16 a[128:131], v[112:115], v[64:67], a[128:131]
  s_add_u32 m0, s25, 106496
  ds_read_b64_tr_b16 v[148:149], v5 offset:40960
  v_mfma_f32_16x16x32_bf16 a[132:135], v[112:115], v[68:71], a[132:135]
  buffer_load_dwordx4 v16, s[16:19], s22 offen lds
  v_mfma_f32_16x16x32_bf16 a[136:139], v[112:115], v[72:75], a[136:139]
  ds_read_b64_tr_b16 v[150:151], v5 offset:41984
  v_mfma_f32_16x16x32_bf16 a[140:143], v[112:115], v[76:79], a[140:143]
  v_mfma_f32_16x16x32_bf16 a[144:147], v[112:115], v[80:83], a[144:147]
  ds_read_b128 v[184:187], v1 offset:38912
  v_mfma_f32_16x16x32_bf16 a[148:151], v[112:115], v[84:87], a[148:151]
  v_mfma_f32_16x16x32_bf16 a[152:155], v[112:115], v[88:91], a[152:155]
  s_add_u32 m0, s25, 99328
  ds_read_b64_tr_b16 v[152:153], v6 offset:40960
  v_mfma_f32_16x16x32_bf16 a[156:159], v[112:115], v[92:95], a[156:159]
  buffer_load_dwordx4 v17, s[12:15], s21 offen lds
  v_mfma_f32_16x16x32_bf16 a[160:163], v[116:119], v[64:67], a[160:163]
  ds_read_b64_tr_b16 v[154:155], v6 offset:41984
  v_mfma_f32_16x16x32_bf16 a[164:167], v[116:119], v[68:71], a[164:167]
  v_mfma_f32_16x16x32_bf16 a[168:171], v[116:119], v[72:75], a[168:171]
  ds_read_b128 v[188:191], v1 offset:39936
  v_mfma_f32_16x16x32_bf16 a[172:175], v[116:119], v[76:79], a[172:175]
  v_mfma_f32_16x16x32_bf16 a[176:179], v[116:119], v[80:83], a[176:179]
  s_add_u32 m0, s25, 107520
  ds_read_b64_tr_b16 v[156:157], v7 offset:40960
  v_mfma_f32_16x16x32_bf16 a[180:183], v[116:119], v[84:87], a[180:183]
  buffer_load_dwordx4 v17, s[16:19], s22 offen lds
  v_mfma_f32_16x16x32_bf16 a[184:187], v[116:119], v[88:91], a[184:187]
  ds_read_b64_tr_b16 v[158:159], v7 offset:41984
  v_mfma_f32_16x16x32_bf16 a[188:191], v[116:119], v[92:95], a[188:191]
  v_mfma_f32_16x16x32_bf16 a[192:195], v[120:123], v[64:67], a[192:195]
  v_mfma_f32_16x16x32_bf16 a[196:199], v[120:123], v[68:71], a[196:199]
  v_mfma_f32_16x16x32_bf16 a[200:203], v[120:123], v[72:75], a[200:203]
  s_add_u32 s20, s20, 131072
  v_mfma_f32_16x16x32_bf16 a[204:207], v[120:123], v[76:79], a[204:207]
  s_add_u32 s21, s21, s23
  v_mfma_f32_16x16x32_bf16 a[208:211], v[120:123], v[80:83], a[208:211]
  s_add_u32 s22, s22, s23
  v_mfma_f32_16x16x32_bf16 a[212:215], v[120:123], v[84:87], a[212:215]
  v_mfma_f32_16x16x32_bf16 a[216:219], v[120:123], v[88:91], a[216:219]
  v_mfma_f32_16x16x32_bf16 a[220:223], v[120:123], v[92:95], a[220:223]
  v_mfma_f32_16x16x32_bf16 a[224:227], v[124:127], v[64:67], a[224:227]
  v_mfma_f32_16x16x32_bf16 a[228:231], v[124:127], v[68:71], a[228:231]
  v_mfma_f32_16x16x32_bf16 a[232:235], v[124:127], v[72:75], a[232:235]
  v_mfma_f32_16x16x32_bf16 a[236:239], v[124:127], v[76:79], a[236:239]
  v_mfma_f32_16x16x32_bf16 a[240:243], v[124:127], v[80:83], a[240:243]
  v_mfma_f32_16x16x32_bf16 a[244:247], v[124:127], v[84:87], a[244:247]
  v_mfma_f32_16x16x32_bf16 a[248:251], v[124:127], v[88:91], a[248:251]
  v_mfma_f32_16x16x32_bf16 a[252:255], v[124:127], v[92:95], a[252:255]
  s_waitcnt vmcnt(8) lgkmcnt(0)
  s_barrier
  v_mfma_f32_16x16x32_bf16 a[0:3], v[160:163], v[128:131], a[0:3]
  ds_read_b128 v[96:99], v2 offset:0
  v_mfma_f32_16x16x32_bf16 a[4:7], v[160:163], v[132:135], a[4:7]
  v_mfma_f32_16x16x32_bf16 a[8:11], v[160:163], v[136:139], a[8:11]
  s_add_u32 m0, s24, 0
  ds_read_b64_tr_b16 v[64:65], v8 offset:0
  v_mfma_f32_16x16x32_bf16 a[12:15], v[160:163], v[140:143], a[12:15]
  buffer_load_dwordx4 v12, s[8:11], s20 offen lds
  v_mfma_f32_16x16x32_bf16 a[16:19], v[160:163], v[144:147], a[16:19]
  ds_read_b64_tr_b16 v[66:67], v8 offset:1024
  v_mfma_f32_16x16x32_bf16 a[20:23], v[160:163], v[148:151], a[20:23]
  v_mfma_f32_16x16x32_bf16 a[24:27], v[160:163], v[152:155], a[24:27]
  ds_read_b128 v[100:103], v2 offset:1024
  v_mfma_f32_16x16x32_bf16 a[28:31], v[160:163], v[156:159], a[28:31]
  v_mfma_f32_16x16x32_bf16 a[32:35], v[164:167], v[128:131], a[32:35]
  s_add_u32 m0, s24, 1024
  ds_read_b64_tr_b16 v[68:69], v9 offset:0
  v_mfma_f32_16x16x32_bf16 a[36:39], v[164:167], v[132:135], a[36:39]
  buffer_load_dwordx4 v13, s[8:11], s20 offen lds
  v_mfma_f32_16x16x32_bf16 a[40:43], v[164:167], v[136:139], a[40:43]
  ds_read_b64_tr_b16 v[70:71], v9 offset:1024
  v_mfma_f32_16x16x32_bf16 a[44:47], v[164:167], v[140:143], a[44:47]
  v_mfma_f32_16x16x32_bf16 a[48:51], v[164:167], v[144:147], a[48:51]
  ds_read_b128 v[104:107], v2 offset:2048
  v_mfma_f32_16x16x32_bf16 a[52:55], v[164:167], v[148:151], a[52:55]
  v_mfma_f32_16x16x32_bf16 a[56:59], v[164:167], v[152:155], a[56:59]
  s_add_u32 m0, s24, 2048
  ds_read_b64_tr_b16 v[72:73], v10 offset:0
  v_mfma_f32_16x16x32_bf16 a[60:63], v[164:167], v[156:159], a[60:63]
  buffer_load_dwordx4 v14, s[8:11], s20 offen lds
  v_mfma_f32_16x16x32_bf16 a[64:67], v[168:171], v[128:131], a[64:67]
  ds_read_b64_tr_b16 v[74:75], v10 offset:1024
  v_mfma_f32_16x16x32_bf16 a[68:71], v[168:171], v[132:135], a[68:71]
  v_mfma_f32_16x16x32_bf16 a[72:75], v[168:171], v[136:139], a[72:75]
  ds_read_b128 v[108:111], v2 offset:3072
  v_mfma_f32_16x16x32_bf16 a[76:79], v[168:171], v[140:143], a[76:79]
  v_mfma_f32_16x16x32_bf16 a[80:83], v[168:171], v[144:147], a[80:83]
  s_add_u32 m0, s24, 3072
  ds_read_b64_tr_b16 v[76:77], v11 offset:0
  v_mfma_f32_16x16x32_bf16 a[84:87], v[168:171], v[148:151], a[84:87]
  buffer_load_dwordx4 v15, s[8:11], s20 offen lds
  v_mfma_f32_16x16x32_bf16 a[88:91], v[168:171], v[152:155], a[88:91]
  ds_read_b64_tr_b16 v[78:79], v11 offset:1024
  v_mfma_f32_16x16x32_bf16 a[92:95], v[168:171], v[156:159], a[92:95]
  v_mfma_f32_16x16x32_bf16 a[96:99], v[172:175], v[128:131], a[96:99]
  ds_read_b128 v[112:115], v2 offset:4096
  v_mfma_f32_16x16x32_bf16 a[100:103], v[172:175], v[132:135], a[100:103]
  v_mfma_f32_16x16x32_bf16 a[104:107], v[172:175], v[136:139], a[104:107]
  s_add_u32 m0, s25, 0
  ds_read_b64_tr_b16 v[80:81], v8 offset:8192
  v_mfma_f32_16x16x32_bf16 a[108:111], v[172:175], v[140:143], a[108:111]
  buffer_load_dwordx4 v16, s[12:15], s21 offen lds
  v_mfma_f32_16x16x32_bf16 a[112:115], v[172:175], v[144:147], a[112:115]
  ds_read_b64_tr_b16 v[82:83], v8 offset:9216
  v_mfma_f32_16x16x32_bf16 a[116:119], v[172:175], v[148:151], a[116:119]
  v_mfma_f32_16x16x32_bf16 a[120:123], v[172:175], v[152:155], a[120:123]
  ds_read_b128 v[116:119], v2 offset:5120
  v_mfma_f32_16x16x32_bf16 a[124:127], v[172:175], v[156:159], a[124:127]
  v_mfma_f32_16x16x32_bf16 a[128:131], v[176:179], v[128:131], a[128:131]
  s_add_u32 m0, s25, 8192
  ds_read_b64_tr_b16 v[84:85], v9 offset:8192
  v_mfma_f32_16x16x32_bf16 a[132:135], v[176:179], v[132:135], a[132:135]
  buffer_load_dwordx4 v16, s[16:19], s22 offen lds
  v_mfma_f32_16x16x32_bf16 a[136:139], v[176:179], v[136:139], a[136:139]
  ds_read_b64_tr_b16 v[86:87], v9 offset:9216
  v_mfma_f32_16x16x32_bf16 a[140:143], v[176:179], v[140:143], a[140:143]
  v_mfma_f32_16x16x32_bf16 a[144:147], v[176:179], v[144:147], a[144:147]
  ds_read_b128 v[120:123], v2 offset:6144
  v_mfma_f32_16x16x32_bf16 a[148:151], v[176:179], v[148:151], a[148:151]
  v_mfma_f32_16x16x32_bf16 a[152:155], v[176:179], v[152:155], a[152:155]
  s_add_u32 m0, s25, 1024
  ds_read_b64_tr_b16 v[88:89], v10 offset:8192
  v_mfma_f32_16x16x32_bf16 a[156:159], v[176:179], v[156:159], a[156:159]
  buffer_load_dwordx4 v17, s[12:15], s21 offen lds
  v_mfma_f32_16x16x32_bf16 a[160:163], v[180:183], v[128:131], a[160:163]
  ds_read_b64_tr_b16 v[90:91], v10 offset:9216
  v_mfma_f32_16x16x32_bf16 a[164:167], v[180:183], v[132:135], a[164:167]
  v_mfma_f32_16x16x32_bf16 a[168:171], v[180:183], v[136:139], a[168:171]
  ds_read_b128 v[124:127], v2 offset:7168
  v_mfma_f32_16x16x32_bf16 a[172:175], v[180:183], v[140:143], a[172:175]
  v_mfma_f32_16x16x32_bf16 a[176:179], v[180:183], v[144:147], a[176:179]
  s_add_u32 m0, s25, 9216
  ds_read_b64_tr_b16 v[92:93], v11 offset:8192
  v_mfma_f32_16x16x32_bf16 a[180:183], v[180:183], v[148:151], a[180:183]
  buffer_load_dwordx4 v17, s[16:19], s22 offen lds
  v_mfma_f32_16x16x32_bf16 a[184:187], v[180:183], v[152:155], a[184:187]
  ds_read_b64_tr_b16 v[94:95], v11 offset:9216
  v_mfma_f32_16x16x32_bf16 a[188:191], v[180:183], v[156:159], a[188:191]
  v_mfma_f32_16x16x32_bf16 a[192:195], v[184:187], v[128:131], a[192:195]
  v_mfma_f32_16x16x32_bf16 a[196:199], v[184:187], v[132:135], a[196:199]
  v_mfma_f32_16x16x32_bf16 a[200:203], v[184:187], v[136:139], a[200:203]
  s_add_u32 s20, s20, 131072
  v_mfma_f32_16x16x32_bf16 a[204:207], v[184:187], v[140:143], a[204:207]
  s_add_u32 s21, s21, s23
  v_mfma_f32_16x16x32_bf16 a[208:211], v[184:187], v[144:147], a[208:211]
  s_add_u32 s22, s22, s23
  v_mfma_f32_16x16x32_bf16 a[212:215], v[184:187], v[148:151], a[212:215]
  v_mfma_f32_16x16x32_bf16 a[216:219], v[184:187], v[152:155], a[216:219]
  v_mfma_f32_16x16x32_bf16 a[220:223], v[184:187], v[156:159], a[220:223]
  v_mfma_f32_16x16x32_bf16 a[224:227], v[188:191], v[128:131], a[224:227]
  v_mfma_f32_16x16x32_bf16 a[228:231], v[188:191], v[132:135], a[228:231]
  v_mfma_f32_16x16x32_bf16 a[232:235], v[188:191], v[136:139], a[232:235]
  v_mfma_f32_16x16x32_bf16 a[236:239], v[188:191], v[140:143], a[236:239]
  v_mfma_f32_16x16x32_bf16 a[240:243], v[188:191], v[144:147], a[240:243]
  v_mfma_f32_16x16x32_bf16 a[244:247], v[188:191], v[148:151], a[244:247]
  v_mfma_f32_16x16x32_bf16 a[248:251], v[188:191], v[152:155], a[248:251]
  v_mfma_f32_16x16x32_bf16 a[252:255], v[188:191], v[156:159], a[252:255]
  s_waitcnt vmcnt(8) lgkmcnt(0)
  s_barrier
  v_mfma_f32_16x16x32_bf16 a[0:3], v[96:99], v[64:67], a[0:3]
  ds_read_b128 v[160:163], v2 offset:32768
  v_mfma_f32_16x16x32_bf16 a[4:7], v[96:99], v[68:71], a[4:7]
  v_mfma_f32_16x16x32_bf16 a[8:11], v[96:99], v[72:75], a[8:11]
  s_add_u32 m0, s24, 32768
  ds_read_b64_tr_b16 v[128:129], v8 offset:32768
  v_mfma_f32_16x16x32_bf16 a[12:15], v[96:99], v[76:79], a[12:15]
  buffer_load_dwordx4 v12, s[8:11], s20 offen lds
  v_mfma_f32_16x16x32_bf16 a[16:19], v[96:99], v[80:83], a[16:19]
  ds_read_b64_tr_b16 v[130:131], v8 offset:33792
  v_mfma_f32_16x16x32_bf16 a[20:23], v[96:99], v[84:87], a[20:23]
  v_mfma_f32_16x16x32_bf16 a[24:27], v[96:99], v[88:91], a[24:27]
  ds_read_b128 v[164:167], v2 offset:33792
  v_mfma_f32_16x16x32_bf16 a[28:31], v[96:99], v[92:95], a[28:31]
  v_mfma_f32_16x16x32_bf16 a[32:35], v[100:103], v[64:67], a[32:35]
  s_add_u32 m0, s24, 33792
  ds_read_b64_tr_b16 v[132:133], v9 offset:32768
  v_mfma_f32_16x16x32_bf16 a[36:39], v[100:103], v[68:71], a[36:39]
  buffer_load_dwordx4 v13, s[8:11], s20 offen lds
  v_mfma_f32_16x16x32_bf16 a[40:43], v[100:103], v[72:75], a[40:43]
  ds_read_b64_tr_b16 v[134:135], v9 offset:33792
  v_mfma_f32_16x16x32_bf16 a[44:47], v[100:103], v[76:79], a[44:47]
  v_mfma_f32_16x16x32_bf16 a[48:51], v[100:103], v[80:83], a[48:51]
  ds_read_b128 v[168:171], v2 offset:34816
  v_mfma_f32_16x16x32_bf16 a[52:55], v[100:103], v[84:87], a[52:55]
  v_mfma_f32_16x16x32_bf16 a[56:59], v[100:103], v[88:91], a[56:59]
  s_add_u32 m0, s24, 34816
  ds_read_b64_tr_b16 v[136:137], v10 offset:32768
  v_mfma_f32_16x16x32_bf16 a[60:63], v[100:103], v[92:95], a[60:63]
  buffer_load_dwordx4 v14, s[8:11], s20 offen lds
  v_mfma_f32_16x16x32_bf16 a[64:67], v[104:107], v[64:67], a[64:67]
  ds_read_b64_tr_b16 v[138:139], v10 offset:33792
  v_mfma_f32_16x16x32_bf16 a[68:71], v[104:107], v[68:71], a[68:71]
  v_mfma_f32_16x16x32_bf16 a[72:75], v[104:107], v[72:75], a[72:75]
  ds_read_b128 v[172:175], v2 offset:35840
  v_mfma_f32_16x16x32_bf16 a[76:79], v[104:107], v[76:79], a[76:79]
  v_mfma_f32_16x16x32_bf16 a[80:83], v[104:107], v[80:83], a[80:83]
  s_add_u32 m0, s24, 35840
  ds_read_b64_tr_b16 v[140:141], v11 offset:32768
  v_mfma_f32_16x16x32_bf16 a[84:87], v[104:107], v[84:87], a[84:87]
  buffer_load_dwordx4 v15, s[8:11], s20 offen lds
  v_mfma_f32_16x16x32_bf16 a[88:91], v[104:107], v[88:91], a[88:91]
  ds_read_b64_tr_b16 v[142:143], v11 offset:33792
  v_mfma_f32_16x16x32_bf16 a[92:95], v[104:107], v[92:95], a[92:95]
  v_mfma_f32_16x16x32_bf16 a[96:99], v[108:111], v[64:67], a[96:99]
  ds_read_b128 v[176:179], v2 offset:36864
  v_mfma_f32_16x16x32_bf16 a[100:103], v[108:111], v[68:71], a[100:103]
  v_mfma_f32_16x16x32_bf16 a[104:107], v[108:111], v[72:75], a[104:107]
  s_add_u32 m0, s25, 32768
  ds_read_b64_tr_b16 v[144:145], v8 offset:40960
  v_mfma_f32_16x16x32_bf16 a[108:111], v[108:111], v[76:79], a[108:111]
  buffer_load_dwordx4 v16, s[12:15], s21 offen lds
  v_mfma_f32_16x16x32_bf16 a[112:115], v[108:111], v[80:83], a[112:115]
  ds_read_b64_tr_b16 v[146:147], v8 offset:41984
  v_mfma_f32_16x16x32_bf16 a[116:119], v[108:111], v[84:87], a[116:119]
  v_mfma_f32_16x16x32_bf16 a[120:123], v[108:111], v[88:91], a[120:123]
  ds_read_b128 v[180:183], v2 offset:37888
  v_mfma_f32_16x16x32_bf16 a[124:127], v[108:111], v[92:95], a[124:127]
  v_mfma_f32_16x16x32_bf16 a[128:131], v[112:115], v[64:67], a[128:131]
  s_add_u32 m0, s25, 40960
  ds_read_b64_tr_b16 v[148:149], v9 offset:40960
  v_mfma_f32_16x16x32_bf16 a[132:135], v[112:115], v[68:71], a[132:135]
  buffer_load_dwordx4 v16, s[16:19], s22 offen lds
  v_mfma_f32_16x16x32_bf16 a[136:139], v[112:115], v[72:75], a[136:139]
  ds_read_b64_tr_b16 v[150:151], v9 offset:41984
  v_mfma_f32_16x16x32_bf16 a[140:143], v[112:115], v[76:79], a[140:143]
  v_mfma_f32_16x16x32_bf16 a[144:147], v[112:115], v[80:83], a[144:147]
  ds_read_b128 v[184:187], v2 offset:38912
  v_mfma_f32_16x16x32_bf16 a[148:151], v[112:115], v[84:87], a[148:151]
  v_mfma_f32_16x16x32_bf16 a[152:155], v[112:115], v[88:91], a[152:155]
  s_add_u32 m0, s25, 33792
  ds_read_b64_tr_b16 v[152:153], v10 offset:40960
  v_mfma_f32_16x16x32_bf16 a[156:159], v[112:115], v[92:95], a[156:159]
  buffer_load_dwordx4 v17, s[12:15], s21 offen lds
  v_mfma_f32_16x16x32_bf16 a[160:163], v[116:119], v[64:67], a[160:163]
  ds_read_b64_tr_b16 v[154:155], v10 offset:41984
  v_mfma_f32_16x16x32_bf16 a[164:167], v[116:119], v[68:71], a[164:167]
  v_mfma_f32_16x16x32_bf16 a[168:171], v[116:119], v[72:75], a[168:171]
  ds_read_b128 v[188:191], v2 offset:39936
  v_mfma_f32_16x16x32_bf16 a[172:175], v[116:119], v[76:79], a[172:175]
  v_mfma_f32_16x16x32_bf16 a[176:179], v[116:119], v[80:83], a[176:179]
  s_add_u32 m0, s25, 41984
  ds_read_b64_tr_b16 v[156:157], v11 offset:40960
  v_mfma_f32_16x16x32_bf16 a[180:183], v[116:119], v[84:87], a[180:183]
  buffer_load_dwordx4 v17, s[16:19], s22 offen lds
  v_mfma_f32_16x16x32_bf16 a[184:187], v[116:119], v[88:91], a[184:187]
  ds_read_b64_tr_b16 v[158:159], v11 offset:41984
  v_mfma_f32_16x16x32_bf16 a[188:191], v[116:119], v[92:95], a[188:191]
  v_mfma_f32_16x16x32_bf16 a[192:195], v[120:123], v[64:67], a[192:195]
  v_mfma_f32_16x16x32_bf16 a[196:199], v[120:123], v[68:71], a[196:199]
  v_mfma_f32_16x16x32_bf16 a[200:203], v[120:123], v[72:75], a[200:203]
  s_add_u32 s20, s20, 131072
  v_mfma_f32_16x16x32_bf16 a[204:207], v[120:123], v[76:79], a[204:207]
  s_add_u32 s21, s21, s23
  v_mfma_f32_16x16x32_bf16 a[208:211], v[120:123], v[80:83], a[208:211]
  s_add_u32 s22, s22, s23
  v_mfma_f32_16x16x32_bf16 a[212:215], v[120:123], v[84:87], a[212:215]
  v_mfma_f32_16x16x32_bf16 a[216:219], v[120:123], v[88:91], a[216:219]
  v_mfma_f32_16x16x32_bf16 a[220:223], v[120:123], v[92:95], a[220:223]
  v_mfma_f32_16x16x32_bf16 a[224:227], v[124:127], v[64:67], a[224:227]
  v_mfma_f32_16x16x32_bf16 a[228:231], v[124:127], v[68:71], a[228:231]
  v_mfma_f32_16x16x32_bf16 a[232:235], v[124:127], v[72:75], a[232:235]
  v_mfma_f32_16x16x32_bf16 a[236:239], v[124:127], v[76:79], a[236:239]
  v_mfma_f32_16x16x32_bf16 a[240:243], v[124:127], v[80:83], a[240:243]
  v_mfma_f32_16x16x32_bf16 a[244:247], v[124:127], v[84:87], a[244:247]
  v_mfma_f32_16x16x32_bf16 a[248:251], v[124:127], v[88:91], a[248:251]
  v_mfma_f32_16x16x32_bf16 a[252:255], v[124:127], v[92:95], a[252:255]
  s_waitcnt vmcnt(8) lgkmcnt(0)
  s_barrier
  v_mfma_f32_16x16x32_bf16 a[0:3], v[160:163], v[128:131], a[0:3]
  ds_read_b128 v[96:99], v1 offset:0
  v_mfma_f32_16x16x32_bf16 a[4:7], v[160:163], v[132:135], a[4:7]
  v_mfma_f32_16x16x32_bf16 a[8:11], v[160:163], v[136:139], a[8:11]
  s_add_u32 m0, s24, 65536
  ds_read_b64_tr_b16 v[64:65], v4 offset:0
  v_mfma_f32_16x16x32_bf16 a[12:15], v[160:163], v[140:143], a[12:15]
  buffer_load_dwordx4 v12, s[8:11], s20 offen lds
  v_mfma_f32_16x16x32_bf16 a[16:19], v[160:163], v[144:147], a[16:19]
  ds_read_b64_tr_b16 v[66:67], v4 offset:1024
  v_mfma_f32_16x16x32_bf16 a[20:23], v[160:163], v[148:151], a[20:23]
  v_mfma_f32_16x16x32_bf16 a[24:27], v[160:163], v[152:155], a[24:27]
  ds_read_b128 v[100:103], v1 offset:1024
  v_mfma_f32_16x16x32_bf16 a[28:31], v[160:163], v[156:159], a[28:31]
  v_mfma_f32_16x16x32_bf16 a[32:35], v[164:167], v[128:131], a[32:35]
  s_add_u32 m0, s24, 66560
  ds_read_b64_tr_b16 v[68:69], v5 offset:0
  v_mfma_f32_16x16x32_bf16 a[36:39], v[164:167], v[132:135], a[36:39]
  buffer_load_dwordx4 v13, s[8:11], s20 offen lds
  v_mfma_f32_16x16x32_bf16 a[40:43], v[164:167], v[136:139], a[40:43]
  ds_read_b64_tr_b16 v[70:71], v5 offset:1024
  v_mfma_f32_16x16x32_bf16 a[44:47], v[164:167], v[140:143], a[44:47]
  v_mfma_f32_16x16x32_bf16 a[48:51], v[164:167], v[144:147], a[48:51]
  ds_read_b128 v[104:107], v1 offset:2048
  v_mfma_f32_16x16x32_bf16 a[52:55], v[164:167], v[148:151], a[52:55]
  v_mfma_f32_16x16x32_bf16 a[56:59], v[164:167], v[152:155], a[56:59]
  s_add_u32 m0, s24, 67584
  ds_read_b64_tr_b16 v[72:73], v6 offset:0
  v_mfma_f32_16x16x32_bf16 a[60:63], v[164:167], v[156:159], a[60:63]
  buffer_load_dwordx4 v14, s[8:11], s20 offen lds
  v_mfma_f32_16x16x32_bf16 a[64:67], v[168:171], v[128:131], a[64:67]
  ds_read_b64_tr_b16 v[74:75], v6 offset:1024
  v_mfma_f32_16x16x32_bf16 a[68:71], v[168:171], v[132:135], a[68:71]
  v_mfma_f32_16x16x32_bf16 a[72:75], v[168:171], v[136:139], a[72:75]
  ds_read_b128 v[108:111], v1 offset:3072
  v_mfma_f32_16x16x32_bf16 a[76:79], v[168:171], v[140:143], a[76:79]
  v_mfma_f32_16x16x32_bf16 a[80:83], v[168:171], v[144:147], a[80:83]
  s_add_u32 m0, s24, 68608
  ds_read_b64_tr_b16 v[76:77], v7 offset:0
  v_mfma_f32_16x16x32_bf16 a[84:87], v[168:171], v[148:151], a[84:87]
  buffer_load_dwordx4 v15, s[8:11], s20 offen lds
  v_mfma_f32_16x16x32_bf16 a[88:91], v[168:171], v[152:155], a[88:91]
  ds_read_b64_tr_b16 v[78:79], v7 offset:1024
  v_mfma_f32_16x16x32_bf16 a[92:95], v[168:171], v[156:159], a[92:95]
  v_mfma_f32_16x16x32_bf16 a[96:99], v[172:175], v[128:131], a[96:99]
  ds_read_b128 v[112:115], v1 offset:4096
  v_mfma_f32_16x16x32_bf16 a[100:103], v[172:175], v[132:135], a[100:103]
  v_mfma_f32_16x16x32_bf16 a[104:107], v[172:175], v[136:139], a[104:107]
  s_add_u32 m0, s25, 65536
  ds_read_b64_tr_b16 v[80:81], v4 offset:8192
  v_mfma_f32_16x16x32_bf16 a[108:111], v[172:175], v[140:143], a[108:111]
  buffer_load_dwordx4 v16, s[12:15], s21 offen lds
  v_mfma_f32_16x16x32_bf16 a[112:115], v[172:175], v[144:147], a[112:115]
  ds_read_b64_tr_b16 v[82:83], v4 offset:9216
  v_mfma_f32_16x16x32_bf16 a[116:119], v[172:175], v[148:151], a[116:119]
  v_mfma_f32_16x16x32_bf16 a[120:123], v[172:175], v[152:155], a[120:123]
  ds_read_b128 v[116:119], v1 offset:5120
  v_mfma_f32_16x16x32_bf16 a[124:127], v[172:175], v[156:159], a[124:127]
  v_mfma_f32_16x16x32_bf16 a[128:131], v[176:179], v[128:131], a[128:131]
  s_add_u32 m0, s25, 73728
  ds_read_b64_tr_b16 v[84:85], v5 offset:8192
  v_mfma_f32_16x16x32_bf16 a[132:135], v[176:179], v[132:135], a[132:135]
  buffer_load_dwordx4 v16, s[16:19], s22 offen lds
  v_mfma_f32_16x16x32_bf16 a[136:139], v[176:179], v[136:139], a[136:139]
  ds_read_b64_tr_b16 v[86:87], v5 offset:9216
  v_mfma_f32_16x16x32_bf16 a[140:143], v[176:179], v[140:143], a[140:143]
  v_mfma_f32_16x16x32_bf16 a[144:147], v[176:179], v[144:147], a[144:147]
  ds_read_b128 v[120:123], v1 offset:6144
  v_mfma_f32_16x16x32_bf16 a[148:151], v[176:179], v[148:151], a[148:151]
  v_mfma_f32_16x16x32_bf16 a[152:155], v[176:179], v[152:155], a[152:155]
  s_add_u32 m0, s25, 66560
  ds_read_b64_tr_b16 v[88:89], v6 offset:8192
  v_mfma_f32_16x16x32_bf16 a[156:159], v[176:179], v[156:159], a[156:159]
  buffer_load_dwordx4 v17, s[12:15], s21 offen lds
  v_mfma_f32_16x16x32_bf16 a[160:163], v[180:183], v[128:131], a[160:163]
  ds_read_b64_tr_b16 v[90:91], v6 offset:9216
  v_mfma_f32_16x16x32_bf16 a[164:167], v[180:183], v[132:135], a[164:167]
  v_mfma_f32_16x16x32_bf16 a[168:171], v[180:183], v[136:139], a[168:171]
  ds_read_b128 v[124:127], v1 offset:7168
  v_mfma_f32_16x16x32_bf16 a[172:175], v[180:183], v[140:143], a[172:175]
  v_mfma_f32_16x16x32_bf16 a[176:179], v[180:183], v[144:147], a[176:179]
  s_add_u32 m0, s25, 74752
  ds_read_b64_tr_b16 v[92:93], v7 offset:8192
  v_mfma_f32_16x16x32_bf16 a[180:183], v[180:183], v[148:151], a[180:183]
  buffer_load_dwordx4 v17, s[16:19], s22 offen lds
  v_mfma_f32_16x16x32_bf16 a[184:187], v[180:183], v[152:155], a[184:187]
  ds_read_b64_tr_b16 v[94:95], v7 offset:9216
  v_mfma_f32_16x16x32_bf16 a[188:191], v[180:183], v[156:159], a[188:191]
  v_mfma_f32_16x16x32_bf16 a[192:195], v[184:187], v[128:131], a[192:195]
  v_mfma_f32_16x16x32_bf16 a[196:199], v[184:187], v[132:135], a[196:199]
  v_mfma_f32_16x16x32_bf16 a[200:203], v[184:187], v[136:139], a[200:203]
  s_add_u32 s20, s20, 131072
  v_mfma_f32_16x16x32_bf16 a[204:207], v[184:187], v[140:143], a[204:207]
  s_add_u32 s21, s21, s23
  v_mfma_f32_16x16x32_bf16 a[208:211], v[184:187], v[144:147], a[208:211]
  s_add_u32 s22, s22, s23
  v_mfma_f32_16x16x32_bf16 a[212:215], v[184:187], v[148:151], a[212:215]
  v_mfma_f32_16x16x32_bf16 a[216:219], v[184:187], v[152:155], a[216:219]
  v_mfma_f32_16x16x32_bf16 a[220:223], v[184:187], v[156:159], a[220:223]
  v_mfma_f32_16x16x32_bf16 a[224:227], v[188:191], v[128:131], a[224:227]
  v_mfma_f32_16x16x32_bf16 a[228:231], v[188:191], v[132:135], a[228:231]
  v_mfma_f32_16x16x32_bf16 a[232:235], v[188:191], v[136:139], a[232:235]
  v_mfma_f32_16x16x32_bf16 a[236:239], v[188:191], v[140:143], a[236:239]
  v_mfma_f32_16x16x32_bf16 a[240:243], v[188:191], v[144:147], a[240:243]
  v_mfma_f32_16x16x32_bf16 a[244:247], v[188:191], v[148:151], a[244:247]
  v_mfma_f32_16x16x32_bf16 a[248:251], v[188:191], v[152:155], a[248:251]
  v_mfma_f32_16x16x32_bf16 a[252:255], v[188:191], v[156:159], a[252:255]
  s_sub_u32 s26, s26, 1
  s_cmp_lg_u32 s26, 0
  s_cbranch_scc1 G_s_loop
  s_waitcnt vmcnt(8) lgkmcnt(0)
  s_barrier
  v_mfma_f32_16x16x32_bf16 a[0:3], v[96:99], v[64:67], a[0:3]
  ds_read_b128 v[160:163], v1 offset:32768
  v_mfma_f32_16x16x32_bf16 a[4:7], v[96:99], v[68:71], a[4:7]
  v_mfma_f32_16x16x32_bf16 a[8:11], v[96:99], v[72:75], a[8:11]
  s_add_u32 m0, s24, 98304
  ds_read_b64_tr_b16 v[128:129], v4 offset:32768
  v_mfma_f32_16x16x32_bf16 a[12:15], v[96:99], v[76:79], a[12:15]
  buffer_load_dwordx4 v12, s[8:11], s20 offen lds
  v_mfma_f32_16x16x32_bf16 a[16:19], v[96:99], v[80:83], a[16:19]
  ds_read_b64_tr_b16 v[130:131], v4 offset:33792
  v_mfma_f32_16x16x32_bf16 a[20:23], v[96:99], v[84:87], a[20:23]
  v_mfma_f32_16x16x32_bf16 a[24:27], v[96:99], v[88:91], a[24:27]
  ds_read_b128 v[164:167], v1 offset:33792
  v_mfma_f32_16x16x32_bf16 a[28:31], v[96:99], v[92:95], a[28:31]
  v_mfma_f32_16x16x32_bf16 a[32:35], v[100:103], v[64:67], a[32:35]
  s_add_u32 m0, s24, 99328
  ds_read_b64_tr_b16 v[132:133], v5 offset:32768
  v_mfma_f32_16x16x32_bf16 a[36:39], v[100:103], v[68:71], a[36:39]
  buffer_load_dwordx4 v13, s[8:11], s20 offen lds
  v_mfma_f32_16x16x32_bf16 a[40:43], v[100:103], v[72:75], a[40:43]
  ds_read_b64_tr_b16 v[134:135], v5 offset:33792
  v_mfma_f32_16x16x32_bf16 a[44:47], v[100:103], v[76:79], a[44:47]
  v_mfma_f32_16x16x32_bf16 a[48:51], v[100:103], v[80:83], a[48:51]
  ds_read_b128 v[168:171], v1 offset:34816
  v_mfma_f32_16x16x32_bf16 a[52:55], v[100:103], v[84:87], a[52:55]
  v_mfma_f32_16x16x32_bf16 a[56:59], v[100:103], v[88:91], a[56:59]
  s_add_u32 m0, s24, 100352
  ds_read_b64_tr_b16 v[136:137], v6 offset:32768
  v_mfma_f32_16x16x32_bf16 a[60:63], v[100:103], v[92:95], a[60:63]
  buffer_load_dwordx4 v14, s[8:11], s20 offen lds
  v_mfma_f32_16x16x32_bf16 a[64:67], v[104:107], v[64:67], a[64:67]
  ds_read_b64_tr_b16 v[138:139], v6 offset:33792
  v_mfma_f32_16x16x32_bf16 a[68:71], v[104:107], v[68:71], a[68:71]
  v_mfma_f32_16x16x32_bf16 a[72:75], v[104:107], v[72:75], a[72:75]
  ds_read_b128 v[172:175], v1 offset:35840
  v_mfma_f32_16x16x32_bf16 a[76:79], v[104:107], v[76:79], a[76:79]
  v_mfma_f32_16x16x32_bf16 a[80:83], v[104:107], v[80:83], a[80:83]
  s_add_u32 m0, s24, 101376
  ds_read_b64_tr_b16 v[140:141], v7 offset:32768
  v_mfma_f32_16x16x32_bf16 a[84:87], v[104:107], v[84:87], a[84:87]
  buffer_load_dwordx4 v15, s[8:11], s20 offen lds
  v_mfma_f32_16x16x32_bf16 a[88:91], v[104:107], v[88:91], a[88:91]
  ds_read_b64_tr_b16 v[142:143], v7 offset:33792
  v_mfma_f32_16x16x32_bf16 a[92:95], v[104:107], v[92:95], a[92:95]
  v_mfma_f32_16x16x32_bf16 a[96:99], v[108:111], v[64:67], a[96:99]
  ds_read_b128 v[176:179], v1 offset:36864
  v_mfma_f32_16x16x32_bf16 a[100:103], v[108:111], v[68:71], a[100:103]
  v_mfma_f32_16x16x32_bf16 a[104:107], v[108:111], v[72:75], a[104:107]
  s_add_u32 m0, s25, 98304
  ds_read_b64_tr_b16 v[144:145], v4 offset:40960
  v_mfma_f32_16x16x32_bf16 a[108:111], v[108:111], v[76:79], a[108:111]
  buffer_load_dwordx4 v16, s[12:15], s21 offen lds
  v_mfma_f32_16x16x32_bf16 a[112:115], v[108:111], v[80:83], a[112:115]
  ds_read_b64_tr_b16 v[146:147], v4 offset:41984
  v_mfma_f32_16x16x32_bf16 a[116:119], v[108:111], v[84:87], a[116:119]
  v_mfma_f32_16x16x32_bf16 a[120:123], v[108:111], v[88:91], a[120:123]
  ds_read_b128 v[180:183], v1 offset:37888
  v_mfma_f32_16x16x32_bf16 a[124:127], v[108:111], v[92:95], a[124:127]
  v_mfma_f32_16x16x32_bf16 a[128:131], v[112:115], v[64:67], a[128:131]
  s_add_u32 m0, s25, 106496
  ds_read_b64_tr_b16 v[148:149], v5 offset:40960
  v_mfma_f32_16x16x32_bf16 a[132:135], v[112:115], v[68:71], a[132:135]
  buffer_load_dwordx4 v16, s[16:19], s22 offen lds
  v_mfma_f32_16x16x32_bf16 a[136:139], v[112:115], v[72:75], a[136:139]
  ds_read_b64_tr_b16 v[150:151], v5 offset:41984
  v_mfma_f32_16x16x32_bf16 a[140:143], v[112:115], v[76:79], a[140:143]
  v_mfma_f32_16x16x32_bf16 a[144:147], v[112:115], v[80:83], a[144:147]
  ds_read_b128 v[184:187], v1 offset:38912
  v_mfma_f32_16x16x32_bf16 a[148:151], v[112:115], v[84:87], a[148:151]
  v_mfma_f32_16x16x32_bf16 a[152:155], v[112:115], v[88:91], a[152:155]
  s_add_u32 m0, s25, 99328
  ds_read_b64_tr_b16 v[152:153], v6 offset:40960
  v_mfma_f32_16x16x32_bf16 a[156:159], v[112:115], v[92:95], a[156:159]
  buffer_load_dwordx4 v17, s[12:15], s21 offen lds
  v_mfma_f32_16x16x32_bf16 a[160:163], v[116:119], v[64:67], a[160:163]
  ds_read_b64_tr_b16 v[154:155], v6 offset:41984
  v_mfma_f32_16x16x32_bf16 a[164:167], v[116:119], v[68:71], a[164:167]
  v_mfma_f32_16x16x32_bf16 a[168:171], v[116:119], v[72:75], a[168:171]
  ds_read_b128 v[188:191], v1 offset:39936
  v_mfma_f32_16x16x32_bf16 a[172:175], v[116:119], v[76:79], a[172:175]
  v_mfma_f32_16x16x32_bf16 a[176:179], v[116:119], v[80:83], a[176:179]
  s_add_u32 m0, s25, 107520
  ds_read_b64_tr_b16 v[156:157], v7 offset:40960
  v_mfma_f32_16x16x32_bf16 a[180:183], v[116:119], v[84:87], a[180:183]
  buffer_load_dwordx4 v17, s[16:19], s22 offen lds
  v_mfma_f32_16x16x32_bf16 a[184:187], v[116:119], v[88:91], a[184:187]
  ds_read_b64_tr_b16 v[158:159], v7 offset:41984
  v_mfma_f32_16x16x32_bf16 a[188:191], v[116:119], v[92:95], a[188:191]
  v_mfma_f32_16x16x32_bf16 a[192:195], v[120:123], v[64:67], a[192:195]
  v_mfma_f32_16x16x32_bf16 a[196:199], v[120:123], v[68:71], a[196:199]
  v_mfma_f32_16x16x32_bf16 a[200:203], v[120:123], v[72:75], a[200:203]
  s_add_u32 s20, s20, 131072
  v_mfma_f32_16x16x32_bf16 a[204:207], v[120:123], v[76:79], a[204:207]
  s_add_u32 s21, s21, s23
  v_mfma_f32_16x16x32_bf16 a[208:211], v[120:123], v[80:83], a[208:211]
  s_add_u32 s22, s22, s23
  v_mfma_f32_16x16x32_bf16 a[212:215], v[120:123], v[84:87], a[212:215]
  v_mfma_f32_16x16x32_bf16 a[216:219], v[120:123], v[88:91], a[216:219]
  v_mfma_f32_16x16x32_bf16 a[220:223], v[120:123], v[92:95], a[220:223]
  v_mfma_f32_16x16x32_bf16 a[224:227], v[124:127], v[64:67], a[224:227]
  v_mfma_f32_16x16x32_bf16 a[228:231], v[124:127], v[68:71], a[228:231]
  v_mfma_f32_16x16x32_bf16 a[232:235], v[124:127], v[72:75], a[232:235]
  v_mfma_f32_16x16x32_bf16 a[236:239], v[124:127], v[76:79], a[236:239]
  v_mfma_f32_16x16x32_bf16 a[240:243], v[124:127], v[80:83], a[240:243]
  v_mfma_f32_16x16x32_bf16 a[244:247], v[124:127], v[84:87], a[244:247]
  v_mfma_f32_16x16x32_bf16 a[248:251], v[124:127], v[88:91], a[248:251]
  v_mfma_f32_16x16x32_bf16 a[252:255], v[124:127], v[92:95], a[252:255]
  s_waitcnt vmcnt(8) lgkmcnt(0)
  s_barrier
  v_mfma_f32_16x16x32_bf16 a[0:3], v[160:163], v[128:131], a[0:3]
  ds_read_b128 v[96:99], v2 offset:0
  v_mfma_f32_16x16x32_bf16 a[4:7], v[160:163], v[132:135], a[4:7]
  v_mfma_f32_16x16x32_bf16 a[8:11], v[160:163], v[136:139], a[8:11]
  ds_read_b64_tr_b16 v[64:65], v8 offset:0
  v_mfma_f32_16x16x32_bf16 a[12:15], v[160:163], v[140:143], a[12:15]
  v_mfma_f32_16x16x32_bf16 a[16:19], v[160:163], v[144:147], a[16:19]
  ds_read_b64_tr_b16 v[66:67], v8 offset:1024
  v_mfma_f32_16x16x32_bf16 a[20:23], v[160:163], v[148:151], a[20:23]
  v_mfma_f32_16x16x32_bf16 a[24:27], v[160:163], v[152:155], a[24:27]
  ds_read_b128 v[100:103], v2 offset:1024
  v_mfma_f32_16x16x32_bf16 a[28:31], v[160:163], v[156:159], a[28:31]
  v_mfma_f32_16x16x32_bf16 a[32:35], v[164:167], v[128:131], a[32:35]
  ds_read_b64_tr_b16 v[68:69], v9 offset:0
  v_mfma_f32_16x16x32_bf16 a[36:39], v[164:167], v[132:135], a[36:39]
  v_mfma_f32_16x16x32_bf16 a[40:43], v[164:167], v[136:139], a[40:43]
  ds_read_b64_tr_b16 v[70:71], v9 offset:1024
  v_mfma_f32_16x16x32_bf16 a[44:47], v[164:167], v[140:143], a[44:47]
  v_mfma_f32_16x16x32_bf16 a[48:51], v[164:167], v[144:147], a[48:51]
  ds_read_b128 v[104:107], v2 offset:2048
  v_mfma_f32_16x16x32_bf16 a[52:55], v[164:167], v[148:151], a[52:55]
  v_mfma_f32_16x16x32_bf16 a[56:59], v[164:167], v[152:155], a[56:59]
  ds_read_b64_tr_b16 v[72:73], v10 offset:0
  v_mfma_f32_16x16x32_bf16 a[60:63], v[164:167], v[156:159], a[60:63]
  v_mfma_f32_16x16x32_bf16 a[64:67], v[168:171], v[128:131], a[64:67]
  ds_read_b64_tr_b16 v[74:75], v10 offset:1024
  v_mfma_f32_16x16x32_bf16 a[68:71], v[168:171], v[132:135], a[68:71]
  v_mfma_f32_16x16x32_bf16 a[72:75], v[168:171], v[136:139], a[72:75]
  ds_read_b128 v[108:111], v2 offset:3072
  v_mfma_f32_16x16x32_bf16 a[76:79], v[168:171], v[140:143], a[76:79]
  v_mfma_f32_16x16x32_bf16 a[80:83], v[168:171], v[144:147], a[80:83]
  ds_read_b64_tr_b16 v[76:77], v11 offset:0
  v_mfma_f32_16x16x32_bf16 a[84:87], v[168:171], v[148:151], a[84:87]
  v_mfma_f32_16x16x32_bf16 a[88:91], v[168:171], v[152:155], a[88:91]
  ds_read_b64_tr_b16 v[78:79], v11 offset:1024
  v_mfma_f32_16x16x32_bf16 a[92:95], v[168:171], v[156:159], a[92:95]
  v_mfma_f32_16x16x32_bf16 a[96:99], v[172:175], v[128:131], a[96:99]
  ds_read_b128 v[112:115], v2 offset:4096
  v_mfma_f32_16x16x32_bf16 a[100:103], v[172:175], v[132:135], a[100:103]
  v_mfma_f32_16x16x32_bf16 a[104:107], v[172:175], v[136:139], a[104:107]
  ds_read_b64_tr_b16 v[80:81], v8 offset:8192
  v_mfma_f32_16x16x32_bf16 a[108:111], v[172:175], v[140:143], a[108:111]
  v_mfma_f32_16x16x32_bf16 a[112:115], v[172:175], v[144:147], a[112:115]
  ds_read_b64_tr_b16 v[82:83], v8 offset:9216
  v_mfma_f32_16x16x32_bf16 a[116:119], v[172:175], v[148:151], a[116:119]
  v_mfma_f32_16x16x32_bf16 a[120:123], v[172:175], v[152:155], a[120:123]
  ds_read_b128 v[116:119], v2 offset:5120
  v_mfma_f32_16x16x32_bf16 a[124:127], v[172:175], v[156:159], a[124:127]
  v_mfma_f32_16x16x32_bf16 a[128:131], v[176:179], v[128:131], a[128:131]
  ds_read_b64_tr_b16 v[84:85], v9 offset:8192
  v_mfma_f32_16x16x32_bf16 a[132:135], v[176:179], v[132:135], a[132:135]
  v_mfma_f32_16x16x32_bf16 a[136:139], v[176:179], v[136:139], a[136:139]
  ds_read_b64_tr_b16 v[86:87], v9 offset:9216
  v_mfma_f32_16x16x32_bf16 a[140:143], v[176:179], v[140:143], a[140:143]
  v_mfma_f32_16x16x32_bf16 a[144:147], v[176:179], v[144:147], a[144:147]
  ds_read_b128 v[120:123], v2 offset:6144
  v_mfma_f32_16x16x32_bf16 a[148:151], v[176:179], v[148:151], a[148:151]
  v_mfma_f32_16x16x32_bf16 a[152:155], v[176:179], v[152:155], a[152:155]
  ds_read_b64_tr_b16 v[88:89], v10 offset:8192
  v_mfma_f32_16x16x32_bf16 a[156:159], v[176:179], v[156:159], a[156:159]
  v_mfma_f32_16x16x32_bf16 a[160:163], v[180:183], v[128:131], a[160:163]
  ds_read_b64_tr_b16 v[90:91], v10 offset:9216
  v_mfma_f32_16x16x32_bf16 a[164:167], v[180:183], v[132:135], a[164:167]
  v_mfma_f32_16x16x32_bf16 a[168:171], v[180:183], v[136:139], a[168:171]
  ds_read_b128 v[124:127], v2 offset:7168
  v_mfma_f32_16x16x32_bf16 a[172:175], v[180:183], v[140:143], a[172:175]
  v_mfma_f32_16x16x32_bf16 a[176:179], v[180:183], v[144:147], a[176:179]
  ds_read_b64_tr_b16 v[92:93], v11 offset:8192
  v_mfma_f32_16x16x32_bf16 a[180:183], v[180:183], v[148:151], a[180:183]
  v_mfma_f32_16x16x32_bf16 a[184:187], v[180:183], v[152:155], a[184:187]
  ds_read_b64_tr_b16 v[94:95], v11 offset:9216
  v_mfma_f32_16x16x32_bf16 a[188:191], v[180:183], v[156:159], a[188:191]
  v_mfma_f32_16x16x32_bf16 a[192:195], v[184:187], v[128:131], a[192:195]
  v_mfma_f32_16x16x32_bf16 a[196:199], v[184:187], v[132:135], a[196:199]
  v_mfma_f32_16x16x32_bf16 a[200:203], v[184:187], v[136:139], a[200:203]
  v_mfma_f32_16x16x32_bf16 a[204:207], v[184:187], v[140:143], a[204:207]
  v_mfma_f32_16x16x32_bf16 a[208:211], v[184:187], v[144:147], a[208:211]
  v_mfma_f32_16x16x32_bf16 a[212:215], v[184:187], v[148:151], a[212:215]
  v_mfma_f32_16x16x32_bf16 a[216:219], v[184:187], v[152:155], a[216:219]
  v_mfma_f32_16x16x32_bf16 a[220:223], v[184:187], v[156:159], a[220:223]
  v_mfma_f32_16x16x32_bf16 a[224:227], v[188:191], v[128:131], a[224:227]
  v_mfma_f32_16x16x32_bf16 a[228:231], v[188:191], v[132:135], a[228:231]
  v_mfma_f32_16x16x32_bf16 a[232:235], v[188:191], v[136:139], a[232:235]
  v_mfma_f32_16x16x32_bf16 a[236:239], v[188:191], v[140:143], a[236:239]
  v_mfma_f32_16x16x32_bf16 a[240:243], v[188:191], v[144:147], a[240:243]
  v_mfma_f32_16x16x32_bf16 a[244:247], v[188:191], v[148:151], a[244:247]
  v_mfma_f32_16x16x32_bf16 a[248:251], v[188:191], v[152:155], a[248:251]
  v_mfma_f32_16x16x32_bf16 a[252:255], v[188:191], v[156:159], a[252:255]
  s_waitcnt vmcnt(0) lgkmcnt(0)
  s_barrier
  v_mfma_f32_16x16x32_bf16 a[0:3], v[96:99], v[64:67], a[0:3]
  ds_read_b128 v[160:163], v2 offset:32768
  v_mfma_f32_16x16x32_bf16 a[4:7], v[96:99], v[68:71], a[4:7]
  v_mfma_f32_16x16x32_bf16 a[8:11], v[96:99], v[72:75], a[8:11]
  ds_read_b64_tr_b16 v[128:129], v8 offset:32768
  v_mfma_f32_16x16x32_bf16 a[12:15], v[96:99], v[76:79], a[12:15]
  v_mfma_f32_16x16x32_bf16 a[16:19], v[96:99], v[80:83], a[16:19]
  ds_read_b64_tr_b16 v[130:131], v8 offset:33792
  v_mfma_f32_16x16x32_bf16 a[20:23], v[96:99], v[84:87], a[20:23]
  v_mfma_f32_16x16x32_bf16 a[24:27], v[96:99], v[88:91], a[24:27]
  ds_read_b128 v[164:167], v2 offset:33792
  v_mfma_f32_16x16x32_bf16 a[28:31], v[96:99], v[92:95], a[28:31]
  v_mfma_f32_16x16x32_bf16 a[32:35], v[100:103], v[64:67], a[32:35]
  ds_read_b64_tr_b16 v[132:133], v9 offset:32768
  v_mfma_f32_16x16x32_bf16 a[36:39], v[100:103], v[68:71], a[36:39]
  v_mfma_f32_16x16x32_bf16 a[40:43], v[100:103], v[72:75], a[40:43]
  ds_read_b64_tr_b16 v[134:135], v9 offset:33792
  v_mfma_f32_16x16x32_bf16 a[44:47], v[100:103], v[76:79], a[44:47]
  v_mfma_f32_16x16x32_bf16 a[48:51], v[100:103], v[80:83], a[48:51]
  ds_read_b128 v[168:171], v2 offset:34816
  v_mfma_f32_16x16x32_bf16 a[52:55], v[100:103], v[84:87], a[52:55]
  v_mfma_f32_16x16x32_bf16 a[56:59], v[100:103], v[88:91], a[56:59]
  ds_read_b64_tr_b16 v[136:137], v10 offset:32768
  v_mfma_f32_16x16x32_bf16 a[60:63], v[100:103], v[92:95], a[60:63]
  v_mfma_f32_16x16x32_bf16 a[64:67], v[104:107], v[64:67], a[64:67]
  ds_read_b64_tr_b16 v[138:139], v10 offset:33792
  v_mfma_f32_16x16x32_bf16 a[68:71], v[104:107], v[68:71], a[68:71]
  v_mfma_f32_16x16x32_bf16 a[72:75], v[104:107], v[72:75], a[72:75]
  ds_read_b128 v[172:175], v2 offset:35840
  v_mfma_f32_16x16x32_bf16 a[76:79], v[104:107], v[76:79], a[76:79]
  v_mfma_f32_16x16x32_bf16 a[80:83], v[104:107], v[80:83], a[80:83]
  ds_read_b64_tr_b16 v[140:141], v11 offset:32768
  v_mfma_f32_16x16x32_bf16 a[84:87], v[104:107], v[84:87], a[84:87]
  v_mfma_f32_16x16x32_bf16 a[88:91], v[104:107], v[88:91], a[88:91]
  ds_read_b64_tr_b16 v[142:143], v11 offset:33792
  v_mfma_f32_16x16x32_bf16 a[92:95], v[104:107], v[92:95], a[92:95]
  v_mfma_f32_16x16x32_bf16 a[96:99], v[108:111], v[64:67], a[96:99]
  ds_read_b128 v[176:179], v2 offset:36864
  v_mfma_f32_16x16x32_bf16 a[100:103], v[108:111], v[68:71], a[100:103]
  v_mfma_f32_16x16x32_bf16 a[104:107], v[108:111], v[72:75], a[104:107]
  ds_read_b64_tr_b16 v[144:145], v8 offset:40960
  v_mfma_f32_16x16x32_bf16 a[108:111], v[108:111], v[76:79], a[108:111]
  v_mfma_f32_16x16x32_bf16 a[112:115], v[108:111], v[80:83], a[112:115]
  ds_read_b64_tr_b16 v[146:147], v8 offset:41984
  v_mfma_f32_16x16x32_bf16 a[116:119], v[108:111], v[84:87], a[116:119]
  v_mfma_f32_16x16x32_bf16 a[120:123], v[108:111], v[88:91], a[120:123]
  ds_read_b128 v[180:183], v2 offset:37888
  v_mfma_f32_16x16x32_bf16 a[124:127], v[108:111], v[92:95], a[124:127]
  v_mfma_f32_16x16x32_bf16 a[128:131], v[112:115], v[64:67], a[128:131]
  ds_read_b64_tr_b16 v[148:149], v9 offset:40960
  v_mfma_f32_16x16x32_bf16 a[132:135], v[112:115], v[68:71], a[132:135]
  v_mfma_f32_16x16x32_bf16 a[136:139], v[112:115], v[72:75], a[136:139]
  ds_read_b64_tr_b16 v[150:151], v9 offset:41984
  v_mfma_f32_16x16x32_bf16 a[140:143], v[112:115], v[76:79], a[140:143]
  v_mfma_f32_16x16x32_bf16 a[144:147], v[112:115], v[80:83], a[144:147]
  ds_read_b128 v[184:187], v2 offset:38912
  v_mfma_f32_16x16x32_bf16 a[148:151], v[112:115], v[84:87], a[148:151]
  v_mfma_f32_16x16x32_bf16 a[152:155], v[112:115], v[88:91], a[152:155]
  ds_read_b64_tr_b16 v[152:153], v10 offset:40960
  v_mfma_f32_16x16x32_bf16 a[156:159], v[112:115], v[92:95], a[156:159]
  v_mfma_f32_16x16x32_bf16 a[160:163], v[116:119], v[64:67], a[160:163]
  ds_read_b64_tr_b16 v[154:155], v10 offset:41984
  v_mfma_f32_16x16x32_bf16 a[164:167], v[116:119], v[68:71], a[164:167]
  v_mfma_f32_16x16x32_bf16 a[168:171], v[116:119], v[72:75], a[168:171]
  ds_read_b128 v[188:191], v2 offset:39936
  v_mfma_f32_16x16x32_bf16 a[172:175], v[116:119], v[76:79], a[172:175]
  v_mfma_f32_16x16x32_bf16 a[176:179], v[116:119], v[80:83], a[176:179]
  ds_read_b64_tr_b16 v[156:157], v11 offset:40960
  v_mfma_f32_16x16x32_bf16 a[180:183], v[116:119], v[84:87], a[180:183]
  v_mfma_f32_16x16x32_bf16 a[184:187], v[116:119], v[88:91], a[184:187]
  ds_read_b64_tr_b16 v[158:159], v11 offset:41984
  v_mfma_f32_16x16x32_bf16 a[188:191], v[116:119], v[92:95], a[188:191]
  v_mfma_f32_16x16x32_bf16 a[192:195], v[120:123], v[64:67], a[192:195]
  v_mfma_f32_16x16x32_bf16 a[196:199], v[120:123], v[68:71], a[196:199]
  v_mfma_f32_16x16x32_bf16 a[200:203], v[120:123], v[72:75], a[200:203]
  v_mfma_f32_16x16x32_bf16 a[204:207], v[120:123], v[76:79], a[204:207]
  v_mfma_f32_16x16x32_bf16 a[208:211], v[120:123], v[80:83], a[208:211]
  v_mfma_f32_16x16x32_bf16 a[212:215], v[120:123], v[84:87], a[212:215]
  v_mfma_f32_16x16x32_bf16 a[216:219], v[120:123], v[88:91], a[216:219]
  v_mfma_f32_16x16x32_bf16 a[220:223], v[120:123], v[92:95], a[220:223]
  v_mfma_f32_16x16x32_bf16 a[224:227], v[124:127], v[64:67], a[224:227]
  v_mfma_f32_16x16x32_bf16 a[228:231], v[124:127], v[68:71], a[228:231]
  v_mfma_f32_16x16x32_bf16 a[232:235], v[124:127], v[72:75], a[232:235]
  v_mfma_f32_16x16x32_bf16 a[236:239], v[124:127], v[76:79], a[236:239]
  v_mfma_f32_16x16x32_bf16 a[240:243], v[124:127], v[80:83], a[240:243]
  v_mfma_f32_16x16x32_bf16 a[244:247], v[124:127], v[84:87], a[244:247]
  v_mfma_f32_16x16x32_bf16 a[248:251], v[124:127], v[88:91], a[248:251]
  v_mfma_f32_16x16x32_bf16 a[252:255], v[124:127], v[92:95], a[252:255]
  s_waitcnt lgkmcnt(0)
  s_barrier
  v_mfma_f32_16x16x32_bf16 a[0:3], v[160:163], v[128:131], a[0:3]
  v_mfma_f32_16x16x32_bf16 a[4:7], v[160:163], v[132:135], a[4:7]
  v_mfma_f32_16x16x32_bf16 a[8:11], v[160:163], v[136:139], a[8:11]
  v_mfma_f32_16x16x32_bf16 a[12:15], v[160:163], v[140:143], a[12:15]
  v_mfma_f32_16x16x32_bf16 a[16:19], v[160:163], v[144:147], a[16:19]
  v_mfma_f32_16x16x32_bf16 a[20:23], v[160:163], v[148:151], a[20:23]
  v_mfma_f32_16x16x32_bf16 a[24:27], v[160:163], v[152:155], a[24:27]
  v_mfma_f32_16x16x32_bf16 a[28:31], v[160:163], v[156:159], a[28:31]
  v_mfma_f32_16x16x32_bf16 a[32:35], v[164:167], v[128:131], a[32:35]
  v_mfma_f32_16x16x32_bf16 a[36:39], v[164:167], v[132:135], a[36:39]
  v_mfma_f32_16x16x32_bf16 a[40:43], v[164:167], v[136:139], a[40:43]
  v_mfma_f32_16x16x32_bf16 a[44:47], v[164:167], v[140:143], a[44:47]
  v_mfma_f32_16x16x32_bf16 a[48:51], v[164:167], v[144:147], a[48:51]
  v_mfma_f32_16x16x32_bf16 a[52:55], v[164:167], v[148:151], a[52:55]
  v_mfma_f32_16x16x32_bf16 a[56:59], v[164:167], v[152:155], a[56:59]
  v_mfma_f32_16x16x32_bf16 a[60:63], v[164:167], v[156:159], a[60:63]
  v_mfma_f32_16x16x32_bf16 a[64:67], v[168:171], v[128:131], a[64:67]
  v_mfma_f32_16x16x32_bf16 a[68:71], v[168:171], v[132:135], a[68:71]
  v_mfma_f32_16x16x32_bf16 a[72:75], v[168:171], v[136:139], a[72:75]
  v_mfma_f32_16x16x32_bf16 a[76:79], v[168:171], v[140:143], a[76:79]
  v_mfma_f32_16x16x32_bf16 a[80:83], v[168:171], v[144:147], a[80:83]
  v_mfma_f32_16x16x32_bf16 a[84:87], v[168:171], v[148:151], a[84:87]
  v_mfma_f32_16x16x32_bf16 a[88:91], v[168:171], v[152:155], a[88:91]
  v_mfma_f32_16x16x32_bf16 a[92:95], v[168:171], v[156:159], a[92:95]
  v_mfma_f32_16x16x32_bf16 a[96:99], v[172:175], v[128:131], a[96:99]
  v_mfma_f32_16x16x32_bf16 a[100:103], v[172:175], v[132:135], a[100:103]
  v_mfma_f32_16x16x32_bf16 a[104:107], v[172:175], v[136:139], a[104:107]
  v_mfma_f32_16x16x32_bf16 a[108:111], v[172:175], v[140:143], a[108:111]
  v_mfma_f32_16x16x32_bf16 a[112:115], v[172:175], v[144:147], a[112:115]
  v_mfma_f32_16x16x32_bf16 a[116:119], v[172:175], v[148:151], a[116:119]
  v_mfma_f32_16x16x32_bf16 a[120:123], v[172:175], v[152:155], a[120:123]
  v_mfma_f32_16x16x32_bf16 a[124:127], v[172:175], v[156:159], a[124:127]
  v_mfma_f32_16x16x32_bf16 a[128:131], v[176:179], v[128:131], a[128:131]
  v_mfma_f32_16x16x32_bf16 a[132:135], v[176:179], v[132:135], a[132:135]
  v_mfma_f32_16x16x32_bf16 a[136:139], v[176:179], v[136:139], a[136:139]
  v_mfma_f32_16x16x32_bf16 a[140:143], v[176:179], v[140:143], a[140:143]
  v_mfma_f32_16x16x32_bf16 a[144:147], v[176:179], v[144:147], a[144:147]
  v_mfma_f32_16x16x32_bf16 a[148:151], v[176:179], v[148:151], a[148:151]
  v_mfma_f32_16x16x32_bf16 a[152:155], v[176:179], v[152:155], a[152:155]
  v_mfma_f32_16x16x32_bf16 a[156:159], v[176:179], v[156:159], a[156:159]
  v_mfma_f32_16x16x32_bf16 a[160:163], v[180:183], v[128:131], a[160:163]
  v_mfma_f32_16x16x32_bf16 a[164:167], v[180:183], v[132:135], a[164:167]
  v_mfma_f32_16x16x32_bf16 a[168:171], v[180:183], v[136:139], a[168:171]
  v_mfma_f32_16x16x32_bf16 a[172:175], v[180:183], v[140:143], a[172:175]
  v_mfma_f32_16x16x32_bf16 a[176:179], v[180:183], v[144:147], a[176:179]
  v_mfma_f32_16x16x32_bf16 a[180:183], v[180:183], v[148:151], a[180:183]
  v_mfma_f32_16x16x32_bf16 a[184:187], v[180:183], v[152:155], a[184:187]
  v_mfma_f32_16x16x32_bf16 a[188:191], v[180:183], v[156:159], a[188:191]
  v_mfma_f32_16x16x32_bf16 a[192:195], v[184:187], v[128:131], a[192:195]
  v_mfma_f32_16x16x32_bf16 a[196:199], v[184:187], v[132:135], a[196:199]
  v_mfma_f32_16x16x32_bf16 a[200:203], v[184:187], v[136:139], a[200:203]
  v_mfma_f32_16x16x32_bf16 a[204:207], v[184:187], v[140:143], a[204:207]
  v_mfma_f32_16x16x32_bf16 a[208:211], v[184:187], v[144:147], a[208:211]
  v_mfma_f32_16x16x32_bf16 a[212:215], v[184:187], v[148:151], a[212:215]
  v_mfma_f32_16x16x32_bf16 a[216:219], v[184:187], v[152:155], a[216:219]
  v_mfma_f32_16x16x32_bf16 a[220:223], v[184:187], v[156:159], a[220:223]
  v_mfma_f32_16x16x32_bf16 a[224:227], v[188:191], v[128:131], a[224:227]
  v_mfma_f32_16x16x32_bf16 a[228:231], v[188:191], v[132:135], a[228:231]
  v_mfma_f32_16x16x32_bf16 a[232:235], v[188:191], v[136:139], a[232:235]
  v_mfma_f32_16x16x32_bf16 a[236:239], v[188:191], v[140:143], a[236:239]
  v_mfma_f32_16x16x32_bf16 a[240:243], v[188:191], v[144:147], a[240:243]
  v_mfma_f32_16x16x32_bf16 a[244:247], v[188:191], v[148:151], a[244:247]
  v_mfma_f32_16x16x32_bf16 a[248:251], v[188:191], v[152:155], a[248:251]
  v_mfma_f32_16x16x32_bf16 a[252:255], v[188:191], v[156:159], a[252:255]
  s_nop 7
  s_cmp_lg_u32 s27, 0
  s_cbranch_scc1 L_te_95
  s_lshl_b32 s47, s96, 7
  s_add_u32 s47, s47, 117449728
  v_mov_b32 v252, s47
  v_mov_b32 v253, 1
  s_mov_b64 exec, 1
  buffer_atomic_add v253, v252, s[4:7], 0 offen sc0 sc1
  s_mov_b64 exec, -1
L_te_95:
  v_and_b32 v20, 63, v0
  v_lshlrev_b32 v23, 4, v20
  s_lshr_b32 s40, s27, 1
  s_and_b32 s41, s27, 1
  s_lshl_b32 s42, s28, 3
  s_lshl_b32 s43, s40, 2
  s_add_u32 s42, s42, s43
  s_lshl_b32 s42, s42, 18
  s_lshl_b32 s43, s29, 14
  s_add_u32 s42, s42, s43
  s_lshl_b32 s43, s41, 12
  s_add_u32 s42, s42, s43
  s_add_u32 s45, s42, 41943040
  s_add_u32 s46, s45, 0
  v_accvgpr_read_b32 v32, a0
  v_accvgpr_read_b32 v33, a1
  v_accvgpr_read_b32 v34, a2
  v_accvgpr_read_b32 v35, a3
  v_accvgpr_read_b32 v36, a32
  v_accvgpr_read_b32 v37, a33
  v_accvgpr_read_b32 v38, a34
  v_accvgpr_read_b32 v39, a35
  v_cvt_pk_bf16_f32 v40, v32, v33
  v_cvt_pk_bf16_f32 v41, v34, v35
  v_cvt_pk_bf16_f32 v42, v36, v37
  v_cvt_pk_bf16_f32 v43, v38, v39
  buffer_store_dwordx4 v[40:43], v23, s[4:7], s46 offen offset:0 sc1
  v_accvgpr_read_b32 v48, a4
  v_accvgpr_read_b32 v49, a5
  v_accvgpr_read_b32 v50, a6
  v_accvgpr_read_b32 v51, a7
  v_accvgpr_read_b32 v52, a36
  v_accvgpr_read_b32 v53, a37
  v_accvgpr_read_b32 v54, a38
  v_accvgpr_read_b32 v55, a39
  v_cvt_pk_bf16_f32 v56, v48, v49
  v_cvt_pk_bf16_f32 v57, v50, v51
  v_cvt_pk_bf16_f32 v58, v52, v53
  v_cvt_pk_bf16_f32 v59, v54, v55
  buffer_store_dwordx4 v[56:59], v23, s[4:7], s46 offen offset:1024 sc1
  v_accvgpr_read_b32 v32, a8
  v_accvgpr_read_b32 v33, a9
  v_accvgpr_read_b32 v34, a10
  v_accvgpr_read_b32 v35, a11
  v_accvgpr_read_b32 v36, a40
  v_accvgpr_read_b32 v37, a41
  v_accvgpr_read_b32 v38, a42
  v_accvgpr_read_b32 v39, a43
  v_cvt_pk_bf16_f32 v40, v32, v33
  v_cvt_pk_bf16_f32 v41, v34, v35
  v_cvt_pk_bf16_f32 v42, v36, v37
  v_cvt_pk_bf16_f32 v43, v38, v39
  buffer_store_dwordx4 v[40:43], v23, s[4:7], s46 offen offset:2048 sc1
  v_accvgpr_read_b32 v48, a12
  v_accvgpr_read_b32 v49, a13
  v_accvgpr_read_b32 v50, a14
  v_accvgpr_read_b32 v51, a15
  v_accvgpr_read_b32 v52, a44
  v_accvgpr_read_b32 v53, a45
  v_accvgpr_read_b32 v54, a46
  v_accvgpr_read_b32 v55, a47
  v_cvt_pk_bf16_f32 v56, v48, v49
  v_cvt_pk_bf16_f32 v57, v50, v51
  v_cvt_pk_bf16_f32 v58, v52, v53
  v_cvt_pk_bf16_f32 v59, v54, v55
  buffer_store_dwordx4 v[56:59], v23, s[4:7], s46 offen offset:3072 sc1
  s_add_u32 s46, s45, 8192
  v_accvgpr_read_b32 v32, a16
  v_accvgpr_read_b32 v33, a17
  v_accvgpr_read_b32 v34, a18
  v_accvgpr_read_b32 v35, a19
  v_accvgpr_read_b32 v36, a48
  v_accvgpr_read_b32 v37, a49
  v_accvgpr_read_b32 v38, a50
  v_accvgpr_read_b32 v39, a51
  v_cvt_pk_bf16_f32 v40, v32, v33
  v_cvt_pk_bf16_f32 v41, v34, v35
  v_cvt_pk_bf16_f32 v42, v36, v37
  v_cvt_pk_bf16_f32 v43, v38, v39
  buffer_store_dwordx4 v[40:43], v23, s[4:7], s46 offen offset:0 sc1
  v_accvgpr_read_b32 v48, a20
  v_accvgpr_read_b32 v49, a21
  v_accvgpr_read_b32 v50, a22
  v_accvgpr_read_b32 v51, a23
  v_accvgpr_read_b32 v52, a52
  v_accvgpr_read_b32 v53, a53
  v_accvgpr_read_b32 v54, a54
  v_accvgpr_read_b32 v55, a55
  v_cvt_pk_bf16_f32 v56, v48, v49
  v_cvt_pk_bf16_f32 v57, v50, v51
  v_cvt_pk_bf16_f32 v58, v52, v53
  v_cvt_pk_bf16_f32 v59, v54, v55
  buffer_store_dwordx4 v[56:59], v23, s[4:7], s46 offen offset:1024 sc1
  v_accvgpr_read_b32 v32, a24
  v_accvgpr_read_b32 v33, a25
  v_accvgpr_read_b32 v34, a26
  v_accvgpr_read_b32 v35, a27
  v_accvgpr_read_b32 v36, a56
  v_accvgpr_read_b32 v37, a57
  v_accvgpr_read_b32 v38, a58
  v_accvgpr_read_b32 v39, a59
  v_cvt_pk_bf16_f32 v40, v32, v33
  v_cvt_pk_bf16_f32 v41, v34, v35
  v_cvt_pk_bf16_f32 v42, v36, v37
  v_cvt_pk_bf16_f32 v43, v38, v39
  buffer_store_dwordx4 v[40:43], v23, s[4:7], s46 offen offset:2048 sc1
  v_accvgpr_read_b32 v48, a28
  v_accvgpr_read_b32 v49, a29
  v_accvgpr_read_b32 v50, a30
  v_accvgpr_read_b32 v51, a31
  v_accvgpr_read_b32 v52, a60
  v_accvgpr_read_b32 v53, a61
  v_accvgpr_read_b32 v54, a62
  v_accvgpr_read_b32 v55, a63
  v_cvt_pk_bf16_f32 v56, v48, v49
  v_cvt_pk_bf16_f32 v57, v50, v51
  v_cvt_pk_bf16_f32 v58, v52, v53
  v_cvt_pk_bf16_f32 v59, v54, v55
  buffer_store_dwordx4 v[56:59], v23, s[4:7], s46 offen offset:3072 sc1
  s_add_u32 s46, s45, 262144
  v_accvgpr_read_b32 v32, a64
  v_accvgpr_read_b32 v33, a65
  v_accvgpr_read_b32 v34, a66
  v_accvgpr_read_b32 v35, a67
  v_accvgpr_read_b32 v36, a96
  v_accvgpr_read_b32 v37, a97
  v_accvgpr_read_b32 v38, a98
  v_accvgpr_read_b32 v39, a99
  v_cvt_pk_bf16_f32 v40, v32, v33
  v_cvt_pk_bf16_f32 v41, v34, v35
  v_cvt_pk_bf16_f32 v42, v36, v37
  v_cvt_pk_bf16_f32 v43, v38, v39
  buffer_store_dwordx4 v[40:43], v23, s[4:7], s46 offen offset:0 sc1
  v_accvgpr_read_b32 v48, a68
  v_accvgpr_read_b32 v49, a69
  v_accvgpr_read_b32 v50, a70
  v_accvgpr_read_b32 v51, a71
  v_accvgpr_read_b32 v52, a100
  v_accvgpr_read_b32 v53, a101
  v_accvgpr_read_b32 v54, a102
  v_accvgpr_read_b32 v55, a103
  v_cvt_pk_bf16_f32 v56, v48, v49
  v_cvt_pk_bf16_f32 v57, v50, v51
  v_cvt_pk_bf16_f32 v58, v52, v53
  v_cvt_pk_bf16_f32 v59, v54, v55
  buffer_store_dwordx4 v[56:59], v23, s[4:7], s46 offen offset:1024 sc1
  v_accvgpr_read_b32 v32, a72
  v_accvgpr_read_b32 v33, a73
  v_accvgpr_read_b32 v34, a74
  v_accvgpr_read_b32 v35, a75
  v_accvgpr_read_b32 v36, a104
  v_accvgpr_read_b32 v37, a105
  v_accvgpr_read_b32 v38, a106
  v_accvgpr_read_b32 v39, a107
  v_cvt_pk_bf16_f32 v40, v32, v33
  v_cvt_pk_bf16_f32 v41, v34, v35
  v_cvt_pk_bf16_f32 v42, v36, v37
  v_cvt_pk_bf16_f32 v43, v38, v39
  buffer_store_dwordx4 v[40:43], v23, s[4:7], s46 offen offset:2048 sc1
  v_accvgpr_read_b32 v48, a76
  v_accvgpr_read_b32 v49, a77
  v_accvgpr_read_b32 v50, a78
  v_accvgpr_read_b32 v51, a79
  v_accvgpr_read_b32 v52, a108
  v_accvgpr_read_b32 v53, a109
  v_accvgpr_read_b32 v54, a110
  v_accvgpr_read_b32 v55, a111
  v_cvt_pk_bf16_f32 v56, v48, v49
  v_cvt_pk_bf16_f32 v57, v50, v51
  v_cvt_pk_bf16_f32 v58, v52, v53
  v_cvt_pk_bf16_f32 v59, v54, v55
  buffer_store_dwordx4 v[56:59], v23, s[4:7], s46 offen offset:3072 sc1
  s_add_u32 s46, s45, 270336
  v_accvgpr_read_b32 v32, a80
  v_accvgpr_read_b32 v33, a81
  v_accvgpr_read_b32 v34, a82
  v_accvgpr_read_b32 v35, a83
  v_accvgpr_read_b32 v36, a112
  v_accvgpr_read_b32 v37, a113
  v_accvgpr_read_b32 v38, a114
  v_accvgpr_read_b32 v39, a115
  v_cvt_pk_bf16_f32 v40, v32, v33
  v_cvt_pk_bf16_f32 v41, v34, v35
  v_cvt_pk_bf16_f32 v42, v36, v37
  v_cvt_pk_bf16_f32 v43, v38, v39
  buffer_store_dwordx4 v[40:43], v23, s[4:7], s46 offen offset:0 sc1
  v_accvgpr_read_b32 v48, a84
  v_accvgpr_read_b32 v49, a85
  v_accvgpr_read_b32 v50, a86
  v_accvgpr_read_b32 v51, a87
  v_accvgpr_read_b32 v52, a116
  v_accvgpr_read_b32 v53, a117
  v_accvgpr_read_b32 v54, a118
  v_accvgpr_read_b32 v55, a119
  v_cvt_pk_bf16_f32 v56, v48, v49
  v_cvt_pk_bf16_f32 v57, v50, v51
  v_cvt_pk_bf16_f32 v58, v52, v53
  v_cvt_pk_bf16_f32 v59, v54, v55
  buffer_store_dwordx4 v[56:59], v23, s[4:7], s46 offen offset:1024 sc1
  v_accvgpr_read_b32 v32, a88
  v_accvgpr_read_b32 v33, a89
  v_accvgpr_read_b32 v34, a90
  v_accvgpr_read_b32 v35, a91
  v_accvgpr_read_b32 v36, a120
  v_accvgpr_read_b32 v37, a121
  v_accvgpr_read_b32 v38, a122
  v_accvgpr_read_b32 v39, a123
  v_cvt_pk_bf16_f32 v40, v32, v33
  v_cvt_pk_bf16_f32 v41, v34, v35
  v_cvt_pk_bf16_f32 v42, v36, v37
  v_cvt_pk_bf16_f32 v43, v38, v39
  buffer_store_dwordx4 v[40:43], v23, s[4:7], s46 offen offset:2048 sc1
  v_accvgpr_read_b32 v48, a92
  v_accvgpr_read_b32 v49, a93
  v_accvgpr_read_b32 v50, a94
  v_accvgpr_read_b32 v51, a95
  v_accvgpr_read_b32 v52, a124
  v_accvgpr_read_b32 v53, a125
  v_accvgpr_read_b32 v54, a126
  v_accvgpr_read_b32 v55, a127
  v_cvt_pk_bf16_f32 v56, v48, v49
  v_cvt_pk_bf16_f32 v57, v50, v51
  v_cvt_pk_bf16_f32 v58, v52, v53
  v_cvt_pk_bf16_f32 v59, v54, v55
  buffer_store_dwordx4 v[56:59], v23, s[4:7], s46 offen offset:3072 sc1
  s_add_u32 s46, s45, 524288
  v_accvgpr_read_b32 v32, a128
  v_accvgpr_read_b32 v33, a129
  v_accvgpr_read_b32 v34, a130
  v_accvgpr_read_b32 v35, a131
  v_accvgpr_read_b32 v36, a160
  v_accvgpr_read_b32 v37, a161
  v_accvgpr_read_b32 v38, a162
  v_accvgpr_read_b32 v39, a163
  v_cvt_pk_bf16_f32 v40, v32, v33
  v_cvt_pk_bf16_f32 v41, v34, v35
  v_cvt_pk_bf16_f32 v42, v36, v37
  v_cvt_pk_bf16_f32 v43, v38, v39
  buffer_store_dwordx4 v[40:43], v23, s[4:7], s46 offen offset:0 sc1
  v_accvgpr_read_b32 v48, a132
  v_accvgpr_read_b32 v49, a133
  v_accvgpr_read_b32 v50, a134
  v_accvgpr_read_b32 v51, a135
  v_accvgpr_read_b32 v52, a164
  v_accvgpr_read_b32 v53, a165
  v_accvgpr_read_b32 v54, a166
  v_accvgpr_read_b32 v55, a167
  v_cvt_pk_bf16_f32 v56, v48, v49
  v_cvt_pk_bf16_f32 v57, v50, v51
  v_cvt_pk_bf16_f32 v58, v52, v53
  v_cvt_pk_bf16_f32 v59, v54, v55
  buffer_store_dwordx4 v[56:59], v23, s[4:7], s46 offen offset:1024 sc1
  v_accvgpr_read_b32 v32, a136
  v_accvgpr_read_b32 v33, a137
  v_accvgpr_read_b32 v34, a138
  v_accvgpr_read_b32 v35, a139
  v_accvgpr_read_b32 v36, a168
  v_accvgpr_read_b32 v37, a169
  v_accvgpr_read_b32 v38, a170
  v_accvgpr_read_b32 v39, a171
  v_cvt_pk_bf16_f32 v40, v32, v33
  v_cvt_pk_bf16_f32 v41, v34, v35
  v_cvt_pk_bf16_f32 v42, v36, v37
  v_cvt_pk_bf16_f32 v43, v38, v39
  buffer_store_dwordx4 v[40:43], v23, s[4:7], s46 offen offset:2048 sc1
  v_accvgpr_read_b32 v48, a140
  v_accvgpr_read_b32 v49, a141
  v_accvgpr_read_b32 v50, a142
  v_accvgpr_read_b32 v51, a143
  v_accvgpr_read_b32 v52, a172
  v_accvgpr_read_b32 v53, a173
  v_accvgpr_read_b32 v54, a174
  v_accvgpr_read_b32 v55, a175
  v_cvt_pk_bf16_f32 v56, v48, v49
  v_cvt_pk_bf16_f32 v57, v50, v51
  v_cvt_pk_bf16_f32 v58, v52, v53
  v_cvt_pk_bf16_f32 v59, v54, v55
  buffer_store_dwordx4 v[56:59], v23, s[4:7], s46 offen offset:3072 sc1
  s_add_u32 s46, s45, 532480
  v_accvgpr_read_b32 v32, a144
  v_accvgpr_read_b32 v33, a145
  v_accvgpr_read_b32 v34, a146
  v_accvgpr_read_b32 v35, a147
  v_accvgpr_read_b32 v36, a176
  v_accvgpr_read_b32 v37, a177
  v_accvgpr_read_b32 v38, a178
  v_accvgpr_read_b32 v39, a179
  v_cvt_pk_bf16_f32 v40, v32, v33
  v_cvt_pk_bf16_f32 v41, v34, v35
  v_cvt_pk_bf16_f32 v42, v36, v37
  v_cvt_pk_bf16_f32 v43, v38, v39
  buffer_store_dwordx4 v[40:43], v23, s[4:7], s46 offen offset:0 sc1
  v_accvgpr_read_b32 v48, a148
  v_accvgpr_read_b32 v49, a149
  v_accvgpr_read_b32 v50, a150
  v_accvgpr_read_b32 v51, a151
  v_accvgpr_read_b32 v52, a180
  v_accvgpr_read_b32 v53, a181
  v_accvgpr_read_b32 v54, a182
  v_accvgpr_read_b32 v55, a183
  v_cvt_pk_bf16_f32 v56, v48, v49
  v_cvt_pk_bf16_f32 v57, v50, v51
  v_cvt_pk_bf16_f32 v58, v52, v53
  v_cvt_pk_bf16_f32 v59, v54, v55
  buffer_store_dwordx4 v[56:59], v23, s[4:7], s46 offen offset:1024 sc1
  v_accvgpr_read_b32 v32, a152
  v_accvgpr_read_b32 v33, a153
  v_accvgpr_read_b32 v34, a154
  v_accvgpr_read_b32 v35, a155
  v_accvgpr_read_b32 v36, a184
  v_accvgpr_read_b32 v37, a185
  v_accvgpr_read_b32 v38, a186
  v_accvgpr_read_b32 v39, a187
  v_cvt_pk_bf16_f32 v40, v32, v33
  v_cvt_pk_bf16_f32 v41, v34, v35
  v_cvt_pk_bf16_f32 v42, v36, v37
  v_cvt_pk_bf16_f32 v43, v38, v39
  buffer_store_dwordx4 v[40:43], v23, s[4:7], s46 offen offset:2048 sc1
  v_accvgpr_read_b32 v48, a156
  v_accvgpr_read_b32 v49, a157
  v_accvgpr_read_b32 v50, a158
  v_accvgpr_read_b32 v51, a159
  v_accvgpr_read_b32 v52, a188
  v_accvgpr_read_b32 v53, a189
  v_accvgpr_read_b32 v54, a190
  v_accvgpr_read_b32 v55, a191
  v_cvt_pk_bf16_f32 v56, v48, v49
  v_cvt_pk_bf16_f32 v57, v50, v51
  v_cvt_pk_bf16_f32 v58, v52, v53
  v_cvt_pk_bf16_f32 v59, v54, v55
  buffer_store_dwordx4 v[56:59], v23, s[4:7], s46 offen offset:3072 sc1
  s_add_u32 s46, s45, 786432
  v_accvgpr_read_b32 v32, a192
  v_accvgpr_read_b32 v33, a193
  v_accvgpr_read_b32 v34, a194
  v_accvgpr_read_b32 v35, a195
  v_accvgpr_read_b32 v36, a224
  v_accvgpr_read_b32 v37, a225
  v_accvgpr_read_b32 v38, a226
  v_accvgpr_read_b32 v39, a227
  v_cvt_pk_bf16_f32 v40, v32, v33
  v_cvt_pk_bf16_f32 v41, v34, v35
  v_cvt_pk_bf16_f32 v42, v36, v37
  v_cvt_pk_bf16_f32 v43, v38, v39
  buffer_store_dwordx4 v[40:43], v23, s[4:7], s46 offen offset:0 sc1
  v_accvgpr_read_b32 v48, a196
  v_accvgpr_read_b32 v49, a197
  v_accvgpr_read_b32 v50, a198
  v_accvgpr_read_b32 v51, a199
  v_accvgpr_read_b32 v52, a228
  v_accvgpr_read_b32 v53, a229
  v_accvgpr_read_b32 v54, a230
  v_accvgpr_read_b32 v55, a231
  v_cvt_pk_bf16_f32 v56, v48, v49
  v_cvt_pk_bf16_f32 v57, v50, v51
  v_cvt_pk_bf16_f32 v58, v52, v53
  v_cvt_pk_bf16_f32 v59, v54, v55
  buffer_store_dwordx4 v[56:59], v23, s[4:7], s46 offen offset:1024 sc1
  v_accvgpr_read_b32 v32, a200
  v_accvgpr_read_b32 v33, a201
  v_accvgpr_read_b32 v34, a202
  v_accvgpr_read_b32 v35, a203
  v_accvgpr_read_b32 v36, a232
  v_accvgpr_read_b32 v37, a233
  v_accvgpr_read_b32 v38, a234
  v_accvgpr_read_b32 v39, a235
  v_cvt_pk_bf16_f32 v40, v32, v33
  v_cvt_pk_bf16_f32 v41, v34, v35
  v_cvt_pk_bf16_f32 v42, v36, v37
  v_cvt_pk_bf16_f32 v43, v38, v39
  buffer_store_dwordx4 v[40:43], v23, s[4:7], s46 offen offset:2048 sc1
  v_accvgpr_read_b32 v48, a204
  v_accvgpr_read_b32 v49, a205
  v_accvgpr_read_b32 v50, a206
  v_accvgpr_read_b32 v51, a207
  v_accvgpr_read_b32 v52, a236
  v_accvgpr_read_b32 v53, a237
  v_accvgpr_read_b32 v54, a238
  v_accvgpr_read_b32 v55, a239
  v_cvt_pk_bf16_f32 v56, v48, v49
  v_cvt_pk_bf16_f32 v57, v50, v51
  v_cvt_pk_bf16_f32 v58, v52, v53
  v_cvt_pk_bf16_f32 v59, v54, v55
  buffer_store_dwordx4 v[56:59], v23, s[4:7], s46 offen offset:3072 sc1
  s_add_u32 s46, s45, 794624
  v_accvgpr_read_b32 v32, a208
  v_accvgpr_read_b32 v33, a209
  v_accvgpr_read_b32 v34, a210
  v_accvgpr_read_b32 v35, a211
  v_accvgpr_read_b32 v36, a240
  v_accvgpr_read_b32 v37, a241
  v_accvgpr_read_b32 v38, a242
  v_accvgpr_read_b32 v39, a243
  v_cvt_pk_bf16_f32 v40, v32, v33
  v_cvt_pk_bf16_f32 v41, v34, v35
  v_cvt_pk_bf16_f32 v42, v36, v37
  v_cvt_pk_bf16_f32 v43, v38, v39
  buffer_store_dwordx4 v[40:43], v23, s[4:7], s46 offen offset:0 sc1
  v_accvgpr_read_b32 v48, a212
  v_accvgpr_read_b32 v49, a213
  v_accvgpr_read_b32 v50, a214
  v_accvgpr_read_b32 v51, a215
  v_accvgpr_read_b32 v52, a244
  v_accvgpr_read_b32 v53, a245
  v_accvgpr_read_b32 v54, a246
  v_accvgpr_read_b32 v55, a247
  v_cvt_pk_bf16_f32 v56, v48, v49
  v_cvt_pk_bf16_f32 v57, v50, v51
  v_cvt_pk_bf16_f32 v58, v52, v53
  v_cvt_pk_bf16_f32 v59, v54, v55
  buffer_store_dwordx4 v[56:59], v23, s[4:7], s46 offen offset:1024 sc1
  v_accvgpr_read_b32 v32, a216
  v_accvgpr_read_b32 v33, a217
  v_accvgpr_read_b32 v34, a218
  v_accvgpr_read_b32 v35, a219
  v_accvgpr_read_b32 v36, a248
  v_accvgpr_read_b32 v37, a249
  v_accvgpr_read_b32 v38, a250
  v_accvgpr_read_b32 v39, a251
  v_cvt_pk_bf16_f32 v40, v32, v33
  v_cvt_pk_bf16_f32 v41, v34, v35
  v_cvt_pk_bf16_f32 v42, v36, v37
  v_cvt_pk_bf16_f32 v43, v38, v39
  buffer_store_dwordx4 v[40:43], v23, s[4:7], s46 offen offset:2048 sc1
  v_accvgpr_read_b32 v48, a220
  v_accvgpr_read_b32 v49, a221
  v_accvgpr_read_b32 v50, a222
  v_accvgpr_read_b32 v51, a223
  v_accvgpr_read_b32 v52, a252
  v_accvgpr_read_b32 v53, a253
  v_accvgpr_read_b32 v54, a254
  v_accvgpr_read_b32 v55, a255
  v_cvt_pk_bf16_f32 v56, v48, v49
  v_cvt_pk_bf16_f32 v57, v50, v51
  v_cvt_pk_bf16_f32 v58, v52, v53
  v_cvt_pk_bf16_f32 v59, v54, v55
  buffer_store_dwordx4 v[56:59], v23, s[4:7], s46 offen offset:3072 sc1
  s_xor_b32 s79, s79, 4
  s_mov_b32 s76, s35
  s_cmp_lg_u32 s27, 0
  s_cbranch_scc1 L_next_b
  v_mov_b32 v1, s79
  s_mov_b64 exec, 1
  s_waitcnt vmcnt(32)
  ds_write_b32 v1, v253
  s_waitcnt lgkmcnt(0)
  s_mov_b64 exec, -1
  s_branch L_next_b
T_WOF:
  s_cmp_eq_u32 s76, -1
  s_cbranch_scc1 L_fp_97
  s_waitcnt vmcnt(0)
  s_barrier
  s_cmp_eq_u32 s76, -1
  s_cbranch_scc1 L_pe_98
  s_cmp_lg_u32 s27, 0
  s_cbranch_scc1 L_pe_98_c
  s_and_b32 s47, s76, 0xffff
  s_add_u32 s47, s47, 117440512
  s_lshr_b32 s48, s76, 16
  s_add_u32 s48, s48, 1
  v_mov_b32 v18, s47
  v_mov_b32 v19, s48
  s_mov_b64 exec, 1
  buffer_atomic_add v19, v18, s[4:7], 0 offen sc1
  s_mov_b64 exec, -1
L_pe_98_c:
  s_mov_b32 s76, -1
L_pe_98:
L_fp_97:
  s_mov_b32 s35, 4096
  s_lshl_b32 s28, s96, 5
  s_lshl_b32 s40, s98, 3
  s_add_u32 s28, s28, s40
  s_add_u32 s29, s28, 8
T_WOF_l:
  s_load_dwordx2 s[52:53], s[0:1], 40
  s_lshl_b32 s40, s28, 16
  s_lshl_b32 s41, s27, 9
  s_add_u32 s40, s40, s41
  s_lshl_b32 s42, s27, 14
  s_waitcnt lgkmcnt(0)
  s_mov_b32 s8, s52
  s_mov_b32 s9, s53
  s_mov_b32 s10, 0x800000
  s_mov_b32 s11, 0x20000
  v_mov_b32 v1, 0
  v_bfe_u32 v255, v0, 5, 1
  v_lshl_add_u32 v1, v255, 11, v1
  v_bfe_u32 v255, v0, 0, 5
  v_lshl_add_u32 v1, v255, 4, v1
  s_mov_b32 s43, s42
  s_mov_b32 m0, s43
  s_add_u32 s43, s43, 1024
  buffer_load_dwordx4 v1, s[8:11], s40 offen lds
  s_add_u32 s40, s40, 4096
  s_mov_b32 m0, s43
  s_add_u32 s43, s43, 1024
  buffer_load_dwordx4 v1, s[8:11], s40 offen lds
  s_add_u32 s40, s40, 4096
  s_mov_b32 m0, s43
  s_add_u32 s43, s43, 1024
  buffer_load_dwordx4 v1, s[8:11], s40 offen lds
  s_add_u32 s40, s40, 4096
  s_mov_b32 m0, s43
  s_add_u32 s43, s43, 1024
  buffer_load_dwordx4 v1, s[8:11], s40 offen lds
  s_add_u32 s40, s40, 4096
  s_mov_b32 m0, s43
  s_add_u32 s43, s43, 1024
  buffer_load_dwordx4 v1, s[8:11], s40 offen lds
  s_add_u32 s40, s40, 4096
  s_mov_b32 m0, s43
  s_add_u32 s43, s43, 1024
  buffer_load_dwordx4 v1, s[8:11], s40 offen lds
  s_add_u32 s40, s40, 4096
  s_mov_b32 m0, s43
  s_add_u32 s43, s43, 1024
  buffer_load_dwordx4 v1, s[8:11], s40 offen lds
  s_add_u32 s40, s40, 4096
  s_mov_b32 m0, s43
  s_add_u32 s43, s43, 1024
  buffer_load_dwordx4 v1, s[8:11], s40 offen lds
  s_add_u32 s40, s40, 4096
  s_mov_b32 m0, s43
  s_add_u32 s43, s43, 1024
  buffer_load_dwordx4 v1, s[8:11], s40 offen lds
  s_add_u32 s40, s40, 4096
  s_mov_b32 m0, s43
  s_add_u32 s43, s43, 1024
  buffer_load_dwordx4 v1, s[8:11], s40 offen lds
  s_add_u32 s40, s40, 4096
  s_mov_b32 m0, s43
  s_add_u32 s43, s43, 1024
  buffer_load_dwordx4 v1, s[8:11], s40 offen lds
  s_add_u32 s40, s40, 4096
  s_mov_b32 m0, s43
  s_add_u32 s43, s43, 1024
  buffer_load_dwordx4 v1, s[8:11], s40 offen lds
  s_add_u32 s40, s40, 4096
  s_mov_b32 m0, s43
  s_add_u32 s43, s43, 1024
  buffer_load_dwordx4 v1, s[8:11], s40 offen lds
  s_add_u32 s40, s40, 4096
  s_mov_b32 m0, s43
  s_add_u32 s43, s43, 1024
  buffer_load_dwordx4 v1, s[8:11], s40 offen lds
  s_add_u32 s40, s40, 4096
  s_mov_b32 m0, s43
  s_add_u32 s43, s43, 1024
  buffer_load_dwordx4 v1, s[8:11], s40 offen lds
  s_add_u32 s40, s40, 4096
  s_mov_b32 m0, s43
  s_add_u32 s43, s43, 1024
  buffer_load_dwordx4 v1, s[8:11], s40 offen lds
  s_add_u32 s40, s40, 4096
  v_mov_b32 v2, 0
  v_bfe_u32 v255, v0, 4, 2
  v_lshl_add_u32 v2, v255, 11, v2
  v_bfe_u32 v255, v0, 2, 2
  v_lshl_add_u32 v2, v255, 9, v2
  v_bfe_u32 v255, v0, 0, 2
  v_lshl_add_u32 v2, v255, 4, v2
  v_add_u32 v2, s42, v2
  s_lshl_b32 s40, s27, 21
  s_lshl_b32 s41, s28, 10
  s_add_u32 s40, s40, s41
  s_add_u32 s40, s40, 109051904
  v_lshlrev_b32 v3, 4, v0
  s_waitcnt vmcnt(0)
  ds_read_b64_tr_b16 v[8:9], v2 offset:0
  ds_read_b64_tr_b16 v[10:11], v2 offset:8192
  s_waitcnt lgkmcnt(0)
  buffer_store_dwordx4 v[8:11], v3, s[4:7], s40 offen sc1
  s_add_u32 s40, s40, 131072
  ds_read_b64_tr_b16 v[12:13], v2 offset:8
  ds_read_b64_tr_b16 v[14:15], v2 offset:8200
  s_waitcnt lgkmcnt(0)
  buffer_store_dwordx4 v[12:15], v3, s[4:7], s40 offen sc1
  s_add_u32 s40, s40, 131072
  ds_read_b64_tr_b16 v[16:17], v2 offset:64
  ds_read_b64_tr_b16 v[18:19], v2 offset:8256
  s_waitcnt lgkmcnt(0)
  buffer_store_dwordx4 v[16:19], v3, s[4:7], s40 offen sc1
  s_add_u32 s40, s40, 131072
  ds_read_b64_tr_b16 v[20:21], v2 offset:72
  ds_read_b64_tr_b16 v[22:23], v2 offset:8264
  s_waitcnt lgkmcnt(0)
  buffer_store_dwordx4 v[20:23], v3, s[4:7], s40 offen sc1
  s_add_u32 s40, s40, 131072
  ds_read_b64_tr_b16 v[8:9], v2 offset:128
  ds_read_b64_tr_b16 v[10:11], v2 offset:8320
  s_waitcnt lgkmcnt(0)
  buffer_store_dwordx4 v[8:11], v3, s[4:7], s40 offen sc1
  s_add_u32 s40, s40, 131072
  ds_read_b64_tr_b16 v[12:13], v2 offset:136
  ds_read_b64_tr_b16 v[14:15], v2 offset:8328
  s_waitcnt lgkmcnt(0)
  buffer_store_dwordx4 v[12:15], v3, s[4:7], s40 offen sc1
  s_add_u32 s40, s40, 131072
  ds_read_b64_tr_b16 v[16:17], v2 offset:192
  ds_read_b64_tr_b16 v[18:19], v2 offset:8384
  s_waitcnt lgkmcnt(0)
  buffer_store_dwordx4 v[16:19], v3, s[4:7], s40 offen sc1
  s_add_u32 s40, s40, 131072
  ds_read_b64_tr_b16 v[20:21], v2 offset:200
  ds_read_b64_tr_b16 v[22:23], v2 offset:8392
  s_waitcnt lgkmcnt(0)
  buffer_store_dwordx4 v[20:23], v3, s[4:7], s40 offen sc1
  s_add_u32 s40, s40, 131072
  ds_read_b64_tr_b16 v[8:9], v2 offset:256
  ds_read_b64_tr_b16 v[10:11], v2 offset:8448
  s_waitcnt lgkmcnt(0)
  buffer_store_dwordx4 v[8:11], v3, s[4:7], s40 offen sc1
  s_add_u32 s40, s40, 131072
  ds_read_b64_tr_b16 v[12:13], v2 offset:264
  ds_read_b64_tr_b16 v[14:15], v2 offset:8456
  s_waitcnt lgkmcnt(0)
  buffer_store_dwordx4 v[12:15], v3, s[4:7], s40 offen sc1
  s_add_u32 s40, s40, 131072
  ds_read_b64_tr_b16 v[16:17], v2 offset:320
  ds_read_b64_tr_b16 v[18:19], v2 offset:8512
  s_waitcnt lgkmcnt(0)
  buffer_store_dwordx4 v[16:19], v3, s[4:7], s40 offen sc1
  s_add_u32 s40, s40, 131072
  ds_read_b64_tr_b16 v[20:21], v2 offset:328
  ds_read_b64_tr_b16 v[22:23], v2 offset:8520
  s_waitcnt lgkmcnt(0)
  buffer_store_dwordx4 v[20:23], v3, s[4:7], s40 offen sc1
  s_add_u32 s40, s40, 131072
  ds_read_b64_tr_b16 v[8:9], v2 offset:384
  ds_read_b64_tr_b16 v[10:11], v2 offset:8576
  s_waitcnt lgkmcnt(0)
  buffer_store_dwordx4 v[8:11], v3, s[4:7], s40 offen sc1
  s_add_u32 s40, s40, 131072
  ds_read_b64_tr_b16 v[12:13], v2 offset:392
  ds_read_b64_tr_b16 v[14:15], v2 offset:8584
  s_waitcnt lgkmcnt(0)
  buffer_store_dwordx4 v[12:15], v3, s[4:7], s40 offen sc1
  s_add_u32 s40, s40, 131072
  ds_read_b64_tr_b16 v[16:17], v2 offset:448
  ds_read_b64_tr_b16 v[18:19], v2 offset:8640
  s_waitcnt lgkmcnt(0)
  buffer_store_dwordx4 v[16:19], v3, s[4:7], s40 offen sc1
  s_add_u32 s40, s40, 131072
  ds_read_b64_tr_b16 v[20:21], v2 offset:456
  ds_read_b64_tr_b16 v[22:23], v2 offset:8648
  s_waitcnt lgkmcnt(0)
  buffer_store_dwordx4 v[20:23], v3, s[4:7], s40 offen sc1
  s_add_u32 s40, s40, 131072
  s_add_u32 s28, s28, 1
  s_cmp_lt_u32 s28, s29
  s_cbranch_scc1 T_WOF_l
  s_branch L_next
T_A:
  s_cmp_eq_u32 s76, -1
  s_cbranch_scc1 L_fp_99
  s_waitcnt vmcnt(0)
  s_barrier
  s_cmp_eq_u32 s76, -1
  s_cbranch_scc1 L_pe_100
  s_cmp_lg_u32 s27, 0
  s_cbranch_scc1 L_pe_100_c
  s_and_b32 s47, s76, 0xffff
  s_add_u32 s47, s47, 117440512
  s_lshr_b32 s48, s76, 16
  s_add_u32 s48, s48, 1
  v_mov_b32 v18, s47
  v_mov_b32 v19, s48
  s_mov_b64 exec, 1
  buffer_atomic_add v19, v18, s[4:7], 0 offen sc1
  s_mov_b64 exec, -1
L_pe_100_c:
  s_mov_b32 s76, -1
L_pe_100:
L_fp_99:
  s_lshr_b32 s28, s98, 2
  s_lshl_b32 s35, s28, 7
  s_add_u32 s35, s35, 5120
  s_and_b32 s40, s98, 1
  s_lshl_b32 s41, s96, 1
  s_add_u32 s29, s41, s40
  s_lshr_b32 s28, s98, 1
  s_lshr_b32 s30, s28, 3
  s_add_u32 s44, s28, 1
  s_cmp_lg_u32 s27, 0
  s_cbranch_scc1 L_wm_101_w
  s_lshl_b32 s41, s30, 7
  s_add_u32 s41, s41, 117441536
  v_writelane_b32 v1, s41, 0
  v_writelane_b32 v2, 16, 0
  s_mov_b32 s41, 117444736
  v_writelane_b32 v1, s41, 1
  v_writelane_b32 v2, s44, 1
  s_mov_b32 s99, 100000
  s_mov_b64 exec, 3
L_wm_101_p:
  buffer_load_dword v3, v1, s[4:7], 0 offen sc1
  s_waitcnt vmcnt(0)
  v_cmp_gt_u32 vcc, v2, v3
  s_cbranch_vccz L_wm_101_x
  s_sub_u32 s99, s99, 1
  s_cbranch_scc0 L_wm_101_p
  v_mov_b32 v1, 236
  v_mov_b32 v2, 1
  s_mov_b64 exec, 1
  global_atomic_add v1, v2, s[90:91] sc1
L_wm_101_x:
  s_mov_b64 exec, -1
L_wm_101_w:
  s_barrier
  s_lshl_b32 s40, s29, 2
  s_add_u32 s40, s40, s27
  s_lshl_b32 s41, s28, 18
  s_lshl_b32 s42, s40, 13
  s_add_u32 s41, s41, s42
  s_add_u32 s42, s41, 8388608
  s_add_u32 s43, s41, 25165824
  s_add_u32 s44, s41, 41943040
  s_lshl_b32 s45, s28, 16
  s_lshl_b32 s46, s40, 11
  s_add_u32 s45, s45, s46
  s_add_u32 s46, s45, 92274688
  s_add_u32 s47, s45, 96468992
  v_lshlrev_b32 v1, 4, v0
  v_add_u32 v2, 4096, v1
  v_lshlrev_b32 v3, 3, v0
  v_mov_b32 v4, 0
  v_bfe_u32 v255, v0, 2, 2
  v_lshl_add_u32 v4, v255, 7, v4
  v_bfe_u32 v255, v0, 0, 1
  v_lshl_add_u32 v4, v255, 6, v4
  v_bfe_u32 v255, v0, 4, 2
  v_lshl_add_u32 v4, v255, 4, v4
  buffer_load_dwordx4 v[112:115], v4, s[4:7], s46 offen offset:0
  buffer_load_dwordx4 v[116:119], v4, s[4:7], s46 offen offset:512
  buffer_load_dwordx4 v[120:123], v4, s[4:7], s46 offen offset:1024
  buffer_load_dwordx4 v[124:127], v4, s[4:7], s46 offen offset:1536
  buffer_load_dwordx4 v[16:19], v1, s[4:7], s42 offen offset:0
  buffer_load_dwordx4 v[20:23], v1, s[4:7], s42 offen offset:1024
  buffer_load_dwordx4 v[24:27], v1, s[4:7], s42 offen offset:2048
  buffer_load_dwordx4 v[28:31], v1, s[4:7], s42 offen offset:3072
  buffer_load_dwordx4 v[32:35], v2, s[4:7], s42 offen offset:0
  buffer_load_dwordx4 v[36:39], v2, s[4:7], s42 offen offset:1024
  buffer_load_dwordx4 v[40:43], v2, s[4:7], s42 offen offset:2048
  buffer_load_dwordx4 v[44:47], v2, s[4:7], s42 offen offset:3072
  buffer_load_dwordx4 v[48:51], v1, s[4:7], s43 offen offset:0
  buffer_load_dwordx4 v[52:55], v1, s[4:7], s43 offen offset:1024
  buffer_load_dwordx4 v[56:59], v1, s[4:7], s43 offen offset:2048
  buffer_load_dwordx4 v[60:63], v1, s[4:7], s43 offen offset:3072
  buffer_load_dwordx4 v[64:67], v2, s[4:7], s43 offen offset:0
  buffer_load_dwordx4 v[68:71], v2, s[4:7], s43 offen offset:1024
  buffer_load_dwordx4 v[72:75], v2, s[4:7], s43 offen offset:2048
  buffer_load_dwordx4 v[76:79], v2, s[4:7], s43 offen offset:3072
  buffer_load_dwordx2 v[128:129], v3, s[4:7], s47 offen offset:0
  buffer_load_dwordx2 v[130:131], v3, s[4:7], s47 offen offset:512
  buffer_load_dwordx2 v[132:133], v3, s[4:7], s47 offen offset:1024
  buffer_load_dwordx2 v[134:135], v3, s[4:7], s47 offen offset:1536
  buffer_load_dwordx4 v[80:83], v1, s[4:7], s44 offen offset:0
  buffer_load_dwordx4 v[84:87], v1, s[4:7], s44 offen offset:1024
  buffer_load_dwordx4 v[88:91], v1, s[4:7], s44 offen offset:2048
  buffer_load_dwordx4 v[92:95], v1, s[4:7], s44 offen offset:3072
  buffer_load_dwordx4 v[96:99], v2, s[4:7], s44 offen offset:0
  buffer_load_dwordx4 v[100:103], v2, s[4:7], s44 offen offset:1024
  buffer_load_dwordx4 v[104:107], v2, s[4:7], s44 offen offset:2048
  buffer_load_dwordx4 v[108:111], v2, s[4:7], s44 offen offset:3072
  v_and_b32 v5, 15, v0
  v_lshrrev_b32 v6, 4, v0
  v_lshlrev_b32 v6, 2, v6
  v_add_u32 v7, 0, v6
  v_cmp_le_u32 s[54:55], v7, v5
  v_add_u32 v7, 1, v6
  v_cmp_le_u32 s[56:57], v7, v5
  v_add_u32 v7, 2, v6
  v_cmp_le_u32 s[58:59], v7, v5
  v_add_u32 v7, 3, v6
  v_cmp_le_u32 s[60:61], v7, v5
  v_mov_b32 v168, 0x3f803f80
  v_mov_b32 v169, 0x3f803f80
  v_mov_b32 v170, 0x3f803f80
  v_mov_b32 v171, 0x3f803f80
  v_mov_b32 v216, 0xff800000
  v_mov_b32 v165, 0
  v_mov_b32 v166, 0
  s_mov_b32 s48, 0x3e0293ee
  s_lshl_b32 s49, s28, 18
  s_lshl_b32 s50, s40, 12
  s_add_u32 s49, s49, s50
  s_add_u32 s49, s49, 58720256
  s_waitcnt vmcnt(12)
  v_mfma_f32_16x16x32_bf16 v[136:139], v[112:115], v[16:19], 0
  v_mfma_f32_16x16x32_bf16 v[140:143], v[48:51], v[16:19], 0
  v_mfma_f32_16x16x32_bf16 v[136:139], v[116:119], v[20:23], v[136:139]
  v_mfma_f32_16x16x32_bf16 v[140:143], v[52:55], v[20:23], v[140:143]
  v_mfma_f32_16x16x32_bf16 v[136:139], v[120:123], v[24:27], v[136:139]
  v_mfma_f32_16x16x32_bf16 v[140:143], v[56:59], v[24:27], v[140:143]
  v_mfma_f32_16x16x32_bf16 v[136:139], v[124:127], v[28:31], v[136:139]
  v_mfma_f32_16x16x32_bf16 v[140:143], v[60:63], v[28:31], v[140:143]
  v_mfma_f32_16x16x32_bf16 v[148:151], v[112:115], v[32:35], 0
  v_mfma_f32_16x16x32_bf16 v[152:155], v[48:51], v[32:35], 0
  v_mfma_f32_16x16x32_bf16 v[156:159], v[64:67], v[32:35], 0
  v_mfma_f32_16x16x32_bf16 v[148:151], v[116:119], v[36:39], v[148:151]
  v_mfma_f32_16x16x32_bf16 v[152:155], v[52:55], v[36:39], v[152:155]
  v_mfma_f32_16x16x32_bf16 v[156:159], v[68:71], v[36:39], v[156:159]
  v_mfma_f32_16x16x32_bf16 v[148:151], v[120:123], v[40:43], v[148:151]
  v_mfma_f32_16x16x32_bf16 v[152:155], v[56:59], v[40:43], v[152:155]
  v_mfma_f32_16x16x32_bf16 v[156:159], v[72:75], v[40:43], v[156:159]
  v_mfma_f32_16x16x32_bf16 v[148:151], v[124:127], v[44:47], v[148:151]
  v_mfma_f32_16x16x32_bf16 v[152:155], v[60:63], v[44:47], v[152:155]
  v_mfma_f32_16x16x32_bf16 v[156:159], v[76:79], v[44:47], v[156:159]
  s_nop 7
  v_cndmask_b32 v140, v216, v140, s[54:55]
  v_cndmask_b32 v141, v216, v141, s[56:57]
  v_cndmask_b32 v142, v216, v142, s[58:59]
  v_cndmask_b32 v143, v216, v143, s[60:61]
  v_max3_f32 v208, v136, v137, v140
  v_max3_f32 v208, v208, v141, v142
  v_max_f32 v208, v208, v143
  v_mov_b32 v209, v208
  s_nop 1
  v_permlane32_swap_b32 v208, v209
  v_max_f32 v208, v208, v209
  v_mov_b32 v209, v208
  s_nop 1
  v_permlane16_swap_b32 v208, v209
  v_max_f32 v208, v208, v209
  v_mul_f32 v208, s48, v208
  v_fma_f32 v136, v136, s48, -v208
  v_fma_f32 v137, v137, s48, -v208
  v_fma_f32 v140, v140, s48, -v208
  v_fma_f32 v141, v141, s48, -v208
  v_fma_f32 v142, v142, s48, -v208
  v_fma_f32 v143, v143, s48, -v208
  v_exp_f32 v136, v136
  v_exp_f32 v137, v137
  v_exp_f32 v140, v140
  v_exp_f32 v141, v141
  v_exp_f32 v142, v142
  v_exp_f32 v143, v143
  s_nop 0
  v_cvt_pk_bf16_f32 v164, v136, v137
  v_cvt_pk_bf16_f32 v167, v136, v137
  v_cvt_pk_bf16_f32 v160, v140, v141
  v_cvt_pk_bf16_f32 v161, v142, v143
  s_waitcnt vmcnt(0)
  s_nop 1
  v_mfma_f32_16x16x16_bf16 v[172:175], v[168:169], v[164:165], 0
  v_mfma_f32_16x16x16_bf16 v[176:179], v[128:129], v[164:165], 0
  v_mfma_f32_16x16x16_bf16 v[180:183], v[128:129], v[166:167], 0
  v_mfma_f32_16x16x16_bf16 v[184:187], v[130:131], v[164:165], 0
  v_mfma_f32_16x16x16_bf16 v[188:191], v[130:131], v[166:167], 0
  v_mfma_f32_16x16x16_bf16 v[192:195], v[132:133], v[164:165], 0
  v_mfma_f32_16x16x16_bf16 v[196:199], v[132:133], v[166:167], 0
  v_mfma_f32_16x16x16_bf16 v[200:203], v[134:135], v[164:165], 0
  v_mfma_f32_16x16x16_bf16 v[204:207], v[134:135], v[166:167], 0
  v_mfma_f32_16x16x16_bf16 v[172:175], v[168:169], v[160:161], v[172:175]
  v_mfma_f32_16x16x16_bf16 v[176:179], v[80:81], v[160:161], v[176:179]
  v_mfma_f32_16x16x16_bf16 v[180:183], v[84:85], v[160:161], v[180:183]
  v_mfma_f32_16x16x16_bf16 v[184:187], v[88:89], v[160:161], v[184:187]
  v_mfma_f32_16x16x16_bf16 v[188:191], v[92:93], v[160:161], v[188:191]
  v_mfma_f32_16x16x16_bf16 v[192:195], v[96:97], v[160:161], v[192:195]
  v_mfma_f32_16x16x16_bf16 v[196:199], v[100:101], v[160:161], v[196:199]
  v_mfma_f32_16x16x16_bf16 v[200:203], v[104:105], v[160:161], v[200:203]
  v_mfma_f32_16x16x16_bf16 v[204:207], v[108:109], v[160:161], v[204:207]
  s_nop 7
  v_rcp_f32 v210, v172
  s_nop 0
  v_mul_f32 v176, v176, v210
  v_mul_f32 v177, v177, v210
  v_mul_f32 v178, v178, v210
  v_mul_f32 v179, v179, v210
  v_mul_f32 v180, v180, v210
  v_mul_f32 v181, v181, v210
  v_mul_f32 v182, v182, v210
  v_mul_f32 v183, v183, v210
  v_cvt_pk_bf16_f32 v212, v176, v177
  v_cvt_pk_bf16_f32 v213, v178, v179
  v_cvt_pk_bf16_f32 v214, v180, v181
  v_cvt_pk_bf16_f32 v215, v182, v183
  buffer_store_dwordx4 v[212:215], v1, s[4:7], s49 offen offset:0 sc1
  v_mul_f32 v184, v184, v210
  v_mul_f32 v185, v185, v210
  v_mul_f32 v186, v186, v210
  v_mul_f32 v187, v187, v210
  v_mul_f32 v188, v188, v210
  v_mul_f32 v189, v189, v210
  v_mul_f32 v190, v190, v210
  v_mul_f32 v191, v191, v210
  v_cvt_pk_bf16_f32 v220, v184, v185
  v_cvt_pk_bf16_f32 v221, v186, v187
  v_cvt_pk_bf16_f32 v222, v188, v189
  v_cvt_pk_bf16_f32 v223, v190, v191
  buffer_store_dwordx4 v[220:223], v1, s[4:7], s49 offen offset:1024 sc1
  v_mul_f32 v192, v192, v210
  v_mul_f32 v193, v193, v210
  v_mul_f32 v194, v194, v210
  v_mul_f32 v195, v195, v210
  v_mul_f32 v196, v196, v210
  v_mul_f32 v197, v197, v210
  v_mul_f32 v198, v198, v210
  v_mul_f32 v199, v199, v210
  v_cvt_pk_bf16_f32 v212, v192, v193
  v_cvt_pk_bf16_f32 v213, v194, v195
  v_cvt_pk_bf16_f32 v214, v196, v197
  v_cvt_pk_bf16_f32 v215, v198, v199
  buffer_store_dwordx4 v[212:215], v1, s[4:7], s49 offen offset:2048 sc1
  v_mul_f32 v200, v200, v210
  v_mul_f32 v201, v201, v210
  v_mul_f32 v202, v202, v210
  v_mul_f32 v203, v203, v210
  v_mul_f32 v204, v204, v210
  v_mul_f32 v205, v205, v210
  v_mul_f32 v206, v206, v210
  v_mul_f32 v207, v207, v210
  v_cvt_pk_bf16_f32 v220, v200, v201
  v_cvt_pk_bf16_f32 v221, v202, v203
  v_cvt_pk_bf16_f32 v222, v204, v205
  v_cvt_pk_bf16_f32 v223, v206, v207
  buffer_store_dwordx4 v[220:223], v1, s[4:7], s49 offen offset:3072 sc1
  s_add_u32 s49, s49, 131072
  s_nop 1
  v_cndmask_b32 v156, v216, v156, s[54:55]
  v_cndmask_b32 v157, v216, v157, s[56:57]
  v_cndmask_b32 v158, v216, v158, s[58:59]
  v_cndmask_b32 v159, v216, v159, s[60:61]
  v_max3_f32 v208, v148, v149, v152
  v_max3_f32 v208, v208, v153, v154
  v_max3_f32 v208, v208, v155, v156
  v_max3_f32 v208, v208, v157, v158
  v_max_f32 v208, v208, v159
  v_mov_b32 v209, v208
  s_nop 1
  v_permlane32_swap_b32 v208, v209
  v_max_f32 v208, v208, v209
  v_mov_b32 v209, v208
  s_nop 1
  v_permlane16_swap_b32 v208, v209
  v_max_f32 v208, v208, v209
  v_mul_f32 v208, s48, v208
  v_fma_f32 v148, v148, s48, -v208
  v_fma_f32 v149, v149, s48, -v208
  v_fma_f32 v152, v152, s48, -v208
  v_fma_f32 v153, v153, s48, -v208
  v_fma_f32 v154, v154, s48, -v208
  v_fma_f32 v155, v155, s48, -v208
  v_fma_f32 v156, v156, s48, -v208
  v_fma_f32 v157, v157, s48, -v208
  v_fma_f32 v158, v158, s48, -v208
  v_fma_f32 v159, v159, s48, -v208
  v_exp_f32 v148, v148
  v_exp_f32 v149, v149
  v_exp_f32 v152, v152
  v_exp_f32 v153, v153
  v_exp_f32 v154, v154
  v_exp_f32 v155, v155
  v_exp_f32 v156, v156
  v_exp_f32 v157, v157
  v_exp_f32 v158, v158
  v_exp_f32 v159, v159
  s_nop 0
  v_cvt_pk_bf16_f32 v164, v148, v149
  v_cvt_pk_bf16_f32 v167, v148, v149
  v_cvt_pk_bf16_f32 v160, v152, v153
  v_cvt_pk_bf16_f32 v161, v154, v155
  v_cvt_pk_bf16_f32 v162, v156, v157
  v_cvt_pk_bf16_f32 v163, v158, v159
  s_nop 1
  v_mfma_f32_16x16x16_bf16 v[172:175], v[168:169], v[164:165], 0
  v_mfma_f32_16x16x16_bf16 v[176:179], v[128:129], v[164:165], 0
  v_mfma_f32_16x16x16_bf16 v[180:183], v[128:129], v[166:167], 0
  v_mfma_f32_16x16x16_bf16 v[184:187], v[130:131], v[164:165], 0
  v_mfma_f32_16x16x16_bf16 v[188:191], v[130:131], v[166:167], 0
  v_mfma_f32_16x16x16_bf16 v[192:195], v[132:133], v[164:165], 0
  v_mfma_f32_16x16x16_bf16 v[196:199], v[132:133], v[166:167], 0
  v_mfma_f32_16x16x16_bf16 v[200:203], v[134:135], v[164:165], 0
  v_mfma_f32_16x16x16_bf16 v[204:207], v[134:135], v[166:167], 0
  v_mfma_f32_16x16x32_bf16 v[172:175], v[168:171], v[160:163], v[172:175]
  v_mfma_f32_16x16x32_bf16 v[176:179], v[80:83], v[160:163], v[176:179]
  v_mfma_f32_16x16x32_bf16 v[180:183], v[84:87], v[160:163], v[180:183]
  v_mfma_f32_16x16x32_bf16 v[184:187], v[88:91], v[160:163], v[184:187]
  v_mfma_f32_16x16x32_bf16 v[188:191], v[92:95], v[160:163], v[188:191]
  v_mfma_f32_16x16x32_bf16 v[192:195], v[96:99], v[160:163], v[192:195]
  v_mfma_f32_16x16x32_bf16 v[196:199], v[100:103], v[160:163], v[196:199]
  v_mfma_f32_16x16x32_bf16 v[200:203], v[104:107], v[160:163], v[200:203]
  v_mfma_f32_16x16x32_bf16 v[204:207], v[108:111], v[160:163], v[204:207]
  s_nop 7
  v_rcp_f32 v210, v172
  s_nop 0
  v_mul_f32 v176, v176, v210
  v_mul_f32 v177, v177, v210
  v_mul_f32 v178, v178, v210
  v_mul_f32 v179, v179, v210
  v_mul_f32 v180, v180, v210
  v_mul_f32 v181, v181, v210
  v_mul_f32 v182, v182, v210
  v_mul_f32 v183, v183, v210
  v_cvt_pk_bf16_f32 v212, v176, v177
  v_cvt_pk_bf16_f32 v213, v178, v179
  v_cvt_pk_bf16_f32 v214, v180, v181
  v_cvt_pk_bf16_f32 v215, v182, v183
  buffer_store_dwordx4 v[212:215], v1, s[4:7], s49 offen offset:0 sc1
  v_mul_f32 v184, v184, v210
  v_mul_f32 v185, v185, v210
  v_mul_f32 v186, v186, v210
  v_mul_f32 v187, v187, v210
  v_mul_f32 v188, v188, v210
  v_mul_f32 v189, v189, v210
  v_mul_f32 v190, v190, v210
  v_mul_f32 v191, v191, v210
  v_cvt_pk_bf16_f32 v220, v184, v185
  v_cvt_pk_bf16_f32 v221, v186, v187
  v_cvt_pk_bf16_f32 v222, v188, v189
  v_cvt_pk_bf16_f32 v223, v190, v191
  buffer_store_dwordx4 v[220:223], v1, s[4:7], s49 offen offset:1024 sc1
  v_mul_f32 v192, v192, v210
  v_mul_f32 v193, v193, v210
  v_mul_f32 v194, v194, v210
  v_mul_f32 v195, v195, v210
  v_mul_f32 v196, v196, v210
  v_mul_f32 v197, v197, v210
  v_mul_f32 v198, v198, v210
  v_mul_f32 v199, v199, v210
  v_cvt_pk_bf16_f32 v212, v192, v193
  v_cvt_pk_bf16_f32 v213, v194, v195
  v_cvt_pk_bf16_f32 v214, v196, v197
  v_cvt_pk_bf16_f32 v215, v198, v199
  buffer_store_dwordx4 v[212:215], v1, s[4:7], s49 offen offset:2048 sc1
  v_mul_f32 v200, v200, v210
  v_mul_f32 v201, v201, v210
  v_mul_f32 v202, v202, v210
  v_mul_f32 v203, v203, v210
  v_mul_f32 v204, v204, v210
  v_mul_f32 v205, v205, v210
  v_mul_f32 v206, v206, v210
  v_mul_f32 v207, v207, v210
  v_cvt_pk_bf16_f32 v220, v200, v201
  v_cvt_pk_bf16_f32 v221, v202, v203
  v_cvt_pk_bf16_f32 v222, v204, v205
  v_cvt_pk_bf16_f32 v223, v206, v207
  buffer_store_dwordx4 v[220:223], v1, s[4:7], s49 offen offset:3072 sc1
  s_branch L_next
T_AL:
  s_cmp_eq_u32 s76, -1
  s_cbranch_scc1 L_fp_102
  s_waitcnt vmcnt(0)
  s_barrier
  s_cmp_eq_u32 s76, -1
  s_cbranch_scc1 L_pe_103
  s_cmp_lg_u32 s27, 0
  s_cbranch_scc1 L_pe_103_c
  s_and_b32 s47, s76, 0xffff
  s_add_u32 s47, s47, 117440512
  s_lshr_b32 s48, s76, 16
  s_add_u32 s48, s48, 1
  v_mov_b32 v18, s47
  v_mov_b32 v19, s48
  s_mov_b64 exec, 1
  buffer_atomic_add v19, v18, s[4:7], 0 offen sc1
  s_mov_b64 exec, -1
L_pe_103_c:
  s_mov_b32 s76, -1
L_pe_103:
L_fp_102:
  s_lshr_b32 s28, s98, 2
  s_lshl_b32 s35, s28, 7
  s_add_u32 s35, s35, 5120
  s_and_b32 s40, s98, 1
  s_lshl_b32 s41, s96, 1
  s_add_u32 s29, s41, s40
  s_lshr_b32 s28, s98, 1
  s_lshr_b32 s30, s28, 3
  s_cmp_lg_u32 s27, 0
  s_cbranch_scc1 L_wm_104_w
  s_lshl_b32 s41, s30, 7
  s_add_u32 s41, s41, 117441536
  v_writelane_b32 v1, s41, 0
  v_writelane_b32 v2, 16, 0
  s_lshl_b32 s41, s30, 7
  s_add_u32 s41, s41, 117440512
  v_writelane_b32 v1, s41, 1
  v_writelane_b32 v2, 64, 1
  s_mov_b32 s99, 100000
  s_mov_b64 exec, 3
L_wm_104_p:
  buffer_load_dword v3, v1, s[4:7], 0 offen sc1
  s_waitcnt vmcnt(0)
  v_cmp_gt_u32 vcc, v2, v3
  s_cbranch_vccz L_wm_104_x
  s_sub_u32 s99, s99, 1
  s_cbranch_scc0 L_wm_104_p
  v_mov_b32 v1, 236
  v_mov_b32 v2, 1
  s_mov_b64 exec, 1
  global_atomic_add v1, v2, s[90:91] sc1
L_wm_104_x:
  s_mov_b64 exec, -1
L_wm_104_w:
  s_barrier
  s_lshl_b32 s40, s29, 2
  s_add_u32 s40, s40, s27
  s_lshl_b32 s41, s28, 18
  s_lshl_b32 s42, s40, 13
  s_add_u32 s41, s41, s42
  s_add_u32 s42, s41, 8388608
  s_add_u32 s43, s41, 25165824
  s_add_u32 s44, s41, 41943040
  s_lshl_b32 s45, s28, 16
  s_lshl_b32 s46, s40, 11
  s_add_u32 s45, s45, s46
  s_add_u32 s46, s45, 92274688
  s_add_u32 s47, s45, 96468992
  v_lshlrev_b32 v1, 4, v0
  v_add_u32 v2, 4096, v1
  v_lshlrev_b32 v3, 3, v0
  v_mov_b32 v4, 0
  v_bfe_u32 v255, v0, 2, 2
  v_lshl_add_u32 v4, v255, 7, v4
  v_bfe_u32 v255, v0, 0, 1
  v_lshl_add_u32 v4, v255, 6, v4
  v_bfe_u32 v255, v0, 4, 2
  v_lshl_add_u32 v4, v255, 4, v4
  buffer_load_dwordx4 v[16:19], v1, s[4:7], s42 offen offset:0
  buffer_load_dwordx4 v[20:23], v1, s[4:7], s42 offen offset:1024
  buffer_load_dwordx4 v[24:27], v1, s[4:7], s42 offen offset:2048
  buffer_load_dwordx4 v[28:31], v1, s[4:7], s42 offen offset:3072
  buffer_load_dwordx4 v[32:35], v2, s[4:7], s42 offen offset:0
  buffer_load_dwordx4 v[36:39], v2, s[4:7], s42 offen offset:1024
  buffer_load_dwordx4 v[40:43], v2, s[4:7], s42 offen offset:2048
  buffer_load_dwordx4 v[44:47], v2, s[4:7], s42 offen offset:3072
  buffer_load_dwordx4 v[48:51], v1, s[4:7], s43 offen offset:0
  buffer_load_dwordx4 v[52:55], v1, s[4:7], s43 offen offset:1024
  buffer_load_dwordx4 v[56:59], v1, s[4:7], s43 offen offset:2048
  buffer_load_dwordx4 v[60:63], v1, s[4:7], s43 offen offset:3072
  buffer_load_dwordx4 v[64:67], v2, s[4:7], s43 offen offset:0
  buffer_load_dwordx4 v[68:71], v2, s[4:7], s43 offen offset:1024
  buffer_load_dwordx4 v[72:75], v2, s[4:7], s43 offen offset:2048
  buffer_load_dwordx4 v[76:79], v2, s[4:7], s43 offen offset:3072
  buffer_load_dwordx4 v[80:83], v1, s[4:7], s44 offen offset:0
  buffer_load_dwordx4 v[84:87], v1, s[4:7], s44 offen offset:1024
  buffer_load_dwordx4 v[88:91], v1, s[4:7], s44 offen offset:2048
  buffer_load_dwordx4 v[92:95], v1, s[4:7], s44 offen offset:3072
  buffer_load_dwordx4 v[96:99], v2, s[4:7], s44 offen offset:0
  buffer_load_dwordx4 v[100:103], v2, s[4:7], s44 offen offset:1024
  buffer_load_dwordx4 v[104:107], v2, s[4:7], s44 offen offset:2048
  buffer_load_dwordx4 v[108:111], v2, s[4:7], s44 offen offset:3072
  v_and_b32 v5, 15, v0
  v_lshrrev_b32 v6, 4, v0
  v_lshlrev_b32 v6, 2, v6
  v_add_u32 v7, 0, v6
  v_cmp_le_u32 s[54:55], v7, v5
  v_add_u32 v7, 1, v6
  v_cmp_le_u32 s[56:57], v7, v5
  v_add_u32 v7, 2, v6
  v_cmp_le_u32 s[58:59], v7, v5
  v_add_u32 v7, 3, v6
  v_cmp_le_u32 s[60:61], v7, v5
  v_mov_b32 v168, 0x3f803f80
  v_mov_b32 v169, 0x3f803f80
  v_mov_b32 v170, 0x3f803f80
  v_mov_b32 v171, 0x3f803f80
  v_mov_b32 v216, 0xff800000
  v_mov_b32 v165, 0
  v_mov_b32 v166, 0
  s_mov_b32 s48, 0x3e0293ee
  s_lshl_b32 s49, s28, 18
  s_lshl_b32 s50, s40, 12
  s_add_u32 s49, s49, s50
  s_add_u32 s49, s49, 58720256
  s_cmp_lg_u32 s27, 0
  s_cbranch_scc1 L_lw_105_w
  s_sub_u32 s52, s28, 1
  s_mov_b32 s51, 117444736
  s_mov_b32 s99, 100000
L_lw_105_p:
  buffer_load_dword v8, off, s[4:7], s51 sc1
  s_waitcnt vmcnt(0)
  v_readfirstlane_b32 s53, v8
  s_nop 0
  s_cmp_ge_u32 s53, s52
  s_cbranch_scc1 L_lw_105_w
  s_sub_u32 s99, s99, 1
  s_cbranch_scc0 L_lw_105_p
L_lw_105_w:
  s_barrier
  s_mov_b32 s51, 200000
L_km_106:
  buffer_load_dwordx4 v[112:115], v4, s[4:7], s46 offen offset:0 sc1
  buffer_load_dwordx4 v[116:119], v4, s[4:7], s46 offen offset:512 sc1
  buffer_load_dwordx4 v[120:123], v4, s[4:7], s46 offen offset:1024 sc1
  buffer_load_dwordx4 v[124:127], v4, s[4:7], s46 offen offset:1536 sc1
  buffer_load_dwordx2 v[128:129], v3, s[4:7], s47 offen offset:0 sc1
  buffer_load_dwordx2 v[130:131], v3, s[4:7], s47 offen offset:512 sc1
  buffer_load_dwordx2 v[132:133], v3, s[4:7], s47 offen offset:1024 sc1
  buffer_load_dwordx2 v[134:135], v3, s[4:7], s47 offen offset:1536 sc1
  s_waitcnt vmcnt(0)
  v_max3_u32 v208, v112, v116, v120
  v_max3_u32 v208, v208, v124, v128
  v_max3_u32 v208, v208, v130, v132
  v_max_u32 v208, v208, v134
  v_cmp_eq_u32 vcc, -1, v208
  s_cbranch_vccz L_km_106_ok
  s_sub_u32 s51, s51, 1
  s_cbranch_scc0 L_km_106
L_km_106_ok:
  v_mfma_f32_16x16x32_bf16 v[136:139], v[112:115], v[16:19], 0
  v_mfma_f32_16x16x32_bf16 v[140:143], v[48:51], v[16:19], 0
  v_mfma_f32_16x16x32_bf16 v[136:139], v[116:119], v[20:23], v[136:139]
  v_mfma_f32_16x16x32_bf16 v[140:143], v[52:55], v[20:23], v[140:143]
  v_mfma_f32_16x16x32_bf16 v[136:139], v[120:123], v[24:27], v[136:139]
  v_mfma_f32_16x16x32_bf16 v[140:143], v[56:59], v[24:27], v[140:143]
  v_mfma_f32_16x16x32_bf16 v[136:139], v[124:127], v[28:31], v[136:139]
  v_mfma_f32_16x16x32_bf16 v[140:143], v[60:63], v[28:31], v[140:143]
  v_mfma_f32_16x16x32_bf16 v[148:151], v[112:115], v[32:35], 0
  v_mfma_f32_16x16x32_bf16 v[152:155], v[48:51], v[32:35], 0
  v_mfma_f32_16x16x32_bf16 v[156:159], v[64:67], v[32:35], 0
  v_mfma_f32_16x16x32_bf16 v[148:151], v[116:119], v[36:39], v[148:151]
  v_mfma_f32_16x16x32_bf16 v[152:155], v[52:55], v[36:39], v[152:155]
  v_mfma_f32_16x16x32_bf16 v[156:159], v[68:71], v[36:39], v[156:159]
  v_mfma_f32_16x16x32_bf16 v[148:151], v[120:123], v[40:43], v[148:151]
  v_mfma_f32_16x16x32_bf16 v[152:155], v[56:59], v[40:43], v[152:155]
  v_mfma_f32_16x16x32_bf16 v[156:159], v[72:75], v[40:43], v[156:159]
  v_mfma_f32_16x16x32_bf16 v[148:151], v[124:127], v[44:47], v[148:151]
  v_mfma_f32_16x16x32_bf16 v[152:155], v[60:63], v[44:47], v[152:155]
  v_mfma_f32_16x16x32_bf16 v[156:159], v[76:79], v[44:47], v[156:159]
  s_nop 7
  v_cndmask_b32 v140, v216, v140, s[54:55]
  v_cndmask_b32 v141, v216, v141, s[56:57]
  v_cndmask_b32 v142, v216, v142, s[58:59]
  v_cndmask_b32 v143, v216, v143, s[60:61]
  v_max3_f32 v208, v136, v137, v140
  v_max3_f32 v208, v208, v141, v142
  v_max_f32 v208, v208, v143
  v_mov_b32 v209, v208
  s_nop 1
  v_permlane32_swap_b32 v208, v209
  v_max_f32 v208, v208, v209
  v_mov_b32 v209, v208
  s_nop 1
  v_permlane16_swap_b32 v208, v209
  v_max_f32 v208, v208, v209
  v_mul_f32 v208, s48, v208
  v_fma_f32 v136, v136, s48, -v208
  v_fma_f32 v137, v137, s48, -v208
  v_fma_f32 v140, v140, s48, -v208
  v_fma_f32 v141, v141, s48, -v208
  v_fma_f32 v142, v142, s48, -v208
  v_fma_f32 v143, v143, s48, -v208
  v_exp_f32 v136, v136
  v_exp_f32 v137, v137
  v_exp_f32 v140, v140
  v_exp_f32 v141, v141
  v_exp_f32 v142, v142
  v_exp_f32 v143, v143
  s_nop 0
  v_cvt_pk_bf16_f32 v164, v136, v137
  v_cvt_pk_bf16_f32 v167, v136, v137
  v_cvt_pk_bf16_f32 v160, v140, v141
  v_cvt_pk_bf16_f32 v161, v142, v143
  s_waitcnt vmcnt(0)
  s_nop 1
  v_mfma_f32_16x16x16_bf16 v[172:175], v[168:169], v[164:165], 0
  v_mfma_f32_16x16x16_bf16 v[176:179], v[128:129], v[164:165], 0
  v_mfma_f32_16x16x16_bf16 v[180:183], v[128:129], v[166:167], 0
  v_mfma_f32_16x16x16_bf16 v[184:187], v[130:131], v[164:165], 0
  v_mfma_f32_16x16x16_bf16 v[188:191], v[130:131], v[166:167], 0
  v_mfma_f32_16x16x16_bf16 v[192:195], v[132:133], v[164:165], 0
  v_mfma_f32_16x16x16_bf16 v[196:199], v[132:133], v[166:167], 0
  v_mfma_f32_16x16x16_bf16 v[200:203], v[134:135], v[164:165], 0
  v_mfma_f32_16x16x16_bf16 v[204:207], v[134:135], v[166:167], 0
  v_mfma_f32_16x16x16_bf16 v[172:175], v[168:169], v[160:161], v[172:175]
  v_mfma_f32_16x16x16_bf16 v[176:179], v[80:81], v[160:161], v[176:179]
  v_mfma_f32_16x16x16_bf16 v[180:183], v[84:85], v[160:161], v[180:183]
  v_mfma_f32_16x16x16_bf16 v[184:187], v[88:89], v[160:161], v[184:187]
  v_mfma_f32_16x16x16_bf16 v[188:191], v[92:93], v[160:161], v[188:191]
  v_mfma_f32_16x16x16_bf16 v[192:195], v[96:97], v[160:161], v[192:195]
  v_mfma_f32_16x16x16_bf16 v[196:199], v[100:101], v[160:161], v[196:199]
  v_mfma_f32_16x16x16_bf16 v[200:203], v[104:105], v[160:161], v[200:203]
  v_mfma_f32_16x16x16_bf16 v[204:207], v[108:109], v[160:161], v[204:207]
  s_nop 7
  v_rcp_f32 v210, v172
  s_nop 0
  v_mul_f32 v176, v176, v210
  v_mul_f32 v177, v177, v210
  v_mul_f32 v178, v178, v210
  v_mul_f32 v179, v179, v210
  v_mul_f32 v180, v180, v210
  v_mul_f32 v181, v181, v210
  v_mul_f32 v182, v182, v210
  v_mul_f32 v183, v183, v210
  v_cvt_pk_bf16_f32 v212, v176, v177
  v_cvt_pk_bf16_f32 v213, v178, v179
  v_cvt_pk_bf16_f32 v214, v180, v181
  v_cvt_pk_bf16_f32 v215, v182, v183
  buffer_store_dwordx4 v[212:215], v1, s[4:7], s49 offen offset:0 sc1
  v_mul_f32 v184, v184, v210
  v_mul_f32 v185, v185, v210
  v_mul_f32 v186, v186, v210
  v_mul_f32 v187, v187, v210
  v_mul_f32 v188, v188, v210
  v_mul_f32 v189, v189, v210
  v_mul_f32 v190, v190, v210
  v_mul_f32 v191, v191, v210
  v_cvt_pk_bf16_f32 v220, v184, v185
  v_cvt_pk_bf16_f32 v221, v186, v187
  v_cvt_pk_bf16_f32 v222, v188, v189
  v_cvt_pk_bf16_f32 v223, v190, v191
  buffer_store_dwordx4 v[220:223], v1, s[4:7], s49 offen offset:1024 sc1
  v_mul_f32 v192, v192, v210
  v_mul_f32 v193, v193, v210
  v_mul_f32 v194, v194, v210
  v_mul_f32 v195, v195, v210
  v_mul_f32 v196, v196, v210
  v_mul_f32 v197, v197, v210
  v_mul_f32 v198, v198, v210
  v_mul_f32 v199, v199, v210
  v_cvt_pk_bf16_f32 v212, v192, v193
  v_cvt_pk_bf16_f32 v213, v194, v195
  v_cvt_pk_bf16_f32 v214, v196, v197
  v_cvt_pk_bf16_f32 v215, v198, v199
  buffer_store_dwordx4 v[212:215], v1, s[4:7], s49 offen offset:2048 sc1
  v_mul_f32 v200, v200, v210
  v_mul_f32 v201, v201, v210
  v_mul_f32 v202, v202, v210
  v_mul_f32 v203, v203, v210
  v_mul_f32 v204, v204, v210
  v_mul_f32 v205, v205, v210
  v_mul_f32 v206, v206, v210
  v_mul_f32 v207, v207, v210
  v_cvt_pk_bf16_f32 v220, v200, v201
  v_cvt_pk_bf16_f32 v221, v202, v203
  v_cvt_pk_bf16_f32 v222, v204, v205
  v_cvt_pk_bf16_f32 v223, v206, v207
  buffer_store_dwordx4 v[220:223], v1, s[4:7], s49 offen offset:3072 sc1
  s_add_u32 s49, s49, 131072
  s_nop 1
  v_cndmask_b32 v156, v216, v156, s[54:55]
  v_cndmask_b32 v157, v216, v157, s[56:57]
  v_cndmask_b32 v158, v216, v158, s[58:59]
  v_cndmask_b32 v159, v216, v159, s[60:61]
  v_max3_f32 v208, v148, v149, v152
  v_max3_f32 v208, v208, v153, v154
  v_max3_f32 v208, v208, v155, v156
  v_max3_f32 v208, v208, v157, v158
  v_max_f32 v208, v208, v159
  v_mov_b32 v209, v208
  s_nop 1
  v_permlane32_swap_b32 v208, v209
  v_max_f32 v208, v208, v209
  v_mov_b32 v209, v208
  s_nop 1
  v_permlane16_swap_b32 v208, v209
  v_max_f32 v208, v208, v209
  v_mul_f32 v208, s48, v208
  v_fma_f32 v148, v148, s48, -v208
  v_fma_f32 v149, v149, s48, -v208
  v_fma_f32 v152, v152, s48, -v208
  v_fma_f32 v153, v153, s48, -v208
  v_fma_f32 v154, v154, s48, -v208
  v_fma_f32 v155, v155, s48, -v208
  v_fma_f32 v156, v156, s48, -v208
  v_fma_f32 v157, v157, s48, -v208
  v_fma_f32 v158, v158, s48, -v208
  v_fma_f32 v159, v159, s48, -v208
  v_exp_f32 v148, v148
  v_exp_f32 v149, v149
  v_exp_f32 v152, v152
  v_exp_f32 v153, v153
  v_exp_f32 v154, v154
  v_exp_f32 v155, v155
  v_exp_f32 v156, v156
  v_exp_f32 v157, v157
  v_exp_f32 v158, v158
  v_exp_f32 v159, v159
  s_nop 0
  v_cvt_pk_bf16_f32 v164, v148, v149
  v_cvt_pk_bf16_f32 v167, v148, v149
  v_cvt_pk_bf16_f32 v160, v152, v153
  v_cvt_pk_bf16_f32 v161, v154, v155
  v_cvt_pk_bf16_f32 v162, v156, v157
  v_cvt_pk_bf16_f32 v163, v158, v159
  s_nop 1
  v_mfma_f32_16x16x16_bf16 v[172:175], v[168:169], v[164:165], 0
  v_mfma_f32_16x16x16_bf16 v[176:179], v[128:129], v[164:165], 0
  v_mfma_f32_16x16x16_bf16 v[180:183], v[128:129], v[166:167], 0
  v_mfma_f32_16x16x16_bf16 v[184:187], v[130:131], v[164:165], 0
  v_mfma_f32_16x16x16_bf16 v[188:191], v[130:131], v[166:167], 0
  v_mfma_f32_16x16x16_bf16 v[192:195], v[132:133], v[164:165], 0
  v_mfma_f32_16x16x16_bf16 v[196:199], v[132:133], v[166:167], 0
  v_mfma_f32_16x16x16_bf16 v[200:203], v[134:135], v[164:165], 0
  v_mfma_f32_16x16x16_bf16 v[204:207], v[134:135], v[166:167], 0
  v_mfma_f32_16x16x32_bf16 v[172:175], v[168:171], v[160:163], v[172:175]
  v_mfma_f32_16x16x32_bf16 v[176:179], v[80:83], v[160:163], v[176:179]
  v_mfma_f32_16x16x32_bf16 v[180:183], v[84:87], v[160:163], v[180:183]
  v_mfma_f32_16x16x32_bf16 v[184:187], v[88:91], v[160:163], v[184:187]
  v_mfma_f32_16x16x32_bf16 v[188:191], v[92:95], v[160:163], v[188:191]
  v_mfma_f32_16x16x32_bf16 v[192:195], v[96:99], v[160:163], v[192:195]
  v_mfma_f32_16x16x32_bf16 v[196:199], v[100:103], v[160:163], v[196:199]
  v_mfma_f32_16x16x32_bf16 v[200:203], v[104:107], v[160:163], v[200:203]
  v_mfma_f32_16x16x32_bf16 v[204:207], v[108:111], v[160:163], v[204:207]
  s_nop 7
  v_rcp_f32 v210, v172
  s_nop 0
  v_mul_f32 v176, v176, v210
  v_mul_f32 v177, v177, v210
  v_mul_f32 v178, v178, v210
  v_mul_f32 v179, v179, v210
  v_mul_f32 v180, v180, v210
  v_mul_f32 v181, v181, v210
  v_mul_f32 v182, v182, v210
  v_mul_f32 v183, v183, v210
  v_cvt_pk_bf16_f32 v212, v176, v177
  v_cvt_pk_bf16_f32 v213, v178, v179
  v_cvt_pk_bf16_f32 v214, v180, v181
  v_cvt_pk_bf16_f32 v215, v182, v183
  buffer_store_dwordx4 v[212:215], v1, s[4:7], s49 offen offset:0 sc1
  v_mul_f32 v184, v184, v210
  v_mul_f32 v185, v185, v210
  v_mul_f32 v186, v186, v210
  v_mul_f32 v187, v187, v210
  v_mul_f32 v188, v188, v210
  v_mul_f32 v189, v189, v210
  v_mul_f32 v190, v190, v210
  v_mul_f32 v191, v191, v210
  v_cvt_pk_bf16_f32 v220, v184, v185
  v_cvt_pk_bf16_f32 v221, v186, v187
  v_cvt_pk_bf16_f32 v222, v188, v189
  v_cvt_pk_bf16_f32 v223, v190, v191
  buffer_store_dwordx4 v[220:223], v1, s[4:7], s49 offen offset:1024 sc1
  v_mul_f32 v192, v192, v210
  v_mul_f32 v193, v193, v210
  v_mul_f32 v194, v194, v210
  v_mul_f32 v195, v195, v210
  v_mul_f32 v196, v196, v210
  v_mul_f32 v197, v197, v210
  v_mul_f32 v198, v198, v210
  v_mul_f32 v199, v199, v210
  v_cvt_pk_bf16_f32 v212, v192, v193
  v_cvt_pk_bf16_f32 v213, v194, v195
  v_cvt_pk_bf16_f32 v214, v196, v197
  v_cvt_pk_bf16_f32 v215, v198, v199
  buffer_store_dwordx4 v[212:215], v1, s[4:7], s49 offen offset:2048 sc1
  v_mul_f32 v200, v200, v210
  v_mul_f32 v201, v201, v210
  v_mul_f32 v202, v202, v210
  v_mul_f32 v203, v203, v210
  v_mul_f32 v204, v204, v210
  v_mul_f32 v205, v205, v210
  v_mul_f32 v206, v206, v210
  v_mul_f32 v207, v207, v210
  v_cvt_pk_bf16_f32 v220, v200, v201
  v_cvt_pk_bf16_f32 v221, v202, v203
  v_cvt_pk_bf16_f32 v222, v204, v205
  v_cvt_pk_bf16_f32 v223, v206, v207
  buffer_store_dwordx4 v[220:223], v1, s[4:7], s49 offen offset:3072 sc1
  s_branch L_next
T_W:
  s_cmp_eq_u32 s76, -1
  s_cbranch_scc1 L_fp_107
  s_waitcnt vmcnt(0)
  s_barrier
  s_cmp_eq_u32 s76, -1
  s_cbranch_scc1 L_pe_108
  s_cmp_lg_u32 s27, 0
  s_cbranch_scc1 L_pe_108_c
  s_and_b32 s47, s76, 0xffff
  s_add_u32 s47, s47, 117440512
  s_lshr_b32 s48, s76, 16
  s_add_u32 s48, s48, 1
  v_mov_b32 v18, s47
  v_mov_b32 v19, s48
  s_mov_b64 exec, 1
  buffer_atomic_add v19, v18, s[4:7], 0 offen sc1
  s_mov_b64 exec, -1
L_pe_108_c:
  s_mov_b32 s76, -1
L_pe_108:
L_fp_107:
  s_mov_b32 s35, 4480
  s_cmp_ge_u32 s98, 56
  s_cbranch_scc1 T_W31
  s_cmp_ge_u32 s98, 8
  s_cbranch_scc1 T_W30

  s_lshl_b32 s28, s98, 1
  s_lshl_b32 s29, s96, 4
  s_add_u32 s28, s28, 1
  s_lshr_b32 s30, s28, 2
  s_cmp_lg_u32 s27, 0
  s_cbranch_scc1 L_wm_109_w
  s_mov_b32 s41, 117444608
  v_writelane_b32 v1, s41, 0
  v_writelane_b32 v2, 16, 0
  s_lshl_b32 s41, s30, 7
  s_add_u32 s41, s41, 117443584
  v_writelane_b32 v1, s41, 1
  v_writelane_b32 v2, 4, 1
  s_lshl_b32 s41, s28, 7
  s_add_u32 s41, s41, 117445632
  v_writelane_b32 v1, s41, 2
  v_writelane_b32 v2, 16, 2
  s_lshl_b32 s41, s28, 7
  s_add_u32 s41, s41, 117445504
  v_writelane_b32 v1, s41, 3
  v_writelane_b32 v2, 16, 3
  s_mov_b32 s99, 100000
  s_mov_b64 exec, 15
L_wm_109_p:
  buffer_load_dword v3, v1, s[4:7], 0 offen sc1
  s_waitcnt vmcnt(0)
  v_cmp_gt_u32 vcc, v2, v3
  s_cbranch_vccz L_wm_109_x
  s_sub_u32 s99, s99, 1
  s_cbranch_scc0 L_wm_109_p
  v_mov_b32 v1, 236
  v_mov_b32 v2, 1
  s_mov_b64 exec, 1
  global_atomic_add v1, v2, s[90:91] sc1
L_wm_109_x:
  s_mov_b64 exec, -1
L_wm_109_w:
  s_barrier
  s_lshl_b32 s28, s98, 3
  s_lshl_b32 s40, s28, 17
  s_add_u32 s40, s40, 58720256
  s_lshl_b32 s41, s29, 17
  s_add_u32 s41, s41, 109051904
  s_sub_u32 s41, s41, 1048576
  s_mul_i32 s42, s27, 6
  s_add_u32 s43, s42, 0
  s_cmp_lt_u32 s43, 8
  s_cselect_b32 s44, s40, s41
  s_lshl_b32 s43, s43, 17
  s_add_u32 s60, s44, s43
  s_add_u32 s43, s42, 1
  s_cmp_lt_u32 s43, 8
  s_cselect_b32 s44, s40, s41
  s_lshl_b32 s43, s43, 17
  s_add_u32 s61, s44, s43
  s_add_u32 s43, s42, 2
  s_cmp_lt_u32 s43, 8
  s_cselect_b32 s44, s40, s41
  s_lshl_b32 s43, s43, 17
  s_add_u32 s62, s44, s43
  s_add_u32 s43, s42, 3
  s_cmp_lt_u32 s43, 8
  s_cselect_b32 s44, s40, s41
  s_lshl_b32 s43, s43, 17
  s_add_u32 s63, s44, s43
  s_add_u32 s43, s42, 4
  s_cmp_lt_u32 s43, 8
  s_cselect_b32 s44, s40, s41
  s_lshl_b32 s43, s43, 17
  s_add_u32 s64, s44, s43
  s_add_u32 s43, s42, 5
  s_cmp_lt_u32 s43, 8
  s_cselect_b32 s44, s40, s41
  s_lshl_b32 s43, s43, 17
  s_add_u32 s65, s44, s43
  v_lshlrev_b32 v1, 4, v0
  s_mul_i32 s68, s27, 6144
  s_lshr_b32 s43, s27, 1
  s_lshl_b32 s43, s43, 12
  v_add_u32 v4, s43, v1
  s_and_b32 s43, s27, 1
  s_lshl_b32 s43, s43, 13
  s_add_u32 s43, s43, 8192
  v_add_u32 v5, s43, v1
  s_add_u32 m0, s68, 0
  s_nop 0
  buffer_load_dwordx4 v1, s[4:7], s60 offen lds
  s_add_u32 m0, s68, 1024
  s_nop 0
  buffer_load_dwordx4 v1, s[4:7], s61 offen lds
  s_add_u32 m0, s68, 2048
  s_nop 0
  buffer_load_dwordx4 v1, s[4:7], s62 offen lds
  s_add_u32 m0, s68, 3072
  s_nop 0
  buffer_load_dwordx4 v1, s[4:7], s63 offen lds
  s_add_u32 m0, s68, 4096
  s_nop 0
  buffer_load_dwordx4 v1, s[4:7], s64 offen lds
  s_add_u32 m0, s68, 5120
  s_nop 0
  buffer_load_dwordx4 v1, s[4:7], s65 offen lds
  v_add_u32 v1, 1024, v1
  s_add_u32 m0, s68, 24576
  s_nop 0
  buffer_load_dwordx4 v1, s[4:7], s60 offen lds
  s_add_u32 m0, s68, 25600
  s_nop 0
  buffer_load_dwordx4 v1, s[4:7], s61 offen lds
  s_add_u32 m0, s68, 26624
  s_nop 0
  buffer_load_dwordx4 v1, s[4:7], s62 offen lds
  s_add_u32 m0, s68, 27648
  s_nop 0
  buffer_load_dwordx4 v1, s[4:7], s63 offen lds
  s_add_u32 m0, s68, 28672
  s_nop 0
  buffer_load_dwordx4 v1, s[4:7], s64 offen lds
  s_add_u32 m0, s68, 29696
  s_nop 0
  buffer_load_dwordx4 v1, s[4:7], s65 offen lds
  v_add_u32 v1, 1024, v1
  s_add_u32 m0, s68, 49152
  s_nop 0
  buffer_load_dwordx4 v1, s[4:7], s60 offen lds
  s_add_u32 m0, s68, 50176
  s_nop 0
  buffer_load_dwordx4 v1, s[4:7], s61 offen lds
  s_add_u32 m0, s68, 51200
  s_nop 0
  buffer_load_dwordx4 v1, s[4:7], s62 offen lds
  s_add_u32 m0, s68, 52224
  s_nop 0
  buffer_load_dwordx4 v1, s[4:7], s63 offen lds
  s_add_u32 m0, s68, 53248
  s_nop 0
  buffer_load_dwordx4 v1, s[4:7], s64 offen lds
  s_add_u32 m0, s68, 54272
  s_nop 0
  buffer_load_dwordx4 v1, s[4:7], s65 offen lds
  v_add_u32 v1, 1024, v1
  s_add_u32 m0, s68, 73728
  s_nop 0
  buffer_load_dwordx4 v1, s[4:7], s60 offen lds
  s_add_u32 m0, s68, 74752
  s_nop 0
  buffer_load_dwordx4 v1, s[4:7], s61 offen lds
  s_add_u32 m0, s68, 75776
  s_nop 0
  buffer_load_dwordx4 v1, s[4:7], s62 offen lds
  s_add_u32 m0, s68, 76800
  s_nop 0
  buffer_load_dwordx4 v1, s[4:7], s63 offen lds
  s_add_u32 m0, s68, 77824
  s_nop 0
  buffer_load_dwordx4 v1, s[4:7], s64 offen lds
  s_add_u32 m0, s68, 78848
  s_nop 0
  buffer_load_dwordx4 v1, s[4:7], s65 offen lds
  v_add_u32 v1, 1024, v1
  s_add_u32 m0, s68, 98304
  s_nop 0
  buffer_load_dwordx4 v1, s[4:7], s60 offen lds
  s_add_u32 m0, s68, 99328
  s_nop 0
  buffer_load_dwordx4 v1, s[4:7], s61 offen lds
  s_add_u32 m0, s68, 100352
  s_nop 0
  buffer_load_dwordx4 v1, s[4:7], s62 offen lds
  s_add_u32 m0, s68, 101376
  s_nop 0
  buffer_load_dwordx4 v1, s[4:7], s63 offen lds
  s_add_u32 m0, s68, 102400
  s_nop 0
  buffer_load_dwordx4 v1, s[4:7], s64 offen lds
  s_add_u32 m0, s68, 103424
  s_nop 0
  buffer_load_dwordx4 v1, s[4:7], s65 offen lds
  v_add_u32 v1, 1024, v1
  s_mov_b32 s67, s68
  s_mov_b32 s66, 24576
  v_mov_b32 v2, v4
  v_mov_b32 v3, v5
  s_waitcnt vmcnt(24)
  s_barrier
  ds_read_b128 v[16:19], v2 offset:0
  ds_read_b128 v[32:35], v3 offset:0
  ds_read_b128 v[36:39], v3 offset:1024
  ds_read_b128 v[20:23], v2 offset:1024
  ds_read_b128 v[40:43], v3 offset:2048
  ds_read_b128 v[44:47], v3 offset:3072
  ds_read_b128 v[24:27], v2 offset:2048
  ds_read_b128 v[48:51], v3 offset:4096
  ds_read_b128 v[52:55], v3 offset:5120
  ds_read_b128 v[28:31], v2 offset:3072
  ds_read_b128 v[56:59], v3 offset:6144
  ds_read_b128 v[60:63], v3 offset:7168
  s_waitcnt vmcnt(18) lgkmcnt(0)
  s_barrier
  v_mfma_f32_16x16x32_bf16 a[0:3], v[32:35], v[16:19], 0
  v_add_u32 v2, s66, v4
  v_add_u32 v3, s66, v5
  v_mfma_f32_16x16x32_bf16 a[4:7], v[32:35], v[20:23], 0
  ds_read_b128 v[64:67], v2 offset:0
  v_mfma_f32_16x16x32_bf16 a[8:11], v[32:35], v[24:27], 0
  s_add_u32 m0, s67, 0
  v_mfma_f32_16x16x32_bf16 a[12:15], v[32:35], v[28:31], 0
  ds_read_b128 v[80:83], v3 offset:0
  v_mfma_f32_16x16x32_bf16 a[16:19], v[36:39], v[16:19], 0
  buffer_load_dwordx4 v1, s[4:7], s60 offen lds
  v_mfma_f32_16x16x32_bf16 a[20:23], v[36:39], v[20:23], 0
  ds_read_b128 v[84:87], v3 offset:1024
  v_mfma_f32_16x16x32_bf16 a[24:27], v[36:39], v[24:27], 0
  s_add_u32 m0, s67, 1024
  v_mfma_f32_16x16x32_bf16 a[28:31], v[36:39], v[28:31], 0
  ds_read_b128 v[68:71], v2 offset:1024
  v_mfma_f32_16x16x32_bf16 a[32:35], v[40:43], v[16:19], 0
  buffer_load_dwordx4 v1, s[4:7], s61 offen lds
  v_mfma_f32_16x16x32_bf16 a[36:39], v[40:43], v[20:23], 0
  ds_read_b128 v[88:91], v3 offset:2048
  v_mfma_f32_16x16x32_bf16 a[40:43], v[40:43], v[24:27], 0
  s_add_u32 m0, s67, 2048
  v_mfma_f32_16x16x32_bf16 a[44:47], v[40:43], v[28:31], 0
  ds_read_b128 v[92:95], v3 offset:3072
  v_mfma_f32_16x16x32_bf16 a[48:51], v[44:47], v[16:19], 0
  buffer_load_dwordx4 v1, s[4:7], s62 offen lds
  v_mfma_f32_16x16x32_bf16 a[52:55], v[44:47], v[20:23], 0
  ds_read_b128 v[72:75], v2 offset:2048
  v_mfma_f32_16x16x32_bf16 a[56:59], v[44:47], v[24:27], 0
  s_add_u32 m0, s67, 3072
  v_mfma_f32_16x16x32_bf16 a[60:63], v[44:47], v[28:31], 0
  ds_read_b128 v[96:99], v3 offset:4096
  v_mfma_f32_16x16x32_bf16 a[64:67], v[48:51], v[16:19], 0
  buffer_load_dwordx4 v1, s[4:7], s63 offen lds
  v_mfma_f32_16x16x32_bf16 a[68:71], v[48:51], v[20:23], 0
  ds_read_b128 v[100:103], v3 offset:5120
  v_mfma_f32_16x16x32_bf16 a[72:75], v[48:51], v[24:27], 0
  s_add_u32 m0, s67, 4096
  v_mfma_f32_16x16x32_bf16 a[76:79], v[48:51], v[28:31], 0
  ds_read_b128 v[76:79], v2 offset:3072
  v_mfma_f32_16x16x32_bf16 a[80:83], v[52:55], v[16:19], 0
  buffer_load_dwordx4 v1, s[4:7], s64 offen lds
  v_mfma_f32_16x16x32_bf16 a[84:87], v[52:55], v[20:23], 0
  ds_read_b128 v[104:107], v3 offset:6144
  v_mfma_f32_16x16x32_bf16 a[88:91], v[52:55], v[24:27], 0
  s_add_u32 m0, s67, 5120
  v_mfma_f32_16x16x32_bf16 a[92:95], v[52:55], v[28:31], 0
  ds_read_b128 v[108:111], v3 offset:7168
  v_mfma_f32_16x16x32_bf16 a[96:99], v[56:59], v[16:19], 0
  buffer_load_dwordx4 v1, s[4:7], s65 offen lds
  v_mfma_f32_16x16x32_bf16 a[100:103], v[56:59], v[20:23], 0
  v_mfma_f32_16x16x32_bf16 a[104:107], v[56:59], v[24:27], 0
  s_add_u32 s66, s66, 24576
  v_mfma_f32_16x16x32_bf16 a[108:111], v[56:59], v[28:31], 0
  s_cmp_eq_u32 s66, 122880
  s_cselect_b32 s66, 0, s66
  v_mfma_f32_16x16x32_bf16 a[112:115], v[60:63], v[16:19], 0
  v_add_u32 v1, 1024, v1
  s_add_u32 s67, s67, 24576
  v_mfma_f32_16x16x32_bf16 a[116:119], v[60:63], v[20:23], 0
  s_sub_u32 s43, s67, s68
  s_cmp_eq_u32 s43, 122880
  v_mfma_f32_16x16x32_bf16 a[120:123], v[60:63], v[24:27], 0
  s_cselect_b32 s67, s68, s67
  v_mfma_f32_16x16x32_bf16 a[124:127], v[60:63], v[28:31], 0
  s_waitcnt vmcnt(18) lgkmcnt(0)
  s_barrier
  v_mfma_f32_16x16x32_bf16 a[0:3], v[80:83], v[64:67], a[0:3]
  v_add_u32 v2, s66, v4
  v_add_u32 v3, s66, v5
  v_mfma_f32_16x16x32_bf16 a[4:7], v[80:83], v[68:71], a[4:7]
  ds_read_b128 v[16:19], v2 offset:0
  v_mfma_f32_16x16x32_bf16 a[8:11], v[80:83], v[72:75], a[8:11]
  s_add_u32 m0, s67, 0
  v_mfma_f32_16x16x32_bf16 a[12:15], v[80:83], v[76:79], a[12:15]
  ds_read_b128 v[32:35], v3 offset:0
  v_mfma_f32_16x16x32_bf16 a[16:19], v[84:87], v[64:67], a[16:19]
  buffer_load_dwordx4 v1, s[4:7], s60 offen lds
  v_mfma_f32_16x16x32_bf16 a[20:23], v[84:87], v[68:71], a[20:23]
  ds_read_b128 v[36:39], v3 offset:1024
  v_mfma_f32_16x16x32_bf16 a[24:27], v[84:87], v[72:75], a[24:27]
  s_add_u32 m0, s67, 1024
  v_mfma_f32_16x16x32_bf16 a[28:31], v[84:87], v[76:79], a[28:31]
  ds_read_b128 v[20:23], v2 offset:1024
  v_mfma_f32_16x16x32_bf16 a[32:35], v[88:91], v[64:67], a[32:35]
  buffer_load_dwordx4 v1, s[4:7], s61 offen lds
  v_mfma_f32_16x16x32_bf16 a[36:39], v[88:91], v[68:71], a[36:39]
  ds_read_b128 v[40:43], v3 offset:2048
  v_mfma_f32_16x16x32_bf16 a[40:43], v[88:91], v[72:75], a[40:43]
  s_add_u32 m0, s67, 2048
  v_mfma_f32_16x16x32_bf16 a[44:47], v[88:91], v[76:79], a[44:47]
  ds_read_b128 v[44:47], v3 offset:3072
  v_mfma_f32_16x16x32_bf16 a[48:51], v[92:95], v[64:67], a[48:51]
  buffer_load_dwordx4 v1, s[4:7], s62 offen lds
  v_mfma_f32_16x16x32_bf16 a[52:55], v[92:95], v[68:71], a[52:55]
  ds_read_b128 v[24:27], v2 offset:2048
  v_mfma_f32_16x16x32_bf16 a[56:59], v[92:95], v[72:75], a[56:59]
  s_add_u32 m0, s67, 3072
  v_mfma_f32_16x16x32_bf16 a[60:63], v[92:95], v[76:79], a[60:63]
  ds_read_b128 v[48:51], v3 offset:4096
  v_mfma_f32_16x16x32_bf16 a[64:67], v[96:99], v[64:67], a[64:67]
  buffer_load_dwordx4 v1, s[4:7], s63 offen lds
  v_mfma_f32_16x16x32_bf16 a[68:71], v[96:99], v[68:71], a[68:71]
  ds_read_b128 v[52:55], v3 offset:5120
  v_mfma_f32_16x16x32_bf16 a[72:75], v[96:99], v[72:75], a[72:75]
  s_add_u32 m0, s67, 4096
  v_mfma_f32_16x16x32_bf16 a[76:79], v[96:99], v[76:79], a[76:79]
  ds_read_b128 v[28:31], v2 offset:3072
  v_mfma_f32_16x16x32_bf16 a[80:83], v[100:103], v[64:67], a[80:83]
  buffer_load_dwordx4 v1, s[4:7], s64 offen lds
  v_mfma_f32_16x16x32_bf16 a[84:87], v[100:103], v[68:71], a[84:87]
  ds_read_b128 v[56:59], v3 offset:6144
  v_mfma_f32_16x16x32_bf16 a[88:91], v[100:103], v[72:75], a[88:91]
  s_add_u32 m0, s67, 5120
  v_mfma_f32_16x16x32_bf16 a[92:95], v[100:103], v[76:79], a[92:95]
  ds_read_b128 v[60:63], v3 offset:7168
  v_mfma_f32_16x16x32_bf16 a[96:99], v[104:107], v[64:67], a[96:99]
  buffer_load_dwordx4 v1, s[4:7], s65 offen lds
  v_mfma_f32_16x16x32_bf16 a[100:103], v[104:107], v[68:71], a[100:103]
  v_mfma_f32_16x16x32_bf16 a[104:107], v[104:107], v[72:75], a[104:107]
  s_add_u32 s66, s66, 24576
  v_mfma_f32_16x16x32_bf16 a[108:111], v[104:107], v[76:79], a[108:111]
  s_cmp_eq_u32 s66, 122880
  s_cselect_b32 s66, 0, s66
  v_mfma_f32_16x16x32_bf16 a[112:115], v[108:111], v[64:67], a[112:115]
  v_add_u32 v1, 1024, v1
  s_add_u32 s67, s67, 24576
  v_mfma_f32_16x16x32_bf16 a[116:119], v[108:111], v[68:71], a[116:119]
  s_sub_u32 s43, s67, s68
  s_cmp_eq_u32 s43, 122880
  v_mfma_f32_16x16x32_bf16 a[120:123], v[108:111], v[72:75], a[120:123]
  s_cselect_b32 s67, s68, s67
  v_mfma_f32_16x16x32_bf16 a[124:127], v[108:111], v[76:79], a[124:127]
  s_mov_b32 s69, 60
W_big_loop:
  s_waitcnt vmcnt(18) lgkmcnt(0)
  s_barrier
  v_mfma_f32_16x16x32_bf16 a[0:3], v[32:35], v[16:19], a[0:3]
  v_add_u32 v2, s66, v4
  v_add_u32 v3, s66, v5
  v_mfma_f32_16x16x32_bf16 a[4:7], v[32:35], v[20:23], a[4:7]
  ds_read_b128 v[64:67], v2 offset:0
  v_mfma_f32_16x16x32_bf16 a[8:11], v[32:35], v[24:27], a[8:11]
  s_add_u32 m0, s67, 0
  v_mfma_f32_16x16x32_bf16 a[12:15], v[32:35], v[28:31], a[12:15]
  ds_read_b128 v[80:83], v3 offset:0
  v_mfma_f32_16x16x32_bf16 a[16:19], v[36:39], v[16:19], a[16:19]
  buffer_load_dwordx4 v1, s[4:7], s60 offen lds
  v_mfma_f32_16x16x32_bf16 a[20:23], v[36:39], v[20:23], a[20:23]
  ds_read_b128 v[84:87], v3 offset:1024
  v_mfma_f32_16x16x32_bf16 a[24:27], v[36:39], v[24:27], a[24:27]
  s_add_u32 m0, s67, 1024
  v_mfma_f32_16x16x32_bf16 a[28:31], v[36:39], v[28:31], a[28:31]
  ds_read_b128 v[68:71], v2 offset:1024
  v_mfma_f32_16x16x32_bf16 a[32:35], v[40:43], v[16:19], a[32:35]
  buffer_load_dwordx4 v1, s[4:7], s61 offen lds
  v_mfma_f32_16x16x32_bf16 a[36:39], v[40:43], v[20:23], a[36:39]
  ds_read_b128 v[88:91], v3 offset:2048
  v_mfma_f32_16x16x32_bf16 a[40:43], v[40:43], v[24:27], a[40:43]
  s_add_u32 m0, s67, 2048
  v_mfma_f32_16x16x32_bf16 a[44:47], v[40:43], v[28:31], a[44:47]
  ds_read_b128 v[92:95], v3 offset:3072
  v_mfma_f32_16x16x32_bf16 a[48:51], v[44:47], v[16:19], a[48:51]
  buffer_load_dwordx4 v1, s[4:7], s62 offen lds
  v_mfma_f32_16x16x32_bf16 a[52:55], v[44:47], v[20:23], a[52:55]
  ds_read_b128 v[72:75], v2 offset:2048
  v_mfma_f32_16x16x32_bf16 a[56:59], v[44:47], v[24:27], a[56:59]
  s_add_u32 m0, s67, 3072
  v_mfma_f32_16x16x32_bf16 a[60:63], v[44:47], v[28:31], a[60:63]
  ds_read_b128 v[96:99], v3 offset:4096
  v_mfma_f32_16x16x32_bf16 a[64:67], v[48:51], v[16:19], a[64:67]
  buffer_load_dwordx4 v1, s[4:7], s63 offen lds
  v_mfma_f32_16x16x32_bf16 a[68:71], v[48:51], v[20:23], a[68:71]
  ds_read_b128 v[100:103], v3 offset:5120
  v_mfma_f32_16x16x32_bf16 a[72:75], v[48:51], v[24:27], a[72:75]
  s_add_u32 m0, s67, 4096
  v_mfma_f32_16x16x32_bf16 a[76:79], v[48:51], v[28:31], a[76:79]
  ds_read_b128 v[76:79], v2 offset:3072
  v_mfma_f32_16x16x32_bf16 a[80:83], v[52:55], v[16:19], a[80:83]
  buffer_load_dwordx4 v1, s[4:7], s64 offen lds
  v_mfma_f32_16x16x32_bf16 a[84:87], v[52:55], v[20:23], a[84:87]
  ds_read_b128 v[104:107], v3 offset:6144
  v_mfma_f32_16x16x32_bf16 a[88:91], v[52:55], v[24:27], a[88:91]
  s_add_u32 m0, s67, 5120
  v_mfma_f32_16x16x32_bf16 a[92:95], v[52:55], v[28:31], a[92:95]
  ds_read_b128 v[108:111], v3 offset:7168
  v_mfma_f32_16x16x32_bf16 a[96:99], v[56:59], v[16:19], a[96:99]
  buffer_load_dwordx4 v1, s[4:7], s65 offen lds
  v_mfma_f32_16x16x32_bf16 a[100:103], v[56:59], v[20:23], a[100:103]
  v_mfma_f32_16x16x32_bf16 a[104:107], v[56:59], v[24:27], a[104:107]
  s_add_u32 s66, s66, 24576
  v_mfma_f32_16x16x32_bf16 a[108:111], v[56:59], v[28:31], a[108:111]
  s_cmp_eq_u32 s66, 122880
  s_cselect_b32 s66, 0, s66
  v_mfma_f32_16x16x32_bf16 a[112:115], v[60:63], v[16:19], a[112:115]
  v_add_u32 v1, 1024, v1
  s_add_u32 s67, s67, 24576
  v_mfma_f32_16x16x32_bf16 a[116:119], v[60:63], v[20:23], a[116:119]
  s_sub_u32 s43, s67, s68
  s_cmp_eq_u32 s43, 122880
  v_mfma_f32_16x16x32_bf16 a[120:123], v[60:63], v[24:27], a[120:123]
  s_cselect_b32 s67, s68, s67
  v_mfma_f32_16x16x32_bf16 a[124:127], v[60:63], v[28:31], a[124:127]
  s_waitcnt vmcnt(18) lgkmcnt(0)
  s_barrier
  v_mfma_f32_16x16x32_bf16 a[0:3], v[80:83], v[64:67], a[0:3]
  v_add_u32 v2, s66, v4
  v_add_u32 v3, s66, v5
  v_mfma_f32_16x16x32_bf16 a[4:7], v[80:83], v[68:71], a[4:7]
  ds_read_b128 v[16:19], v2 offset:0
  v_mfma_f32_16x16x32_bf16 a[8:11], v[80:83], v[72:75], a[8:11]
  s_add_u32 m0, s67, 0
  v_mfma_f32_16x16x32_bf16 a[12:15], v[80:83], v[76:79], a[12:15]
  ds_read_b128 v[32:35], v3 offset:0
  v_mfma_f32_16x16x32_bf16 a[16:19], v[84:87], v[64:67], a[16:19]
  buffer_load_dwordx4 v1, s[4:7], s60 offen lds
  v_mfma_f32_16x16x32_bf16 a[20:23], v[84:87], v[68:71], a[20:23]
  ds_read_b128 v[36:39], v3 offset:1024
  v_mfma_f32_16x16x32_bf16 a[24:27], v[84:87], v[72:75], a[24:27]
  s_add_u32 m0, s67, 1024
  v_mfma_f32_16x16x32_bf16 a[28:31], v[84:87], v[76:79], a[28:31]
  ds_read_b128 v[20:23], v2 offset:1024
  v_mfma_f32_16x16x32_bf16 a[32:35], v[88:91], v[64:67], a[32:35]
  buffer_load_dwordx4 v1, s[4:7], s61 offen lds
  v_mfma_f32_16x16x32_bf16 a[36:39], v[88:91], v[68:71], a[36:39]
  ds_read_b128 v[40:43], v3 offset:2048
  v_mfma_f32_16x16x32_bf16 a[40:43], v[88:91], v[72:75], a[40:43]
  s_add_u32 m0, s67, 2048
  v_mfma_f32_16x16x32_bf16 a[44:47], v[88:91], v[76:79], a[44:47]
  ds_read_b128 v[44:47], v3 offset:3072
  v_mfma_f32_16x16x32_bf16 a[48:51], v[92:95], v[64:67], a[48:51]
  buffer_load_dwordx4 v1, s[4:7], s62 offen lds
  v_mfma_f32_16x16x32_bf16 a[52:55], v[92:95], v[68:71], a[52:55]
  ds_read_b128 v[24:27], v2 offset:2048
  v_mfma_f32_16x16x32_bf16 a[56:59], v[92:95], v[72:75], a[56:59]
  s_add_u32 m0, s67, 3072
  v_mfma_f32_16x16x32_bf16 a[60:63], v[92:95], v[76:79], a[60:63]
  ds_read_b128 v[48:51], v3 offset:4096
  v_mfma_f32_16x16x32_bf16 a[64:67], v[96:99], v[64:67], a[64:67]
  buffer_load_dwordx4 v1, s[4:7], s63 offen lds
  v_mfma_f32_16x16x32_bf16 a[68:71], v[96:99], v[68:71], a[68:71]
  ds_read_b128 v[52:55], v3 offset:5120
  v_mfma_f32_16x16x32_bf16 a[72:75], v[96:99], v[72:75], a[72:75]
  s_add_u32 m0, s67, 4096
  v_mfma_f32_16x16x32_bf16 a[76:79], v[96:99], v[76:79], a[76:79]
  ds_read_b128 v[28:31], v2 offset:3072
  v_mfma_f32_16x16x32_bf16 a[80:83], v[100:103], v[64:67], a[80:83]
  buffer_load_dwordx4 v1, s[4:7], s64 offen lds
  v_mfma_f32_16x16x32_bf16 a[84:87], v[100:103], v[68:71], a[84:87]
  ds_read_b128 v[56:59], v3 offset:6144
  v_mfma_f32_16x16x32_bf16 a[88:91], v[100:103], v[72:75], a[88:91]
  s_add_u32 m0, s67, 5120
  v_mfma_f32_16x16x32_bf16 a[92:95], v[100:103], v[76:79], a[92:95]
  ds_read_b128 v[60:63], v3 offset:7168
  v_mfma_f32_16x16x32_bf16 a[96:99], v[104:107], v[64:67], a[96:99]
  buffer_load_dwordx4 v1, s[4:7], s65 offen lds
  v_mfma_f32_16x16x32_bf16 a[100:103], v[104:107], v[68:71], a[100:103]
  v_mfma_f32_16x16x32_bf16 a[104:107], v[104:107], v[72:75], a[104:107]
  s_add_u32 s66, s66, 24576
  v_mfma_f32_16x16x32_bf16 a[108:111], v[104:107], v[76:79], a[108:111]
  s_cmp_eq_u32 s66, 122880
  s_cselect_b32 s66, 0, s66
  v_mfma_f32_16x16x32_bf16 a[112:115], v[108:111], v[64:67], a[112:115]
  v_add_u32 v1, 1024, v1
  s_add_u32 s67, s67, 24576
  v_mfma_f32_16x16x32_bf16 a[116:119], v[108:111], v[68:71], a[116:119]
  s_sub_u32 s43, s67, s68
  s_cmp_eq_u32 s43, 122880
  v_mfma_f32_16x16x32_bf16 a[120:123], v[108:111], v[72:75], a[120:123]
  s_cselect_b32 s67, s68, s67
  v_mfma_f32_16x16x32_bf16 a[124:127], v[108:111], v[76:79], a[124:127]
  s_sub_u32 s69, s69, 1
  s_cmp_lg_u32 s69, 0
  s_cbranch_scc1 W_big_loop
  s_waitcnt vmcnt(18) lgkmcnt(0)
  s_barrier
  v_mfma_f32_16x16x32_bf16 a[0:3], v[32:35], v[16:19], a[0:3]
  v_add_u32 v2, s66, v4
  v_add_u32 v3, s66, v5
  v_mfma_f32_16x16x32_bf16 a[4:7], v[32:35], v[20:23], a[4:7]
  ds_read_b128 v[64:67], v2 offset:0
  v_mfma_f32_16x16x32_bf16 a[8:11], v[32:35], v[24:27], a[8:11]
  s_add_u32 m0, s67, 0
  v_mfma_f32_16x16x32_bf16 a[12:15], v[32:35], v[28:31], a[12:15]
  ds_read_b128 v[80:83], v3 offset:0
  v_mfma_f32_16x16x32_bf16 a[16:19], v[36:39], v[16:19], a[16:19]
  buffer_load_dwordx4 v1, s[4:7], s60 offen lds
  v_mfma_f32_16x16x32_bf16 a[20:23], v[36:39], v[20:23], a[20:23]
  ds_read_b128 v[84:87], v3 offset:1024
  v_mfma_f32_16x16x32_bf16 a[24:27], v[36:39], v[24:27], a[24:27]
  s_add_u32 m0, s67, 1024
  v_mfma_f32_16x16x32_bf16 a[28:31], v[36:39], v[28:31], a[28:31]
  ds_read_b128 v[68:71], v2 offset:1024
  v_mfma_f32_16x16x32_bf16 a[32:35], v[40:43], v[16:19], a[32:35]
  buffer_load_dwordx4 v1, s[4:7], s61 offen lds
  v_mfma_f32_16x16x32_bf16 a[36:39], v[40:43], v[20:23], a[36:39]
  ds_read_b128 v[88:91], v3 offset:2048
  v_mfma_f32_16x16x32_bf16 a[40:43], v[40:43], v[24:27], a[40:43]
  s_add_u32 m0, s67, 2048
  v_mfma_f32_16x16x32_bf16 a[44:47], v[40:43], v[28:31], a[44:47]
  ds_read_b128 v[92:95], v3 offset:3072
  v_mfma_f32_16x16x32_bf16 a[48:51], v[44:47], v[16:19], a[48:51]
  buffer_load_dwordx4 v1, s[4:7], s62 offen lds
  v_mfma_f32_16x16x32_bf16 a[52:55], v[44:47], v[20:23], a[52:55]
  ds_read_b128 v[72:75], v2 offset:2048
  v_mfma_f32_16x16x32_bf16 a[56:59], v[44:47], v[24:27], a[56:59]
  s_add_u32 m0, s67, 3072
  v_mfma_f32_16x16x32_bf16 a[60:63], v[44:47], v[28:31], a[60:63]
  ds_read_b128 v[96:99], v3 offset:4096
  v_mfma_f32_16x16x32_bf16 a[64:67], v[48:51], v[16:19], a[64:67]
  buffer_load_dwordx4 v1, s[4:7], s63 offen lds
  v_mfma_f32_16x16x32_bf16 a[68:71], v[48:51], v[20:23], a[68:71]
  ds_read_b128 v[100:103], v3 offset:5120
  v_mfma_f32_16x16x32_bf16 a[72:75], v[48:51], v[24:27], a[72:75]
  s_add_u32 m0, s67, 4096
  v_mfma_f32_16x16x32_bf16 a[76:79], v[48:51], v[28:31], a[76:79]
  ds_read_b128 v[76:79], v2 offset:3072
  v_mfma_f32_16x16x32_bf16 a[80:83], v[52:55], v[16:19], a[80:83]
  buffer_load_dwordx4 v1, s[4:7], s64 offen lds
  v_mfma_f32_16x16x32_bf16 a[84:87], v[52:55], v[20:23], a[84:87]
  ds_read_b128 v[104:107], v3 offset:6144
  v_mfma_f32_16x16x32_bf16 a[88:91], v[52:55], v[24:27], a[88:91]
  s_add_u32 m0, s67, 5120
  v_mfma_f32_16x16x32_bf16 a[92:95], v[52:55], v[28:31], a[92:95]
  ds_read_b128 v[108:111], v3 offset:7168
  v_mfma_f32_16x16x32_bf16 a[96:99], v[56:59], v[16:19], a[96:99]
  buffer_load_dwordx4 v1, s[4:7], s65 offen lds
  v_mfma_f32_16x16x32_bf16 a[100:103], v[56:59], v[20:23], a[100:103]
  v_mfma_f32_16x16x32_bf16 a[104:107], v[56:59], v[24:27], a[104:107]
  s_add_u32 s66, s66, 24576
  v_mfma_f32_16x16x32_bf16 a[108:111], v[56:59], v[28:31], a[108:111]
  s_cmp_eq_u32 s66, 122880
  s_cselect_b32 s66, 0, s66
  v_mfma_f32_16x16x32_bf16 a[112:115], v[60:63], v[16:19], a[112:115]
  v_add_u32 v1, 1024, v1
  s_add_u32 s67, s67, 24576
  v_mfma_f32_16x16x32_bf16 a[116:119], v[60:63], v[20:23], a[116:119]
  s_sub_u32 s43, s67, s68
  s_cmp_eq_u32 s43, 122880
  v_mfma_f32_16x16x32_bf16 a[120:123], v[60:63], v[24:27], a[120:123]
  s_cselect_b32 s67, s68, s67
  v_mfma_f32_16x16x32_bf16 a[124:127], v[60:63], v[28:31], a[124:127]
  s_waitcnt vmcnt(18) lgkmcnt(0)
  s_barrier
  v_mfma_f32_16x16x32_bf16 a[0:3], v[80:83], v[64:67], a[0:3]
  v_add_u32 v2, s66, v4
  v_add_u32 v3, s66, v5
  v_mfma_f32_16x16x32_bf16 a[4:7], v[80:83], v[68:71], a[4:7]
  ds_read_b128 v[16:19], v2 offset:0
  v_mfma_f32_16x16x32_bf16 a[8:11], v[80:83], v[72:75], a[8:11]
  v_mfma_f32_16x16x32_bf16 a[12:15], v[80:83], v[76:79], a[12:15]
  ds_read_b128 v[32:35], v3 offset:0
  v_mfma_f32_16x16x32_bf16 a[16:19], v[84:87], v[64:67], a[16:19]
  v_mfma_f32_16x16x32_bf16 a[20:23], v[84:87], v[68:71], a[20:23]
  ds_read_b128 v[36:39], v3 offset:1024
  v_mfma_f32_16x16x32_bf16 a[24:27], v[84:87], v[72:75], a[24:27]
  v_mfma_f32_16x16x32_bf16 a[28:31], v[84:87], v[76:79], a[28:31]
  ds_read_b128 v[20:23], v2 offset:1024
  v_mfma_f32_16x16x32_bf16 a[32:35], v[88:91], v[64:67], a[32:35]
  v_mfma_f32_16x16x32_bf16 a[36:39], v[88:91], v[68:71], a[36:39]
  ds_read_b128 v[40:43], v3 offset:2048
  v_mfma_f32_16x16x32_bf16 a[40:43], v[88:91], v[72:75], a[40:43]
  v_mfma_f32_16x16x32_bf16 a[44:47], v[88:91], v[76:79], a[44:47]
  ds_read_b128 v[44:47], v3 offset:3072
  v_mfma_f32_16x16x32_bf16 a[48:51], v[92:95], v[64:67], a[48:51]
  v_mfma_f32_16x16x32_bf16 a[52:55], v[92:95], v[68:71], a[52:55]
  ds_read_b128 v[24:27], v2 offset:2048
  v_mfma_f32_16x16x32_bf16 a[56:59], v[92:95], v[72:75], a[56:59]
  v_mfma_f32_16x16x32_bf16 a[60:63], v[92:95], v[76:79], a[60:63]
  ds_read_b128 v[48:51], v3 offset:4096
  v_mfma_f32_16x16x32_bf16 a[64:67], v[96:99], v[64:67], a[64:67]
  v_mfma_f32_16x16x32_bf16 a[68:71], v[96:99], v[68:71], a[68:71]
  ds_read_b128 v[52:55], v3 offset:5120
  v_mfma_f32_16x16x32_bf16 a[72:75], v[96:99], v[72:75], a[72:75]
  v_mfma_f32_16x16x32_bf16 a[76:79], v[96:99], v[76:79], a[76:79]
  ds_read_b128 v[28:31], v2 offset:3072
  v_mfma_f32_16x16x32_bf16 a[80:83], v[100:103], v[64:67], a[80:83]
  v_mfma_f32_16x16x32_bf16 a[84:87], v[100:103], v[68:71], a[84:87]
  ds_read_b128 v[56:59], v3 offset:6144
  v_mfma_f32_16x16x32_bf16 a[88:91], v[100:103], v[72:75], a[88:91]
  v_mfma_f32_16x16x32_bf16 a[92:95], v[100:103], v[76:79], a[92:95]
  ds_read_b128 v[60:63], v3 offset:7168
  v_mfma_f32_16x16x32_bf16 a[96:99], v[104:107], v[64:67], a[96:99]
  v_mfma_f32_16x16x32_bf16 a[100:103], v[104:107], v[68:71], a[100:103]
  v_mfma_f32_16x16x32_bf16 a[104:107], v[104:107], v[72:75], a[104:107]
  s_add_u32 s66, s66, 24576
  v_mfma_f32_16x16x32_bf16 a[108:111], v[104:107], v[76:79], a[108:111]
  s_cmp_eq_u32 s66, 122880
  s_cselect_b32 s66, 0, s66
  v_mfma_f32_16x16x32_bf16 a[112:115], v[108:111], v[64:67], a[112:115]
  v_mfma_f32_16x16x32_bf16 a[116:119], v[108:111], v[68:71], a[116:119]
  v_mfma_f32_16x16x32_bf16 a[120:123], v[108:111], v[72:75], a[120:123]
  v_mfma_f32_16x16x32_bf16 a[124:127], v[108:111], v[76:79], a[124:127]
  s_waitcnt vmcnt(12) lgkmcnt(0)
  s_barrier
  v_mfma_f32_16x16x32_bf16 a[0:3], v[32:35], v[16:19], a[0:3]
  v_add_u32 v2, s66, v4
  v_add_u32 v3, s66, v5
  v_mfma_f32_16x16x32_bf16 a[4:7], v[32:35], v[20:23], a[4:7]
  ds_read_b128 v[64:67], v2 offset:0
  v_mfma_f32_16x16x32_bf16 a[8:11], v[32:35], v[24:27], a[8:11]
  v_mfma_f32_16x16x32_bf16 a[12:15], v[32:35], v[28:31], a[12:15]
  ds_read_b128 v[80:83], v3 offset:0
  v_mfma_f32_16x16x32_bf16 a[16:19], v[36:39], v[16:19], a[16:19]
  v_mfma_f32_16x16x32_bf16 a[20:23], v[36:39], v[20:23], a[20:23]
  ds_read_b128 v[84:87], v3 offset:1024
  v_mfma_f32_16x16x32_bf16 a[24:27], v[36:39], v[24:27], a[24:27]
  v_mfma_f32_16x16x32_bf16 a[28:31], v[36:39], v[28:31], a[28:31]
  ds_read_b128 v[68:71], v2 offset:1024
  v_mfma_f32_16x16x32_bf16 a[32:35], v[40:43], v[16:19], a[32:35]
  v_mfma_f32_16x16x32_bf16 a[36:39], v[40:43], v[20:23], a[36:39]
  ds_read_b128 v[88:91], v3 offset:2048
  v_mfma_f32_16x16x32_bf16 a[40:43], v[40:43], v[24:27], a[40:43]
  v_mfma_f32_16x16x32_bf16 a[44:47], v[40:43], v[28:31], a[44:47]
  ds_read_b128 v[92:95], v3 offset:3072
  v_mfma_f32_16x16x32_bf16 a[48:51], v[44:47], v[16:19], a[48:51]
  v_mfma_f32_16x16x32_bf16 a[52:55], v[44:47], v[20:23], a[52:55]
  ds_read_b128 v[72:75], v2 offset:2048
  v_mfma_f32_16x16x32_bf16 a[56:59], v[44:47], v[24:27], a[56:59]
  v_mfma_f32_16x16x32_bf16 a[60:63], v[44:47], v[28:31], a[60:63]
  ds_read_b128 v[96:99], v3 offset:4096
  v_mfma_f32_16x16x32_bf16 a[64:67], v[48:51], v[16:19], a[64:67]
  v_mfma_f32_16x16x32_bf16 a[68:71], v[48:51], v[20:23], a[68:71]
  ds_read_b128 v[100:103], v3 offset:5120
  v_mfma_f32_16x16x32_bf16 a[72:75], v[48:51], v[24:27], a[72:75]
  v_mfma_f32_16x16x32_bf16 a[76:79], v[48:51], v[28:31], a[76:79]
  ds_read_b128 v[76:79], v2 offset:3072
  v_mfma_f32_16x16x32_bf16 a[80:83], v[52:55], v[16:19], a[80:83]
  v_mfma_f32_16x16x32_bf16 a[84:87], v[52:55], v[20:23], a[84:87]
  ds_read_b128 v[104:107], v3 offset:6144
  v_mfma_f32_16x16x32_bf16 a[88:91], v[52:55], v[24:27], a[88:91]
  v_mfma_f32_16x16x32_bf16 a[92:95], v[52:55], v[28:31], a[92:95]
  ds_read_b128 v[108:111], v3 offset:7168
  v_mfma_f32_16x16x32_bf16 a[96:99], v[56:59], v[16:19], a[96:99]
  v_mfma_f32_16x16x32_bf16 a[100:103], v[56:59], v[20:23], a[100:103]
  v_mfma_f32_16x16x32_bf16 a[104:107], v[56:59], v[24:27], a[104:107]
  s_add_u32 s66, s66, 24576
  v_mfma_f32_16x16x32_bf16 a[108:111], v[56:59], v[28:31], a[108:111]
  s_cmp_eq_u32 s66, 122880
  s_cselect_b32 s66, 0, s66
  v_mfma_f32_16x16x32_bf16 a[112:115], v[60:63], v[16:19], a[112:115]
  v_mfma_f32_16x16x32_bf16 a[116:119], v[60:63], v[20:23], a[116:119]
  v_mfma_f32_16x16x32_bf16 a[120:123], v[60:63], v[24:27], a[120:123]
  v_mfma_f32_16x16x32_bf16 a[124:127], v[60:63], v[28:31], a[124:127]
  s_waitcnt vmcnt(6) lgkmcnt(0)
  s_barrier
  v_mfma_f32_16x16x32_bf16 a[0:3], v[80:83], v[64:67], a[0:3]
  v_add_u32 v2, s66, v4
  v_add_u32 v3, s66, v5
  v_mfma_f32_16x16x32_bf16 a[4:7], v[80:83], v[68:71], a[4:7]
  ds_read_b128 v[16:19], v2 offset:0
  v_mfma_f32_16x16x32_bf16 a[8:11], v[80:83], v[72:75], a[8:11]
  v_mfma_f32_16x16x32_bf16 a[12:15], v[80:83], v[76:79], a[12:15]
  ds_read_b128 v[32:35], v3 offset:0
  v_mfma_f32_16x16x32_bf16 a[16:19], v[84:87], v[64:67], a[16:19]
  v_mfma_f32_16x16x32_bf16 a[20:23], v[84:87], v[68:71], a[20:23]
  ds_read_b128 v[36:39], v3 offset:1024
  v_mfma_f32_16x16x32_bf16 a[24:27], v[84:87], v[72:75], a[24:27]
  v_mfma_f32_16x16x32_bf16 a[28:31], v[84:87], v[76:79], a[28:31]
  ds_read_b128 v[20:23], v2 offset:1024
  v_mfma_f32_16x16x32_bf16 a[32:35], v[88:91], v[64:67], a[32:35]
  v_mfma_f32_16x16x32_bf16 a[36:39], v[88:91], v[68:71], a[36:39]
  ds_read_b128 v[40:43], v3 offset:2048
  v_mfma_f32_16x16x32_bf16 a[40:43], v[88:91], v[72:75], a[40:43]
  v_mfma_f32_16x16x32_bf16 a[44:47], v[88:91], v[76:79], a[44:47]
  ds_read_b128 v[44:47], v3 offset:3072
  v_mfma_f32_16x16x32_bf16 a[48:51], v[92:95], v[64:67], a[48:51]
  v_mfma_f32_16x16x32_bf16 a[52:55], v[92:95], v[68:71], a[52:55]
  ds_read_b128 v[24:27], v2 offset:2048
  v_mfma_f32_16x16x32_bf16 a[56:59], v[92:95], v[72:75], a[56:59]
  v_mfma_f32_16x16x32_bf16 a[60:63], v[92:95], v[76:79], a[60:63]
  ds_read_b128 v[48:51], v3 offset:4096
  v_mfma_f32_16x16x32_bf16 a[64:67], v[96:99], v[64:67], a[64:67]
  v_mfma_f32_16x16x32_bf16 a[68:71], v[96:99], v[68:71], a[68:71]
  ds_read_b128 v[52:55], v3 offset:5120
  v_mfma_f32_16x16x32_bf16 a[72:75], v[96:99], v[72:75], a[72:75]
  v_mfma_f32_16x16x32_bf16 a[76:79], v[96:99], v[76:79], a[76:79]
  ds_read_b128 v[28:31], v2 offset:3072
  v_mfma_f32_16x16x32_bf16 a[80:83], v[100:103], v[64:67], a[80:83]
  v_mfma_f32_16x16x32_bf16 a[84:87], v[100:103], v[68:71], a[84:87]
  ds_read_b128 v[56:59], v3 offset:6144
  v_mfma_f32_16x16x32_bf16 a[88:91], v[100:103], v[72:75], a[88:91]
  v_mfma_f32_16x16x32_bf16 a[92:95], v[100:103], v[76:79], a[92:95]
  ds_read_b128 v[60:63], v3 offset:7168
  v_mfma_f32_16x16x32_bf16 a[96:99], v[104:107], v[64:67], a[96:99]
  v_mfma_f32_16x16x32_bf16 a[100:103], v[104:107], v[68:71], a[100:103]
  v_mfma_f32_16x16x32_bf16 a[104:107], v[104:107], v[72:75], a[104:107]
  s_add_u32 s66, s66, 24576
  v_mfma_f32_16x16x32_bf16 a[108:111], v[104:107], v[76:79], a[108:111]
  s_cmp_eq_u32 s66, 122880
  s_cselect_b32 s66, 0, s66
  v_mfma_f32_16x16x32_bf16 a[112:115], v[108:111], v[64:67], a[112:115]
  v_mfma_f32_16x16x32_bf16 a[116:119], v[108:111], v[68:71], a[116:119]
  v_mfma_f32_16x16x32_bf16 a[120:123], v[108:111], v[72:75], a[120:123]
  v_mfma_f32_16x16x32_bf16 a[124:127], v[108:111], v[76:79], a[124:127]
  s_waitcnt vmcnt(0) lgkmcnt(0)
  s_barrier
  v_mfma_f32_16x16x32_bf16 a[0:3], v[32:35], v[16:19], a[0:3]
  v_add_u32 v2, s66, v4
  v_add_u32 v3, s66, v5
  v_mfma_f32_16x16x32_bf16 a[4:7], v[32:35], v[20:23], a[4:7]
  ds_read_b128 v[64:67], v2 offset:0
  v_mfma_f32_16x16x32_bf16 a[8:11], v[32:35], v[24:27], a[8:11]
  v_mfma_f32_16x16x32_bf16 a[12:15], v[32:35], v[28:31], a[12:15]
  ds_read_b128 v[80:83], v3 offset:0
  v_mfma_f32_16x16x32_bf16 a[16:19], v[36:39], v[16:19], a[16:19]
  v_mfma_f32_16x16x32_bf16 a[20:23], v[36:39], v[20:23], a[20:23]
  ds_read_b128 v[84:87], v3 offset:1024
  v_mfma_f32_16x16x32_bf16 a[24:27], v[36:39], v[24:27], a[24:27]
  v_mfma_f32_16x16x32_bf16 a[28:31], v[36:39], v[28:31], a[28:31]
  ds_read_b128 v[68:71], v2 offset:1024
  v_mfma_f32_16x16x32_bf16 a[32:35], v[40:43], v[16:19], a[32:35]
  v_mfma_f32_16x16x32_bf16 a[36:39], v[40:43], v[20:23], a[36:39]
  ds_read_b128 v[88:91], v3 offset:2048
  v_mfma_f32_16x16x32_bf16 a[40:43], v[40:43], v[24:27], a[40:43]
  v_mfma_f32_16x16x32_bf16 a[44:47], v[40:43], v[28:31], a[44:47]
  ds_read_b128 v[92:95], v3 offset:3072
  v_mfma_f32_16x16x32_bf16 a[48:51], v[44:47], v[16:19], a[48:51]
  v_mfma_f32_16x16x32_bf16 a[52:55], v[44:47], v[20:23], a[52:55]
  ds_read_b128 v[72:75], v2 offset:2048
  v_mfma_f32_16x16x32_bf16 a[56:59], v[44:47], v[24:27], a[56:59]
  v_mfma_f32_16x16x32_bf16 a[60:63], v[44:47], v[28:31], a[60:63]
  ds_read_b128 v[96:99], v3 offset:4096
  v_mfma_f32_16x16x32_bf16 a[64:67], v[48:51], v[16:19], a[64:67]
  v_mfma_f32_16x16x32_bf16 a[68:71], v[48:51], v[20:23], a[68:71]
  ds_read_b128 v[100:103], v3 offset:5120
  v_mfma_f32_16x16x32_bf16 a[72:75], v[48:51], v[24:27], a[72:75]
  v_mfma_f32_16x16x32_bf16 a[76:79], v[48:51], v[28:31], a[76:79]
  ds_read_b128 v[76:79], v2 offset:3072
  v_mfma_f32_16x16x32_bf16 a[80:83], v[52:55], v[16:19], a[80:83]
  v_mfma_f32_16x16x32_bf16 a[84:87], v[52:55], v[20:23], a[84:87]
  ds_read_b128 v[104:107], v3 offset:6144
  v_mfma_f32_16x16x32_bf16 a[88:91], v[52:55], v[24:27], a[88:91]
  v_mfma_f32_16x16x32_bf16 a[92:95], v[52:55], v[28:31], a[92:95]
  ds_read_b128 v[108:111], v3 offset:7168
  v_mfma_f32_16x16x32_bf16 a[96:99], v[56:59], v[16:19], a[96:99]
  v_mfma_f32_16x16x32_bf16 a[100:103], v[56:59], v[20:23], a[100:103]
  v_mfma_f32_16x16x32_bf16 a[104:107], v[56:59], v[24:27], a[104:107]
  s_add_u32 s66, s66, 24576
  v_mfma_f32_16x16x32_bf16 a[108:111], v[56:59], v[28:31], a[108:111]
  s_cmp_eq_u32 s66, 122880
  s_cselect_b32 s66, 0, s66
  v_mfma_f32_16x16x32_bf16 a[112:115], v[60:63], v[16:19], a[112:115]
  v_mfma_f32_16x16x32_bf16 a[116:119], v[60:63], v[20:23], a[116:119]
  v_mfma_f32_16x16x32_bf16 a[120:123], v[60:63], v[24:27], a[120:123]
  v_mfma_f32_16x16x32_bf16 a[124:127], v[60:63], v[28:31], a[124:127]
  s_waitcnt lgkmcnt(0)
  s_barrier
  v_mfma_f32_16x16x32_bf16 a[0:3], v[80:83], v[64:67], a[0:3]
  v_mfma_f32_16x16x32_bf16 a[4:7], v[80:83], v[68:71], a[4:7]
  v_mfma_f32_16x16x32_bf16 a[8:11], v[80:83], v[72:75], a[8:11]
  v_mfma_f32_16x16x32_bf16 a[12:15], v[80:83], v[76:79], a[12:15]
  v_mfma_f32_16x16x32_bf16 a[16:19], v[84:87], v[64:67], a[16:19]
  v_mfma_f32_16x16x32_bf16 a[20:23], v[84:87], v[68:71], a[20:23]
  v_mfma_f32_16x16x32_bf16 a[24:27], v[84:87], v[72:75], a[24:27]
  v_mfma_f32_16x16x32_bf16 a[28:31], v[84:87], v[76:79], a[28:31]
  v_mfma_f32_16x16x32_bf16 a[32:35], v[88:91], v[64:67], a[32:35]
  v_mfma_f32_16x16x32_bf16 a[36:39], v[88:91], v[68:71], a[36:39]
  v_mfma_f32_16x16x32_bf16 a[40:43], v[88:91], v[72:75], a[40:43]
  v_mfma_f32_16x16x32_bf16 a[44:47], v[88:91], v[76:79], a[44:47]
  v_mfma_f32_16x16x32_bf16 a[48:51], v[92:95], v[64:67], a[48:51]
  v_mfma_f32_16x16x32_bf16 a[52:55], v[92:95], v[68:71], a[52:55]
  v_mfma_f32_16x16x32_bf16 a[56:59], v[92:95], v[72:75], a[56:59]
  v_mfma_f32_16x16x32_bf16 a[60:63], v[92:95], v[76:79], a[60:63]
  v_mfma_f32_16x16x32_bf16 a[64:67], v[96:99], v[64:67], a[64:67]
  v_mfma_f32_16x16x32_bf16 a[68:71], v[96:99], v[68:71], a[68:71]
  v_mfma_f32_16x16x32_bf16 a[72:75], v[96:99], v[72:75], a[72:75]
  v_mfma_f32_16x16x32_bf16 a[76:79], v[96:99], v[76:79], a[76:79]
  v_mfma_f32_16x16x32_bf16 a[80:83], v[100:103], v[64:67], a[80:83]
  v_mfma_f32_16x16x32_bf16 a[84:87], v[100:103], v[68:71], a[84:87]
  v_mfma_f32_16x16x32_bf16 a[88:91], v[100:103], v[72:75], a[88:91]
  v_mfma_f32_16x16x32_bf16 a[92:95], v[100:103], v[76:79], a[92:95]
  v_mfma_f32_16x16x32_bf16 a[96:99], v[104:107], v[64:67], a[96:99]
  v_mfma_f32_16x16x32_bf16 a[100:103], v[104:107], v[68:71], a[100:103]
  v_mfma_f32_16x16x32_bf16 a[104:107], v[104:107], v[72:75], a[104:107]
  v_mfma_f32_16x16x32_bf16 a[108:111], v[104:107], v[76:79], a[108:111]
  v_mfma_f32_16x16x32_bf16 a[112:115], v[108:111], v[64:67], a[112:115]
  v_mfma_f32_16x16x32_bf16 a[116:119], v[108:111], v[68:71], a[116:119]
  v_mfma_f32_16x16x32_bf16 a[120:123], v[108:111], v[72:75], a[120:123]
  v_mfma_f32_16x16x32_bf16 a[124:127], v[108:111], v[76:79], a[124:127]
  s_load_dwordx2 s[52:53], s[0:1], 0
  s_load_dwordx2 s[54:55], s[0:1], 88
  v_mov_b32 v5, 0
  v_bfe_u32 v255, v0, 0, 4
  v_lshl_add_u32 v5, v255, 11, v5
  v_bfe_u32 v255, v0, 4, 2
  v_lshl_add_u32 v5, v255, 4, v5
  s_lshr_b32 s40, s27, 1
  s_lshl_b32 s40, s40, 2
  s_add_u32 s40, s40, s28
  s_lshl_b32 s40, s40, 15
  s_and_b32 s41, s27, 1
  s_lshl_b32 s41, s41, 3
  s_add_u32 s41, s41, s29
  s_lshl_b32 s41, s41, 5
  s_add_u32 s43, s40, s41
  s_waitcnt lgkmcnt(0)
  s_mov_b32 s8, s52
  s_mov_b32 s9, s53
  s_mov_b32 s10, 0x400000
  s_mov_b32 s11, 0x20000
  s_mov_b32 s36, s54
  s_mov_b32 s37, s55
  s_mov_b32 s38, 0x400000
  s_mov_b32 s39, 0x20000
  s_add_u32 s44, s43, 0
  s_add_u32 s48, s44, 4194304
  s_add_u32 s45, s43, 32768
  s_add_u32 s49, s45, 4194304
  s_add_u32 s46, s43, 65536
  s_add_u32 s50, s46, 4194304
  s_add_u32 s47, s43, 98304
  s_add_u32 s51, s47, 4194304
  buffer_load_dwordx4 v[112:115], v5, s[8:11], s44 offen offset:0
  buffer_load_dwordx4 v[116:119], v5, s[4:7], s48 offen offset:0
  buffer_load_dwordx4 v[120:123], v5, s[8:11], s44 offen offset:64
  buffer_load_dwordx4 v[124:127], v5, s[4:7], s48 offen offset:64
  buffer_load_dwordx4 v[128:131], v5, s[8:11], s44 offen offset:128
  buffer_load_dwordx4 v[132:135], v5, s[4:7], s48 offen offset:128
  buffer_load_dwordx4 v[136:139], v5, s[8:11], s44 offen offset:192
  buffer_load_dwordx4 v[140:143], v5, s[4:7], s48 offen offset:192
  buffer_load_dwordx4 v[144:147], v5, s[8:11], s45 offen offset:0
  buffer_load_dwordx4 v[148:151], v5, s[4:7], s49 offen offset:0
  buffer_load_dwordx4 v[152:155], v5, s[8:11], s45 offen offset:64
  buffer_load_dwordx4 v[156:159], v5, s[4:7], s49 offen offset:64
  buffer_load_dwordx4 v[160:163], v5, s[8:11], s45 offen offset:128
  buffer_load_dwordx4 v[164:167], v5, s[4:7], s49 offen offset:128
  buffer_load_dwordx4 v[168:171], v5, s[8:11], s45 offen offset:192
  buffer_load_dwordx4 v[172:175], v5, s[4:7], s49 offen offset:192
  buffer_load_dwordx4 v[176:179], v5, s[8:11], s46 offen offset:0
  buffer_load_dwordx4 v[180:183], v5, s[4:7], s50 offen offset:0
  buffer_load_dwordx4 v[184:187], v5, s[8:11], s46 offen offset:64
  buffer_load_dwordx4 v[188:191], v5, s[4:7], s50 offen offset:64
  buffer_load_dwordx4 v[192:195], v5, s[8:11], s46 offen offset:128
  buffer_load_dwordx4 v[196:199], v5, s[4:7], s50 offen offset:128
  buffer_load_dwordx4 v[200:203], v5, s[8:11], s46 offen offset:192
  buffer_load_dwordx4 v[204:207], v5, s[4:7], s50 offen offset:192
  buffer_load_dwordx4 v[208:211], v5, s[8:11], s47 offen offset:0
  buffer_load_dwordx4 v[212:215], v5, s[4:7], s51 offen offset:0
  buffer_load_dwordx4 v[216:219], v5, s[8:11], s47 offen offset:64
  buffer_load_dwordx4 v[220:223], v5, s[4:7], s51 offen offset:64
  buffer_load_dwordx4 v[224:227], v5, s[8:11], s47 offen offset:128
  buffer_load_dwordx4 v[228:231], v5, s[4:7], s51 offen offset:128
  buffer_load_dwordx4 v[232:235], v5, s[8:11], s47 offen offset:192
  buffer_load_dwordx4 v[236:239], v5, s[4:7], s51 offen offset:192
  v_accvgpr_read_b32 v16, a0
  v_accvgpr_read_b32 v17, a1
  v_accvgpr_read_b32 v18, a2
  v_accvgpr_read_b32 v19, a3
  v_accvgpr_read_b32 v20, a16
  v_accvgpr_read_b32 v21, a17
  v_accvgpr_read_b32 v22, a18
  v_accvgpr_read_b32 v23, a19
  s_waitcnt vmcnt(30)
  v_lshlrev_b32 v24, 16, v112
  v_and_b32 v25, 0xffff0000, v112
  v_lshlrev_b32 v26, 16, v116
  v_and_b32 v27, 0xffff0000, v116
  v_fmac_f32 v24, v16, v26
  v_fmac_f32 v25, v17, v27
  v_cvt_pk_bf16_f32 v28, v24, v25
  v_lshlrev_b32 v24, 16, v113
  v_and_b32 v25, 0xffff0000, v113
  v_lshlrev_b32 v26, 16, v117
  v_and_b32 v27, 0xffff0000, v117
  v_fmac_f32 v24, v18, v26
  v_fmac_f32 v25, v19, v27
  v_cvt_pk_bf16_f32 v29, v24, v25
  v_lshlrev_b32 v24, 16, v114
  v_and_b32 v25, 0xffff0000, v114
  v_lshlrev_b32 v26, 16, v118
  v_and_b32 v27, 0xffff0000, v118
  v_fmac_f32 v24, v20, v26
  v_fmac_f32 v25, v21, v27
  v_cvt_pk_bf16_f32 v30, v24, v25
  v_lshlrev_b32 v24, 16, v115
  v_and_b32 v25, 0xffff0000, v115
  v_lshlrev_b32 v26, 16, v119
  v_and_b32 v27, 0xffff0000, v119
  v_fmac_f32 v24, v22, v26
  v_fmac_f32 v25, v23, v27
  v_cvt_pk_bf16_f32 v31, v24, v25
  buffer_store_dwordx4 v[28:31], v5, s[36:39], s44 offen offset:0
  v_accvgpr_read_b32 v32, a32
  v_accvgpr_read_b32 v33, a33
  v_accvgpr_read_b32 v34, a34
  v_accvgpr_read_b32 v35, a35
  v_accvgpr_read_b32 v36, a48
  v_accvgpr_read_b32 v37, a49
  v_accvgpr_read_b32 v38, a50
  v_accvgpr_read_b32 v39, a51
  s_waitcnt vmcnt(29)
  v_lshlrev_b32 v40, 16, v120
  v_and_b32 v41, 0xffff0000, v120
  v_lshlrev_b32 v42, 16, v124
  v_and_b32 v43, 0xffff0000, v124
  v_fmac_f32 v40, v32, v42
  v_fmac_f32 v41, v33, v43
  v_cvt_pk_bf16_f32 v44, v40, v41
  v_lshlrev_b32 v40, 16, v121
  v_and_b32 v41, 0xffff0000, v121
  v_lshlrev_b32 v42, 16, v125
  v_and_b32 v43, 0xffff0000, v125
  v_fmac_f32 v40, v34, v42
  v_fmac_f32 v41, v35, v43
  v_cvt_pk_bf16_f32 v45, v40, v41
  v_lshlrev_b32 v40, 16, v122
  v_and_b32 v41, 0xffff0000, v122
  v_lshlrev_b32 v42, 16, v126
  v_and_b32 v43, 0xffff0000, v126
  v_fmac_f32 v40, v36, v42
  v_fmac_f32 v41, v37, v43
  v_cvt_pk_bf16_f32 v46, v40, v41
  v_lshlrev_b32 v40, 16, v123
  v_and_b32 v41, 0xffff0000, v123
  v_lshlrev_b32 v42, 16, v127
  v_and_b32 v43, 0xffff0000, v127
  v_fmac_f32 v40, v38, v42
  v_fmac_f32 v41, v39, v43
  v_cvt_pk_bf16_f32 v47, v40, v41
  buffer_store_dwordx4 v[44:47], v5, s[36:39], s44 offen offset:64
  v_accvgpr_read_b32 v16, a64
  v_accvgpr_read_b32 v17, a65
  v_accvgpr_read_b32 v18, a66
  v_accvgpr_read_b32 v19, a67
  v_accvgpr_read_b32 v20, a80
  v_accvgpr_read_b32 v21, a81
  v_accvgpr_read_b32 v22, a82
  v_accvgpr_read_b32 v23, a83
  s_waitcnt vmcnt(28)
  v_lshlrev_b32 v24, 16, v128
  v_and_b32 v25, 0xffff0000, v128
  v_lshlrev_b32 v26, 16, v132
  v_and_b32 v27, 0xffff0000, v132
  v_fmac_f32 v24, v16, v26
  v_fmac_f32 v25, v17, v27
  v_cvt_pk_bf16_f32 v28, v24, v25
  v_lshlrev_b32 v24, 16, v129
  v_and_b32 v25, 0xffff0000, v129
  v_lshlrev_b32 v26, 16, v133
  v_and_b32 v27, 0xffff0000, v133
  v_fmac_f32 v24, v18, v26
  v_fmac_f32 v25, v19, v27
  v_cvt_pk_bf16_f32 v29, v24, v25
  v_lshlrev_b32 v24, 16, v130
  v_and_b32 v25, 0xffff0000, v130
  v_lshlrev_b32 v26, 16, v134
  v_and_b32 v27, 0xffff0000, v134
  v_fmac_f32 v24, v20, v26
  v_fmac_f32 v25, v21, v27
  v_cvt_pk_bf16_f32 v30, v24, v25
  v_lshlrev_b32 v24, 16, v131
  v_and_b32 v25, 0xffff0000, v131
  v_lshlrev_b32 v26, 16, v135
  v_and_b32 v27, 0xffff0000, v135
  v_fmac_f32 v24, v22, v26
  v_fmac_f32 v25, v23, v27
  v_cvt_pk_bf16_f32 v31, v24, v25
  buffer_store_dwordx4 v[28:31], v5, s[36:39], s44 offen offset:128
  v_accvgpr_read_b32 v32, a96
  v_accvgpr_read_b32 v33, a97
  v_accvgpr_read_b32 v34, a98
  v_accvgpr_read_b32 v35, a99
  v_accvgpr_read_b32 v36, a112
  v_accvgpr_read_b32 v37, a113
  v_accvgpr_read_b32 v38, a114
  v_accvgpr_read_b32 v39, a115
  s_waitcnt vmcnt(27)
  v_lshlrev_b32 v40, 16, v136
  v_and_b32 v41, 0xffff0000, v136
  v_lshlrev_b32 v42, 16, v140
  v_and_b32 v43, 0xffff0000, v140
  v_fmac_f32 v40, v32, v42
  v_fmac_f32 v41, v33, v43
  v_cvt_pk_bf16_f32 v44, v40, v41
  v_lshlrev_b32 v40, 16, v137
  v_and_b32 v41, 0xffff0000, v137
  v_lshlrev_b32 v42, 16, v141
  v_and_b32 v43, 0xffff0000, v141
  v_fmac_f32 v40, v34, v42
  v_fmac_f32 v41, v35, v43
  v_cvt_pk_bf16_f32 v45, v40, v41
  v_lshlrev_b32 v40, 16, v138
  v_and_b32 v41, 0xffff0000, v138
  v_lshlrev_b32 v42, 16, v142
  v_and_b32 v43, 0xffff0000, v142
  v_fmac_f32 v40, v36, v42
  v_fmac_f32 v41, v37, v43
  v_cvt_pk_bf16_f32 v46, v40, v41
  v_lshlrev_b32 v40, 16, v139
  v_and_b32 v41, 0xffff0000, v139
  v_lshlrev_b32 v42, 16, v143
  v_and_b32 v43, 0xffff0000, v143
  v_fmac_f32 v40, v38, v42
  v_fmac_f32 v41, v39, v43
  v_cvt_pk_bf16_f32 v47, v40, v41
  buffer_store_dwordx4 v[44:47], v5, s[36:39], s44 offen offset:192
  v_accvgpr_read_b32 v16, a4
  v_accvgpr_read_b32 v17, a5
  v_accvgpr_read_b32 v18, a6
  v_accvgpr_read_b32 v19, a7
  v_accvgpr_read_b32 v20, a20
  v_accvgpr_read_b32 v21, a21
  v_accvgpr_read_b32 v22, a22
  v_accvgpr_read_b32 v23, a23
  s_waitcnt vmcnt(26)
  v_lshlrev_b32 v24, 16, v144
  v_and_b32 v25, 0xffff0000, v144
  v_lshlrev_b32 v26, 16, v148
  v_and_b32 v27, 0xffff0000, v148
  v_fmac_f32 v24, v16, v26
  v_fmac_f32 v25, v17, v27
  v_cvt_pk_bf16_f32 v28, v24, v25
  v_lshlrev_b32 v24, 16, v145
  v_and_b32 v25, 0xffff0000, v145
  v_lshlrev_b32 v26, 16, v149
  v_and_b32 v27, 0xffff0000, v149
  v_fmac_f32 v24, v18, v26
  v_fmac_f32 v25, v19, v27
  v_cvt_pk_bf16_f32 v29, v24, v25
  v_lshlrev_b32 v24, 16, v146
  v_and_b32 v25, 0xffff0000, v146
  v_lshlrev_b32 v26, 16, v150
  v_and_b32 v27, 0xffff0000, v150
  v_fmac_f32 v24, v20, v26
  v_fmac_f32 v25, v21, v27
  v_cvt_pk_bf16_f32 v30, v24, v25
  v_lshlrev_b32 v24, 16, v147
  v_and_b32 v25, 0xffff0000, v147
  v_lshlrev_b32 v26, 16, v151
  v_and_b32 v27, 0xffff0000, v151
  v_fmac_f32 v24, v22, v26
  v_fmac_f32 v25, v23, v27
  v_cvt_pk_bf16_f32 v31, v24, v25
  buffer_store_dwordx4 v[28:31], v5, s[36:39], s45 offen offset:0
  v_accvgpr_read_b32 v32, a36
  v_accvgpr_read_b32 v33, a37
  v_accvgpr_read_b32 v34, a38
  v_accvgpr_read_b32 v35, a39
  v_accvgpr_read_b32 v36, a52
  v_accvgpr_read_b32 v37, a53
  v_accvgpr_read_b32 v38, a54
  v_accvgpr_read_b32 v39, a55
  s_waitcnt vmcnt(25)
  v_lshlrev_b32 v40, 16, v152
  v_and_b32 v41, 0xffff0000, v152
  v_lshlrev_b32 v42, 16, v156
  v_and_b32 v43, 0xffff0000, v156
  v_fmac_f32 v40, v32, v42
  v_fmac_f32 v41, v33, v43
  v_cvt_pk_bf16_f32 v44, v40, v41
  v_lshlrev_b32 v40, 16, v153
  v_and_b32 v41, 0xffff0000, v153
  v_lshlrev_b32 v42, 16, v157
  v_and_b32 v43, 0xffff0000, v157
  v_fmac_f32 v40, v34, v42
  v_fmac_f32 v41, v35, v43
  v_cvt_pk_bf16_f32 v45, v40, v41
  v_lshlrev_b32 v40, 16, v154
  v_and_b32 v41, 0xffff0000, v154
  v_lshlrev_b32 v42, 16, v158
  v_and_b32 v43, 0xffff0000, v158
  v_fmac_f32 v40, v36, v42
  v_fmac_f32 v41, v37, v43
  v_cvt_pk_bf16_f32 v46, v40, v41
  v_lshlrev_b32 v40, 16, v155
  v_and_b32 v41, 0xffff0000, v155
  v_lshlrev_b32 v42, 16, v159
  v_and_b32 v43, 0xffff0000, v159
  v_fmac_f32 v40, v38, v42
  v_fmac_f32 v41, v39, v43
  v_cvt_pk_bf16_f32 v47, v40, v41
  buffer_store_dwordx4 v[44:47], v5, s[36:39], s45 offen offset:64
  v_accvgpr_read_b32 v16, a68
  v_accvgpr_read_b32 v17, a69
  v_accvgpr_read_b32 v18, a70
  v_accvgpr_read_b32 v19, a71
  v_accvgpr_read_b32 v20, a84
  v_accvgpr_read_b32 v21, a85
  v_accvgpr_read_b32 v22, a86
  v_accvgpr_read_b32 v23, a87
  s_waitcnt vmcnt(24)
  v_lshlrev_b32 v24, 16, v160
  v_and_b32 v25, 0xffff0000, v160
  v_lshlrev_b32 v26, 16, v164
  v_and_b32 v27, 0xffff0000, v164
  v_fmac_f32 v24, v16, v26
  v_fmac_f32 v25, v17, v27
  v_cvt_pk_bf16_f32 v28, v24, v25
  v_lshlrev_b32 v24, 16, v161
  v_and_b32 v25, 0xffff0000, v161
  v_lshlrev_b32 v26, 16, v165
  v_and_b32 v27, 0xffff0000, v165
  v_fmac_f32 v24, v18, v26
  v_fmac_f32 v25, v19, v27
  v_cvt_pk_bf16_f32 v29, v24, v25
  v_lshlrev_b32 v24, 16, v162
  v_and_b32 v25, 0xffff0000, v162
  v_lshlrev_b32 v26, 16, v166
  v_and_b32 v27, 0xffff0000, v166
  v_fmac_f32 v24, v20, v26
  v_fmac_f32 v25, v21, v27
  v_cvt_pk_bf16_f32 v30, v24, v25
  v_lshlrev_b32 v24, 16, v163
  v_and_b32 v25, 0xffff0000, v163
  v_lshlrev_b32 v26, 16, v167
  v_and_b32 v27, 0xffff0000, v167
  v_fmac_f32 v24, v22, v26
  v_fmac_f32 v25, v23, v27
  v_cvt_pk_bf16_f32 v31, v24, v25
  buffer_store_dwordx4 v[28:31], v5, s[36:39], s45 offen offset:128
  v_accvgpr_read_b32 v32, a100
  v_accvgpr_read_b32 v33, a101
  v_accvgpr_read_b32 v34, a102
  v_accvgpr_read_b32 v35, a103
  v_accvgpr_read_b32 v36, a116
  v_accvgpr_read_b32 v37, a117
  v_accvgpr_read_b32 v38, a118
  v_accvgpr_read_b32 v39, a119
  s_waitcnt vmcnt(23)
  v_lshlrev_b32 v40, 16, v168
  v_and_b32 v41, 0xffff0000, v168
  v_lshlrev_b32 v42, 16, v172
  v_and_b32 v43, 0xffff0000, v172
  v_fmac_f32 v40, v32, v42
  v_fmac_f32 v41, v33, v43
  v_cvt_pk_bf16_f32 v44, v40, v41
  v_lshlrev_b32 v40, 16, v169
  v_and_b32 v41, 0xffff0000, v169
  v_lshlrev_b32 v42, 16, v173
  v_and_b32 v43, 0xffff0000, v173
  v_fmac_f32 v40, v34, v42
  v_fmac_f32 v41, v35, v43
  v_cvt_pk_bf16_f32 v45, v40, v41
  v_lshlrev_b32 v40, 16, v170
  v_and_b32 v41, 0xffff0000, v170
  v_lshlrev_b32 v42, 16, v174
  v_and_b32 v43, 0xffff0000, v174
  v_fmac_f32 v40, v36, v42
  v_fmac_f32 v41, v37, v43
  v_cvt_pk_bf16_f32 v46, v40, v41
  v_lshlrev_b32 v40, 16, v171
  v_and_b32 v41, 0xffff0000, v171
  v_lshlrev_b32 v42, 16, v175
  v_and_b32 v43, 0xffff0000, v175
  v_fmac_f32 v40, v38, v42
  v_fmac_f32 v41, v39, v43
  v_cvt_pk_bf16_f32 v47, v40, v41
  buffer_store_dwordx4 v[44:47], v5, s[36:39], s45 offen offset:192
  v_accvgpr_read_b32 v16, a8
  v_accvgpr_read_b32 v17, a9
  v_accvgpr_read_b32 v18, a10
  v_accvgpr_read_b32 v19, a11
  v_accvgpr_read_b32 v20, a24
  v_accvgpr_read_b32 v21, a25
  v_accvgpr_read_b32 v22, a26
  v_accvgpr_read_b32 v23, a27
  s_waitcnt vmcnt(22)
  v_lshlrev_b32 v24, 16, v176
  v_and_b32 v25, 0xffff0000, v176
  v_lshlrev_b32 v26, 16, v180
  v_and_b32 v27, 0xffff0000, v180
  v_fmac_f32 v24, v16, v26
  v_fmac_f32 v25, v17, v27
  v_cvt_pk_bf16_f32 v28, v24, v25
  v_lshlrev_b32 v24, 16, v177
  v_and_b32 v25, 0xffff0000, v177
  v_lshlrev_b32 v26, 16, v181
  v_and_b32 v27, 0xffff0000, v181
  v_fmac_f32 v24, v18, v26
  v_fmac_f32 v25, v19, v27
  v_cvt_pk_bf16_f32 v29, v24, v25
  v_lshlrev_b32 v24, 16, v178
  v_and_b32 v25, 0xffff0000, v178
  v_lshlrev_b32 v26, 16, v182
  v_and_b32 v27, 0xffff0000, v182
  v_fmac_f32 v24, v20, v26
  v_fmac_f32 v25, v21, v27
  v_cvt_pk_bf16_f32 v30, v24, v25
  v_lshlrev_b32 v24, 16, v179
  v_and_b32 v25, 0xffff0000, v179
  v_lshlrev_b32 v26, 16, v183
  v_and_b32 v27, 0xffff0000, v183
  v_fmac_f32 v24, v22, v26
  v_fmac_f32 v25, v23, v27
  v_cvt_pk_bf16_f32 v31, v24, v25
  buffer_store_dwordx4 v[28:31], v5, s[36:39], s46 offen offset:0
  v_accvgpr_read_b32 v32, a40
  v_accvgpr_read_b32 v33, a41
  v_accvgpr_read_b32 v34, a42
  v_accvgpr_read_b32 v35, a43
  v_accvgpr_read_b32 v36, a56
  v_accvgpr_read_b32 v37, a57
  v_accvgpr_read_b32 v38, a58
  v_accvgpr_read_b32 v39, a59
  s_waitcnt vmcnt(21)
  v_lshlrev_b32 v40, 16, v184
  v_and_b32 v41, 0xffff0000, v184
  v_lshlrev_b32 v42, 16, v188
  v_and_b32 v43, 0xffff0000, v188
  v_fmac_f32 v40, v32, v42
  v_fmac_f32 v41, v33, v43
  v_cvt_pk_bf16_f32 v44, v40, v41
  v_lshlrev_b32 v40, 16, v185
  v_and_b32 v41, 0xffff0000, v185
  v_lshlrev_b32 v42, 16, v189
  v_and_b32 v43, 0xffff0000, v189
  v_fmac_f32 v40, v34, v42
  v_fmac_f32 v41, v35, v43
  v_cvt_pk_bf16_f32 v45, v40, v41
  v_lshlrev_b32 v40, 16, v186
  v_and_b32 v41, 0xffff0000, v186
  v_lshlrev_b32 v42, 16, v190
  v_and_b32 v43, 0xffff0000, v190
  v_fmac_f32 v40, v36, v42
  v_fmac_f32 v41, v37, v43
  v_cvt_pk_bf16_f32 v46, v40, v41
  v_lshlrev_b32 v40, 16, v187
  v_and_b32 v41, 0xffff0000, v187
  v_lshlrev_b32 v42, 16, v191
  v_and_b32 v43, 0xffff0000, v191
  v_fmac_f32 v40, v38, v42
  v_fmac_f32 v41, v39, v43
  v_cvt_pk_bf16_f32 v47, v40, v41
  buffer_store_dwordx4 v[44:47], v5, s[36:39], s46 offen offset:64
  v_accvgpr_read_b32 v16, a72
  v_accvgpr_read_b32 v17, a73
  v_accvgpr_read_b32 v18, a74
  v_accvgpr_read_b32 v19, a75
  v_accvgpr_read_b32 v20, a88
  v_accvgpr_read_b32 v21, a89
  v_accvgpr_read_b32 v22, a90
  v_accvgpr_read_b32 v23, a91
  s_waitcnt vmcnt(20)
  v_lshlrev_b32 v24, 16, v192
  v_and_b32 v25, 0xffff0000, v192
  v_lshlrev_b32 v26, 16, v196
  v_and_b32 v27, 0xffff0000, v196
  v_fmac_f32 v24, v16, v26
  v_fmac_f32 v25, v17, v27
  v_cvt_pk_bf16_f32 v28, v24, v25
  v_lshlrev_b32 v24, 16, v193
  v_and_b32 v25, 0xffff0000, v193
  v_lshlrev_b32 v26, 16, v197
  v_and_b32 v27, 0xffff0000, v197
  v_fmac_f32 v24, v18, v26
  v_fmac_f32 v25, v19, v27
  v_cvt_pk_bf16_f32 v29, v24, v25
  v_lshlrev_b32 v24, 16, v194
  v_and_b32 v25, 0xffff0000, v194
  v_lshlrev_b32 v26, 16, v198
  v_and_b32 v27, 0xffff0000, v198
  v_fmac_f32 v24, v20, v26
  v_fmac_f32 v25, v21, v27
  v_cvt_pk_bf16_f32 v30, v24, v25
  v_lshlrev_b32 v24, 16, v195
  v_and_b32 v25, 0xffff0000, v195
  v_lshlrev_b32 v26, 16, v199
  v_and_b32 v27, 0xffff0000, v199
  v_fmac_f32 v24, v22, v26
  v_fmac_f32 v25, v23, v27
  v_cvt_pk_bf16_f32 v31, v24, v25
  buffer_store_dwordx4 v[28:31], v5, s[36:39], s46 offen offset:128
  v_accvgpr_read_b32 v32, a104
  v_accvgpr_read_b32 v33, a105
  v_accvgpr_read_b32 v34, a106
  v_accvgpr_read_b32 v35, a107
  v_accvgpr_read_b32 v36, a120
  v_accvgpr_read_b32 v37, a121
  v_accvgpr_read_b32 v38, a122
  v_accvgpr_read_b32 v39, a123
  s_waitcnt vmcnt(19)
  v_lshlrev_b32 v40, 16, v200
  v_and_b32 v41, 0xffff0000, v200
  v_lshlrev_b32 v42, 16, v204
  v_and_b32 v43, 0xffff0000, v204
  v_fmac_f32 v40, v32, v42
  v_fmac_f32 v41, v33, v43
  v_cvt_pk_bf16_f32 v44, v40, v41
  v_lshlrev_b32 v40, 16, v201
  v_and_b32 v41, 0xffff0000, v201
  v_lshlrev_b32 v42, 16, v205
  v_and_b32 v43, 0xffff0000, v205
  v_fmac_f32 v40, v34, v42
  v_fmac_f32 v41, v35, v43
  v_cvt_pk_bf16_f32 v45, v40, v41
  v_lshlrev_b32 v40, 16, v202
  v_and_b32 v41, 0xffff0000, v202
  v_lshlrev_b32 v42, 16, v206
  v_and_b32 v43, 0xffff0000, v206
  v_fmac_f32 v40, v36, v42
  v_fmac_f32 v41, v37, v43
  v_cvt_pk_bf16_f32 v46, v40, v41
  v_lshlrev_b32 v40, 16, v203
  v_and_b32 v41, 0xffff0000, v203
  v_lshlrev_b32 v42, 16, v207
  v_and_b32 v43, 0xffff0000, v207
  v_fmac_f32 v40, v38, v42
  v_fmac_f32 v41, v39, v43
  v_cvt_pk_bf16_f32 v47, v40, v41
  buffer_store_dwordx4 v[44:47], v5, s[36:39], s46 offen offset:192
  v_accvgpr_read_b32 v16, a12
  v_accvgpr_read_b32 v17, a13
  v_accvgpr_read_b32 v18, a14
  v_accvgpr_read_b32 v19, a15
  v_accvgpr_read_b32 v20, a28
  v_accvgpr_read_b32 v21, a29
  v_accvgpr_read_b32 v22, a30
  v_accvgpr_read_b32 v23, a31
  s_waitcnt vmcnt(18)
  v_lshlrev_b32 v24, 16, v208
  v_and_b32 v25, 0xffff0000, v208
  v_lshlrev_b32 v26, 16, v212
  v_and_b32 v27, 0xffff0000, v212
  v_fmac_f32 v24, v16, v26
  v_fmac_f32 v25, v17, v27
  v_cvt_pk_bf16_f32 v28, v24, v25
  v_lshlrev_b32 v24, 16, v209
  v_and_b32 v25, 0xffff0000, v209
  v_lshlrev_b32 v26, 16, v213
  v_and_b32 v27, 0xffff0000, v213
  v_fmac_f32 v24, v18, v26
  v_fmac_f32 v25, v19, v27
  v_cvt_pk_bf16_f32 v29, v24, v25
  v_lshlrev_b32 v24, 16, v210
  v_and_b32 v25, 0xffff0000, v210
  v_lshlrev_b32 v26, 16, v214
  v_and_b32 v27, 0xffff0000, v214
  v_fmac_f32 v24, v20, v26
  v_fmac_f32 v25, v21, v27
  v_cvt_pk_bf16_f32 v30, v24, v25
  v_lshlrev_b32 v24, 16, v211
  v_and_b32 v25, 0xffff0000, v211
  v_lshlrev_b32 v26, 16, v215
  v_and_b32 v27, 0xffff0000, v215
  v_fmac_f32 v24, v22, v26
  v_fmac_f32 v25, v23, v27
  v_cvt_pk_bf16_f32 v31, v24, v25
  buffer_store_dwordx4 v[28:31], v5, s[36:39], s47 offen offset:0
  v_accvgpr_read_b32 v32, a44
  v_accvgpr_read_b32 v33, a45
  v_accvgpr_read_b32 v34, a46
  v_accvgpr_read_b32 v35, a47
  v_accvgpr_read_b32 v36, a60
  v_accvgpr_read_b32 v37, a61
  v_accvgpr_read_b32 v38, a62
  v_accvgpr_read_b32 v39, a63
  s_waitcnt vmcnt(17)
  v_lshlrev_b32 v40, 16, v216
  v_and_b32 v41, 0xffff0000, v216
  v_lshlrev_b32 v42, 16, v220
  v_and_b32 v43, 0xffff0000, v220
  v_fmac_f32 v40, v32, v42
  v_fmac_f32 v41, v33, v43
  v_cvt_pk_bf16_f32 v44, v40, v41
  v_lshlrev_b32 v40, 16, v217
  v_and_b32 v41, 0xffff0000, v217
  v_lshlrev_b32 v42, 16, v221
  v_and_b32 v43, 0xffff0000, v221
  v_fmac_f32 v40, v34, v42
  v_fmac_f32 v41, v35, v43
  v_cvt_pk_bf16_f32 v45, v40, v41
  v_lshlrev_b32 v40, 16, v218
  v_and_b32 v41, 0xffff0000, v218
  v_lshlrev_b32 v42, 16, v222
  v_and_b32 v43, 0xffff0000, v222
  v_fmac_f32 v40, v36, v42
  v_fmac_f32 v41, v37, v43
  v_cvt_pk_bf16_f32 v46, v40, v41
  v_lshlrev_b32 v40, 16, v219
  v_and_b32 v41, 0xffff0000, v219
  v_lshlrev_b32 v42, 16, v223
  v_and_b32 v43, 0xffff0000, v223
  v_fmac_f32 v40, v38, v42
  v_fmac_f32 v41, v39, v43
  v_cvt_pk_bf16_f32 v47, v40, v41
  buffer_store_dwordx4 v[44:47], v5, s[36:39], s47 offen offset:64
  v_accvgpr_read_b32 v16, a76
  v_accvgpr_read_b32 v17, a77
  v_accvgpr_read_b32 v18, a78
  v_accvgpr_read_b32 v19, a79
  v_accvgpr_read_b32 v20, a92
  v_accvgpr_read_b32 v21, a93
  v_accvgpr_read_b32 v22, a94
  v_accvgpr_read_b32 v23, a95
  s_waitcnt vmcnt(16)
  v_lshlrev_b32 v24, 16, v224
  v_and_b32 v25, 0xffff0000, v224
  v_lshlrev_b32 v26, 16, v228
  v_and_b32 v27, 0xffff0000, v228
  v_fmac_f32 v24, v16, v26
  v_fmac_f32 v25, v17, v27
  v_cvt_pk_bf16_f32 v28, v24, v25
  v_lshlrev_b32 v24, 16, v225
  v_and_b32 v25, 0xffff0000, v225
  v_lshlrev_b32 v26, 16, v229
  v_and_b32 v27, 0xffff0000, v229
  v_fmac_f32 v24, v18, v26
  v_fmac_f32 v25, v19, v27
  v_cvt_pk_bf16_f32 v29, v24, v25
  v_lshlrev_b32 v24, 16, v226
  v_and_b32 v25, 0xffff0000, v226
  v_lshlrev_b32 v26, 16, v230
  v_and_b32 v27, 0xffff0000, v230
  v_fmac_f32 v24, v20, v26
  v_fmac_f32 v25, v21, v27
  v_cvt_pk_bf16_f32 v30, v24, v25
  v_lshlrev_b32 v24, 16, v227
  v_and_b32 v25, 0xffff0000, v227
  v_lshlrev_b32 v26, 16, v231
  v_and_b32 v27, 0xffff0000, v231
  v_fmac_f32 v24, v22, v26
  v_fmac_f32 v25, v23, v27
  v_cvt_pk_bf16_f32 v31, v24, v25
  buffer_store_dwordx4 v[28:31], v5, s[36:39], s47 offen offset:128
  v_accvgpr_read_b32 v32, a108
  v_accvgpr_read_b32 v33, a109
  v_accvgpr_read_b32 v34, a110
  v_accvgpr_read_b32 v35, a111
  v_accvgpr_read_b32 v36, a124
  v_accvgpr_read_b32 v37, a125
  v_accvgpr_read_b32 v38, a126
  v_accvgpr_read_b32 v39, a127
  s_waitcnt vmcnt(15)
  v_lshlrev_b32 v40, 16, v232
  v_and_b32 v41, 0xffff0000, v232
  v_lshlrev_b32 v42, 16, v236
  v_and_b32 v43, 0xffff0000, v236
  v_fmac_f32 v40, v32, v42
  v_fmac_f32 v41, v33, v43
  v_cvt_pk_bf16_f32 v44, v40, v41
  v_lshlrev_b32 v40, 16, v233
  v_and_b32 v41, 0xffff0000, v233
  v_lshlrev_b32 v42, 16, v237
  v_and_b32 v43, 0xffff0000, v237
  v_fmac_f32 v40, v34, v42
  v_fmac_f32 v41, v35, v43
  v_cvt_pk_bf16_f32 v45, v40, v41
  v_lshlrev_b32 v40, 16, v234
  v_and_b32 v41, 0xffff0000, v234
  v_lshlrev_b32 v42, 16, v238
  v_and_b32 v43, 0xffff0000, v238
  v_fmac_f32 v40, v36, v42
  v_fmac_f32 v41, v37, v43
  v_cvt_pk_bf16_f32 v46, v40, v41
  v_lshlrev_b32 v40, 16, v235
  v_and_b32 v41, 0xffff0000, v235
  v_lshlrev_b32 v42, 16, v239
  v_and_b32 v43, 0xffff0000, v239
  v_fmac_f32 v40, v38, v42
  v_fmac_f32 v41, v39, v43
  v_cvt_pk_bf16_f32 v47, v40, v41
  buffer_store_dwordx4 v[44:47], v5, s[36:39], s47 offen offset:192
  s_branch L_next
T_W30:
  s_sub_u32 s40, s98, 8
  s_lshr_b32 s28, s40, 2
  s_add_u32 s28, s28, 16
  s_and_b32 s40, s40, 3
  s_lshl_b32 s29, s96, 2
  s_add_u32 s29, s29, s40
  s_lshl_b32 s29, s29, 2
  s_lshr_b32 s30, s28, 2
  s_cmp_lg_u32 s27, 0
  s_cbranch_scc1 L_wm_110_w
  s_mov_b32 s41, 117444608
  v_writelane_b32 v1, s41, 0
  v_writelane_b32 v2, 16, 0
  s_lshl_b32 s41, s30, 7
  s_add_u32 s41, s41, 117443584
  v_writelane_b32 v1, s41, 1
  v_writelane_b32 v2, 4, 1
  s_lshl_b32 s41, s28, 7
  s_add_u32 s41, s41, 117445632
  v_writelane_b32 v1, s41, 2
  v_writelane_b32 v2, 16, 2
  s_mov_b32 s99, 100000
  s_mov_b64 exec, 7
L_wm_110_p:
  buffer_load_dword v3, v1, s[4:7], 0 offen sc1
  s_waitcnt vmcnt(0)
  v_cmp_gt_u32 vcc, v2, v3
  s_cbranch_vccz L_wm_110_x
  s_sub_u32 s99, s99, 1
  s_cbranch_scc0 L_wm_110_p
  v_mov_b32 v1, 236
  v_mov_b32 v2, 1
  s_mov_b64 exec, 1
  global_atomic_add v1, v2, s[90:91] sc1
L_wm_110_x:
  s_mov_b64 exec, -1
L_wm_110_w:
  s_barrier
  s_lshl_b32 s28, s28, 2
  s_lshl_b32 s40, s27, 15
  s_lshl_b32 s41, s29, 17
  s_add_u32 s41, s41, s40
  s_add_u32 s41, s41, 109051904
  s_lshl_b32 s42, s28, 17
  s_add_u32 s42, s42, s40
  s_add_u32 s42, s42, 58720256
  v_lshlrev_b32 v1, 4, v0
  s_add_u32 s60, s41, 0
  s_add_u32 s61, s41, 131072
  s_add_u32 s62, s41, 262144
  s_add_u32 s63, s41, 393216
  s_add_u32 s64, s42, 0
  s_add_u32 s65, s42, 131072
  s_add_u32 s66, s42, 262144
  s_add_u32 s67, s42, 393216
  v_add_u32 v2, 4096, v1
  buffer_load_dwordx4 v[32:35], v1, s[4:7], s60 offen offset:0
  buffer_load_dwordx4 v[36:39], v1, s[4:7], s61 offen offset:0
  buffer_load_dwordx4 v[40:43], v1, s[4:7], s62 offen offset:0
  buffer_load_dwordx4 v[44:47], v1, s[4:7], s63 offen offset:0
  buffer_load_dwordx4 v[48:51], v1, s[4:7], s64 offen offset:0
  buffer_load_dwordx4 v[52:55], v1, s[4:7], s65 offen offset:0
  buffer_load_dwordx4 v[56:59], v1, s[4:7], s66 offen offset:0
  buffer_load_dwordx4 v[60:63], v1, s[4:7], s67 offen offset:0
  buffer_load_dwordx4 v[64:67], v1, s[4:7], s60 offen offset:1024
  buffer_load_dwordx4 v[68:71], v1, s[4:7], s61 offen offset:1024
  buffer_load_dwordx4 v[72:75], v1, s[4:7], s62 offen offset:1024
  buffer_load_dwordx4 v[76:79], v1, s[4:7], s63 offen offset:1024
  buffer_load_dwordx4 v[80:83], v1, s[4:7], s64 offen offset:1024
  buffer_load_dwordx4 v[84:87], v1, s[4:7], s65 offen offset:1024
  buffer_load_dwordx4 v[88:91], v1, s[4:7], s66 offen offset:1024
  buffer_load_dwordx4 v[92:95], v1, s[4:7], s67 offen offset:1024
  buffer_load_dwordx4 v[96:99], v1, s[4:7], s60 offen offset:2048
  buffer_load_dwordx4 v[100:103], v1, s[4:7], s61 offen offset:2048
  buffer_load_dwordx4 v[104:107], v1, s[4:7], s62 offen offset:2048
  buffer_load_dwordx4 v[108:111], v1, s[4:7], s63 offen offset:2048
  buffer_load_dwordx4 v[112:115], v1, s[4:7], s64 offen offset:2048
  buffer_load_dwordx4 v[116:119], v1, s[4:7], s65 offen offset:2048
  buffer_load_dwordx4 v[120:123], v1, s[4:7], s66 offen offset:2048
  buffer_load_dwordx4 v[124:127], v1, s[4:7], s67 offen offset:2048
  buffer_load_dwordx4 v[128:131], v1, s[4:7], s60 offen offset:3072
  buffer_load_dwordx4 v[132:135], v1, s[4:7], s61 offen offset:3072
  buffer_load_dwordx4 v[136:139], v1, s[4:7], s62 offen offset:3072
  buffer_load_dwordx4 v[140:143], v1, s[4:7], s63 offen offset:3072
  buffer_load_dwordx4 v[144:147], v1, s[4:7], s64 offen offset:3072
  buffer_load_dwordx4 v[148:151], v1, s[4:7], s65 offen offset:3072
  buffer_load_dwordx4 v[152:155], v1, s[4:7], s66 offen offset:3072
  buffer_load_dwordx4 v[156:159], v1, s[4:7], s67 offen offset:3072
  buffer_load_dwordx4 v[160:163], v2, s[4:7], s60 offen offset:0
  buffer_load_dwordx4 v[164:167], v2, s[4:7], s61 offen offset:0
  buffer_load_dwordx4 v[168:171], v2, s[4:7], s62 offen offset:0
  buffer_load_dwordx4 v[172:175], v2, s[4:7], s63 offen offset:0
  buffer_load_dwordx4 v[176:179], v2, s[4:7], s64 offen offset:0
  buffer_load_dwordx4 v[180:183], v2, s[4:7], s65 offen offset:0
  buffer_load_dwordx4 v[184:187], v2, s[4:7], s66 offen offset:0
  buffer_load_dwordx4 v[188:191], v2, s[4:7], s67 offen offset:0
  buffer_load_dwordx4 v[192:195], v2, s[4:7], s60 offen offset:1024
  buffer_load_dwordx4 v[196:199], v2, s[4:7], s61 offen offset:1024
  buffer_load_dwordx4 v[200:203], v2, s[4:7], s62 offen offset:1024
  buffer_load_dwordx4 v[204:207], v2, s[4:7], s63 offen offset:1024
  buffer_load_dwordx4 v[208:211], v2, s[4:7], s64 offen offset:1024
  buffer_load_dwordx4 v[212:215], v2, s[4:7], s65 offen offset:1024
  buffer_load_dwordx4 v[216:219], v2, s[4:7], s66 offen offset:1024
  buffer_load_dwordx4 v[220:223], v2, s[4:7], s67 offen offset:1024
  s_waitcnt vmcnt(40)
  v_mfma_f32_16x16x32_bf16 a[0:3], v[32:35], v[48:51], 0
  v_mfma_f32_16x16x32_bf16 a[4:7], v[32:35], v[52:55], 0
  v_mfma_f32_16x16x32_bf16 a[8:11], v[32:35], v[56:59], 0
  v_mfma_f32_16x16x32_bf16 a[12:15], v[32:35], v[60:63], 0
  v_mfma_f32_16x16x32_bf16 a[16:19], v[36:39], v[48:51], 0
  v_mfma_f32_16x16x32_bf16 a[20:23], v[36:39], v[52:55], 0
  v_mfma_f32_16x16x32_bf16 a[24:27], v[36:39], v[56:59], 0
  v_mfma_f32_16x16x32_bf16 a[28:31], v[36:39], v[60:63], 0
  v_mfma_f32_16x16x32_bf16 a[32:35], v[40:43], v[48:51], 0
  v_mfma_f32_16x16x32_bf16 a[36:39], v[40:43], v[52:55], 0
  v_mfma_f32_16x16x32_bf16 a[40:43], v[40:43], v[56:59], 0
  v_mfma_f32_16x16x32_bf16 a[44:47], v[40:43], v[60:63], 0
  v_mfma_f32_16x16x32_bf16 a[48:51], v[44:47], v[48:51], 0
  v_mfma_f32_16x16x32_bf16 a[52:55], v[44:47], v[52:55], 0
  v_mfma_f32_16x16x32_bf16 a[56:59], v[44:47], v[56:59], 0
  v_mfma_f32_16x16x32_bf16 a[60:63], v[44:47], v[60:63], 0
  s_nop 2
  buffer_load_dwordx4 v[32:35], v2, s[4:7], s60 offen offset:2048
  buffer_load_dwordx4 v[36:39], v2, s[4:7], s61 offen offset:2048
  buffer_load_dwordx4 v[40:43], v2, s[4:7], s62 offen offset:2048
  buffer_load_dwordx4 v[44:47], v2, s[4:7], s63 offen offset:2048
  buffer_load_dwordx4 v[48:51], v2, s[4:7], s64 offen offset:2048
  buffer_load_dwordx4 v[52:55], v2, s[4:7], s65 offen offset:2048
  buffer_load_dwordx4 v[56:59], v2, s[4:7], s66 offen offset:2048
  buffer_load_dwordx4 v[60:63], v2, s[4:7], s67 offen offset:2048
  s_waitcnt vmcnt(40)
  v_mfma_f32_16x16x32_bf16 a[0:3], v[64:67], v[80:83], a[0:3]
  v_mfma_f32_16x16x32_bf16 a[4:7], v[64:67], v[84:87], a[4:7]
  v_mfma_f32_16x16x32_bf16 a[8:11], v[64:67], v[88:91], a[8:11]
  v_mfma_f32_16x16x32_bf16 a[12:15], v[64:67], v[92:95], a[12:15]
  v_mfma_f32_16x16x32_bf16 a[16:19], v[68:71], v[80:83], a[16:19]
  v_mfma_f32_16x16x32_bf16 a[20:23], v[68:71], v[84:87], a[20:23]
  v_mfma_f32_16x16x32_bf16 a[24:27], v[68:71], v[88:91], a[24:27]
  v_mfma_f32_16x16x32_bf16 a[28:31], v[68:71], v[92:95], a[28:31]
  v_mfma_f32_16x16x32_bf16 a[32:35], v[72:75], v[80:83], a[32:35]
  v_mfma_f32_16x16x32_bf16 a[36:39], v[72:75], v[84:87], a[36:39]
  v_mfma_f32_16x16x32_bf16 a[40:43], v[72:75], v[88:91], a[40:43]
  v_mfma_f32_16x16x32_bf16 a[44:47], v[72:75], v[92:95], a[44:47]
  v_mfma_f32_16x16x32_bf16 a[48:51], v[76:79], v[80:83], a[48:51]
  v_mfma_f32_16x16x32_bf16 a[52:55], v[76:79], v[84:87], a[52:55]
  v_mfma_f32_16x16x32_bf16 a[56:59], v[76:79], v[88:91], a[56:59]
  v_mfma_f32_16x16x32_bf16 a[60:63], v[76:79], v[92:95], a[60:63]
  s_nop 2
  buffer_load_dwordx4 v[64:67], v2, s[4:7], s60 offen offset:3072
  buffer_load_dwordx4 v[68:71], v2, s[4:7], s61 offen offset:3072
  buffer_load_dwordx4 v[72:75], v2, s[4:7], s62 offen offset:3072
  buffer_load_dwordx4 v[76:79], v2, s[4:7], s63 offen offset:3072
  buffer_load_dwordx4 v[80:83], v2, s[4:7], s64 offen offset:3072
  buffer_load_dwordx4 v[84:87], v2, s[4:7], s65 offen offset:3072
  buffer_load_dwordx4 v[88:91], v2, s[4:7], s66 offen offset:3072
  buffer_load_dwordx4 v[92:95], v2, s[4:7], s67 offen offset:3072
  s_waitcnt vmcnt(40)
  v_mfma_f32_16x16x32_bf16 a[0:3], v[96:99], v[112:115], a[0:3]
  v_mfma_f32_16x16x32_bf16 a[4:7], v[96:99], v[116:119], a[4:7]
  v_mfma_f32_16x16x32_bf16 a[8:11], v[96:99], v[120:123], a[8:11]
  v_mfma_f32_16x16x32_bf16 a[12:15], v[96:99], v[124:127], a[12:15]
  v_mfma_f32_16x16x32_bf16 a[16:19], v[100:103], v[112:115], a[16:19]
  v_mfma_f32_16x16x32_bf16 a[20:23], v[100:103], v[116:119], a[20:23]
  v_mfma_f32_16x16x32_bf16 a[24:27], v[100:103], v[120:123], a[24:27]
  v_mfma_f32_16x16x32_bf16 a[28:31], v[100:103], v[124:127], a[28:31]
  v_mfma_f32_16x16x32_bf16 a[32:35], v[104:107], v[112:115], a[32:35]
  v_mfma_f32_16x16x32_bf16 a[36:39], v[104:107], v[116:119], a[36:39]
  v_mfma_f32_16x16x32_bf16 a[40:43], v[104:107], v[120:123], a[40:43]
  v_mfma_f32_16x16x32_bf16 a[44:47], v[104:107], v[124:127], a[44:47]
  v_mfma_f32_16x16x32_bf16 a[48:51], v[108:111], v[112:115], a[48:51]
  v_mfma_f32_16x16x32_bf16 a[52:55], v[108:111], v[116:119], a[52:55]
  v_mfma_f32_16x16x32_bf16 a[56:59], v[108:111], v[120:123], a[56:59]
  v_mfma_f32_16x16x32_bf16 a[60:63], v[108:111], v[124:127], a[60:63]
  s_nop 2
  v_add_u32 v1, 8192, v1
  buffer_load_dwordx4 v[96:99], v1, s[4:7], s60 offen offset:0
  buffer_load_dwordx4 v[100:103], v1, s[4:7], s61 offen offset:0
  buffer_load_dwordx4 v[104:107], v1, s[4:7], s62 offen offset:0
  buffer_load_dwordx4 v[108:111], v1, s[4:7], s63 offen offset:0
  buffer_load_dwordx4 v[112:115], v1, s[4:7], s64 offen offset:0
  buffer_load_dwordx4 v[116:119], v1, s[4:7], s65 offen offset:0
  buffer_load_dwordx4 v[120:123], v1, s[4:7], s66 offen offset:0
  buffer_load_dwordx4 v[124:127], v1, s[4:7], s67 offen offset:0
  s_waitcnt vmcnt(40)
  v_mfma_f32_16x16x32_bf16 a[0:3], v[128:131], v[144:147], a[0:3]
  v_mfma_f32_16x16x32_bf16 a[4:7], v[128:131], v[148:151], a[4:7]
  v_mfma_f32_16x16x32_bf16 a[8:11], v[128:131], v[152:155], a[8:11]
  v_mfma_f32_16x16x32_bf16 a[12:15], v[128:131], v[156:159], a[12:15]
  v_mfma_f32_16x16x32_bf16 a[16:19], v[132:135], v[144:147], a[16:19]
  v_mfma_f32_16x16x32_bf16 a[20:23], v[132:135], v[148:151], a[20:23]
  v_mfma_f32_16x16x32_bf16 a[24:27], v[132:135], v[152:155], a[24:27]
  v_mfma_f32_16x16x32_bf16 a[28:31], v[132:135], v[156:159], a[28:31]
  v_mfma_f32_16x16x32_bf16 a[32:35], v[136:139], v[144:147], a[32:35]
  v_mfma_f32_16x16x32_bf16 a[36:39], v[136:139], v[148:151], a[36:39]
  v_mfma_f32_16x16x32_bf16 a[40:43], v[136:139], v[152:155], a[40:43]
  v_mfma_f32_16x16x32_bf16 a[44:47], v[136:139], v[156:159], a[44:47]
  v_mfma_f32_16x16x32_bf16 a[48:51], v[140:143], v[144:147], a[48:51]
  v_mfma_f32_16x16x32_bf16 a[52:55], v[140:143], v[148:151], a[52:55]
  v_mfma_f32_16x16x32_bf16 a[56:59], v[140:143], v[152:155], a[56:59]
  v_mfma_f32_16x16x32_bf16 a[60:63], v[140:143], v[156:159], a[60:63]
  s_nop 2
  buffer_load_dwordx4 v[128:131], v1, s[4:7], s60 offen offset:1024
  buffer_load_dwordx4 v[132:135], v1, s[4:7], s61 offen offset:1024
  buffer_load_dwordx4 v[136:139], v1, s[4:7], s62 offen offset:1024
  buffer_load_dwordx4 v[140:143], v1, s[4:7], s63 offen offset:1024
  buffer_load_dwordx4 v[144:147], v1, s[4:7], s64 offen offset:1024
  buffer_load_dwordx4 v[148:151], v1, s[4:7], s65 offen offset:1024
  buffer_load_dwordx4 v[152:155], v1, s[4:7], s66 offen offset:1024
  buffer_load_dwordx4 v[156:159], v1, s[4:7], s67 offen offset:1024
  s_waitcnt vmcnt(40)
  v_mfma_f32_16x16x32_bf16 a[0:3], v[160:163], v[176:179], a[0:3]
  v_mfma_f32_16x16x32_bf16 a[4:7], v[160:163], v[180:183], a[4:7]
  v_mfma_f32_16x16x32_bf16 a[8:11], v[160:163], v[184:187], a[8:11]
  v_mfma_f32_16x16x32_bf16 a[12:15], v[160:163], v[188:191], a[12:15]
  v_mfma_f32_16x16x32_bf16 a[16:19], v[164:167], v[176:179], a[16:19]
  v_mfma_f32_16x16x32_bf16 a[20:23], v[164:167], v[180:183], a[20:23]
  v_mfma_f32_16x16x32_bf16 a[24:27], v[164:167], v[184:187], a[24:27]
  v_mfma_f32_16x16x32_bf16 a[28:31], v[164:167], v[188:191], a[28:31]
  v_mfma_f32_16x16x32_bf16 a[32:35], v[168:171], v[176:179], a[32:35]
  v_mfma_f32_16x16x32_bf16 a[36:39], v[168:171], v[180:183], a[36:39]
  v_mfma_f32_16x16x32_bf16 a[40:43], v[168:171], v[184:187], a[40:43]
  v_mfma_f32_16x16x32_bf16 a[44:47], v[168:171], v[188:191], a[44:47]
  v_mfma_f32_16x16x32_bf16 a[48:51], v[172:175], v[176:179], a[48:51]
  v_mfma_f32_16x16x32_bf16 a[52:55], v[172:175], v[180:183], a[52:55]
  v_mfma_f32_16x16x32_bf16 a[56:59], v[172:175], v[184:187], a[56:59]
  v_mfma_f32_16x16x32_bf16 a[60:63], v[172:175], v[188:191], a[60:63]
  s_nop 2
  buffer_load_dwordx4 v[160:163], v1, s[4:7], s60 offen offset:2048
  buffer_load_dwordx4 v[164:167], v1, s[4:7], s61 offen offset:2048
  buffer_load_dwordx4 v[168:171], v1, s[4:7], s62 offen offset:2048
  buffer_load_dwordx4 v[172:175], v1, s[4:7], s63 offen offset:2048
  buffer_load_dwordx4 v[176:179], v1, s[4:7], s64 offen offset:2048
  buffer_load_dwordx4 v[180:183], v1, s[4:7], s65 offen offset:2048
  buffer_load_dwordx4 v[184:187], v1, s[4:7], s66 offen offset:2048
  buffer_load_dwordx4 v[188:191], v1, s[4:7], s67 offen offset:2048
  s_waitcnt vmcnt(40)
  v_mfma_f32_16x16x32_bf16 a[0:3], v[192:195], v[208:211], a[0:3]
  v_mfma_f32_16x16x32_bf16 a[4:7], v[192:195], v[212:215], a[4:7]
  v_mfma_f32_16x16x32_bf16 a[8:11], v[192:195], v[216:219], a[8:11]
  v_mfma_f32_16x16x32_bf16 a[12:15], v[192:195], v[220:223], a[12:15]
  v_mfma_f32_16x16x32_bf16 a[16:19], v[196:199], v[208:211], a[16:19]
  v_mfma_f32_16x16x32_bf16 a[20:23], v[196:199], v[212:215], a[20:23]
  v_mfma_f32_16x16x32_bf16 a[24:27], v[196:199], v[216:219], a[24:27]
  v_mfma_f32_16x16x32_bf16 a[28:31], v[196:199], v[220:223], a[28:31]
  v_mfma_f32_16x16x32_bf16 a[32:35], v[200:203], v[208:211], a[32:35]
  v_mfma_f32_16x16x32_bf16 a[36:39], v[200:203], v[212:215], a[36:39]
  v_mfma_f32_16x16x32_bf16 a[40:43], v[200:203], v[216:219], a[40:43]
  v_mfma_f32_16x16x32_bf16 a[44:47], v[200:203], v[220:223], a[44:47]
  v_mfma_f32_16x16x32_bf16 a[48:51], v[204:207], v[208:211], a[48:51]
  v_mfma_f32_16x16x32_bf16 a[52:55], v[204:207], v[212:215], a[52:55]
  v_mfma_f32_16x16x32_bf16 a[56:59], v[204:207], v[216:219], a[56:59]
  v_mfma_f32_16x16x32_bf16 a[60:63], v[204:207], v[220:223], a[60:63]
  s_nop 2
  buffer_load_dwordx4 v[192:195], v1, s[4:7], s60 offen offset:3072
  buffer_load_dwordx4 v[196:199], v1, s[4:7], s61 offen offset:3072
  buffer_load_dwordx4 v[200:203], v1, s[4:7], s62 offen offset:3072
  buffer_load_dwordx4 v[204:207], v1, s[4:7], s63 offen offset:3072
  buffer_load_dwordx4 v[208:211], v1, s[4:7], s64 offen offset:3072
  buffer_load_dwordx4 v[212:215], v1, s[4:7], s65 offen offset:3072
  buffer_load_dwordx4 v[216:219], v1, s[4:7], s66 offen offset:3072
  buffer_load_dwordx4 v[220:223], v1, s[4:7], s67 offen offset:3072
  s_waitcnt vmcnt(40)
  v_mfma_f32_16x16x32_bf16 a[0:3], v[32:35], v[48:51], a[0:3]
  v_mfma_f32_16x16x32_bf16 a[4:7], v[32:35], v[52:55], a[4:7]
  v_mfma_f32_16x16x32_bf16 a[8:11], v[32:35], v[56:59], a[8:11]
  v_mfma_f32_16x16x32_bf16 a[12:15], v[32:35], v[60:63], a[12:15]
  v_mfma_f32_16x16x32_bf16 a[16:19], v[36:39], v[48:51], a[16:19]
  v_mfma_f32_16x16x32_bf16 a[20:23], v[36:39], v[52:55], a[20:23]
  v_mfma_f32_16x16x32_bf16 a[24:27], v[36:39], v[56:59], a[24:27]
  v_mfma_f32_16x16x32_bf16 a[28:31], v[36:39], v[60:63], a[28:31]
  v_mfma_f32_16x16x32_bf16 a[32:35], v[40:43], v[48:51], a[32:35]
  v_mfma_f32_16x16x32_bf16 a[36:39], v[40:43], v[52:55], a[36:39]
  v_mfma_f32_16x16x32_bf16 a[40:43], v[40:43], v[56:59], a[40:43]
  v_mfma_f32_16x16x32_bf16 a[44:47], v[40:43], v[60:63], a[44:47]
  v_mfma_f32_16x16x32_bf16 a[48:51], v[44:47], v[48:51], a[48:51]
  v_mfma_f32_16x16x32_bf16 a[52:55], v[44:47], v[52:55], a[52:55]
  v_mfma_f32_16x16x32_bf16 a[56:59], v[44:47], v[56:59], a[56:59]
  v_mfma_f32_16x16x32_bf16 a[60:63], v[44:47], v[60:63], a[60:63]
  s_nop 2
  v_add_u32 v2, 8192, v2
  buffer_load_dwordx4 v[32:35], v2, s[4:7], s60 offen offset:0
  buffer_load_dwordx4 v[36:39], v2, s[4:7], s61 offen offset:0
  buffer_load_dwordx4 v[40:43], v2, s[4:7], s62 offen offset:0
  buffer_load_dwordx4 v[44:47], v2, s[4:7], s63 offen offset:0
  buffer_load_dwordx4 v[48:51], v2, s[4:7], s64 offen offset:0
  buffer_load_dwordx4 v[52:55], v2, s[4:7], s65 offen offset:0
  buffer_load_dwordx4 v[56:59], v2, s[4:7], s66 offen offset:0
  buffer_load_dwordx4 v[60:63], v2, s[4:7], s67 offen offset:0
  s_waitcnt vmcnt(40)
  v_mfma_f32_16x16x32_bf16 a[0:3], v[64:67], v[80:83], a[0:3]
  v_mfma_f32_16x16x32_bf16 a[4:7], v[64:67], v[84:87], a[4:7]
  v_mfma_f32_16x16x32_bf16 a[8:11], v[64:67], v[88:91], a[8:11]
  v_mfma_f32_16x16x32_bf16 a[12:15], v[64:67], v[92:95], a[12:15]
  v_mfma_f32_16x16x32_bf16 a[16:19], v[68:71], v[80:83], a[16:19]
  v_mfma_f32_16x16x32_bf16 a[20:23], v[68:71], v[84:87], a[20:23]
  v_mfma_f32_16x16x32_bf16 a[24:27], v[68:71], v[88:91], a[24:27]
  v_mfma_f32_16x16x32_bf16 a[28:31], v[68:71], v[92:95], a[28:31]
  v_mfma_f32_16x16x32_bf16 a[32:35], v[72:75], v[80:83], a[32:35]
  v_mfma_f32_16x16x32_bf16 a[36:39], v[72:75], v[84:87], a[36:39]
  v_mfma_f32_16x16x32_bf16 a[40:43], v[72:75], v[88:91], a[40:43]
  v_mfma_f32_16x16x32_bf16 a[44:47], v[72:75], v[92:95], a[44:47]
  v_mfma_f32_16x16x32_bf16 a[48:51], v[76:79], v[80:83], a[48:51]
  v_mfma_f32_16x16x32_bf16 a[52:55], v[76:79], v[84:87], a[52:55]
  v_mfma_f32_16x16x32_bf16 a[56:59], v[76:79], v[88:91], a[56:59]
  v_mfma_f32_16x16x32_bf16 a[60:63], v[76:79], v[92:95], a[60:63]
  s_nop 2
  buffer_load_dwordx4 v[64:67], v2, s[4:7], s60 offen offset:1024
  buffer_load_dwordx4 v[68:71], v2, s[4:7], s61 offen offset:1024
  buffer_load_dwordx4 v[72:75], v2, s[4:7], s62 offen offset:1024
  buffer_load_dwordx4 v[76:79], v2, s[4:7], s63 offen offset:1024
  buffer_load_dwordx4 v[80:83], v2, s[4:7], s64 offen offset:1024
  buffer_load_dwordx4 v[84:87], v2, s[4:7], s65 offen offset:1024
  buffer_load_dwordx4 v[88:91], v2, s[4:7], s66 offen offset:1024
  buffer_load_dwordx4 v[92:95], v2, s[4:7], s67 offen offset:1024
  s_waitcnt vmcnt(40)
  v_mfma_f32_16x16x32_bf16 a[0:3], v[96:99], v[112:115], a[0:3]
  v_mfma_f32_16x16x32_bf16 a[4:7], v[96:99], v[116:119], a[4:7]
  v_mfma_f32_16x16x32_bf16 a[8:11], v[96:99], v[120:123], a[8:11]
  v_mfma_f32_16x16x32_bf16 a[12:15], v[96:99], v[124:127], a[12:15]
  v_mfma_f32_16x16x32_bf16 a[16:19], v[100:103], v[112:115], a[16:19]
  v_mfma_f32_16x16x32_bf16 a[20:23], v[100:103], v[116:119], a[20:23]
  v_mfma_f32_16x16x32_bf16 a[24:27], v[100:103], v[120:123], a[24:27]
  v_mfma_f32_16x16x32_bf16 a[28:31], v[100:103], v[124:127], a[28:31]
  v_mfma_f32_16x16x32_bf16 a[32:35], v[104:107], v[112:115], a[32:35]
  v_mfma_f32_16x16x32_bf16 a[36:39], v[104:107], v[116:119], a[36:39]
  v_mfma_f32_16x16x32_bf16 a[40:43], v[104:107], v[120:123], a[40:43]
  v_mfma_f32_16x16x32_bf16 a[44:47], v[104:107], v[124:127], a[44:47]
  v_mfma_f32_16x16x32_bf16 a[48:51], v[108:111], v[112:115], a[48:51]
  v_mfma_f32_16x16x32_bf16 a[52:55], v[108:111], v[116:119], a[52:55]
  v_mfma_f32_16x16x32_bf16 a[56:59], v[108:111], v[120:123], a[56:59]
  v_mfma_f32_16x16x32_bf16 a[60:63], v[108:111], v[124:127], a[60:63]
  s_nop 2
  buffer_load_dwordx4 v[96:99], v2, s[4:7], s60 offen offset:2048
  buffer_load_dwordx4 v[100:103], v2, s[4:7], s61 offen offset:2048
  buffer_load_dwordx4 v[104:107], v2, s[4:7], s62 offen offset:2048
  buffer_load_dwordx4 v[108:111], v2, s[4:7], s63 offen offset:2048
  buffer_load_dwordx4 v[112:115], v2, s[4:7], s64 offen offset:2048
  buffer_load_dwordx4 v[116:119], v2, s[4:7], s65 offen offset:2048
  buffer_load_dwordx4 v[120:123], v2, s[4:7], s66 offen offset:2048
  buffer_load_dwordx4 v[124:127], v2, s[4:7], s67 offen offset:2048
  s_waitcnt vmcnt(40)
  v_mfma_f32_16x16x32_bf16 a[0:3], v[128:131], v[144:147], a[0:3]
  v_mfma_f32_16x16x32_bf16 a[4:7], v[128:131], v[148:151], a[4:7]
  v_mfma_f32_16x16x32_bf16 a[8:11], v[128:131], v[152:155], a[8:11]
  v_mfma_f32_16x16x32_bf16 a[12:15], v[128:131], v[156:159], a[12:15]
  v_mfma_f32_16x16x32_bf16 a[16:19], v[132:135], v[144:147], a[16:19]
  v_mfma_f32_16x16x32_bf16 a[20:23], v[132:135], v[148:151], a[20:23]
  v_mfma_f32_16x16x32_bf16 a[24:27], v[132:135], v[152:155], a[24:27]
  v_mfma_f32_16x16x32_bf16 a[28:31], v[132:135], v[156:159], a[28:31]
  v_mfma_f32_16x16x32_bf16 a[32:35], v[136:139], v[144:147], a[32:35]
  v_mfma_f32_16x16x32_bf16 a[36:39], v[136:139], v[148:151], a[36:39]
  v_mfma_f32_16x16x32_bf16 a[40:43], v[136:139], v[152:155], a[40:43]
  v_mfma_f32_16x16x32_bf16 a[44:47], v[136:139], v[156:159], a[44:47]
  v_mfma_f32_16x16x32_bf16 a[48:51], v[140:143], v[144:147], a[48:51]
  v_mfma_f32_16x16x32_bf16 a[52:55], v[140:143], v[148:151], a[52:55]
  v_mfma_f32_16x16x32_bf16 a[56:59], v[140:143], v[152:155], a[56:59]
  v_mfma_f32_16x16x32_bf16 a[60:63], v[140:143], v[156:159], a[60:63]
  s_nop 2
  buffer_load_dwordx4 v[128:131], v2, s[4:7], s60 offen offset:3072
  buffer_load_dwordx4 v[132:135], v2, s[4:7], s61 offen offset:3072
  buffer_load_dwordx4 v[136:139], v2, s[4:7], s62 offen offset:3072
  buffer_load_dwordx4 v[140:143], v2, s[4:7], s63 offen offset:3072
  buffer_load_dwordx4 v[144:147], v2, s[4:7], s64 offen offset:3072
  buffer_load_dwordx4 v[148:151], v2, s[4:7], s65 offen offset:3072
  buffer_load_dwordx4 v[152:155], v2, s[4:7], s66 offen offset:3072
  buffer_load_dwordx4 v[156:159], v2, s[4:7], s67 offen offset:3072
  s_waitcnt vmcnt(40)
  v_mfma_f32_16x16x32_bf16 a[0:3], v[160:163], v[176:179], a[0:3]
  v_mfma_f32_16x16x32_bf16 a[4:7], v[160:163], v[180:183], a[4:7]
  v_mfma_f32_16x16x32_bf16 a[8:11], v[160:163], v[184:187], a[8:11]
  v_mfma_f32_16x16x32_bf16 a[12:15], v[160:163], v[188:191], a[12:15]
  v_mfma_f32_16x16x32_bf16 a[16:19], v[164:167], v[176:179], a[16:19]
  v_mfma_f32_16x16x32_bf16 a[20:23], v[164:167], v[180:183], a[20:23]
  v_mfma_f32_16x16x32_bf16 a[24:27], v[164:167], v[184:187], a[24:27]
  v_mfma_f32_16x16x32_bf16 a[28:31], v[164:167], v[188:191], a[28:31]
  v_mfma_f32_16x16x32_bf16 a[32:35], v[168:171], v[176:179], a[32:35]
  v_mfma_f32_16x16x32_bf16 a[36:39], v[168:171], v[180:183], a[36:39]
  v_mfma_f32_16x16x32_bf16 a[40:43], v[168:171], v[184:187], a[40:43]
  v_mfma_f32_16x16x32_bf16 a[44:47], v[168:171], v[188:191], a[44:47]
  v_mfma_f32_16x16x32_bf16 a[48:51], v[172:175], v[176:179], a[48:51]
  v_mfma_f32_16x16x32_bf16 a[52:55], v[172:175], v[180:183], a[52:55]
  v_mfma_f32_16x16x32_bf16 a[56:59], v[172:175], v[184:187], a[56:59]
  v_mfma_f32_16x16x32_bf16 a[60:63], v[172:175], v[188:191], a[60:63]
  s_nop 2
  v_add_u32 v1, 8192, v1
  buffer_load_dwordx4 v[160:163], v1, s[4:7], s60 offen offset:0
  buffer_load_dwordx4 v[164:167], v1, s[4:7], s61 offen offset:0
  buffer_load_dwordx4 v[168:171], v1, s[4:7], s62 offen offset:0
  buffer_load_dwordx4 v[172:175], v1, s[4:7], s63 offen offset:0
  buffer_load_dwordx4 v[176:179], v1, s[4:7], s64 offen offset:0
  buffer_load_dwordx4 v[180:183], v1, s[4:7], s65 offen offset:0
  buffer_load_dwordx4 v[184:187], v1, s[4:7], s66 offen offset:0
  buffer_load_dwordx4 v[188:191], v1, s[4:7], s67 offen offset:0
  s_waitcnt vmcnt(40)
  v_mfma_f32_16x16x32_bf16 a[0:3], v[192:195], v[208:211], a[0:3]
  v_mfma_f32_16x16x32_bf16 a[4:7], v[192:195], v[212:215], a[4:7]
  v_mfma_f32_16x16x32_bf16 a[8:11], v[192:195], v[216:219], a[8:11]
  v_mfma_f32_16x16x32_bf16 a[12:15], v[192:195], v[220:223], a[12:15]
  v_mfma_f32_16x16x32_bf16 a[16:19], v[196:199], v[208:211], a[16:19]
  v_mfma_f32_16x16x32_bf16 a[20:23], v[196:199], v[212:215], a[20:23]
  v_mfma_f32_16x16x32_bf16 a[24:27], v[196:199], v[216:219], a[24:27]
  v_mfma_f32_16x16x32_bf16 a[28:31], v[196:199], v[220:223], a[28:31]
  v_mfma_f32_16x16x32_bf16 a[32:35], v[200:203], v[208:211], a[32:35]
  v_mfma_f32_16x16x32_bf16 a[36:39], v[200:203], v[212:215], a[36:39]
  v_mfma_f32_16x16x32_bf16 a[40:43], v[200:203], v[216:219], a[40:43]
  v_mfma_f32_16x16x32_bf16 a[44:47], v[200:203], v[220:223], a[44:47]
  v_mfma_f32_16x16x32_bf16 a[48:51], v[204:207], v[208:211], a[48:51]
  v_mfma_f32_16x16x32_bf16 a[52:55], v[204:207], v[212:215], a[52:55]
  v_mfma_f32_16x16x32_bf16 a[56:59], v[204:207], v[216:219], a[56:59]
  v_mfma_f32_16x16x32_bf16 a[60:63], v[204:207], v[220:223], a[60:63]
  s_nop 2
  buffer_load_dwordx4 v[192:195], v1, s[4:7], s60 offen offset:1024
  buffer_load_dwordx4 v[196:199], v1, s[4:7], s61 offen offset:1024
  buffer_load_dwordx4 v[200:203], v1, s[4:7], s62 offen offset:1024
  buffer_load_dwordx4 v[204:207], v1, s[4:7], s63 offen offset:1024
  buffer_load_dwordx4 v[208:211], v1, s[4:7], s64 offen offset:1024
  buffer_load_dwordx4 v[212:215], v1, s[4:7], s65 offen offset:1024
  buffer_load_dwordx4 v[216:219], v1, s[4:7], s66 offen offset:1024
  buffer_load_dwordx4 v[220:223], v1, s[4:7], s67 offen offset:1024
  s_waitcnt vmcnt(40)
  v_mfma_f32_16x16x32_bf16 a[0:3], v[32:35], v[48:51], a[0:3]
  v_mfma_f32_16x16x32_bf16 a[4:7], v[32:35], v[52:55], a[4:7]
  v_mfma_f32_16x16x32_bf16 a[8:11], v[32:35], v[56:59], a[8:11]
  v_mfma_f32_16x16x32_bf16 a[12:15], v[32:35], v[60:63], a[12:15]
  v_mfma_f32_16x16x32_bf16 a[16:19], v[36:39], v[48:51], a[16:19]
  v_mfma_f32_16x16x32_bf16 a[20:23], v[36:39], v[52:55], a[20:23]
  v_mfma_f32_16x16x32_bf16 a[24:27], v[36:39], v[56:59], a[24:27]
  v_mfma_f32_16x16x32_bf16 a[28:31], v[36:39], v[60:63], a[28:31]
  v_mfma_f32_16x16x32_bf16 a[32:35], v[40:43], v[48:51], a[32:35]
  v_mfma_f32_16x16x32_bf16 a[36:39], v[40:43], v[52:55], a[36:39]
  v_mfma_f32_16x16x32_bf16 a[40:43], v[40:43], v[56:59], a[40:43]
  v_mfma_f32_16x16x32_bf16 a[44:47], v[40:43], v[60:63], a[44:47]
  v_mfma_f32_16x16x32_bf16 a[48:51], v[44:47], v[48:51], a[48:51]
  v_mfma_f32_16x16x32_bf16 a[52:55], v[44:47], v[52:55], a[52:55]
  v_mfma_f32_16x16x32_bf16 a[56:59], v[44:47], v[56:59], a[56:59]
  v_mfma_f32_16x16x32_bf16 a[60:63], v[44:47], v[60:63], a[60:63]
  s_nop 2
  buffer_load_dwordx4 v[32:35], v1, s[4:7], s60 offen offset:2048
  buffer_load_dwordx4 v[36:39], v1, s[4:7], s61 offen offset:2048
  buffer_load_dwordx4 v[40:43], v1, s[4:7], s62 offen offset:2048
  buffer_load_dwordx4 v[44:47], v1, s[4:7], s63 offen offset:2048
  buffer_load_dwordx4 v[48:51], v1, s[4:7], s64 offen offset:2048
  buffer_load_dwordx4 v[52:55], v1, s[4:7], s65 offen offset:2048
  buffer_load_dwordx4 v[56:59], v1, s[4:7], s66 offen offset:2048
  buffer_load_dwordx4 v[60:63], v1, s[4:7], s67 offen offset:2048
  s_waitcnt vmcnt(40)
  v_mfma_f32_16x16x32_bf16 a[0:3], v[64:67], v[80:83], a[0:3]
  v_mfma_f32_16x16x32_bf16 a[4:7], v[64:67], v[84:87], a[4:7]
  v_mfma_f32_16x16x32_bf16 a[8:11], v[64:67], v[88:91], a[8:11]
  v_mfma_f32_16x16x32_bf16 a[12:15], v[64:67], v[92:95], a[12:15]
  v_mfma_f32_16x16x32_bf16 a[16:19], v[68:71], v[80:83], a[16:19]
  v_mfma_f32_16x16x32_bf16 a[20:23], v[68:71], v[84:87], a[20:23]
  v_mfma_f32_16x16x32_bf16 a[24:27], v[68:71], v[88:91], a[24:27]
  v_mfma_f32_16x16x32_bf16 a[28:31], v[68:71], v[92:95], a[28:31]
  v_mfma_f32_16x16x32_bf16 a[32:35], v[72:75], v[80:83], a[32:35]
  v_mfma_f32_16x16x32_bf16 a[36:39], v[72:75], v[84:87], a[36:39]
  v_mfma_f32_16x16x32_bf16 a[40:43], v[72:75], v[88:91], a[40:43]
  v_mfma_f32_16x16x32_bf16 a[44:47], v[72:75], v[92:95], a[44:47]
  v_mfma_f32_16x16x32_bf16 a[48:51], v[76:79], v[80:83], a[48:51]
  v_mfma_f32_16x16x32_bf16 a[52:55], v[76:79], v[84:87], a[52:55]
  v_mfma_f32_16x16x32_bf16 a[56:59], v[76:79], v[88:91], a[56:59]
  v_mfma_f32_16x16x32_bf16 a[60:63], v[76:79], v[92:95], a[60:63]
  s_nop 2
  buffer_load_dwordx4 v[64:67], v1, s[4:7], s60 offen offset:3072
  buffer_load_dwordx4 v[68:71], v1, s[4:7], s61 offen offset:3072
  buffer_load_dwordx4 v[72:75], v1, s[4:7], s62 offen offset:3072
  buffer_load_dwordx4 v[76:79], v1, s[4:7], s63 offen offset:3072
  buffer_load_dwordx4 v[80:83], v1, s[4:7], s64 offen offset:3072
  buffer_load_dwordx4 v[84:87], v1, s[4:7], s65 offen offset:3072
  buffer_load_dwordx4 v[88:91], v1, s[4:7], s66 offen offset:3072
  buffer_load_dwordx4 v[92:95], v1, s[4:7], s67 offen offset:3072
  s_waitcnt vmcnt(40)
  v_mfma_f32_16x16x32_bf16 a[0:3], v[96:99], v[112:115], a[0:3]
  v_mfma_f32_16x16x32_bf16 a[4:7], v[96:99], v[116:119], a[4:7]
  v_mfma_f32_16x16x32_bf16 a[8:11], v[96:99], v[120:123], a[8:11]
  v_mfma_f32_16x16x32_bf16 a[12:15], v[96:99], v[124:127], a[12:15]
  v_mfma_f32_16x16x32_bf16 a[16:19], v[100:103], v[112:115], a[16:19]
  v_mfma_f32_16x16x32_bf16 a[20:23], v[100:103], v[116:119], a[20:23]
  v_mfma_f32_16x16x32_bf16 a[24:27], v[100:103], v[120:123], a[24:27]
  v_mfma_f32_16x16x32_bf16 a[28:31], v[100:103], v[124:127], a[28:31]
  v_mfma_f32_16x16x32_bf16 a[32:35], v[104:107], v[112:115], a[32:35]
  v_mfma_f32_16x16x32_bf16 a[36:39], v[104:107], v[116:119], a[36:39]
  v_mfma_f32_16x16x32_bf16 a[40:43], v[104:107], v[120:123], a[40:43]
  v_mfma_f32_16x16x32_bf16 a[44:47], v[104:107], v[124:127], a[44:47]
  v_mfma_f32_16x16x32_bf16 a[48:51], v[108:111], v[112:115], a[48:51]
  v_mfma_f32_16x16x32_bf16 a[52:55], v[108:111], v[116:119], a[52:55]
  v_mfma_f32_16x16x32_bf16 a[56:59], v[108:111], v[120:123], a[56:59]
  v_mfma_f32_16x16x32_bf16 a[60:63], v[108:111], v[124:127], a[60:63]
  s_nop 2
  v_add_u32 v2, 8192, v2
  buffer_load_dwordx4 v[96:99], v2, s[4:7], s60 offen offset:0
  buffer_load_dwordx4 v[100:103], v2, s[4:7], s61 offen offset:0
  buffer_load_dwordx4 v[104:107], v2, s[4:7], s62 offen offset:0
  buffer_load_dwordx4 v[108:111], v2, s[4:7], s63 offen offset:0
  buffer_load_dwordx4 v[112:115], v2, s[4:7], s64 offen offset:0
  buffer_load_dwordx4 v[116:119], v2, s[4:7], s65 offen offset:0
  buffer_load_dwordx4 v[120:123], v2, s[4:7], s66 offen offset:0
  buffer_load_dwordx4 v[124:127], v2, s[4:7], s67 offen offset:0
  s_waitcnt vmcnt(40)
  v_mfma_f32_16x16x32_bf16 a[0:3], v[128:131], v[144:147], a[0:3]
  v_mfma_f32_16x16x32_bf16 a[4:7], v[128:131], v[148:151], a[4:7]
  v_mfma_f32_16x16x32_bf16 a[8:11], v[128:131], v[152:155], a[8:11]
  v_mfma_f32_16x16x32_bf16 a[12:15], v[128:131], v[156:159], a[12:15]
  v_mfma_f32_16x16x32_bf16 a[16:19], v[132:135], v[144:147], a[16:19]
  v_mfma_f32_16x16x32_bf16 a[20:23], v[132:135], v[148:151], a[20:23]
  v_mfma_f32_16x16x32_bf16 a[24:27], v[132:135], v[152:155], a[24:27]
  v_mfma_f32_16x16x32_bf16 a[28:31], v[132:135], v[156:159], a[28:31]
  v_mfma_f32_16x16x32_bf16 a[32:35], v[136:139], v[144:147], a[32:35]
  v_mfma_f32_16x16x32_bf16 a[36:39], v[136:139], v[148:151], a[36:39]
  v_mfma_f32_16x16x32_bf16 a[40:43], v[136:139], v[152:155], a[40:43]
  v_mfma_f32_16x16x32_bf16 a[44:47], v[136:139], v[156:159], a[44:47]
  v_mfma_f32_16x16x32_bf16 a[48:51], v[140:143], v[144:147], a[48:51]
  v_mfma_f32_16x16x32_bf16 a[52:55], v[140:143], v[148:151], a[52:55]
  v_mfma_f32_16x16x32_bf16 a[56:59], v[140:143], v[152:155], a[56:59]
  v_mfma_f32_16x16x32_bf16 a[60:63], v[140:143], v[156:159], a[60:63]
  s_nop 2
  buffer_load_dwordx4 v[128:131], v2, s[4:7], s60 offen offset:1024
  buffer_load_dwordx4 v[132:135], v2, s[4:7], s61 offen offset:1024
  buffer_load_dwordx4 v[136:139], v2, s[4:7], s62 offen offset:1024
  buffer_load_dwordx4 v[140:143], v2, s[4:7], s63 offen offset:1024
  buffer_load_dwordx4 v[144:147], v2, s[4:7], s64 offen offset:1024
  buffer_load_dwordx4 v[148:151], v2, s[4:7], s65 offen offset:1024
  buffer_load_dwordx4 v[152:155], v2, s[4:7], s66 offen offset:1024
  buffer_load_dwordx4 v[156:159], v2, s[4:7], s67 offen offset:1024
  s_waitcnt vmcnt(40)
  v_mfma_f32_16x16x32_bf16 a[0:3], v[160:163], v[176:179], a[0:3]
  v_mfma_f32_16x16x32_bf16 a[4:7], v[160:163], v[180:183], a[4:7]
  v_mfma_f32_16x16x32_bf16 a[8:11], v[160:163], v[184:187], a[8:11]
  v_mfma_f32_16x16x32_bf16 a[12:15], v[160:163], v[188:191], a[12:15]
  v_mfma_f32_16x16x32_bf16 a[16:19], v[164:167], v[176:179], a[16:19]
  v_mfma_f32_16x16x32_bf16 a[20:23], v[164:167], v[180:183], a[20:23]
  v_mfma_f32_16x16x32_bf16 a[24:27], v[164:167], v[184:187], a[24:27]
  v_mfma_f32_16x16x32_bf16 a[28:31], v[164:167], v[188:191], a[28:31]
  v_mfma_f32_16x16x32_bf16 a[32:35], v[168:171], v[176:179], a[32:35]
  v_mfma_f32_16x16x32_bf16 a[36:39], v[168:171], v[180:183], a[36:39]
  v_mfma_f32_16x16x32_bf16 a[40:43], v[168:171], v[184:187], a[40:43]
  v_mfma_f32_16x16x32_bf16 a[44:47], v[168:171], v[188:191], a[44:47]
  v_mfma_f32_16x16x32_bf16 a[48:51], v[172:175], v[176:179], a[48:51]
  v_mfma_f32_16x16x32_bf16 a[52:55], v[172:175], v[180:183], a[52:55]
  v_mfma_f32_16x16x32_bf16 a[56:59], v[172:175], v[184:187], a[56:59]
  v_mfma_f32_16x16x32_bf16 a[60:63], v[172:175], v[188:191], a[60:63]
  s_nop 2
  buffer_load_dwordx4 v[160:163], v2, s[4:7], s60 offen offset:2048
  buffer_load_dwordx4 v[164:167], v2, s[4:7], s61 offen offset:2048
  buffer_load_dwordx4 v[168:171], v2, s[4:7], s62 offen offset:2048
  buffer_load_dwordx4 v[172:175], v2, s[4:7], s63 offen offset:2048
  buffer_load_dwordx4 v[176:179], v2, s[4:7], s64 offen offset:2048
  buffer_load_dwordx4 v[180:183], v2, s[4:7], s65 offen offset:2048
  buffer_load_dwordx4 v[184:187], v2, s[4:7], s66 offen offset:2048
  buffer_load_dwordx4 v[188:191], v2, s[4:7], s67 offen offset:2048
  s_waitcnt vmcnt(40)
  v_mfma_f32_16x16x32_bf16 a[0:3], v[192:195], v[208:211], a[0:3]
  v_mfma_f32_16x16x32_bf16 a[4:7], v[192:195], v[212:215], a[4:7]
  v_mfma_f32_16x16x32_bf16 a[8:11], v[192:195], v[216:219], a[8:11]
  v_mfma_f32_16x16x32_bf16 a[12:15], v[192:195], v[220:223], a[12:15]
  v_mfma_f32_16x16x32_bf16 a[16:19], v[196:199], v[208:211], a[16:19]
  v_mfma_f32_16x16x32_bf16 a[20:23], v[196:199], v[212:215], a[20:23]
  v_mfma_f32_16x16x32_bf16 a[24:27], v[196:199], v[216:219], a[24:27]
  v_mfma_f32_16x16x32_bf16 a[28:31], v[196:199], v[220:223], a[28:31]
  v_mfma_f32_16x16x32_bf16 a[32:35], v[200:203], v[208:211], a[32:35]
  v_mfma_f32_16x16x32_bf16 a[36:39], v[200:203], v[212:215], a[36:39]
  v_mfma_f32_16x16x32_bf16 a[40:43], v[200:203], v[216:219], a[40:43]
  v_mfma_f32_16x16x32_bf16 a[44:47], v[200:203], v[220:223], a[44:47]
  v_mfma_f32_16x16x32_bf16 a[48:51], v[204:207], v[208:211], a[48:51]
  v_mfma_f32_16x16x32_bf16 a[52:55], v[204:207], v[212:215], a[52:55]
  v_mfma_f32_16x16x32_bf16 a[56:59], v[204:207], v[216:219], a[56:59]
  v_mfma_f32_16x16x32_bf16 a[60:63], v[204:207], v[220:223], a[60:63]
  s_nop 2
  buffer_load_dwordx4 v[192:195], v2, s[4:7], s60 offen offset:3072
  buffer_load_dwordx4 v[196:199], v2, s[4:7], s61 offen offset:3072
  buffer_load_dwordx4 v[200:203], v2, s[4:7], s62 offen offset:3072
  buffer_load_dwordx4 v[204:207], v2, s[4:7], s63 offen offset:3072
  buffer_load_dwordx4 v[208:211], v2, s[4:7], s64 offen offset:3072
  buffer_load_dwordx4 v[212:215], v2, s[4:7], s65 offen offset:3072
  buffer_load_dwordx4 v[216:219], v2, s[4:7], s66 offen offset:3072
  buffer_load_dwordx4 v[220:223], v2, s[4:7], s67 offen offset:3072
  s_waitcnt vmcnt(40)
  v_mfma_f32_16x16x32_bf16 a[0:3], v[32:35], v[48:51], a[0:3]
  v_mfma_f32_16x16x32_bf16 a[4:7], v[32:35], v[52:55], a[4:7]
  v_mfma_f32_16x16x32_bf16 a[8:11], v[32:35], v[56:59], a[8:11]
  v_mfma_f32_16x16x32_bf16 a[12:15], v[32:35], v[60:63], a[12:15]
  v_mfma_f32_16x16x32_bf16 a[16:19], v[36:39], v[48:51], a[16:19]
  v_mfma_f32_16x16x32_bf16 a[20:23], v[36:39], v[52:55], a[20:23]
  v_mfma_f32_16x16x32_bf16 a[24:27], v[36:39], v[56:59], a[24:27]
  v_mfma_f32_16x16x32_bf16 a[28:31], v[36:39], v[60:63], a[28:31]
  v_mfma_f32_16x16x32_bf16 a[32:35], v[40:43], v[48:51], a[32:35]
  v_mfma_f32_16x16x32_bf16 a[36:39], v[40:43], v[52:55], a[36:39]
  v_mfma_f32_16x16x32_bf16 a[40:43], v[40:43], v[56:59], a[40:43]
  v_mfma_f32_16x16x32_bf16 a[44:47], v[40:43], v[60:63], a[44:47]
  v_mfma_f32_16x16x32_bf16 a[48:51], v[44:47], v[48:51], a[48:51]
  v_mfma_f32_16x16x32_bf16 a[52:55], v[44:47], v[52:55], a[52:55]
  v_mfma_f32_16x16x32_bf16 a[56:59], v[44:47], v[56:59], a[56:59]
  v_mfma_f32_16x16x32_bf16 a[60:63], v[44:47], v[60:63], a[60:63]
  s_nop 2
  v_add_u32 v1, 8192, v1
  buffer_load_dwordx4 v[32:35], v1, s[4:7], s60 offen offset:0
  buffer_load_dwordx4 v[36:39], v1, s[4:7], s61 offen offset:0
  buffer_load_dwordx4 v[40:43], v1, s[4:7], s62 offen offset:0
  buffer_load_dwordx4 v[44:47], v1, s[4:7], s63 offen offset:0
  buffer_load_dwordx4 v[48:51], v1, s[4:7], s64 offen offset:0
  buffer_load_dwordx4 v[52:55], v1, s[4:7], s65 offen offset:0
  buffer_load_dwordx4 v[56:59], v1, s[4:7], s66 offen offset:0
  buffer_load_dwordx4 v[60:63], v1, s[4:7], s67 offen offset:0
  s_waitcnt vmcnt(40)
  v_mfma_f32_16x16x32_bf16 a[0:3], v[64:67], v[80:83], a[0:3]
  v_mfma_f32_16x16x32_bf16 a[4:7], v[64:67], v[84:87], a[4:7]
  v_mfma_f32_16x16x32_bf16 a[8:11], v[64:67], v[88:91], a[8:11]
  v_mfma_f32_16x16x32_bf16 a[12:15], v[64:67], v[92:95], a[12:15]
  v_mfma_f32_16x16x32_bf16 a[16:19], v[68:71], v[80:83], a[16:19]
  v_mfma_f32_16x16x32_bf16 a[20:23], v[68:71], v[84:87], a[20:23]
  v_mfma_f32_16x16x32_bf16 a[24:27], v[68:71], v[88:91], a[24:27]
  v_mfma_f32_16x16x32_bf16 a[28:31], v[68:71], v[92:95], a[28:31]
  v_mfma_f32_16x16x32_bf16 a[32:35], v[72:75], v[80:83], a[32:35]
  v_mfma_f32_16x16x32_bf16 a[36:39], v[72:75], v[84:87], a[36:39]
  v_mfma_f32_16x16x32_bf16 a[40:43], v[72:75], v[88:91], a[40:43]
  v_mfma_f32_16x16x32_bf16 a[44:47], v[72:75], v[92:95], a[44:47]
  v_mfma_f32_16x16x32_bf16 a[48:51], v[76:79], v[80:83], a[48:51]
  v_mfma_f32_16x16x32_bf16 a[52:55], v[76:79], v[84:87], a[52:55]
  v_mfma_f32_16x16x32_bf16 a[56:59], v[76:79], v[88:91], a[56:59]
  v_mfma_f32_16x16x32_bf16 a[60:63], v[76:79], v[92:95], a[60:63]
  s_nop 2
  buffer_load_dwordx4 v[64:67], v1, s[4:7], s60 offen offset:1024
  buffer_load_dwordx4 v[68:71], v1, s[4:7], s61 offen offset:1024
  buffer_load_dwordx4 v[72:75], v1, s[4:7], s62 offen offset:1024
  buffer_load_dwordx4 v[76:79], v1, s[4:7], s63 offen offset:1024
  buffer_load_dwordx4 v[80:83], v1, s[4:7], s64 offen offset:1024
  buffer_load_dwordx4 v[84:87], v1, s[4:7], s65 offen offset:1024
  buffer_load_dwordx4 v[88:91], v1, s[4:7], s66 offen offset:1024
  buffer_load_dwordx4 v[92:95], v1, s[4:7], s67 offen offset:1024
  s_waitcnt vmcnt(40)
  v_mfma_f32_16x16x32_bf16 a[0:3], v[96:99], v[112:115], a[0:3]
  v_mfma_f32_16x16x32_bf16 a[4:7], v[96:99], v[116:119], a[4:7]
  v_mfma_f32_16x16x32_bf16 a[8:11], v[96:99], v[120:123], a[8:11]
  v_mfma_f32_16x16x32_bf16 a[12:15], v[96:99], v[124:127], a[12:15]
  v_mfma_f32_16x16x32_bf16 a[16:19], v[100:103], v[112:115], a[16:19]
  v_mfma_f32_16x16x32_bf16 a[20:23], v[100:103], v[116:119], a[20:23]
  v_mfma_f32_16x16x32_bf16 a[24:27], v[100:103], v[120:123], a[24:27]
  v_mfma_f32_16x16x32_bf16 a[28:31], v[100:103], v[124:127], a[28:31]
  v_mfma_f32_16x16x32_bf16 a[32:35], v[104:107], v[112:115], a[32:35]
  v_mfma_f32_16x16x32_bf16 a[36:39], v[104:107], v[116:119], a[36:39]
  v_mfma_f32_16x16x32_bf16 a[40:43], v[104:107], v[120:123], a[40:43]
  v_mfma_f32_16x16x32_bf16 a[44:47], v[104:107], v[124:127], a[44:47]
  v_mfma_f32_16x16x32_bf16 a[48:51], v[108:111], v[112:115], a[48:51]
  v_mfma_f32_16x16x32_bf16 a[52:55], v[108:111], v[116:119], a[52:55]
  v_mfma_f32_16x16x32_bf16 a[56:59], v[108:111], v[120:123], a[56:59]
  v_mfma_f32_16x16x32_bf16 a[60:63], v[108:111], v[124:127], a[60:63]
  s_nop 2
  buffer_load_dwordx4 v[96:99], v1, s[4:7], s60 offen offset:2048
  buffer_load_dwordx4 v[100:103], v1, s[4:7], s61 offen offset:2048
  buffer_load_dwordx4 v[104:107], v1, s[4:7], s62 offen offset:2048
  buffer_load_dwordx4 v[108:111], v1, s[4:7], s63 offen offset:2048
  buffer_load_dwordx4 v[112:115], v1, s[4:7], s64 offen offset:2048
  buffer_load_dwordx4 v[116:119], v1, s[4:7], s65 offen offset:2048
  buffer_load_dwordx4 v[120:123], v1, s[4:7], s66 offen offset:2048
  buffer_load_dwordx4 v[124:127], v1, s[4:7], s67 offen offset:2048
  s_waitcnt vmcnt(40)
  v_mfma_f32_16x16x32_bf16 a[0:3], v[128:131], v[144:147], a[0:3]
  v_mfma_f32_16x16x32_bf16 a[4:7], v[128:131], v[148:151], a[4:7]
  v_mfma_f32_16x16x32_bf16 a[8:11], v[128:131], v[152:155], a[8:11]
  v_mfma_f32_16x16x32_bf16 a[12:15], v[128:131], v[156:159], a[12:15]
  v_mfma_f32_16x16x32_bf16 a[16:19], v[132:135], v[144:147], a[16:19]
  v_mfma_f32_16x16x32_bf16 a[20:23], v[132:135], v[148:151], a[20:23]
  v_mfma_f32_16x16x32_bf16 a[24:27], v[132:135], v[152:155], a[24:27]
  v_mfma_f32_16x16x32_bf16 a[28:31], v[132:135], v[156:159], a[28:31]
  v_mfma_f32_16x16x32_bf16 a[32:35], v[136:139], v[144:147], a[32:35]
  v_mfma_f32_16x16x32_bf16 a[36:39], v[136:139], v[148:151], a[36:39]
  v_mfma_f32_16x16x32_bf16 a[40:43], v[136:139], v[152:155], a[40:43]
  v_mfma_f32_16x16x32_bf16 a[44:47], v[136:139], v[156:159], a[44:47]
  v_mfma_f32_16x16x32_bf16 a[48:51], v[140:143], v[144:147], a[48:51]
  v_mfma_f32_16x16x32_bf16 a[52:55], v[140:143], v[148:151], a[52:55]
  v_mfma_f32_16x16x32_bf16 a[56:59], v[140:143], v[152:155], a[56:59]
  v_mfma_f32_16x16x32_bf16 a[60:63], v[140:143], v[156:159], a[60:63]
  s_nop 2
  buffer_load_dwordx4 v[128:131], v1, s[4:7], s60 offen offset:3072
  buffer_load_dwordx4 v[132:135], v1, s[4:7], s61 offen offset:3072
  buffer_load_dwordx4 v[136:139], v1, s[4:7], s62 offen offset:3072
  buffer_load_dwordx4 v[140:143], v1, s[4:7], s63 offen offset:3072
  buffer_load_dwordx4 v[144:147], v1, s[4:7], s64 offen offset:3072
  buffer_load_dwordx4 v[148:151], v1, s[4:7], s65 offen offset:3072
  buffer_load_dwordx4 v[152:155], v1, s[4:7], s66 offen offset:3072
  buffer_load_dwordx4 v[156:159], v1, s[4:7], s67 offen offset:3072
  s_waitcnt vmcnt(40)
  v_mfma_f32_16x16x32_bf16 a[0:3], v[160:163], v[176:179], a[0:3]
  v_mfma_f32_16x16x32_bf16 a[4:7], v[160:163], v[180:183], a[4:7]
  v_mfma_f32_16x16x32_bf16 a[8:11], v[160:163], v[184:187], a[8:11]
  v_mfma_f32_16x16x32_bf16 a[12:15], v[160:163], v[188:191], a[12:15]
  v_mfma_f32_16x16x32_bf16 a[16:19], v[164:167], v[176:179], a[16:19]
  v_mfma_f32_16x16x32_bf16 a[20:23], v[164:167], v[180:183], a[20:23]
  v_mfma_f32_16x16x32_bf16 a[24:27], v[164:167], v[184:187], a[24:27]
  v_mfma_f32_16x16x32_bf16 a[28:31], v[164:167], v[188:191], a[28:31]
  v_mfma_f32_16x16x32_bf16 a[32:35], v[168:171], v[176:179], a[32:35]
  v_mfma_f32_16x16x32_bf16 a[36:39], v[168:171], v[180:183], a[36:39]
  v_mfma_f32_16x16x32_bf16 a[40:43], v[168:171], v[184:187], a[40:43]
  v_mfma_f32_16x16x32_bf16 a[44:47], v[168:171], v[188:191], a[44:47]
  v_mfma_f32_16x16x32_bf16 a[48:51], v[172:175], v[176:179], a[48:51]
  v_mfma_f32_16x16x32_bf16 a[52:55], v[172:175], v[180:183], a[52:55]
  v_mfma_f32_16x16x32_bf16 a[56:59], v[172:175], v[184:187], a[56:59]
  v_mfma_f32_16x16x32_bf16 a[60:63], v[172:175], v[188:191], a[60:63]
  s_nop 2
  v_add_u32 v2, 8192, v2
  buffer_load_dwordx4 v[160:163], v2, s[4:7], s60 offen offset:0
  buffer_load_dwordx4 v[164:167], v2, s[4:7], s61 offen offset:0
  buffer_load_dwordx4 v[168:171], v2, s[4:7], s62 offen offset:0
  buffer_load_dwordx4 v[172:175], v2, s[4:7], s63 offen offset:0
  buffer_load_dwordx4 v[176:179], v2, s[4:7], s64 offen offset:0
  buffer_load_dwordx4 v[180:183], v2, s[4:7], s65 offen offset:0
  buffer_load_dwordx4 v[184:187], v2, s[4:7], s66 offen offset:0
  buffer_load_dwordx4 v[188:191], v2, s[4:7], s67 offen offset:0
  s_waitcnt vmcnt(40)
  v_mfma_f32_16x16x32_bf16 a[0:3], v[192:195], v[208:211], a[0:3]
  v_mfma_f32_16x16x32_bf16 a[4:7], v[192:195], v[212:215], a[4:7]
  v_mfma_f32_16x16x32_bf16 a[8:11], v[192:195], v[216:219], a[8:11]
  v_mfma_f32_16x16x32_bf16 a[12:15], v[192:195], v[220:223], a[12:15]
  v_mfma_f32_16x16x32_bf16 a[16:19], v[196:199], v[208:211], a[16:19]
  v_mfma_f32_16x16x32_bf16 a[20:23], v[196:199], v[212:215], a[20:23]
  v_mfma_f32_16x16x32_bf16 a[24:27], v[196:199], v[216:219], a[24:27]
  v_mfma_f32_16x16x32_bf16 a[28:31], v[196:199], v[220:223], a[28:31]
  v_mfma_f32_16x16x32_bf16 a[32:35], v[200:203], v[208:211], a[32:35]
  v_mfma_f32_16x16x32_bf16 a[36:39], v[200:203], v[212:215], a[36:39]
  v_mfma_f32_16x16x32_bf16 a[40:43], v[200:203], v[216:219], a[40:43]
  v_mfma_f32_16x16x32_bf16 a[44:47], v[200:203], v[220:223], a[44:47]
  v_mfma_f32_16x16x32_bf16 a[48:51], v[204:207], v[208:211], a[48:51]
  v_mfma_f32_16x16x32_bf16 a[52:55], v[204:207], v[212:215], a[52:55]
  v_mfma_f32_16x16x32_bf16 a[56:59], v[204:207], v[216:219], a[56:59]
  v_mfma_f32_16x16x32_bf16 a[60:63], v[204:207], v[220:223], a[60:63]
  s_nop 2
  buffer_load_dwordx4 v[192:195], v2, s[4:7], s60 offen offset:1024
  buffer_load_dwordx4 v[196:199], v2, s[4:7], s61 offen offset:1024
  buffer_load_dwordx4 v[200:203], v2, s[4:7], s62 offen offset:1024
  buffer_load_dwordx4 v[204:207], v2, s[4:7], s63 offen offset:1024
  buffer_load_dwordx4 v[208:211], v2, s[4:7], s64 offen offset:1024
  buffer_load_dwordx4 v[212:215], v2, s[4:7], s65 offen offset:1024
  buffer_load_dwordx4 v[216:219], v2, s[4:7], s66 offen offset:1024
  buffer_load_dwordx4 v[220:223], v2, s[4:7], s67 offen offset:1024
  s_waitcnt vmcnt(40)
  v_mfma_f32_16x16x32_bf16 a[0:3], v[32:35], v[48:51], a[0:3]
  v_mfma_f32_16x16x32_bf16 a[4:7], v[32:35], v[52:55], a[4:7]
  v_mfma_f32_16x16x32_bf16 a[8:11], v[32:35], v[56:59], a[8:11]
  v_mfma_f32_16x16x32_bf16 a[12:15], v[32:35], v[60:63], a[12:15]
  v_mfma_f32_16x16x32_bf16 a[16:19], v[36:39], v[48:51], a[16:19]
  v_mfma_f32_16x16x32_bf16 a[20:23], v[36:39], v[52:55], a[20:23]
  v_mfma_f32_16x16x32_bf16 a[24:27], v[36:39], v[56:59], a[24:27]
  v_mfma_f32_16x16x32_bf16 a[28:31], v[36:39], v[60:63], a[28:31]
  v_mfma_f32_16x16x32_bf16 a[32:35], v[40:43], v[48:51], a[32:35]
  v_mfma_f32_16x16x32_bf16 a[36:39], v[40:43], v[52:55], a[36:39]
  v_mfma_f32_16x16x32_bf16 a[40:43], v[40:43], v[56:59], a[40:43]
  v_mfma_f32_16x16x32_bf16 a[44:47], v[40:43], v[60:63], a[44:47]
  v_mfma_f32_16x16x32_bf16 a[48:51], v[44:47], v[48:51], a[48:51]
  v_mfma_f32_16x16x32_bf16 a[52:55], v[44:47], v[52:55], a[52:55]
  v_mfma_f32_16x16x32_bf16 a[56:59], v[44:47], v[56:59], a[56:59]
  v_mfma_f32_16x16x32_bf16 a[60:63], v[44:47], v[60:63], a[60:63]
  s_nop 2
  buffer_load_dwordx4 v[32:35], v2, s[4:7], s60 offen offset:2048
  buffer_load_dwordx4 v[36:39], v2, s[4:7], s61 offen offset:2048
  buffer_load_dwordx4 v[40:43], v2, s[4:7], s62 offen offset:2048
  buffer_load_dwordx4 v[44:47], v2, s[4:7], s63 offen offset:2048
  buffer_load_dwordx4 v[48:51], v2, s[4:7], s64 offen offset:2048
  buffer_load_dwordx4 v[52:55], v2, s[4:7], s65 offen offset:2048
  buffer_load_dwordx4 v[56:59], v2, s[4:7], s66 offen offset:2048
  buffer_load_dwordx4 v[60:63], v2, s[4:7], s67 offen offset:2048
  s_waitcnt vmcnt(40)
  v_mfma_f32_16x16x32_bf16 a[0:3], v[64:67], v[80:83], a[0:3]
  v_mfma_f32_16x16x32_bf16 a[4:7], v[64:67], v[84:87], a[4:7]
  v_mfma_f32_16x16x32_bf16 a[8:11], v[64:67], v[88:91], a[8:11]
  v_mfma_f32_16x16x32_bf16 a[12:15], v[64:67], v[92:95], a[12:15]
  v_mfma_f32_16x16x32_bf16 a[16:19], v[68:71], v[80:83], a[16:19]
  v_mfma_f32_16x16x32_bf16 a[20:23], v[68:71], v[84:87], a[20:23]
  v_mfma_f32_16x16x32_bf16 a[24:27], v[68:71], v[88:91], a[24:27]
  v_mfma_f32_16x16x32_bf16 a[28:31], v[68:71], v[92:95], a[28:31]
  v_mfma_f32_16x16x32_bf16 a[32:35], v[72:75], v[80:83], a[32:35]
  v_mfma_f32_16x16x32_bf16 a[36:39], v[72:75], v[84:87], a[36:39]
  v_mfma_f32_16x16x32_bf16 a[40:43], v[72:75], v[88:91], a[40:43]
  v_mfma_f32_16x16x32_bf16 a[44:47], v[72:75], v[92:95], a[44:47]
  v_mfma_f32_16x16x32_bf16 a[48:51], v[76:79], v[80:83], a[48:51]
  v_mfma_f32_16x16x32_bf16 a[52:55], v[76:79], v[84:87], a[52:55]
  v_mfma_f32_16x16x32_bf16 a[56:59], v[76:79], v[88:91], a[56:59]
  v_mfma_f32_16x16x32_bf16 a[60:63], v[76:79], v[92:95], a[60:63]
  s_nop 2
  buffer_load_dwordx4 v[64:67], v2, s[4:7], s60 offen offset:3072
  buffer_load_dwordx4 v[68:71], v2, s[4:7], s61 offen offset:3072
  buffer_load_dwordx4 v[72:75], v2, s[4:7], s62 offen offset:3072
  buffer_load_dwordx4 v[76:79], v2, s[4:7], s63 offen offset:3072
  buffer_load_dwordx4 v[80:83], v2, s[4:7], s64 offen offset:3072
  buffer_load_dwordx4 v[84:87], v2, s[4:7], s65 offen offset:3072
  buffer_load_dwordx4 v[88:91], v2, s[4:7], s66 offen offset:3072
  buffer_load_dwordx4 v[92:95], v2, s[4:7], s67 offen offset:3072
  s_waitcnt vmcnt(40)
  v_mfma_f32_16x16x32_bf16 a[0:3], v[96:99], v[112:115], a[0:3]
  v_mfma_f32_16x16x32_bf16 a[4:7], v[96:99], v[116:119], a[4:7]
  v_mfma_f32_16x16x32_bf16 a[8:11], v[96:99], v[120:123], a[8:11]
  v_mfma_f32_16x16x32_bf16 a[12:15], v[96:99], v[124:127], a[12:15]
  v_mfma_f32_16x16x32_bf16 a[16:19], v[100:103], v[112:115], a[16:19]
  v_mfma_f32_16x16x32_bf16 a[20:23], v[100:103], v[116:119], a[20:23]
  v_mfma_f32_16x16x32_bf16 a[24:27], v[100:103], v[120:123], a[24:27]
  v_mfma_f32_16x16x32_bf16 a[28:31], v[100:103], v[124:127], a[28:31]
  v_mfma_f32_16x16x32_bf16 a[32:35], v[104:107], v[112:115], a[32:35]
  v_mfma_f32_16x16x32_bf16 a[36:39], v[104:107], v[116:119], a[36:39]
  v_mfma_f32_16x16x32_bf16 a[40:43], v[104:107], v[120:123], a[40:43]
  v_mfma_f32_16x16x32_bf16 a[44:47], v[104:107], v[124:127], a[44:47]
  v_mfma_f32_16x16x32_bf16 a[48:51], v[108:111], v[112:115], a[48:51]
  v_mfma_f32_16x16x32_bf16 a[52:55], v[108:111], v[116:119], a[52:55]
  v_mfma_f32_16x16x32_bf16 a[56:59], v[108:111], v[120:123], a[56:59]
  v_mfma_f32_16x16x32_bf16 a[60:63], v[108:111], v[124:127], a[60:63]
  s_waitcnt vmcnt(32)
  v_mfma_f32_16x16x32_bf16 a[0:3], v[128:131], v[144:147], a[0:3]
  v_mfma_f32_16x16x32_bf16 a[4:7], v[128:131], v[148:151], a[4:7]
  v_mfma_f32_16x16x32_bf16 a[8:11], v[128:131], v[152:155], a[8:11]
  v_mfma_f32_16x16x32_bf16 a[12:15], v[128:131], v[156:159], a[12:15]
  v_mfma_f32_16x16x32_bf16 a[16:19], v[132:135], v[144:147], a[16:19]
  v_mfma_f32_16x16x32_bf16 a[20:23], v[132:135], v[148:151], a[20:23]
  v_mfma_f32_16x16x32_bf16 a[24:27], v[132:135], v[152:155], a[24:27]
  v_mfma_f32_16x16x32_bf16 a[28:31], v[132:135], v[156:159], a[28:31]
  v_mfma_f32_16x16x32_bf16 a[32:35], v[136:139], v[144:147], a[32:35]
  v_mfma_f32_16x16x32_bf16 a[36:39], v[136:139], v[148:151], a[36:39]
  v_mfma_f32_16x16x32_bf16 a[40:43], v[136:139], v[152:155], a[40:43]
  v_mfma_f32_16x16x32_bf16 a[44:47], v[136:139], v[156:159], a[44:47]
  v_mfma_f32_16x16x32_bf16 a[48:51], v[140:143], v[144:147], a[48:51]
  v_mfma_f32_16x16x32_bf16 a[52:55], v[140:143], v[148:151], a[52:55]
  v_mfma_f32_16x16x32_bf16 a[56:59], v[140:143], v[152:155], a[56:59]
  v_mfma_f32_16x16x32_bf16 a[60:63], v[140:143], v[156:159], a[60:63]
  s_waitcnt vmcnt(24)
  v_mfma_f32_16x16x32_bf16 a[0:3], v[160:163], v[176:179], a[0:3]
  v_mfma_f32_16x16x32_bf16 a[4:7], v[160:163], v[180:183], a[4:7]
  v_mfma_f32_16x16x32_bf16 a[8:11], v[160:163], v[184:187], a[8:11]
  v_mfma_f32_16x16x32_bf16 a[12:15], v[160:163], v[188:191], a[12:15]
  v_mfma_f32_16x16x32_bf16 a[16:19], v[164:167], v[176:179], a[16:19]
  v_mfma_f32_16x16x32_bf16 a[20:23], v[164:167], v[180:183], a[20:23]
  v_mfma_f32_16x16x32_bf16 a[24:27], v[164:167], v[184:187], a[24:27]
  v_mfma_f32_16x16x32_bf16 a[28:31], v[164:167], v[188:191], a[28:31]
  v_mfma_f32_16x16x32_bf16 a[32:35], v[168:171], v[176:179], a[32:35]
  v_mfma_f32_16x16x32_bf16 a[36:39], v[168:171], v[180:183], a[36:39]
  v_mfma_f32_16x16x32_bf16 a[40:43], v[168:171], v[184:187], a[40:43]
  v_mfma_f32_16x16x32_bf16 a[44:47], v[168:171], v[188:191], a[44:47]
  v_mfma_f32_16x16x32_bf16 a[48:51], v[172:175], v[176:179], a[48:51]
  v_mfma_f32_16x16x32_bf16 a[52:55], v[172:175], v[180:183], a[52:55]
  v_mfma_f32_16x16x32_bf16 a[56:59], v[172:175], v[184:187], a[56:59]
  v_mfma_f32_16x16x32_bf16 a[60:63], v[172:175], v[188:191], a[60:63]
  s_waitcnt vmcnt(16)
  v_mfma_f32_16x16x32_bf16 a[0:3], v[192:195], v[208:211], a[0:3]
  v_mfma_f32_16x16x32_bf16 a[4:7], v[192:195], v[212:215], a[4:7]
  v_mfma_f32_16x16x32_bf16 a[8:11], v[192:195], v[216:219], a[8:11]
  v_mfma_f32_16x16x32_bf16 a[12:15], v[192:195], v[220:223], a[12:15]
  v_mfma_f32_16x16x32_bf16 a[16:19], v[196:199], v[208:211], a[16:19]
  v_mfma_f32_16x16x32_bf16 a[20:23], v[196:199], v[212:215], a[20:23]
  v_mfma_f32_16x16x32_bf16 a[24:27], v[196:199], v[216:219], a[24:27]
  v_mfma_f32_16x16x32_bf16 a[28:31], v[196:199], v[220:223], a[28:31]
  v_mfma_f32_16x16x32_bf16 a[32:35], v[200:203], v[208:211], a[32:35]
  v_mfma_f32_16x16x32_bf16 a[36:39], v[200:203], v[212:215], a[36:39]
  v_mfma_f32_16x16x32_bf16 a[40:43], v[200:203], v[216:219], a[40:43]
  v_mfma_f32_16x16x32_bf16 a[44:47], v[200:203], v[220:223], a[44:47]
  v_mfma_f32_16x16x32_bf16 a[48:51], v[204:207], v[208:211], a[48:51]
  v_mfma_f32_16x16x32_bf16 a[52:55], v[204:207], v[212:215], a[52:55]
  v_mfma_f32_16x16x32_bf16 a[56:59], v[204:207], v[216:219], a[56:59]
  v_mfma_f32_16x16x32_bf16 a[60:63], v[204:207], v[220:223], a[60:63]
  s_waitcnt vmcnt(8)
  v_mfma_f32_16x16x32_bf16 a[0:3], v[32:35], v[48:51], a[0:3]
  v_mfma_f32_16x16x32_bf16 a[4:7], v[32:35], v[52:55], a[4:7]
  v_mfma_f32_16x16x32_bf16 a[8:11], v[32:35], v[56:59], a[8:11]
  v_mfma_f32_16x16x32_bf16 a[12:15], v[32:35], v[60:63], a[12:15]
  v_mfma_f32_16x16x32_bf16 a[16:19], v[36:39], v[48:51], a[16:19]
  v_mfma_f32_16x16x32_bf16 a[20:23], v[36:39], v[52:55], a[20:23]
  v_mfma_f32_16x16x32_bf16 a[24:27], v[36:39], v[56:59], a[24:27]
  v_mfma_f32_16x16x32_bf16 a[28:31], v[36:39], v[60:63], a[28:31]
  v_mfma_f32_16x16x32_bf16 a[32:35], v[40:43], v[48:51], a[32:35]
  v_mfma_f32_16x16x32_bf16 a[36:39], v[40:43], v[52:55], a[36:39]
  v_mfma_f32_16x16x32_bf16 a[40:43], v[40:43], v[56:59], a[40:43]
  v_mfma_f32_16x16x32_bf16 a[44:47], v[40:43], v[60:63], a[44:47]
  v_mfma_f32_16x16x32_bf16 a[48:51], v[44:47], v[48:51], a[48:51]
  v_mfma_f32_16x16x32_bf16 a[52:55], v[44:47], v[52:55], a[52:55]
  v_mfma_f32_16x16x32_bf16 a[56:59], v[44:47], v[56:59], a[56:59]
  v_mfma_f32_16x16x32_bf16 a[60:63], v[44:47], v[60:63], a[60:63]
  s_waitcnt vmcnt(0)
  v_mfma_f32_16x16x32_bf16 a[0:3], v[64:67], v[80:83], a[0:3]
  v_mfma_f32_16x16x32_bf16 a[4:7], v[64:67], v[84:87], a[4:7]
  v_mfma_f32_16x16x32_bf16 a[8:11], v[64:67], v[88:91], a[8:11]
  v_mfma_f32_16x16x32_bf16 a[12:15], v[64:67], v[92:95], a[12:15]
  v_mfma_f32_16x16x32_bf16 a[16:19], v[68:71], v[80:83], a[16:19]
  v_mfma_f32_16x16x32_bf16 a[20:23], v[68:71], v[84:87], a[20:23]
  v_mfma_f32_16x16x32_bf16 a[24:27], v[68:71], v[88:91], a[24:27]
  v_mfma_f32_16x16x32_bf16 a[28:31], v[68:71], v[92:95], a[28:31]
  v_mfma_f32_16x16x32_bf16 a[32:35], v[72:75], v[80:83], a[32:35]
  v_mfma_f32_16x16x32_bf16 a[36:39], v[72:75], v[84:87], a[36:39]
  v_mfma_f32_16x16x32_bf16 a[40:43], v[72:75], v[88:91], a[40:43]
  v_mfma_f32_16x16x32_bf16 a[44:47], v[72:75], v[92:95], a[44:47]
  v_mfma_f32_16x16x32_bf16 a[48:51], v[76:79], v[80:83], a[48:51]
  v_mfma_f32_16x16x32_bf16 a[52:55], v[76:79], v[84:87], a[52:55]
  v_mfma_f32_16x16x32_bf16 a[56:59], v[76:79], v[88:91], a[56:59]
  v_mfma_f32_16x16x32_bf16 a[60:63], v[76:79], v[92:95], a[60:63]
  s_mul_i32 s40, s27, 16384
  s_add_u32 s40, s40, 0
  v_lshlrev_b32 v3, 4, v0
  v_add_u32 v4, s40, v3
  v_add_u32 v3, 0, v3
  v_add_u32 v6, 0x10000, v3
  s_nop 7
  ds_write_b128 v4, a[0:3] offset:0
  ds_write_b128 v4, a[4:7] offset:1024
  ds_write_b128 v4, a[8:11] offset:2048
  ds_write_b128 v4, a[12:15] offset:3072
  ds_write_b128 v4, a[16:19] offset:4096
  ds_write_b128 v4, a[20:23] offset:5120
  ds_write_b128 v4, a[24:27] offset:6144
  ds_write_b128 v4, a[28:31] offset:7168
  ds_write_b128 v4, a[32:35] offset:8192
  ds_write_b128 v4, a[36:39] offset:9216
  ds_write_b128 v4, a[40:43] offset:10240
  ds_write_b128 v4, a[44:47] offset:11264
  ds_write_b128 v4, a[48:51] offset:12288
  ds_write_b128 v4, a[52:55] offset:13312
  ds_write_b128 v4, a[56:59] offset:14336
  ds_write_b128 v4, a[60:63] offset:15360
  s_load_dwordx2 s[52:53], s[0:1], 0
  s_load_dwordx2 s[54:55], s[0:1], 88
  v_mov_b32 v5, 0
  v_bfe_u32 v255, v0, 0, 4
  v_lshl_add_u32 v5, v255, 11, v5
  v_bfe_u32 v255, v0, 4, 2
  v_lshl_add_u32 v5, v255, 4, v5
  s_waitcnt lgkmcnt(0)
  s_mov_b32 s8, s52
  s_mov_b32 s9, s53
  s_mov_b32 s10, 0x400000
  s_mov_b32 s11, 0x20000
  s_mov_b32 s36, s54
  s_mov_b32 s37, s55
  s_mov_b32 s38, 0x400000
  s_mov_b32 s39, 0x20000
  s_lshl_b32 s43, s28, 15
  s_lshl_b32 s44, s29, 5
  s_add_u32 s43, s43, s44
  s_barrier
  s_cmp_eq_u32 s27, 0
  s_cbranch_scc0 L_wo_111_n0
  s_add_u32 s44, s43, 0
  buffer_load_dwordx4 v[16:19], v5, s[8:11], s44 offen
  s_add_u32 s48, s44, 4194304
  buffer_load_dwordx4 v[20:23], v5, s[4:7], s48 offen
  s_add_u32 s45, s43, 64
  buffer_load_dwordx4 v[24:27], v5, s[8:11], s45 offen
  s_add_u32 s48, s45, 4194304
  buffer_load_dwordx4 v[28:31], v5, s[4:7], s48 offen
  ds_read_b128 v[64:67], v3 offset:0
  ds_read_b128 v[68:71], v3 offset:16384
  ds_read_b128 v[72:75], v3 offset:32768
  ds_read_b128 v[76:79], v3 offset:49152
  ds_read_b128 v[80:83], v3 offset:4096
  ds_read_b128 v[84:87], v3 offset:20480
  ds_read_b128 v[88:91], v3 offset:36864
  ds_read_b128 v[92:95], v3 offset:53248
  s_waitcnt lgkmcnt(0)
  v_pk_add_f32 v[64:65], v[64:65], v[68:69]
  v_pk_add_f32 v[66:67], v[66:67], v[70:71]
  v_pk_add_f32 v[72:73], v[72:73], v[76:77]
  v_pk_add_f32 v[74:75], v[74:75], v[78:79]
  v_pk_add_f32 v[64:65], v[64:65], v[72:73]
  v_pk_add_f32 v[66:67], v[66:67], v[74:75]
  v_pk_add_f32 v[80:81], v[80:81], v[84:85]
  v_pk_add_f32 v[82:83], v[82:83], v[86:87]
  v_pk_add_f32 v[88:89], v[88:89], v[92:93]
  v_pk_add_f32 v[90:91], v[90:91], v[94:95]
  v_pk_add_f32 v[80:81], v[80:81], v[88:89]
  v_pk_add_f32 v[82:83], v[82:83], v[90:91]
  s_waitcnt vmcnt(2)
  v_lshlrev_b32 v100, 16, v16
  v_and_b32 v101, 0xffff0000, v16
  v_lshlrev_b32 v102, 16, v20
  v_and_b32 v103, 0xffff0000, v20
  v_fmac_f32 v100, v64, v102
  v_fmac_f32 v101, v65, v103
  v_cvt_pk_bf16_f32 v104, v100, v101
  v_lshlrev_b32 v100, 16, v17
  v_and_b32 v101, 0xffff0000, v17
  v_lshlrev_b32 v102, 16, v21
  v_and_b32 v103, 0xffff0000, v21
  v_fmac_f32 v100, v66, v102
  v_fmac_f32 v101, v67, v103
  v_cvt_pk_bf16_f32 v105, v100, v101
  v_lshlrev_b32 v100, 16, v18
  v_and_b32 v101, 0xffff0000, v18
  v_lshlrev_b32 v102, 16, v22
  v_and_b32 v103, 0xffff0000, v22
  v_fmac_f32 v100, v80, v102
  v_fmac_f32 v101, v81, v103
  v_cvt_pk_bf16_f32 v106, v100, v101
  v_lshlrev_b32 v100, 16, v19
  v_and_b32 v101, 0xffff0000, v19
  v_lshlrev_b32 v102, 16, v23
  v_and_b32 v103, 0xffff0000, v23
  v_fmac_f32 v100, v82, v102
  v_fmac_f32 v101, v83, v103
  v_cvt_pk_bf16_f32 v107, v100, v101
  buffer_store_dwordx4 v[104:107], v5, s[36:39], s44 offen
  s_nop 1
  ds_read_b128 v[64:67], v3 offset:8192
  ds_read_b128 v[68:71], v3 offset:24576
  ds_read_b128 v[72:75], v3 offset:40960
  ds_read_b128 v[76:79], v3 offset:57344
  ds_read_b128 v[80:83], v3 offset:12288
  ds_read_b128 v[84:87], v3 offset:28672
  ds_read_b128 v[88:91], v3 offset:45056
  ds_read_b128 v[92:95], v3 offset:61440
  s_waitcnt lgkmcnt(0)
  v_pk_add_f32 v[64:65], v[64:65], v[68:69]
  v_pk_add_f32 v[66:67], v[66:67], v[70:71]
  v_pk_add_f32 v[72:73], v[72:73], v[76:77]
  v_pk_add_f32 v[74:75], v[74:75], v[78:79]
  v_pk_add_f32 v[64:65], v[64:65], v[72:73]
  v_pk_add_f32 v[66:67], v[66:67], v[74:75]
  v_pk_add_f32 v[80:81], v[80:81], v[84:85]
  v_pk_add_f32 v[82:83], v[82:83], v[86:87]
  v_pk_add_f32 v[88:89], v[88:89], v[92:93]
  v_pk_add_f32 v[90:91], v[90:91], v[94:95]
  v_pk_add_f32 v[80:81], v[80:81], v[88:89]
  v_pk_add_f32 v[82:83], v[82:83], v[90:91]
  s_waitcnt vmcnt(1)
  v_lshlrev_b32 v100, 16, v24
  v_and_b32 v101, 0xffff0000, v24
  v_lshlrev_b32 v102, 16, v28
  v_and_b32 v103, 0xffff0000, v28
  v_fmac_f32 v100, v64, v102
  v_fmac_f32 v101, v65, v103
  v_cvt_pk_bf16_f32 v104, v100, v101
  v_lshlrev_b32 v100, 16, v25
  v_and_b32 v101, 0xffff0000, v25
  v_lshlrev_b32 v102, 16, v29
  v_and_b32 v103, 0xffff0000, v29
  v_fmac_f32 v100, v66, v102
  v_fmac_f32 v101, v67, v103
  v_cvt_pk_bf16_f32 v105, v100, v101
  v_lshlrev_b32 v100, 16, v26
  v_and_b32 v101, 0xffff0000, v26
  v_lshlrev_b32 v102, 16, v30
  v_and_b32 v103, 0xffff0000, v30
  v_fmac_f32 v100, v80, v102
  v_fmac_f32 v101, v81, v103
  v_cvt_pk_bf16_f32 v106, v100, v101
  v_lshlrev_b32 v100, 16, v27
  v_and_b32 v101, 0xffff0000, v27
  v_lshlrev_b32 v102, 16, v31
  v_and_b32 v103, 0xffff0000, v31
  v_fmac_f32 v100, v82, v102
  v_fmac_f32 v101, v83, v103
  v_cvt_pk_bf16_f32 v107, v100, v101
  buffer_store_dwordx4 v[104:107], v5, s[36:39], s45 offen
  s_nop 1
  s_branch L_wo_111_done
L_wo_111_n0:
  s_cmp_eq_u32 s27, 1
  s_cbranch_scc0 L_wo_111_n1
  s_add_u32 s44, s43, 32768
  buffer_load_dwordx4 v[16:19], v5, s[8:11], s44 offen
  s_add_u32 s48, s44, 4194304
  buffer_load_dwordx4 v[20:23], v5, s[4:7], s48 offen
  s_add_u32 s45, s43, 32832
  buffer_load_dwordx4 v[24:27], v5, s[8:11], s45 offen
  s_add_u32 s48, s45, 4194304
  buffer_load_dwordx4 v[28:31], v5, s[4:7], s48 offen
  ds_read_b128 v[64:67], v3 offset:1024
  ds_read_b128 v[68:71], v3 offset:17408
  ds_read_b128 v[72:75], v3 offset:33792
  ds_read_b128 v[76:79], v3 offset:50176
  ds_read_b128 v[80:83], v3 offset:5120
  ds_read_b128 v[84:87], v3 offset:21504
  ds_read_b128 v[88:91], v3 offset:37888
  ds_read_b128 v[92:95], v3 offset:54272
  s_waitcnt lgkmcnt(0)
  v_pk_add_f32 v[64:65], v[64:65], v[68:69]
  v_pk_add_f32 v[66:67], v[66:67], v[70:71]
  v_pk_add_f32 v[72:73], v[72:73], v[76:77]
  v_pk_add_f32 v[74:75], v[74:75], v[78:79]
  v_pk_add_f32 v[64:65], v[64:65], v[72:73]
  v_pk_add_f32 v[66:67], v[66:67], v[74:75]
  v_pk_add_f32 v[80:81], v[80:81], v[84:85]
  v_pk_add_f32 v[82:83], v[82:83], v[86:87]
  v_pk_add_f32 v[88:89], v[88:89], v[92:93]
  v_pk_add_f32 v[90:91], v[90:91], v[94:95]
  v_pk_add_f32 v[80:81], v[80:81], v[88:89]
  v_pk_add_f32 v[82:83], v[82:83], v[90:91]
  s_waitcnt vmcnt(2)
  v_lshlrev_b32 v100, 16, v16
  v_and_b32 v101, 0xffff0000, v16
  v_lshlrev_b32 v102, 16, v20
  v_and_b32 v103, 0xffff0000, v20
  v_fmac_f32 v100, v64, v102
  v_fmac_f32 v101, v65, v103
  v_cvt_pk_bf16_f32 v104, v100, v101
  v_lshlrev_b32 v100, 16, v17
  v_and_b32 v101, 0xffff0000, v17
  v_lshlrev_b32 v102, 16, v21
  v_and_b32 v103, 0xffff0000, v21
  v_fmac_f32 v100, v66, v102
  v_fmac_f32 v101, v67, v103
  v_cvt_pk_bf16_f32 v105, v100, v101
  v_lshlrev_b32 v100, 16, v18
  v_and_b32 v101, 0xffff0000, v18
  v_lshlrev_b32 v102, 16, v22
  v_and_b32 v103, 0xffff0000, v22
  v_fmac_f32 v100, v80, v102
  v_fmac_f32 v101, v81, v103
  v_cvt_pk_bf16_f32 v106, v100, v101
  v_lshlrev_b32 v100, 16, v19
  v_and_b32 v101, 0xffff0000, v19
  v_lshlrev_b32 v102, 16, v23
  v_and_b32 v103, 0xffff0000, v23
  v_fmac_f32 v100, v82, v102
  v_fmac_f32 v101, v83, v103
  v_cvt_pk_bf16_f32 v107, v100, v101
  buffer_store_dwordx4 v[104:107], v5, s[36:39], s44 offen
  s_nop 1
  ds_read_b128 v[64:67], v3 offset:9216
  ds_read_b128 v[68:71], v3 offset:25600
  ds_read_b128 v[72:75], v3 offset:41984
  ds_read_b128 v[76:79], v3 offset:58368
  ds_read_b128 v[80:83], v3 offset:13312
  ds_read_b128 v[84:87], v3 offset:29696
  ds_read_b128 v[88:91], v3 offset:46080
  ds_read_b128 v[92:95], v3 offset:62464
  s_waitcnt lgkmcnt(0)
  v_pk_add_f32 v[64:65], v[64:65], v[68:69]
  v_pk_add_f32 v[66:67], v[66:67], v[70:71]
  v_pk_add_f32 v[72:73], v[72:73], v[76:77]
  v_pk_add_f32 v[74:75], v[74:75], v[78:79]
  v_pk_add_f32 v[64:65], v[64:65], v[72:73]
  v_pk_add_f32 v[66:67], v[66:67], v[74:75]
  v_pk_add_f32 v[80:81], v[80:81], v[84:85]
  v_pk_add_f32 v[82:83], v[82:83], v[86:87]
  v_pk_add_f32 v[88:89], v[88:89], v[92:93]
  v_pk_add_f32 v[90:91], v[90:91], v[94:95]
  v_pk_add_f32 v[80:81], v[80:81], v[88:89]
  v_pk_add_f32 v[82:83], v[82:83], v[90:91]
  s_waitcnt vmcnt(1)
  v_lshlrev_b32 v100, 16, v24
  v_and_b32 v101, 0xffff0000, v24
  v_lshlrev_b32 v102, 16, v28
  v_and_b32 v103, 0xffff0000, v28
  v_fmac_f32 v100, v64, v102
  v_fmac_f32 v101, v65, v103
  v_cvt_pk_bf16_f32 v104, v100, v101
  v_lshlrev_b32 v100, 16, v25
  v_and_b32 v101, 0xffff0000, v25
  v_lshlrev_b32 v102, 16, v29
  v_and_b32 v103, 0xffff0000, v29
  v_fmac_f32 v100, v66, v102
  v_fmac_f32 v101, v67, v103
  v_cvt_pk_bf16_f32 v105, v100, v101
  v_lshlrev_b32 v100, 16, v26
  v_and_b32 v101, 0xffff0000, v26
  v_lshlrev_b32 v102, 16, v30
  v_and_b32 v103, 0xffff0000, v30
  v_fmac_f32 v100, v80, v102
  v_fmac_f32 v101, v81, v103
  v_cvt_pk_bf16_f32 v106, v100, v101
  v_lshlrev_b32 v100, 16, v27
  v_and_b32 v101, 0xffff0000, v27
  v_lshlrev_b32 v102, 16, v31
  v_and_b32 v103, 0xffff0000, v31
  v_fmac_f32 v100, v82, v102
  v_fmac_f32 v101, v83, v103
  v_cvt_pk_bf16_f32 v107, v100, v101
  buffer_store_dwordx4 v[104:107], v5, s[36:39], s45 offen
  s_nop 1
  s_branch L_wo_111_done
L_wo_111_n1:
  s_cmp_eq_u32 s27, 2
  s_cbranch_scc0 L_wo_111_n2
  s_add_u32 s44, s43, 65536
  buffer_load_dwordx4 v[16:19], v5, s[8:11], s44 offen
  s_add_u32 s48, s44, 4194304
  buffer_load_dwordx4 v[20:23], v5, s[4:7], s48 offen
  s_add_u32 s45, s43, 65600
  buffer_load_dwordx4 v[24:27], v5, s[8:11], s45 offen
  s_add_u32 s48, s45, 4194304
  buffer_load_dwordx4 v[28:31], v5, s[4:7], s48 offen
  ds_read_b128 v[64:67], v3 offset:2048
  ds_read_b128 v[68:71], v3 offset:18432
  ds_read_b128 v[72:75], v3 offset:34816
  ds_read_b128 v[76:79], v3 offset:51200
  ds_read_b128 v[80:83], v3 offset:6144
  ds_read_b128 v[84:87], v3 offset:22528
  ds_read_b128 v[88:91], v3 offset:38912
  ds_read_b128 v[92:95], v3 offset:55296
  s_waitcnt lgkmcnt(0)
  v_pk_add_f32 v[64:65], v[64:65], v[68:69]
  v_pk_add_f32 v[66:67], v[66:67], v[70:71]
  v_pk_add_f32 v[72:73], v[72:73], v[76:77]
  v_pk_add_f32 v[74:75], v[74:75], v[78:79]
  v_pk_add_f32 v[64:65], v[64:65], v[72:73]
  v_pk_add_f32 v[66:67], v[66:67], v[74:75]
  v_pk_add_f32 v[80:81], v[80:81], v[84:85]
  v_pk_add_f32 v[82:83], v[82:83], v[86:87]
  v_pk_add_f32 v[88:89], v[88:89], v[92:93]
  v_pk_add_f32 v[90:91], v[90:91], v[94:95]
  v_pk_add_f32 v[80:81], v[80:81], v[88:89]
  v_pk_add_f32 v[82:83], v[82:83], v[90:91]
  s_waitcnt vmcnt(2)
  v_lshlrev_b32 v100, 16, v16
  v_and_b32 v101, 0xffff0000, v16
  v_lshlrev_b32 v102, 16, v20
  v_and_b32 v103, 0xffff0000, v20
  v_fmac_f32 v100, v64, v102
  v_fmac_f32 v101, v65, v103
  v_cvt_pk_bf16_f32 v104, v100, v101
  v_lshlrev_b32 v100, 16, v17
  v_and_b32 v101, 0xffff0000, v17
  v_lshlrev_b32 v102, 16, v21
  v_and_b32 v103, 0xffff0000, v21
  v_fmac_f32 v100, v66, v102
  v_fmac_f32 v101, v67, v103
  v_cvt_pk_bf16_f32 v105, v100, v101
  v_lshlrev_b32 v100, 16, v18
  v_and_b32 v101, 0xffff0000, v18
  v_lshlrev_b32 v102, 16, v22
  v_and_b32 v103, 0xffff0000, v22
  v_fmac_f32 v100, v80, v102
  v_fmac_f32 v101, v81, v103
  v_cvt_pk_bf16_f32 v106, v100, v101
  v_lshlrev_b32 v100, 16, v19
  v_and_b32 v101, 0xffff0000, v19
  v_lshlrev_b32 v102, 16, v23
  v_and_b32 v103, 0xffff0000, v23
  v_fmac_f32 v100, v82, v102
  v_fmac_f32 v101, v83, v103
  v_cvt_pk_bf16_f32 v107, v100, v101
  buffer_store_dwordx4 v[104:107], v5, s[36:39], s44 offen
  s_nop 1
  ds_read_b128 v[64:67], v3 offset:10240
  ds_read_b128 v[68:71], v3 offset:26624
  ds_read_b128 v[72:75], v3 offset:43008
  ds_read_b128 v[76:79], v3 offset:59392
  ds_read_b128 v[80:83], v3 offset:14336
  ds_read_b128 v[84:87], v3 offset:30720
  ds_read_b128 v[88:91], v3 offset:47104
  ds_read_b128 v[92:95], v3 offset:63488
  s_waitcnt lgkmcnt(0)
  v_pk_add_f32 v[64:65], v[64:65], v[68:69]
  v_pk_add_f32 v[66:67], v[66:67], v[70:71]
  v_pk_add_f32 v[72:73], v[72:73], v[76:77]
  v_pk_add_f32 v[74:75], v[74:75], v[78:79]
  v_pk_add_f32 v[64:65], v[64:65], v[72:73]
  v_pk_add_f32 v[66:67], v[66:67], v[74:75]
  v_pk_add_f32 v[80:81], v[80:81], v[84:85]
  v_pk_add_f32 v[82:83], v[82:83], v[86:87]
  v_pk_add_f32 v[88:89], v[88:89], v[92:93]
  v_pk_add_f32 v[90:91], v[90:91], v[94:95]
  v_pk_add_f32 v[80:81], v[80:81], v[88:89]
  v_pk_add_f32 v[82:83], v[82:83], v[90:91]
  s_waitcnt vmcnt(1)
  v_lshlrev_b32 v100, 16, v24
  v_and_b32 v101, 0xffff0000, v24
  v_lshlrev_b32 v102, 16, v28
  v_and_b32 v103, 0xffff0000, v28
  v_fmac_f32 v100, v64, v102
  v_fmac_f32 v101, v65, v103
  v_cvt_pk_bf16_f32 v104, v100, v101
  v_lshlrev_b32 v100, 16, v25
  v_and_b32 v101, 0xffff0000, v25
  v_lshlrev_b32 v102, 16, v29
  v_and_b32 v103, 0xffff0000, v29
  v_fmac_f32 v100, v66, v102
  v_fmac_f32 v101, v67, v103
  v_cvt_pk_bf16_f32 v105, v100, v101
  v_lshlrev_b32 v100, 16, v26
  v_and_b32 v101, 0xffff0000, v26
  v_lshlrev_b32 v102, 16, v30
  v_and_b32 v103, 0xffff0000, v30
  v_fmac_f32 v100, v80, v102
  v_fmac_f32 v101, v81, v103
  v_cvt_pk_bf16_f32 v106, v100, v101
  v_lshlrev_b32 v100, 16, v27
  v_and_b32 v101, 0xffff0000, v27
  v_lshlrev_b32 v102, 16, v31
  v_and_b32 v103, 0xffff0000, v31
  v_fmac_f32 v100, v82, v102
  v_fmac_f32 v101, v83, v103
  v_cvt_pk_bf16_f32 v107, v100, v101
  buffer_store_dwordx4 v[104:107], v5, s[36:39], s45 offen
  s_nop 1
  s_branch L_wo_111_done
L_wo_111_n2:
  s_cmp_eq_u32 s27, 3
  s_cbranch_scc0 L_wo_111_n3
  s_add_u32 s44, s43, 98304
  buffer_load_dwordx4 v[16:19], v5, s[8:11], s44 offen
  s_add_u32 s48, s44, 4194304
  buffer_load_dwordx4 v[20:23], v5, s[4:7], s48 offen
  s_add_u32 s45, s43, 98368
  buffer_load_dwordx4 v[24:27], v5, s[8:11], s45 offen
  s_add_u32 s48, s45, 4194304
  buffer_load_dwordx4 v[28:31], v5, s[4:7], s48 offen
  ds_read_b128 v[64:67], v3 offset:3072
  ds_read_b128 v[68:71], v3 offset:19456
  ds_read_b128 v[72:75], v3 offset:35840
  ds_read_b128 v[76:79], v3 offset:52224
  ds_read_b128 v[80:83], v3 offset:7168
  ds_read_b128 v[84:87], v3 offset:23552
  ds_read_b128 v[88:91], v3 offset:39936
  ds_read_b128 v[92:95], v3 offset:56320
  s_waitcnt lgkmcnt(0)
  v_pk_add_f32 v[64:65], v[64:65], v[68:69]
  v_pk_add_f32 v[66:67], v[66:67], v[70:71]
  v_pk_add_f32 v[72:73], v[72:73], v[76:77]
  v_pk_add_f32 v[74:75], v[74:75], v[78:79]
  v_pk_add_f32 v[64:65], v[64:65], v[72:73]
  v_pk_add_f32 v[66:67], v[66:67], v[74:75]
  v_pk_add_f32 v[80:81], v[80:81], v[84:85]
  v_pk_add_f32 v[82:83], v[82:83], v[86:87]
  v_pk_add_f32 v[88:89], v[88:89], v[92:93]
  v_pk_add_f32 v[90:91], v[90:91], v[94:95]
  v_pk_add_f32 v[80:81], v[80:81], v[88:89]
  v_pk_add_f32 v[82:83], v[82:83], v[90:91]
  s_waitcnt vmcnt(2)
  v_lshlrev_b32 v100, 16, v16
  v_and_b32 v101, 0xffff0000, v16
  v_lshlrev_b32 v102, 16, v20
  v_and_b32 v103, 0xffff0000, v20
  v_fmac_f32 v100, v64, v102
  v_fmac_f32 v101, v65, v103
  v_cvt_pk_bf16_f32 v104, v100, v101
  v_lshlrev_b32 v100, 16, v17
  v_and_b32 v101, 0xffff0000, v17
  v_lshlrev_b32 v102, 16, v21
  v_and_b32 v103, 0xffff0000, v21
  v_fmac_f32 v100, v66, v102
  v_fmac_f32 v101, v67, v103
  v_cvt_pk_bf16_f32 v105, v100, v101
  v_lshlrev_b32 v100, 16, v18
  v_and_b32 v101, 0xffff0000, v18
  v_lshlrev_b32 v102, 16, v22
  v_and_b32 v103, 0xffff0000, v22
  v_fmac_f32 v100, v80, v102
  v_fmac_f32 v101, v81, v103
  v_cvt_pk_bf16_f32 v106, v100, v101
  v_lshlrev_b32 v100, 16, v19
  v_and_b32 v101, 0xffff0000, v19
  v_lshlrev_b32 v102, 16, v23
  v_and_b32 v103, 0xffff0000, v23
  v_fmac_f32 v100, v82, v102
  v_fmac_f32 v101, v83, v103
  v_cvt_pk_bf16_f32 v107, v100, v101
  buffer_store_dwordx4 v[104:107], v5, s[36:39], s44 offen
  s_nop 1
  ds_read_b128 v[64:67], v3 offset:11264
  ds_read_b128 v[68:71], v3 offset:27648
  ds_read_b128 v[72:75], v3 offset:44032
  ds_read_b128 v[76:79], v3 offset:60416
  ds_read_b128 v[80:83], v3 offset:15360
  ds_read_b128 v[84:87], v3 offset:31744
  ds_read_b128 v[88:91], v3 offset:48128
  ds_read_b128 v[92:95], v3 offset:64512
  s_waitcnt lgkmcnt(0)
  v_pk_add_f32 v[64:65], v[64:65], v[68:69]
  v_pk_add_f32 v[66:67], v[66:67], v[70:71]
  v_pk_add_f32 v[72:73], v[72:73], v[76:77]
  v_pk_add_f32 v[74:75], v[74:75], v[78:79]
  v_pk_add_f32 v[64:65], v[64:65], v[72:73]
  v_pk_add_f32 v[66:67], v[66:67], v[74:75]
  v_pk_add_f32 v[80:81], v[80:81], v[84:85]
  v_pk_add_f32 v[82:83], v[82:83], v[86:87]
  v_pk_add_f32 v[88:89], v[88:89], v[92:93]
  v_pk_add_f32 v[90:91], v[90:91], v[94:95]
  v_pk_add_f32 v[80:81], v[80:81], v[88:89]
  v_pk_add_f32 v[82:83], v[82:83], v[90:91]
  s_waitcnt vmcnt(1)
  v_lshlrev_b32 v100, 16, v24
  v_and_b32 v101, 0xffff0000, v24
  v_lshlrev_b32 v102, 16, v28
  v_and_b32 v103, 0xffff0000, v28
  v_fmac_f32 v100, v64, v102
  v_fmac_f32 v101, v65, v103
  v_cvt_pk_bf16_f32 v104, v100, v101
  v_lshlrev_b32 v100, 16, v25
  v_and_b32 v101, 0xffff0000, v25
  v_lshlrev_b32 v102, 16, v29
  v_and_b32 v103, 0xffff0000, v29
  v_fmac_f32 v100, v66, v102
  v_fmac_f32 v101, v67, v103
  v_cvt_pk_bf16_f32 v105, v100, v101
  v_lshlrev_b32 v100, 16, v26
  v_and_b32 v101, 0xffff0000, v26
  v_lshlrev_b32 v102, 16, v30
  v_and_b32 v103, 0xffff0000, v30
  v_fmac_f32 v100, v80, v102
  v_fmac_f32 v101, v81, v103
  v_cvt_pk_bf16_f32 v106, v100, v101
  v_lshlrev_b32 v100, 16, v27
  v_and_b32 v101, 0xffff0000, v27
  v_lshlrev_b32 v102, 16, v31
  v_and_b32 v103, 0xffff0000, v31
  v_fmac_f32 v100, v82, v102
  v_fmac_f32 v101, v83, v103
  v_cvt_pk_bf16_f32 v107, v100, v101
  buffer_store_dwordx4 v[104:107], v5, s[36:39], s45 offen
  s_nop 1
  s_branch L_wo_111_done
L_wo_111_n3:
L_wo_111_done:
  s_branch L_next
T_W31:
  s_sub_u32 s98, s98, 56
  s_lshr_b32 s28, s98, 4
  s_add_u32 s28, s28, 28
  s_lshr_b32 s30, s28, 2
  s_cmp_lg_u32 s27, 0
  s_cbranch_scc1 L_wm_112_w
  s_mov_b32 s41, 117444608
  v_writelane_b32 v1, s41, 0
  v_writelane_b32 v2, 16, 0
  s_lshl_b32 s41, s30, 7
  s_add_u32 s41, s41, 117443584
  v_writelane_b32 v1, s41, 1
  v_writelane_b32 v2, 4, 1
  s_mov_b32 s99, 100000
  s_mov_b64 exec, 3
L_wm_112_p:
  buffer_load_dword v3, v1, s[4:7], 0 offen sc1
  s_waitcnt vmcnt(0)
  v_cmp_gt_u32 vcc, v2, v3
  s_cbranch_vccz L_wm_112_x
  s_sub_u32 s99, s99, 1
  s_cbranch_scc0 L_wm_112_p
  v_mov_b32 v1, 236
  v_mov_b32 v2, 1
  s_mov_b64 exec, 1
  global_atomic_add v1, v2, s[90:91] sc1
L_wm_112_x:
  s_mov_b64 exec, -1
L_wm_112_w:
  s_barrier
  s_mov_b32 s30, s28
  s_bfe_u32 s40, s98, 0x10003
  s_lshl_b32 s40, s40, 1
  s_lshl_b32 s28, s28, 2
  s_add_u32 s28, s28, s40
  s_and_b32 s40, s98, 7
  s_lshl_b32 s29, s96, 3
  s_add_u32 s29, s29, s40
  s_lshl_b32 s29, s29, 1
  s_lshl_b32 s40, s27, 15
  s_lshl_b32 s43, s29, 17
  s_add_u32 s43, s43, s40
  s_add_u32 s60, s43, 109051904
  s_add_u32 s61, s60, 131072
  s_lshl_b32 s43, s28, 17
  s_add_u32 s43, s43, s40
  s_add_u32 s62, s43, 58720256
  s_add_u32 s63, s62, 131072
  v_lshlrev_b32 v1, 4, v0
  v_add_u32 v2, 4096, v1
  v_add_u32 v3, 8192, v1
  v_add_u32 v4, 12288, v1
  v_add_u32 v5, 16384, v1
  v_add_u32 v6, 20480, v1
  v_add_u32 v7, 24576, v1
  v_add_u32 v8, 28672, v1
  s_load_dwordx2 s[52:53], s[0:1], 0
  s_load_dwordx2 s[54:55], s[0:1], 88
  buffer_load_dwordx4 a[0:3], v1, s[4:7], s60 offen offset:0
  buffer_load_dwordx4 a[4:7], v1, s[4:7], s61 offen offset:0
  buffer_load_dwordx4 a[8:11], v1, s[4:7], s60 offen offset:1024
  buffer_load_dwordx4 a[12:15], v1, s[4:7], s61 offen offset:1024
  buffer_load_dwordx4 a[16:19], v1, s[4:7], s60 offen offset:2048
  buffer_load_dwordx4 a[20:23], v1, s[4:7], s61 offen offset:2048
  buffer_load_dwordx4 a[24:27], v1, s[4:7], s60 offen offset:3072
  buffer_load_dwordx4 a[28:31], v1, s[4:7], s61 offen offset:3072
  buffer_load_dwordx4 a[32:35], v2, s[4:7], s60 offen offset:0
  buffer_load_dwordx4 a[36:39], v2, s[4:7], s61 offen offset:0
  buffer_load_dwordx4 a[40:43], v2, s[4:7], s60 offen offset:1024
  buffer_load_dwordx4 a[44:47], v2, s[4:7], s61 offen offset:1024
  buffer_load_dwordx4 a[48:51], v2, s[4:7], s60 offen offset:2048
  buffer_load_dwordx4 a[52:55], v2, s[4:7], s61 offen offset:2048
  buffer_load_dwordx4 a[56:59], v2, s[4:7], s60 offen offset:3072
  buffer_load_dwordx4 a[60:63], v2, s[4:7], s61 offen offset:3072
  buffer_load_dwordx4 a[64:67], v3, s[4:7], s60 offen offset:0
  buffer_load_dwordx4 a[68:71], v3, s[4:7], s61 offen offset:0
  buffer_load_dwordx4 a[72:75], v3, s[4:7], s60 offen offset:1024
  buffer_load_dwordx4 a[76:79], v3, s[4:7], s61 offen offset:1024
  buffer_load_dwordx4 a[80:83], v3, s[4:7], s60 offen offset:2048
  buffer_load_dwordx4 a[84:87], v3, s[4:7], s61 offen offset:2048
  buffer_load_dwordx4 a[88:91], v3, s[4:7], s60 offen offset:3072
  buffer_load_dwordx4 a[92:95], v3, s[4:7], s61 offen offset:3072
  buffer_load_dwordx4 a[96:99], v4, s[4:7], s60 offen offset:0
  buffer_load_dwordx4 a[100:103], v4, s[4:7], s61 offen offset:0
  buffer_load_dwordx4 a[104:107], v4, s[4:7], s60 offen offset:1024
  buffer_load_dwordx4 a[108:111], v4, s[4:7], s61 offen offset:1024
  buffer_load_dwordx4 a[112:115], v4, s[4:7], s60 offen offset:2048
  buffer_load_dwordx4 a[116:119], v4, s[4:7], s61 offen offset:2048
  buffer_load_dwordx4 a[120:123], v4, s[4:7], s60 offen offset:3072
  buffer_load_dwordx4 a[124:127], v4, s[4:7], s61 offen offset:3072
  buffer_load_dwordx4 a[128:131], v5, s[4:7], s60 offen offset:0
  buffer_load_dwordx4 a[132:135], v5, s[4:7], s61 offen offset:0
  buffer_load_dwordx4 a[136:139], v5, s[4:7], s60 offen offset:1024
  buffer_load_dwordx4 a[140:143], v5, s[4:7], s61 offen offset:1024
  buffer_load_dwordx4 a[144:147], v5, s[4:7], s60 offen offset:2048
  buffer_load_dwordx4 a[148:151], v5, s[4:7], s61 offen offset:2048
  buffer_load_dwordx4 a[152:155], v5, s[4:7], s60 offen offset:3072
  buffer_load_dwordx4 a[156:159], v5, s[4:7], s61 offen offset:3072
  buffer_load_dwordx4 a[160:163], v6, s[4:7], s60 offen offset:0
  buffer_load_dwordx4 a[164:167], v6, s[4:7], s61 offen offset:0
  buffer_load_dwordx4 a[168:171], v6, s[4:7], s60 offen offset:1024
  buffer_load_dwordx4 a[172:175], v6, s[4:7], s61 offen offset:1024
  buffer_load_dwordx4 a[176:179], v6, s[4:7], s60 offen offset:2048
  buffer_load_dwordx4 a[180:183], v6, s[4:7], s61 offen offset:2048
  buffer_load_dwordx4 a[184:187], v6, s[4:7], s60 offen offset:3072
  buffer_load_dwordx4 a[188:191], v6, s[4:7], s61 offen offset:3072
  buffer_load_dwordx4 a[192:195], v7, s[4:7], s60 offen offset:0
  buffer_load_dwordx4 a[196:199], v7, s[4:7], s61 offen offset:0
  buffer_load_dwordx4 a[200:203], v7, s[4:7], s60 offen offset:1024
  buffer_load_dwordx4 a[204:207], v7, s[4:7], s61 offen offset:1024
  buffer_load_dwordx4 a[208:211], v7, s[4:7], s60 offen offset:2048
  buffer_load_dwordx4 a[212:215], v7, s[4:7], s61 offen offset:2048
  buffer_load_dwordx4 a[216:219], v7, s[4:7], s60 offen offset:3072
  buffer_load_dwordx4 a[220:223], v7, s[4:7], s61 offen offset:3072
  buffer_load_dwordx4 a[224:227], v8, s[4:7], s60 offen offset:0
  buffer_load_dwordx4 a[228:231], v8, s[4:7], s61 offen offset:0
  buffer_load_dwordx4 a[232:235], v8, s[4:7], s60 offen offset:1024
  buffer_load_dwordx4 a[236:239], v8, s[4:7], s61 offen offset:1024
  buffer_load_dwordx4 a[240:243], v8, s[4:7], s60 offen offset:2048
  buffer_load_dwordx4 a[244:247], v8, s[4:7], s61 offen offset:2048
  buffer_load_dwordx4 a[248:251], v8, s[4:7], s60 offen offset:3072
  buffer_load_dwordx4 a[252:255], v8, s[4:7], s61 offen offset:3072
  v_mov_b32 v9, 0
  v_bfe_u32 v255, v0, 0, 4
  v_lshl_add_u32 v9, v255, 11, v9
  v_bfe_u32 v255, v0, 4, 2
  v_lshl_add_u32 v9, v255, 4, v9
  s_waitcnt lgkmcnt(0)
  s_mov_b32 s8, s52
  s_mov_b32 s9, s53
  s_mov_b32 s10, 0x400000
  s_mov_b32 s11, 0x20000
  s_mov_b32 s36, s54
  s_mov_b32 s37, s55
  s_mov_b32 s38, 0x400000
  s_mov_b32 s39, 0x20000
  s_and_b32 s44, s27, 1
  s_add_u32 s44, s44, s28
  s_lshl_b32 s44, s44, 15
  s_lshl_b32 s45, s29, 5
  s_add_u32 s44, s44, s45
  s_add_u32 s48, s44, 4194304
  buffer_load_dwordx4 v[16:19], v9, s[8:11], s44 offen
  buffer_load_dwordx4 v[20:23], v9, s[4:7], s48 offen
  s_lshl_b32 s41, s30, 7
  s_add_u32 s41, s41, 117445632
  s_cmp_lg_u32 s27, 0
  s_cbranch_scc1 L_wf_113_w
  s_mov_b32 s99, 100000
L_wf_113_p:
  buffer_load_dword v10, off, s[4:7], s41 sc1
  s_waitcnt vmcnt(0)
  v_readfirstlane_b32 s42, v10
  s_nop 0
  s_cmp_ge_u32 s42, 16
  s_cbranch_scc1 L_wf_113_w
  s_sub_u32 s99, s99, 1
  s_cbranch_scc0 L_wf_113_p
  v_mov_b32 v1, 236
  v_mov_b32 v2, 1
  s_mov_b64 exec, 1
  global_atomic_add v1, v2, s[90:91] sc1
  s_mov_b64 exec, -1
L_wf_113_w:
  s_barrier
  buffer_load_dwordx4 v[32:35], v1, s[4:7], s62 offen offset:0
  buffer_load_dwordx4 v[36:39], v1, s[4:7], s63 offen offset:0
  buffer_load_dwordx4 v[40:43], v1, s[4:7], s62 offen offset:1024
  buffer_load_dwordx4 v[44:47], v1, s[4:7], s63 offen offset:1024
  buffer_load_dwordx4 v[48:51], v1, s[4:7], s62 offen offset:2048
  buffer_load_dwordx4 v[52:55], v1, s[4:7], s63 offen offset:2048
  buffer_load_dwordx4 v[56:59], v1, s[4:7], s62 offen offset:3072
  buffer_load_dwordx4 v[60:63], v1, s[4:7], s63 offen offset:3072
  buffer_load_dwordx4 v[64:67], v2, s[4:7], s62 offen offset:0
  buffer_load_dwordx4 v[68:71], v2, s[4:7], s63 offen offset:0
  buffer_load_dwordx4 v[72:75], v2, s[4:7], s62 offen offset:1024
  buffer_load_dwordx4 v[76:79], v2, s[4:7], s63 offen offset:1024
  buffer_load_dwordx4 v[80:83], v2, s[4:7], s62 offen offset:2048
  buffer_load_dwordx4 v[84:87], v2, s[4:7], s63 offen offset:2048
  buffer_load_dwordx4 v[88:91], v2, s[4:7], s62 offen offset:3072
  buffer_load_dwordx4 v[92:95], v2, s[4:7], s63 offen offset:3072
  buffer_load_dwordx4 v[96:99], v3, s[4:7], s62 offen offset:0
  buffer_load_dwordx4 v[100:103], v3, s[4:7], s63 offen offset:0
  buffer_load_dwordx4 v[104:107], v3, s[4:7], s62 offen offset:1024
  buffer_load_dwordx4 v[108:111], v3, s[4:7], s63 offen offset:1024
  buffer_load_dwordx4 v[112:115], v3, s[4:7], s62 offen offset:2048
  buffer_load_dwordx4 v[116:119], v3, s[4:7], s63 offen offset:2048
  buffer_load_dwordx4 v[120:123], v3, s[4:7], s62 offen offset:3072
  buffer_load_dwordx4 v[124:127], v3, s[4:7], s63 offen offset:3072
  buffer_load_dwordx4 v[128:131], v4, s[4:7], s62 offen offset:0
  buffer_load_dwordx4 v[132:135], v4, s[4:7], s63 offen offset:0
  buffer_load_dwordx4 v[136:139], v4, s[4:7], s62 offen offset:1024
  buffer_load_dwordx4 v[140:143], v4, s[4:7], s63 offen offset:1024
  buffer_load_dwordx4 v[144:147], v4, s[4:7], s62 offen offset:2048
  buffer_load_dwordx4 v[148:151], v4, s[4:7], s63 offen offset:2048
  buffer_load_dwordx4 v[152:155], v4, s[4:7], s62 offen offset:3072
  buffer_load_dwordx4 v[156:159], v4, s[4:7], s63 offen offset:3072
  buffer_load_dwordx4 v[160:163], v5, s[4:7], s62 offen offset:0
  buffer_load_dwordx4 v[164:167], v5, s[4:7], s63 offen offset:0
  buffer_load_dwordx4 v[168:171], v5, s[4:7], s62 offen offset:1024
  buffer_load_dwordx4 v[172:175], v5, s[4:7], s63 offen offset:1024
  buffer_load_dwordx4 v[176:179], v5, s[4:7], s62 offen offset:2048
  buffer_load_dwordx4 v[180:183], v5, s[4:7], s63 offen offset:2048
  buffer_load_dwordx4 v[184:187], v5, s[4:7], s62 offen offset:3072
  buffer_load_dwordx4 v[188:191], v5, s[4:7], s63 offen offset:3072
  buffer_load_dwordx4 v[192:195], v6, s[4:7], s62 offen offset:0
  buffer_load_dwordx4 v[196:199], v6, s[4:7], s63 offen offset:0
  buffer_load_dwordx4 v[200:203], v6, s[4:7], s62 offen offset:1024
  buffer_load_dwordx4 v[204:207], v6, s[4:7], s63 offen offset:1024
  buffer_load_dwordx4 v[208:211], v6, s[4:7], s62 offen offset:2048
  buffer_load_dwordx4 v[212:215], v6, s[4:7], s63 offen offset:2048
  buffer_load_dwordx4 v[216:219], v6, s[4:7], s62 offen offset:3072
  buffer_load_dwordx4 v[220:223], v6, s[4:7], s63 offen offset:3072
  s_waitcnt vmcnt(46)
  v_mfma_f32_16x16x32_bf16 v[232:235], a[0:3], v[32:35], 0
  v_mfma_f32_16x16x32_bf16 v[236:239], a[0:3], v[36:39], 0
  v_mfma_f32_16x16x32_bf16 v[240:243], a[4:7], v[32:35], 0
  v_mfma_f32_16x16x32_bf16 v[244:247], a[4:7], v[36:39], 0
  s_nop 2
  buffer_load_dwordx4 v[32:35], v7, s[4:7], s62 offen offset:0
  buffer_load_dwordx4 v[36:39], v7, s[4:7], s63 offen offset:0
  s_waitcnt vmcnt(46)
  v_mfma_f32_16x16x32_bf16 v[232:235], a[8:11], v[40:43], v[232:235]
  v_mfma_f32_16x16x32_bf16 v[236:239], a[8:11], v[44:47], v[236:239]
  v_mfma_f32_16x16x32_bf16 v[240:243], a[12:15], v[40:43], v[240:243]
  v_mfma_f32_16x16x32_bf16 v[244:247], a[12:15], v[44:47], v[244:247]
  s_nop 2
  buffer_load_dwordx4 v[40:43], v7, s[4:7], s62 offen offset:1024
  buffer_load_dwordx4 v[44:47], v7, s[4:7], s63 offen offset:1024
  s_waitcnt vmcnt(46)
  v_mfma_f32_16x16x32_bf16 v[232:235], a[16:19], v[48:51], v[232:235]
  v_mfma_f32_16x16x32_bf16 v[236:239], a[16:19], v[52:55], v[236:239]
  v_mfma_f32_16x16x32_bf16 v[240:243], a[20:23], v[48:51], v[240:243]
  v_mfma_f32_16x16x32_bf16 v[244:247], a[20:23], v[52:55], v[244:247]
  s_nop 2
  buffer_load_dwordx4 v[48:51], v7, s[4:7], s62 offen offset:2048
  buffer_load_dwordx4 v[52:55], v7, s[4:7], s63 offen offset:2048
  s_waitcnt vmcnt(46)
  v_mfma_f32_16x16x32_bf16 v[232:235], a[24:27], v[56:59], v[232:235]
  v_mfma_f32_16x16x32_bf16 v[236:239], a[24:27], v[60:63], v[236:239]
  v_mfma_f32_16x16x32_bf16 v[240:243], a[28:31], v[56:59], v[240:243]
  v_mfma_f32_16x16x32_bf16 v[244:247], a[28:31], v[60:63], v[244:247]
  s_nop 2
  buffer_load_dwordx4 v[56:59], v7, s[4:7], s62 offen offset:3072
  buffer_load_dwordx4 v[60:63], v7, s[4:7], s63 offen offset:3072
  s_waitcnt vmcnt(46)
  v_mfma_f32_16x16x32_bf16 v[232:235], a[32:35], v[64:67], v[232:235]
  v_mfma_f32_16x16x32_bf16 v[236:239], a[32:35], v[68:71], v[236:239]
  v_mfma_f32_16x16x32_bf16 v[240:243], a[36:39], v[64:67], v[240:243]
  v_mfma_f32_16x16x32_bf16 v[244:247], a[36:39], v[68:71], v[244:247]
  s_nop 2
  buffer_load_dwordx4 v[64:67], v8, s[4:7], s62 offen offset:0
  buffer_load_dwordx4 v[68:71], v8, s[4:7], s63 offen offset:0
  s_waitcnt vmcnt(46)
  v_mfma_f32_16x16x32_bf16 v[232:235], a[40:43], v[72:75], v[232:235]
  v_mfma_f32_16x16x32_bf16 v[236:239], a[40:43], v[76:79], v[236:239]
  v_mfma_f32_16x16x32_bf16 v[240:243], a[44:47], v[72:75], v[240:243]
  v_mfma_f32_16x16x32_bf16 v[244:247], a[44:47], v[76:79], v[244:247]
  s_nop 2
  buffer_load_dwordx4 v[72:75], v8, s[4:7], s62 offen offset:1024
  buffer_load_dwordx4 v[76:79], v8, s[4:7], s63 offen offset:1024
  s_waitcnt vmcnt(46)
  v_mfma_f32_16x16x32_bf16 v[232:235], a[48:51], v[80:83], v[232:235]
  v_mfma_f32_16x16x32_bf16 v[236:239], a[48:51], v[84:87], v[236:239]
  v_mfma_f32_16x16x32_bf16 v[240:243], a[52:55], v[80:83], v[240:243]
  v_mfma_f32_16x16x32_bf16 v[244:247], a[52:55], v[84:87], v[244:247]
  s_nop 2
  buffer_load_dwordx4 v[80:83], v8, s[4:7], s62 offen offset:2048
  buffer_load_dwordx4 v[84:87], v8, s[4:7], s63 offen offset:2048
  s_waitcnt vmcnt(46)
  v_mfma_f32_16x16x32_bf16 v[232:235], a[56:59], v[88:91], v[232:235]
  v_mfma_f32_16x16x32_bf16 v[236:239], a[56:59], v[92:95], v[236:239]
  v_mfma_f32_16x16x32_bf16 v[240:243], a[60:63], v[88:91], v[240:243]
  v_mfma_f32_16x16x32_bf16 v[244:247], a[60:63], v[92:95], v[244:247]
  s_nop 2
  buffer_load_dwordx4 v[88:91], v8, s[4:7], s62 offen offset:3072
  buffer_load_dwordx4 v[92:95], v8, s[4:7], s63 offen offset:3072
  s_waitcnt vmcnt(46)
  v_mfma_f32_16x16x32_bf16 v[232:235], a[64:67], v[96:99], v[232:235]
  v_mfma_f32_16x16x32_bf16 v[236:239], a[64:67], v[100:103], v[236:239]
  v_mfma_f32_16x16x32_bf16 v[240:243], a[68:71], v[96:99], v[240:243]
  v_mfma_f32_16x16x32_bf16 v[244:247], a[68:71], v[100:103], v[244:247]
  s_waitcnt vmcnt(44)
  v_mfma_f32_16x16x32_bf16 v[232:235], a[72:75], v[104:107], v[232:235]
  v_mfma_f32_16x16x32_bf16 v[236:239], a[72:75], v[108:111], v[236:239]
  v_mfma_f32_16x16x32_bf16 v[240:243], a[76:79], v[104:107], v[240:243]
  v_mfma_f32_16x16x32_bf16 v[244:247], a[76:79], v[108:111], v[244:247]
  s_waitcnt vmcnt(42)
  v_mfma_f32_16x16x32_bf16 v[232:235], a[80:83], v[112:115], v[232:235]
  v_mfma_f32_16x16x32_bf16 v[236:239], a[80:83], v[116:119], v[236:239]
  v_mfma_f32_16x16x32_bf16 v[240:243], a[84:87], v[112:115], v[240:243]
  v_mfma_f32_16x16x32_bf16 v[244:247], a[84:87], v[116:119], v[244:247]
  s_waitcnt vmcnt(40)
  v_mfma_f32_16x16x32_bf16 v[232:235], a[88:91], v[120:123], v[232:235]
  v_mfma_f32_16x16x32_bf16 v[236:239], a[88:91], v[124:127], v[236:239]
  v_mfma_f32_16x16x32_bf16 v[240:243], a[92:95], v[120:123], v[240:243]
  v_mfma_f32_16x16x32_bf16 v[244:247], a[92:95], v[124:127], v[244:247]
  s_waitcnt vmcnt(38)
  v_mfma_f32_16x16x32_bf16 v[232:235], a[96:99], v[128:131], v[232:235]
  v_mfma_f32_16x16x32_bf16 v[236:239], a[96:99], v[132:135], v[236:239]
  v_mfma_f32_16x16x32_bf16 v[240:243], a[100:103], v[128:131], v[240:243]
  v_mfma_f32_16x16x32_bf16 v[244:247], a[100:103], v[132:135], v[244:247]
  s_waitcnt vmcnt(36)
  v_mfma_f32_16x16x32_bf16 v[232:235], a[104:107], v[136:139], v[232:235]
  v_mfma_f32_16x16x32_bf16 v[236:239], a[104:107], v[140:143], v[236:239]
  v_mfma_f32_16x16x32_bf16 v[240:243], a[108:111], v[136:139], v[240:243]
  v_mfma_f32_16x16x32_bf16 v[244:247], a[108:111], v[140:143], v[244:247]
  s_waitcnt vmcnt(34)
  v_mfma_f32_16x16x32_bf16 v[232:235], a[112:115], v[144:147], v[232:235]
  v_mfma_f32_16x16x32_bf16 v[236:239], a[112:115], v[148:151], v[236:239]
  v_mfma_f32_16x16x32_bf16 v[240:243], a[116:119], v[144:147], v[240:243]
  v_mfma_f32_16x16x32_bf16 v[244:247], a[116:119], v[148:151], v[244:247]
  s_waitcnt vmcnt(32)
  v_mfma_f32_16x16x32_bf16 v[232:235], a[120:123], v[152:155], v[232:235]
  v_mfma_f32_16x16x32_bf16 v[236:239], a[120:123], v[156:159], v[236:239]
  v_mfma_f32_16x16x32_bf16 v[240:243], a[124:127], v[152:155], v[240:243]
  v_mfma_f32_16x16x32_bf16 v[244:247], a[124:127], v[156:159], v[244:247]
  s_waitcnt vmcnt(30)
  v_mfma_f32_16x16x32_bf16 v[232:235], a[128:131], v[160:163], v[232:235]
  v_mfma_f32_16x16x32_bf16 v[236:239], a[128:131], v[164:167], v[236:239]
  v_mfma_f32_16x16x32_bf16 v[240:243], a[132:135], v[160:163], v[240:243]
  v_mfma_f32_16x16x32_bf16 v[244:247], a[132:135], v[164:167], v[244:247]
  s_waitcnt vmcnt(28)
  v_mfma_f32_16x16x32_bf16 v[232:235], a[136:139], v[168:171], v[232:235]
  v_mfma_f32_16x16x32_bf16 v[236:239], a[136:139], v[172:175], v[236:239]
  v_mfma_f32_16x16x32_bf16 v[240:243], a[140:143], v[168:171], v[240:243]
  v_mfma_f32_16x16x32_bf16 v[244:247], a[140:143], v[172:175], v[244:247]
  s_waitcnt vmcnt(26)
  v_mfma_f32_16x16x32_bf16 v[232:235], a[144:147], v[176:179], v[232:235]
  v_mfma_f32_16x16x32_bf16 v[236:239], a[144:147], v[180:183], v[236:239]
  v_mfma_f32_16x16x32_bf16 v[240:243], a[148:151], v[176:179], v[240:243]
  v_mfma_f32_16x16x32_bf16 v[244:247], a[148:151], v[180:183], v[244:247]
  s_waitcnt vmcnt(24)
  v_mfma_f32_16x16x32_bf16 v[232:235], a[152:155], v[184:187], v[232:235]
  v_mfma_f32_16x16x32_bf16 v[236:239], a[152:155], v[188:191], v[236:239]
  v_mfma_f32_16x16x32_bf16 v[240:243], a[156:159], v[184:187], v[240:243]
  v_mfma_f32_16x16x32_bf16 v[244:247], a[156:159], v[188:191], v[244:247]
  s_waitcnt vmcnt(22)
  v_mfma_f32_16x16x32_bf16 v[232:235], a[160:163], v[192:195], v[232:235]
  v_mfma_f32_16x16x32_bf16 v[236:239], a[160:163], v[196:199], v[236:239]
  v_mfma_f32_16x16x32_bf16 v[240:243], a[164:167], v[192:195], v[240:243]
  v_mfma_f32_16x16x32_bf16 v[244:247], a[164:167], v[196:199], v[244:247]
  s_waitcnt vmcnt(20)
  v_mfma_f32_16x16x32_bf16 v[232:235], a[168:171], v[200:203], v[232:235]
  v_mfma_f32_16x16x32_bf16 v[236:239], a[168:171], v[204:207], v[236:239]
  v_mfma_f32_16x16x32_bf16 v[240:243], a[172:175], v[200:203], v[240:243]
  v_mfma_f32_16x16x32_bf16 v[244:247], a[172:175], v[204:207], v[244:247]
  s_waitcnt vmcnt(18)
  v_mfma_f32_16x16x32_bf16 v[232:235], a[176:179], v[208:211], v[232:235]
  v_mfma_f32_16x16x32_bf16 v[236:239], a[176:179], v[212:215], v[236:239]
  v_mfma_f32_16x16x32_bf16 v[240:243], a[180:183], v[208:211], v[240:243]
  v_mfma_f32_16x16x32_bf16 v[244:247], a[180:183], v[212:215], v[244:247]
  s_waitcnt vmcnt(16)
  v_mfma_f32_16x16x32_bf16 v[232:235], a[184:187], v[216:219], v[232:235]
  v_mfma_f32_16x16x32_bf16 v[236:239], a[184:187], v[220:223], v[236:239]
  v_mfma_f32_16x16x32_bf16 v[240:243], a[188:191], v[216:219], v[240:243]
  v_mfma_f32_16x16x32_bf16 v[244:247], a[188:191], v[220:223], v[244:247]
  s_waitcnt vmcnt(14)
  v_mfma_f32_16x16x32_bf16 v[232:235], a[192:195], v[32:35], v[232:235]
  v_mfma_f32_16x16x32_bf16 v[236:239], a[192:195], v[36:39], v[236:239]
  v_mfma_f32_16x16x32_bf16 v[240:243], a[196:199], v[32:35], v[240:243]
  v_mfma_f32_16x16x32_bf16 v[244:247], a[196:199], v[36:39], v[244:247]
  s_waitcnt vmcnt(12)
  v_mfma_f32_16x16x32_bf16 v[232:235], a[200:203], v[40:43], v[232:235]
  v_mfma_f32_16x16x32_bf16 v[236:239], a[200:203], v[44:47], v[236:239]
  v_mfma_f32_16x16x32_bf16 v[240:243], a[204:207], v[40:43], v[240:243]
  v_mfma_f32_16x16x32_bf16 v[244:247], a[204:207], v[44:47], v[244:247]
  s_waitcnt vmcnt(10)
  v_mfma_f32_16x16x32_bf16 v[232:235], a[208:211], v[48:51], v[232:235]
  v_mfma_f32_16x16x32_bf16 v[236:239], a[208:211], v[52:55], v[236:239]
  v_mfma_f32_16x16x32_bf16 v[240:243], a[212:215], v[48:51], v[240:243]
  v_mfma_f32_16x16x32_bf16 v[244:247], a[212:215], v[52:55], v[244:247]
  s_waitcnt vmcnt(8)
  v_mfma_f32_16x16x32_bf16 v[232:235], a[216:219], v[56:59], v[232:235]
  v_mfma_f32_16x16x32_bf16 v[236:239], a[216:219], v[60:63], v[236:239]
  v_mfma_f32_16x16x32_bf16 v[240:243], a[220:223], v[56:59], v[240:243]
  v_mfma_f32_16x16x32_bf16 v[244:247], a[220:223], v[60:63], v[244:247]
  s_waitcnt vmcnt(6)
  v_mfma_f32_16x16x32_bf16 v[232:235], a[224:227], v[64:67], v[232:235]
  v_mfma_f32_16x16x32_bf16 v[236:239], a[224:227], v[68:71], v[236:239]
  v_mfma_f32_16x16x32_bf16 v[240:243], a[228:231], v[64:67], v[240:243]
  v_mfma_f32_16x16x32_bf16 v[244:247], a[228:231], v[68:71], v[244:247]
  s_waitcnt vmcnt(4)
  v_mfma_f32_16x16x32_bf16 v[232:235], a[232:235], v[72:75], v[232:235]
  v_mfma_f32_16x16x32_bf16 v[236:239], a[232:235], v[76:79], v[236:239]
  v_mfma_f32_16x16x32_bf16 v[240:243], a[236:239], v[72:75], v[240:243]
  v_mfma_f32_16x16x32_bf16 v[244:247], a[236:239], v[76:79], v[244:247]
  s_waitcnt vmcnt(2)
  v_mfma_f32_16x16x32_bf16 v[232:235], a[240:243], v[80:83], v[232:235]
  v_mfma_f32_16x16x32_bf16 v[236:239], a[240:243], v[84:87], v[236:239]
  v_mfma_f32_16x16x32_bf16 v[240:243], a[244:247], v[80:83], v[240:243]
  v_mfma_f32_16x16x32_bf16 v[244:247], a[244:247], v[84:87], v[244:247]
  s_waitcnt vmcnt(0)
  v_mfma_f32_16x16x32_bf16 v[232:235], a[248:251], v[88:91], v[232:235]
  v_mfma_f32_16x16x32_bf16 v[236:239], a[248:251], v[92:95], v[236:239]
  v_mfma_f32_16x16x32_bf16 v[240:243], a[252:255], v[88:91], v[240:243]
  v_mfma_f32_16x16x32_bf16 v[244:247], a[252:255], v[92:95], v[244:247]
  s_mul_i32 s40, s27, 4096
  s_add_u32 s40, s40, 0
  v_lshlrev_b32 v3, 4, v0
  v_add_u32 v4, s40, v3
  v_add_u32 v3, 0, v3
  s_nop 7
  ds_write_b128 v4, v[232:235] offset:0
  ds_write_b128 v4, v[236:239] offset:1024
  ds_write_b128 v4, v[240:243] offset:2048
  ds_write_b128 v4, v[244:247] offset:3072
  s_waitcnt lgkmcnt(0)
  s_barrier
  s_cmp_ge_u32 s27, 2
  s_cbranch_scc1 L_wp_114_done
  s_lshl_b32 s40, s27, 10
  v_add_u32 v3, s40, v3
  ds_read_b128 v[64:67], v3 offset:0
  ds_read_b128 v[68:71], v3 offset:4096
  ds_read_b128 v[72:75], v3 offset:8192
  ds_read_b128 v[76:79], v3 offset:12288
  ds_read_b128 v[80:83], v3 offset:2048
  ds_read_b128 v[84:87], v3 offset:6144
  ds_read_b128 v[88:91], v3 offset:10240
  ds_read_b128 v[92:95], v3 offset:14336
  s_waitcnt lgkmcnt(0)
  v_pk_add_f32 v[64:65], v[64:65], v[68:69]
  v_pk_add_f32 v[66:67], v[66:67], v[70:71]
  v_pk_add_f32 v[72:73], v[72:73], v[76:77]
  v_pk_add_f32 v[74:75], v[74:75], v[78:79]
  v_pk_add_f32 v[64:65], v[64:65], v[72:73]
  v_pk_add_f32 v[66:67], v[66:67], v[74:75]
  v_pk_add_f32 v[80:81], v[80:81], v[84:85]
  v_pk_add_f32 v[82:83], v[82:83], v[86:87]
  v_pk_add_f32 v[88:89], v[88:89], v[92:93]
  v_pk_add_f32 v[90:91], v[90:91], v[94:95]
  v_pk_add_f32 v[80:81], v[80:81], v[88:89]
  v_pk_add_f32 v[82:83], v[82:83], v[90:91]
  v_lshlrev_b32 v100, 16, v16
  v_and_b32 v101, 0xffff0000, v16
  v_lshlrev_b32 v102, 16, v20
  v_and_b32 v103, 0xffff0000, v20
  v_fmac_f32 v100, v64, v102
  v_fmac_f32 v101, v65, v103
  v_cvt_pk_bf16_f32 v104, v100, v101
  v_lshlrev_b32 v100, 16, v17
  v_and_b32 v101, 0xffff0000, v17
  v_lshlrev_b32 v102, 16, v21
  v_and_b32 v103, 0xffff0000, v21
  v_fmac_f32 v100, v66, v102
  v_fmac_f32 v101, v67, v103
  v_cvt_pk_bf16_f32 v105, v100, v101
  v_lshlrev_b32 v100, 16, v18
  v_and_b32 v101, 0xffff0000, v18
  v_lshlrev_b32 v102, 16, v22
  v_and_b32 v103, 0xffff0000, v22
  v_fmac_f32 v100, v80, v102
  v_fmac_f32 v101, v81, v103
  v_cvt_pk_bf16_f32 v106, v100, v101
  v_lshlrev_b32 v100, 16, v19
  v_and_b32 v101, 0xffff0000, v19
  v_lshlrev_b32 v102, 16, v23
  v_and_b32 v103, 0xffff0000, v23
  v_fmac_f32 v100, v82, v102
  v_fmac_f32 v101, v83, v103
  v_cvt_pk_bf16_f32 v107, v100, v101
  buffer_store_dwordx4 v[104:107], v9, s[36:39], s44 offen sc1
L_wp_114_done:
  s_branch L_next
  s_endpgm
.section .rodata,"a"
.p2align 6
.amdhsa_kernel recurrent_scan__memory_aug_recurrent_mem_tr__glu_gated_reglu__prompt_kernel
  .amdhsa_next_free_vgpr 512
  .amdhsa_next_free_sgpr 102
  .amdhsa_accum_offset 256
  .amdhsa_group_segment_fixed_size 0
  .amdhsa_kernarg_size 112
  .amdhsa_user_sgpr_count 2
  .amdhsa_user_sgpr_kernarg_segment_ptr 1
  .amdhsa_system_sgpr_workgroup_id_x 1
.end_amdhsa_kernel
```
